```python
import torch

def _softmax(x, axis=-1):
    return torch.softmax(x, dim=axis)
def _gelu(x):
    return torch.nn.functional.gelu(x, approximate="tanh")
def _silu(x):
    return torch.nn.functional.silu(x)
def _sigmoid(x):
    return torch.sigmoid(x)
def _layernorm(x, axis=-1, eps=1e-5):
    m = x.mean(dim=axis, keepdim=True)
    v = x.var(dim=axis, keepdim=True, unbiased=False)
    return (x - m) / torch.sqrt(v + eps)
def _scatter_add(tgt, idx, src, axis=0):
    return tgt.clone().index_add_(axis, idx, src)
def _segment_sum(src, seg, n):
    out = torch.zeros((n,) + src.shape[1:], dtype=src.dtype)
    return out.index_add_(0, seg, src)
def _pad(x, pw):
    flat = tuple(v for pair in reversed(pw) for v in pair)
    return torch.nn.functional.pad(x, flat)

kernel_name = 'sequential_preLN__linear_kernel_hedgehog__glu_gated_glu__prompt'

def setup_inputs():

    _w = (lambda a: (lambda t: t.to(torch.bfloat16) if t.is_floating_point() else t)(torch.as_tensor(a)))
    def _A_setup():
        B, S, D, H = 1, 2048, 1024, 32
        Dh = D // H
        return {
            "x": _w((lambda *s: torch.randn(*s, dtype=torch.bfloat16) * 0.05)(B, S, D)),
            "wqkv": _w((lambda *s: torch.randn(*s, dtype=torch.bfloat16) * 0.2)(D, 3 * D)),
            "w_phi": _w((lambda *s: torch.randn(*s, dtype=torch.bfloat16) * 0.2)(H, Dh, Dh) * (Dh ** -0.5)),
            "wo": _w((lambda *s: torch.randn(*s, dtype=torch.bfloat16) * 0.05)(D, D)),
        }
    _A_in = _A_setup()

    def _B_setup():
        B, S, D, F = 1, 2048, 1024, 3584
        return {
            "x": _w((lambda *s: torch.randn(*s, dtype=torch.bfloat16) * 0.05)(B, S, D)),
            "w_gate": _w((lambda *s: torch.randn(*s, dtype=torch.bfloat16) * 0.05)(D, F)),
            "w_up": _w((lambda *s: torch.randn(*s, dtype=torch.bfloat16) * 0.05)(D, F)),
            "w_down": _w((lambda *s: torch.randn(*s, dtype=torch.bfloat16) * 0.05)(F, D)),
        }
    _B_in = _B_setup()

    return {
        "A_x": _A_in["x"],
        "A_wqkv": _A_in["wqkv"],
        "A_w_phi": _A_in["w_phi"],
        "A_wo": _A_in["wo"],
        "B_x": _B_in["x"],
        "B_w_gate": _B_in["w_gate"],
        "B_w_up": _B_in["w_up"],
        "B_w_down": _B_in["w_down"],
    }

def reference(A_x, A_wqkv, A_w_phi, A_wo, B_x, B_w_gate, B_w_up, B_w_down):
    def _A_ref(x, wqkv, w_phi, wo):
        B, S, D = x.shape
        H = 32; Dh = D // H
        qkv = (lambda x, *d: x.permute(*d))((x @ wqkv).reshape(B, S, 3, H, Dh), 2, 0, 3, 1, 4)
        q, k, v = qkv[0], qkv[1], qkv[2]
        pq = torch.einsum("bhsd,hdf->bhsf", q, w_phi)
        pk = torch.einsum("bhsd,hdf->bhsf", k, w_phi)
        phi_q = torch.concatenate([_softmax(pq, axis=-1), _softmax(-pq, axis=-1)], axis=-1)
        phi_k = torch.concatenate([_softmax(pk, axis=-1), _softmax(-pk, axis=-1)], axis=-1)
        kv = torch.einsum("bhsf,bhsd->bhfd", phi_k, v)
        z  = torch.einsum("bhsf->bhf", phi_k)
        num = torch.einsum("bhqf,bhfd->bhqd", phi_q, kv)
        den = torch.einsum("bhqf,bhf->bhq", phi_q, z)[..., None] + 1e-6
        o = num / den
        return (lambda x, *d: x.permute(*d))(o, 0, 2, 1, 3).reshape(B, S, D) @ wo

    def _B_ref(x, w_gate, w_up, w_down):
        g = torch.einsum("bsd,df->bsf", x, w_gate)
        u = torch.einsum("bsd,df->bsf", x, w_up)
        h = _sigmoid(g) * u
        return torch.einsum("bsf,fd->bsd", h, w_down)

    x = A_x
    h = x + _A_ref(_layernorm(x, axis=-1), A_wqkv, A_w_phi, A_wo)
    h2 = h + _B_ref(_layernorm(h, axis=-1), B_w_gate, B_w_up, B_w_down)
    return h2
```

```asm
; @launch grid=(256,1,1) block=(256,1,1) lds=163840
.amdgcn_target "amdgcn-amd-amdhsa--gfx950"
.text
.globl sequential_preLN__linear_kernel_hedgehog__glu_gated_glu__prompt_kernel
.p2align 8
.type sequential_preLN__linear_kernel_hedgehog__glu_gated_glu__prompt_kernel,@function
sequential_preLN__linear_kernel_hedgehog__glu_gated_glu__prompt_kernel:
s_cmp_ge_u32 s2, 256
s_cbranch_scc1 L_done
s_load_dwordx8 s[64:71], s[0:1], 0
s_load_dwordx2 s[32:33], s[0:1], 80
s_load_dwordx8 s[72:79], s[0:1], 40
s_load_dwordx2 s[30:31], s[0:1], 72
s_getpc_b64 s[56:57]
L_pc0:
v_lshlrev_b32 v24, 4, v0
v_mov_b32 v25, s57
v_add_co_u32 v24, vcc, s56, v24
s_lshr_b32 s58, s2, 3
s_lshl_b32 s58, s58, 11
v_addc_co_u32 v25, vcc, 0, v25, vcc
global_load_dword a250, v[24:25], off
v_lshl_add_u32 v24, v0, 3, s58
v_min_u32 v24, L_code_end-L_go-4, v24
v_add_u32 v24, L_go-L_pc0, v24
v_mov_b32 v25, s57
v_add_co_u32 v24, vcc, s56, v24
s_nop 1
v_addc_co_u32 v25, vcc, 0, v25, vcc
global_load_dword a249, v[24:25], off
v_lshrrev_b32 v1, 6, v0
v_lshlrev_b32 v31, 2, v0
v_and_b32 v0, 63, v0
v_readfirstlane_b32 s20, v1
s_and_b32 s26, s2, 4
s_lshl_b32 s26, s26, 1
s_bfe_u32 s27, s2, 0x30003
s_add_u32 s26, s26, s27
s_and_b32 s25, s2, 3
s_lshl_b32 s25, s25, 2
s_lshr_b32 s27, s2, 6
s_add_u32 s25, s25, s27
s_and_b32 s46, s20, 1
s_lshr_b32 s47, s20, 1
v_lshlrev_b32 v30, 4, v0
s_lshl_b32 s51, s26, 6
s_lshl_b32 s27, s25, 2
s_add_u32 s51, s51, s27
s_add_u32 s51, s51, s20
s_lshl_b32 s34, s51, 12
s_and_b32 s21, s26, 3
s_lshl_b32 s21, s21, 9
s_mul_i32 s22, s21, 3072
s_lshl_b32 s35, s26, 18
s_lshl_b32 s27, s20, 16
s_add_u32 s35, s35, s27
v_lshrrev_b32 v16, 4, v0
v_and_b32 v17, 7, v0
v_xor_b32 v16, v16, v17
v_lshl_add_u32 v16, v16, 4, s35
v_lshrrev_b32 v18, 3, v0
v_lshl_add_u32 v2, v18, 11, v16
v_xor_b32 v3, 64, v2
v_add_u32 v4, 30720, v2
v_add_u32 v5, 46080, v3
v_add_u32 v3, 15360, v3
s_lshl_b32 s27, s47, 5
s_lshl_b32 s35, s46, 2
s_add_u32 s35, s35, s27
s_mul_i32 s35, s35, 6144
s_lshl_b32 s27, s25, 7
s_add_u32 s35, s35, s27
v_lshrrev_b32 v16, 4, v0
v_lshlrev_b32 v16, 1, v16
v_xor_b32 v16, v16, v17
v_lshl_add_u32 v16, v16, 4, s35
v_lshrrev_b32 v18, 5, v0
v_lshlrev_b32 v18, 3, v18
v_bfe_u32 v19, v0, 3, 2
v_add_u32 v18, v18, v19
v_mul_u32_u24 v18, 6144, v18
v_add_u32 v6, v18, v16
v_add_u32 v7, 97280, v6
v_add_u32 v8, 0, v6
v_add_u32 v9, 97280, v6
v_add_u32 v10, 4096, v6
v_add_u32 v11, 101376, v6
s_mul_i32 s45, s20, 10240
s_mov_b32 s23, s45
s_mov_b32 s44, 0
s_waitcnt lgkmcnt(0)
s_mov_b32 s8, s64
s_mov_b32 s9, s65
s_mov_b32 s10, 4194304
s_mov_b32 s11, 0x20000
s_mov_b32 s4, s66
s_mov_b32 s5, s67
s_mov_b32 s6, 6291456
s_mov_b32 s7, 0x20000
s_add_u32 s16, s32, 25165824
s_addc_u32 s17, s33, 0
s_mov_b32 s18, 12582912
s_mov_b32 s19, 0x20000
s_cmp_ge_u32 s2, 8
s_cbranch_scc1 L_nz
v_mov_b32 v24, 0
v_mov_b32 v25, 0
v_mov_b32 v26, 0
v_mov_b32 v27, 0
s_lshl_b32 s24, s2, 2
s_add_u32 s24, s24, s20
s_lshl_b32 s24, s24, 7
s_add_u32 s24, s24, 163840
s_add_u32 s27, s24, 32768
v_lshrrev_b32 v16, 3, v0
v_lshlrev_b32 v16, 12, v16
v_lshl_add_u32 v16, v17, 4, v16
buffer_store_dwordx4 v[24:27], v16, s[16:19], s24 offen sc1
buffer_store_dwordx4 v[24:27], v16, s[16:19], s27 offen sc1
L_nz:
buffer_load_dwordx4 v[228:231], v30, s[8:11], s34 offen offset:0
buffer_load_dwordx4 v[232:235], v30, s[8:11], s34 offen offset:1024
buffer_load_dwordx4 v[236:239], v30, s[8:11], s34 offen offset:2048
buffer_load_dwordx4 v[240:243], v30, s[8:11], s34 offen offset:3072
s_lshr_b32 s50, s26, 2
s_mov_b32 m0, s23
s_nop 0
buffer_load_dwordx4 v2, s[8:11], s21 offen offset:0 lds
buffer_load_dwordx4 v3, s[8:11], s21 offen offset:1024 lds
buffer_load_dwordx4 v4, s[8:11], s21 offen offset:2048 lds
buffer_load_dwordx4 v5, s[8:11], s21 offen offset:3072 lds
s_lshl_b32 s61, s25, 18
s_add_u32 s61, s61, 8388608
s_mul_i32 s27, s26, 16512
s_add_u32 s49, s61, s27
s_mul_i32 s27, s46, 2624
s_lshl_b32 s35, s47, 13
s_add_u32 s27, s27, s35
s_add_u32 s27, s27, s49
s_add_u32 s36, s16, s27
s_addc_u32 s37, s17, 0
s_mov_b32 s38, 2624
s_mov_b32 s39, 0x20000
v_accvgpr_write_b32 a96, -1
v_accvgpr_write_b32 a97, -1
v_accvgpr_write_b32 a98, -1
v_accvgpr_write_b32 a99, -1
s_mov_b32 s12, s68
s_mov_b32 s13, s69
s_mov_b32 s14, 65536
s_mov_b32 s15, 0x20000
s_lshl_b32 s92, s20, 10
s_lshl_b32 s93, s25, 12
s_add_u32 s93, s93, s92
s_mov_b32 s41, 40960
s_mov_b32 s42, 4294885376
s_mov_b32 s40, 163840
s_lshl_b32 s27, s25, 1
s_add_u32 s48, s27, s47
s_lshl_b32 s27, s46, 11
s_add_u32 s62, s49, s27
s_lshl_b32 s27, s47, 13
s_add_u32 s62, s62, s27
s_lshl_b32 s27, s47, 8
s_lshl_b32 s35, s46, 3
s_add_u32 s63, s27, s35
s_add_u32 s63, s63, s49
s_add_u32 s63, s63, 4096
s_add_u32 s49, s49, 4736
v_and_b32 v28, 28, v31
v_and_b32 v16, 15, v0
v_bfe_u32 v17, v0, 1, 3
v_lshrrev_b32 v18, 4, v0
v_xor_b32 v17, v17, v18
v_lshlrev_b32 v17, 4, v17
v_lshl_add_u32 v12, v16, 7, v17
s_mul_i32 s27, s46, 20480
v_add_u32 v12, s27, v12
v_xor_b32 v13, 64, v12
v_lshlrev_b32 v22, 3, v0
v_mov_b32 v29, 1.0
v_mul_u32_u24 v27, 16512, v18
v_lshl_add_u32 v27, v16, 4, v27
v_and_b32 v17, 3, v0
v_and_b32 v18, 12, v0
v_lshl_or_b32 v17, v18, 4, v17
s_and_b32 s27, s2, 0x3c
v_or_b32 v17, s27, v17
s_and_b32 s27, s2, 0xc3
v_lshl_or_b32 v19, v16, 2, s27
v_and_b32 v18, 16, v0
v_cmp_eq_u32 vcc, 0, v18
v_lshrrev_b32 v18, 2, v0
s_nop 0
v_cndmask_b32 v19, v19, v17, vcc
v_lshlrev_b32 v19, 7, v19
v_lshlrev_b32 v16, 7, v18
v_bfe_u32 v17, v0, 3, 2
v_lshlrev_b32 v17, 5, v17
v_and_b32 v18, 3, v0
v_lshlrev_b32 v18, 3, v18
v_add3_u32 v14, v16, v17, v18
s_lshl_b32 s27, s47, 6
v_xor_b32 v14, s27, v14
v_xor_b32 v15, 32, v14
s_lshl_b32 s52, s48, 13
s_add_u32 s52, s52, 229376
s_lshl_b32 s27, s46, 12
s_add_u32 s53, s52, s27
s_lshl_b32 s55, s26, 10
s_lshl_b32 s27, s46, 9
s_add_u32 s55, s55, s27
s_add_u32 s55, s55, 131072
s_bitcmp1_b32 s20, 0
s_cselect_b32 s56, s74, s72
s_cselect_b32 s57, s75, s73
s_mov_b32 s58, 7340032
s_mov_b32 s59, 0x20000
s_lshr_b32 s60, s2, 3
s_lshl_b32 s60, s60, 1
s_add_u32 s60, s60, s47
s_mul_i32 s60, s60, 28672
s_and_b32 s27, s2, 3
s_mul_i32 s27, s27, 1792
s_add_u32 s60, s60, s27
s_and_b32 s27, s2, 4
s_mul_i32 s27, s27, 224
s_add_u32 s60, s60, s27
v_lshrrev_b32 v23, 3, v0
v_min_u32 v23, 3, v23
v_mul_u32_u24 v23, 7168, v23
v_and_b32 v17, 7, v0
v_min_u32 v17, 6, v17
v_lshl_add_u32 v23, v17, 7, v23
s_lshr_b32 s27, s66, 7
s_sub_u32 s27, 3, s27
s_and_b32 s27, s27, 7
s_lshl_b32 s27, s27, 7
s_mul_i32 s94, s51, 6144
s_add_u32 s94, s94, s27
v_min_u32 v1, 5, v0
v_lshlrev_b32 v1, 10, v1
v_mov_b32 v136, 0x3f803f80
v_mov_b32 v137, 0x3f803f80
v_mov_b32 v138, 0x3f803f80
v_mov_b32 v139, 0x3f803f80
s_bfe_u32 s80, s2, 0x20001
s_lshl_b32 s80, s80, 2
s_bfe_u32 s27, s2, 0x20003
s_add_u32 s80, s80, s27
s_and_b32 s81, s2, 1
s_lshr_b32 s27, s2, 5
s_lshl_b32 s27, s27, 1
s_add_u32 s81, s81, s27
s_lshl_b32 s82, s80, 3
s_lshl_b32 s27, s20, 1
s_add_u32 s82, s82, s27
s_lshl_b32 s83, s20, 16
s_lshl_b32 s27, s81, 7
s_add_u32 s83, s83, s27
s_lshl_b32 s84, s20, 12
v_bfe_u32 v253, v0, 4, 2
v_lshlrev_b32 v253, 1, v253
v_and_b32 v254, 7, v0
v_xor_b32 v253, v253, v254
v_lshlrev_b32 v253, 4, v253
v_lshrrev_b32 v254, 3, v0
v_lshl_add_u32 v252, v254, 11, v253
v_add_u32 v253, 15360, v252
v_add_u32 v254, 30720, v252
v_add_u32 v255, 46080, v252
s_waitcnt vmcnt(4)
s_add_u32 m0, s23, 4096
s_nop 0
buffer_load_dwordx4 v6, s[4:7], s22 offen offset:0 lds
v_lshlrev_b32 v196, 16, v228
v_and_b32 v197, 0xffff0000, v228
v_lshlrev_b32 v198, 16, v229
v_and_b32 v199, 0xffff0000, v229
v_lshlrev_b32 v200, 16, v230
v_and_b32 v201, 0xffff0000, v230
v_lshlrev_b32 v202, 16, v231
v_and_b32 v203, 0xffff0000, v231
v_lshlrev_b32 v204, 16, v232
v_and_b32 v205, 0xffff0000, v232
v_lshlrev_b32 v206, 16, v233
v_and_b32 v207, 0xffff0000, v233
v_lshlrev_b32 v208, 16, v234
v_and_b32 v209, 0xffff0000, v234
buffer_load_dwordx4 v7, s[4:7], s22 offen offset:1024 lds
v_lshlrev_b32 v210, 16, v235
v_and_b32 v211, 0xffff0000, v235
v_lshlrev_b32 v212, 16, v236
v_and_b32 v213, 0xffff0000, v236
v_lshlrev_b32 v214, 16, v237
v_and_b32 v215, 0xffff0000, v237
v_lshlrev_b32 v216, 16, v238
v_and_b32 v217, 0xffff0000, v238
v_lshlrev_b32 v218, 16, v239
v_and_b32 v219, 0xffff0000, v239
v_lshlrev_b32 v220, 16, v240
v_and_b32 v221, 0xffff0000, v240
v_lshlrev_b32 v222, 16, v241
v_and_b32 v223, 0xffff0000, v241
v_lshlrev_b32 v224, 16, v242
buffer_load_dwordx4 v8, s[4:7], s22 offen offset:2048 lds
v_and_b32 v225, 0xffff0000, v242
v_lshlrev_b32 v226, 16, v243
v_and_b32 v227, 0xffff0000, v243
v_add_f32 v140, v196, v197
v_add_f32 v140, v140, v198
v_add_f32 v140, v140, v199
v_add_f32 v140, v140, v200
v_add_f32 v140, v140, v201
v_add_f32 v140, v140, v202
v_add_f32 v140, v140, v203
v_add_f32 v140, v140, v204
v_add_f32 v140, v140, v205
v_add_f32 v140, v140, v206
v_add_f32 v140, v140, v207
v_add_f32 v140, v140, v208
buffer_load_dwordx4 v9, s[4:7], s22 offen offset:3072 lds
v_add_f32 v140, v140, v209
v_add_f32 v140, v140, v210
v_add_f32 v140, v140, v211
v_add_f32 v142, v212, v213
v_add_f32 v142, v142, v214
v_add_f32 v142, v142, v215
v_add_f32 v142, v142, v216
v_add_f32 v142, v142, v217
v_add_f32 v142, v142, v218
v_add_f32 v142, v142, v219
v_add_f32 v142, v142, v220
v_add_f32 v142, v142, v221
v_add_f32 v142, v142, v222
v_add_f32 v142, v142, v223
v_add_f32 v142, v142, v224
s_add_u32 m0, s23, 8192
s_nop 0
buffer_load_dwordx4 v10, s[4:7], s22 offen offset:0 lds
v_add_f32 v142, v142, v225
v_add_f32 v142, v142, v226
v_add_f32 v142, v142, v227
s_nop 1
v_add_f32_dpp v140, v140, v140 quad_perm:[1,0,3,2] row_mask:0xf bank_mask:0xf
v_add_f32_dpp v142, v142, v142 quad_perm:[1,0,3,2] row_mask:0xf bank_mask:0xf
s_nop 0
v_add_f32_dpp v140, v140, v140 quad_perm:[2,3,0,1] row_mask:0xf bank_mask:0xf
v_add_f32_dpp v142, v142, v142 quad_perm:[2,3,0,1] row_mask:0xf bank_mask:0xf
s_nop 0
v_add_f32_dpp v140, v140, v140 row_half_mirror row_mask:0xf bank_mask:0xf
v_add_f32_dpp v142, v142, v142 row_half_mirror row_mask:0xf bank_mask:0xf
s_nop 0
v_add_f32_dpp v140, v140, v140 row_mirror row_mask:0xf bank_mask:0xf
buffer_load_dwordx4 v11, s[4:7], s22 offen offset:1024 lds
v_add_f32_dpp v142, v142, v142 row_mirror row_mask:0xf bank_mask:0xf
v_mov_b32 v144, v140
v_mov_b32 v145, v142
s_nop 1
v_permlane16_swap_b32 v140, v144
v_permlane16_swap_b32 v142, v145
v_add_f32 v140, v140, v144
v_add_f32 v142, v142, v145
v_mov_b32 v144, v140
v_mov_b32 v145, v142
s_nop 1
v_permlane32_swap_b32 v140, v144
v_permlane32_swap_b32 v142, v145
v_add_f32 v140, v140, v144
v_add_f32 v142, v142, v145
s_add_u32 m0, s92, 122880
s_nop 0
buffer_load_dwordx4 v30, s[12:15], s93 offen lds
v_mul_f32 v140, 0x3a800000, v140
v_sub_f32 v196, v196, v140
v_sub_f32 v197, v197, v140
v_sub_f32 v198, v198, v140
v_sub_f32 v199, v199, v140
v_sub_f32 v200, v200, v140
v_sub_f32 v201, v201, v140
v_sub_f32 v202, v202, v140
v_sub_f32 v203, v203, v140
v_sub_f32 v204, v204, v140
v_sub_f32 v205, v205, v140
v_sub_f32 v206, v206, v140
v_sub_f32 v207, v207, v140
v_sub_f32 v208, v208, v140
v_sub_f32 v209, v209, v140
buffer_load_dword a249, v1, s[4:7], s94 offen
v_sub_f32 v210, v210, v140
v_sub_f32 v211, v211, v140
v_mul_f32 v141, v196, v196
v_fmac_f32 v141, v197, v197
v_fmac_f32 v141, v198, v198
v_fmac_f32 v141, v199, v199
v_fmac_f32 v141, v200, v200
v_fmac_f32 v141, v201, v201
v_fmac_f32 v141, v202, v202
v_fmac_f32 v141, v203, v203
v_fmac_f32 v141, v204, v204
v_fmac_f32 v141, v205, v205
v_fmac_f32 v141, v206, v206
v_fmac_f32 v141, v207, v207
v_fmac_f32 v141, v208, v208
s_add_u32 s23, s23, 40960
s_add_u32 s21, s21, 128
s_and_b32 s21, s21, 0x7ff
s_mov_b32 m0, s23
s_nop 0
buffer_load_dwordx4 v2, s[8:11], s21 offen offset:0 lds
v_fmac_f32 v141, v209, v209
v_fmac_f32 v141, v210, v210
v_fmac_f32 v141, v211, v211
v_mul_f32 v142, 0x3a800000, v142
v_sub_f32 v212, v212, v142
v_sub_f32 v213, v213, v142
v_sub_f32 v214, v214, v142
v_sub_f32 v215, v215, v142
v_sub_f32 v216, v216, v142
v_sub_f32 v217, v217, v142
v_sub_f32 v218, v218, v142
v_sub_f32 v219, v219, v142
v_sub_f32 v220, v220, v142
v_sub_f32 v221, v221, v142
v_sub_f32 v222, v222, v142
buffer_load_dwordx4 v3, s[8:11], s21 offen offset:1024 lds
v_sub_f32 v223, v223, v142
v_sub_f32 v224, v224, v142
v_sub_f32 v225, v225, v142
v_sub_f32 v226, v226, v142
v_sub_f32 v227, v227, v142
v_mul_f32 v143, v212, v212
v_fmac_f32 v143, v213, v213
v_fmac_f32 v143, v214, v214
v_fmac_f32 v143, v215, v215
v_fmac_f32 v143, v216, v216
v_fmac_f32 v143, v217, v217
v_fmac_f32 v143, v218, v218
v_fmac_f32 v143, v219, v219
v_fmac_f32 v143, v220, v220
buffer_load_dwordx4 v4, s[8:11], s21 offen offset:2048 lds
v_fmac_f32 v143, v221, v221
v_fmac_f32 v143, v222, v222
v_fmac_f32 v143, v223, v223
v_fmac_f32 v143, v224, v224
v_fmac_f32 v143, v225, v225
v_fmac_f32 v143, v226, v226
v_fmac_f32 v143, v227, v227
s_nop 1
v_add_f32_dpp v141, v141, v141 quad_perm:[1,0,3,2] row_mask:0xf bank_mask:0xf
v_add_f32_dpp v143, v143, v143 quad_perm:[1,0,3,2] row_mask:0xf bank_mask:0xf
s_nop 0
v_add_f32_dpp v141, v141, v141 quad_perm:[2,3,0,1] row_mask:0xf bank_mask:0xf
v_add_f32_dpp v143, v143, v143 quad_perm:[2,3,0,1] row_mask:0xf bank_mask:0xf
s_nop 0
v_add_f32_dpp v141, v141, v141 row_half_mirror row_mask:0xf bank_mask:0xf
buffer_load_dwordx4 v5, s[8:11], s21 offen offset:3072 lds
v_add_f32_dpp v143, v143, v143 row_half_mirror row_mask:0xf bank_mask:0xf
s_nop 0
v_add_f32_dpp v141, v141, v141 row_mirror row_mask:0xf bank_mask:0xf
v_add_f32_dpp v143, v143, v143 row_mirror row_mask:0xf bank_mask:0xf
v_mov_b32 v144, v141
v_mov_b32 v145, v143
s_nop 1
v_permlane16_swap_b32 v141, v144
v_permlane16_swap_b32 v143, v145
v_add_f32 v141, v141, v144
v_add_f32 v143, v143, v145
v_mov_b32 v144, v141
v_mov_b32 v145, v143
s_nop 1
v_permlane32_swap_b32 v141, v144
s_mul_i32 s22, s21, 3072
s_add_u32 m0, s23, 4096
s_nop 0
buffer_load_dwordx4 v6, s[4:7], s22 offen offset:0 lds
v_permlane32_swap_b32 v143, v145
v_add_f32 v141, v141, v144
v_add_f32 v143, v143, v145
v_mov_b32 v144, 0x3727c5ac
v_fmac_f32 v144, 0x3a800000, v141
v_rsq_f32 v141, v144
v_mov_b32 v144, 0x3727c5ac
v_fmac_f32 v144, 0x3a800000, v143
v_rsq_f32 v143, v144
v_bfe_u32 v180, v0, 1, 2
v_lshlrev_b32 v180, 2, v180
v_and_b32 v181, 1, v0
v_bfe_u32 v182, v0, 3, 1
v_lshlrev_b32 v182, 1, v182
v_or3_b32 v180, v180, v181, v182
buffer_load_dwordx4 v7, s[4:7], s22 offen offset:1024 lds
v_lshrrev_b32 v181, 4, v0
v_xor_b32 v180, v180, v181
v_lshlrev_b32 v180, 3, v180
v_and_b32 v181, 15, v0
v_lshl_add_u32 v180, v181, 7, v180
s_lshl_b32 s27, s20, 13
v_add_u32 v180, s27, v180
v_accvgpr_write_b32 a100, v180
v_xor_b32 v181, 32, v180
v_accvgpr_write_b32 a101, v181
v_xor_b32 v181, 64, v180
v_accvgpr_write_b32 a109, v181
v_xor_b32 v181, 96, v180
v_accvgpr_write_b32 a110, v181
buffer_load_dwordx4 v8, s[4:7], s22 offen offset:2048 lds
v_bfe_u32 v180, v0, 3, 2
v_lshlrev_b32 v180, 2, v180
v_bfe_u32 v181, v0, 2, 1
v_lshrrev_b32 v182, 5, v0
v_lshlrev_b32 v182, 1, v182
v_or3_b32 v180, v180, v181, v182
v_and_b32 v181, 3, v0
v_xor_b32 v180, v180, v181
v_lshlrev_b32 v180, 3, v180
v_lshrrev_b32 v181, 2, v0
v_lshl_add_u32 v180, v181, 7, v180
s_lshl_b32 s35, s46, 6
s_or_b32 s27, s27, s35
v_xor_b32 v180, s27, v180
v_accvgpr_write_b32 a112, v180
buffer_load_dwordx4 v9, s[4:7], s22 offen offset:3072 lds
v_xor_b32 v181, 32, v180
v_accvgpr_write_b32 a113, v181
v_xor_b32 v181, 8192, v180
v_accvgpr_write_b32 a102, v181
v_xor_b32 v181, 8224, v180
v_accvgpr_write_b32 a103, v181
s_lshl_b32 s27, s20, 12
s_add_u32 s27, s27, 32768
v_add_u32 v180, s27, v30
v_xor_b32 v181, 4096, v180
v_accvgpr_write_b32 a105, v180
v_accvgpr_write_b32 a106, v181
v_lshrrev_b32 v180, 4, v0
v_mul_u32_u24 v181, 16512, v180
v_and_b32 v182, 0x70, v30
s_add_u32 m0, s23, 8192
s_nop 0
buffer_load_dwordx4 v10, s[4:7], s22 offen offset:0 lds
v_lshl_add_u32 v180, v180, 2, v182
v_and_b32 v183, 8, v0
v_lshl_or_b32 v180, v183, 10, v180
v_accvgpr_write_b32 a107, v181
v_accvgpr_write_b32 a108, v180
v_and_b32 v180, 0xf0, v30
v_and_b32 v181, 16, v0
v_lshl_or_b32 v26, v181, 9, v180
v_lshrrev_b32 v180, 3, v0
v_mul_u32_u24 v180, 16512, v180
v_add_u32 v180, v180, v182
v_lshrrev_b32 v181, 5, v0
v_mul_u32_u24 v181, 16000, v181
v_add_u32 v181, v181, v30
v_accvgpr_write_b32 a104, v180
buffer_load_dwordx4 v11, s[4:7], s22 offen offset:1024 lds
v_accvgpr_write_b32 a111, v181
v_and_b32 v180, 15, v0
v_lshlrev_b32 v180, 11, v180
v_bfe_u32 v181, v0, 4, 1
v_lshlrev_b32 v181, 5, v181
v_lshrrev_b32 v182, 5, v0
v_lshlrev_b32 v182, 4, v182
v_add3_u32 v180, v180, v181, v182
v_accvgpr_write_b32 a114, v180
s_lshr_b32 s27, s70, 7
s_sub_u32 s27, 3, s27
s_and_b32 s27, s27, 7
s_sub_u32 s35, s81, s27
s_sub_u32 s35, s35, 2
s_and_b32 s35, s35, 7
s_lshl_b32 s27, s27, 7
s_add_u32 s27, s27, 524288
s_lshr_b32 s28, s81, 3
s_bitcmp1_b32 s35, 0
s_cselect_b32 s35, 64, s35
s_add_u32 s35, s35, s28
s_lshl_b32 s35, s35, 2
s_and_b32 s28, s80, 3
s_add_u32 s35, s35, s28
s_lshl_b32 s35, s35, 2
s_add_u32 s35, s35, s20
s_cmp_ge_u32 s35, 96
s_cselect_b32 s35, 1024, s35
v_mul_u32_u24 v180, 96, v0
v_add_u32 v180, s35, v180
v_cmp_gt_u32 vcc, 1024, v180
v_lshl_add_u32 v180, v180, 10, s27
v_mov_b32 v181, 0x7ffffff0
v_cndmask_b32 v180, v181, v180, vcc
v_accvgpr_write_b32 a115, v180
s_lshl_b32 s95, s25, 4
s_add_u32 s95, s95, s26
s_lshl_b32 s95, s95, 2
s_add_u32 s95, s95, s20
s_lshl_b32 s95, s95, 11
s_mov_b32 s12, s30
s_mov_b32 s13, s31
s_mov_b32 s14, 256
s_mov_b32 s15, 0x20000
s_getpc_b64 s[92:93]
L_pc_a2:
s_add_u32 s92, s92, L_tail1-L_pc_a2
s_addc_u32 s93, s93, 0
s_lshr_b32 s94, s2, 3
s_lshl_b32 s94, s94, 2
s_add_u32 s94, s94, s20
s_mul_i32 s94, s94, 1
v_min_u32 v24, 0, v0
v_add_u32 v24, s94, v24
v_lshlrev_b32 v24, 7, v24
v_min_u32 v24, L_ph3-L_tail1-4, v24
v_mov_b32 v25, s93
v_add_co_u32 v24, vcc, s92, v24
s_nop 1
v_addc_co_u32 v25, vcc, 0, v25, vcc
s_and_b32 s24, s25, 8
s_lshl_b32 s24, s24, 10
s_lshl_b32 s27, s20, 7
s_add_u32 s24, s24, s27
s_add_u32 s24, s24, s49
s_sub_u32 s24, s24, 4736
s_mov_b32 s28, 0
s_lshl_b32 s27, s51, 4
s_add_u32 s27, s27, 131072
s_mov_b64 exec, 1
buffer_store_dwordx4 v[140:143], v30, s[16:19], s27 offen sc1
s_mov_b64 exec, -1
s_branch L_go
L_sh0:
s_call_b64 s[100:101], L_share
s_branch L_ns0
L_sh1:
s_call_b64 s[100:101], L_share
s_branch L_ns1
L_sh2:
s_call_b64 s[100:101], L_share
s_branch L_ns2
L_sh3:
s_call_b64 s[100:101], L_share
s_branch L_ns3
L_share:
s_lshl_b32 s27, s46, 5
v_xor_b32 v16, s27, v14
ds_read_b64_tr_b16 v[156:157], v16 offset:4096
ds_read_b64_tr_b16 v[158:159], v16 offset:14336
ds_read_b64_tr_b16 v[160:161], v16 offset:24576
ds_read_b64_tr_b16 v[162:163], v16 offset:34816
ds_read_b64_tr_b16 v[164:165], v16 offset:6144
ds_read_b64_tr_b16 v[166:167], v16 offset:16384
ds_read_b64_tr_b16 v[168:169], v16 offset:26624
ds_read_b64_tr_b16 v[170:171], v16 offset:36864
ds_read_b64_tr_b16 v[172:173], v16 offset:8192
ds_read_b64_tr_b16 v[174:175], v16 offset:18432
ds_read_b64_tr_b16 v[176:177], v16 offset:28672
ds_read_b64_tr_b16 v[178:179], v16 offset:38912
s_lshl_b32 s27, s46, 12
s_lshl_b32 s35, s26, 8
s_add_u32 s27, s27, s35
s_add_u32 s27, s27, s52
s_waitcnt lgkmcnt(0)
v_mfma_f32_16x16x32_bf16 v[144:147], v[136:139], v[156:159], 0
v_mfma_f32_16x16x32_bf16 v[144:147], v[136:139], v[160:163], v[144:147]
v_mfma_f32_16x16x32_bf16 v[148:151], v[136:139], v[164:167], 0
v_mfma_f32_16x16x32_bf16 v[148:151], v[136:139], v[168:171], v[148:151]
v_mfma_f32_16x16x32_bf16 v[152:155], v[136:139], v[172:175], 0
v_mfma_f32_16x16x32_bf16 v[152:155], v[136:139], v[176:179], v[152:155]
s_nop 7
v_mov_b32 v145, v148
v_mov_b32 v146, v152
s_mov_b64 exec, 0xffff
buffer_store_dwordx4 v[144:147], v30, s[16:19], s27 offen sc1
s_mov_b64 exec, -1
s_setpc_b64 s[100:101]
L_flag:
s_mov_b32 s27, 131072
L_flagb:
v_cmp_eq_u32 vcc, 0, v20
s_sub_u32 s27, s27, 1
s_cbranch_vccz L_flagc
s_cmp_eq_u32 s27, 0
s_cbranch_scc1 L_flagc
buffer_load_dword v20, v28, s[12:15], 0 offen sc1
s_waitcnt vmcnt(0)
s_branch L_flagb
L_flagc:
v_mov_b32 v16, 1
s_lshl_b32 s27, s2, 7
s_add_u32 s27, s27, s40
s_mov_b64 exec, 1
buffer_store_dword v16, v30, s[16:19], s27 offen sc1
s_cmp_ge_u32 s2, 16
s_cbranch_scc1 L_flage
s_sub_u32 s27, 0, s28
s_bitcmp1_b32 s2, 2
s_cselect_b32 s28, s27, s28
s_add_u32 s28, s28, 64
s_and_b32 s28, s28, 127
s_max_u32 s28, s28, 1
v_mov_b32 v17, s28
s_lshl_b32 s27, s2, 2
buffer_store_dword v17, v30, s[12:15], s27 offen offset:128 sc1
L_flage:
s_mov_b64 exec, -1
s_branch L_ret
L_vret:
s_setpc_b64 s[98:99]
L_visit0:
s_mov_b64 exec, 0
s_cmp_lg_u32 s20, 0
s_cbranch_scc1 L_visit0_0
s_call_b64 s[98:99], L_pg1
L_visit0_0:
s_cmp_lg_u32 s20, 1
s_cbranch_scc1 L_visit0_1
s_call_b64 s[98:99], L_pg2
L_visit0_1:
s_cmp_lg_u32 s20, 2
s_cbranch_scc1 L_visit0_2
s_call_b64 s[98:99], L_pg3
L_visit0_2:
s_cmp_lg_u32 s20, 3
s_cbranch_scc1 L_visit0_3
s_call_b64 s[98:99], L_pg4
L_visit0_3:
s_mov_b64 exec, -1
s_setpc_b64 s[96:97]
L_visit1:
s_mov_b64 exec, 0
s_cmp_lg_u32 s20, 1
s_cbranch_scc1 L_visit1_0
s_call_b64 s[98:99], L_pg5
s_call_b64 s[98:99], L_pg8
L_visit1_0:
s_cmp_lg_u32 s20, 2
s_cbranch_scc1 L_visit1_1
s_call_b64 s[98:99], L_pg6
s_call_b64 s[98:99], L_pg9
L_visit1_1:
s_cmp_lg_u32 s20, 3
s_cbranch_scc1 L_visit1_2
s_call_b64 s[98:99], L_pg7
s_call_b64 s[98:99], L_pg10
L_visit1_2:
s_mov_b64 exec, -1
s_setpc_b64 s[96:97]
L_visit2:
s_mov_b64 exec, 0
s_cmp_lg_u32 s20, 1
s_cbranch_scc1 L_visit2_0
s_call_b64 s[98:99], L_pg11
s_call_b64 s[98:99], L_pg14
L_visit2_0:
s_cmp_lg_u32 s20, 2
s_cbranch_scc1 L_visit2_1
s_call_b64 s[98:99], L_pg12
s_call_b64 s[98:99], L_pg15
L_visit2_1:
s_cmp_lg_u32 s20, 3
s_cbranch_scc1 L_visit2_2
s_call_b64 s[98:99], L_pg13
L_visit2_2:
s_mov_b64 exec, -1
s_setpc_b64 s[96:97]
.p2align 12
L_go:
L_pg0:
s_cbranch_execz L_vret
s_waitcnt vmcnt(13)
s_barrier
s_lshr_b32 s27, s2, 3
s_or_b32 s27, s27, s20
s_cbranch_scc1 L_nl
v_mov_b32 v16, 1
s_lshl_b32 s27, s2, 2
s_mov_b64 exec, 1
buffer_store_dword v16, v30, s[12:15], s27 offen sc1
s_mov_b64 exec, -1
L_nl:
s_cmp_eq_u32 s50, 0
s_cbranch_scc1 L_sh0
L_ns0:
ds_read_b64_tr_b16 a[0:1], v14 offset:4096
ds_read_b64_tr_b16 a[2:3], v14 offset:14336
ds_read_b128 a[24:27], v12 offset:0
ds_read_b64_tr_b16 a[4:5], v14 offset:24576
ds_read_b64_tr_b16 a[6:7], v14 offset:34816
ds_read_b128 a[28:31], v13 offset:0
ds_read_b128 a[36:39], v13 offset:2048
ds_read_b128 a[32:35], v12 offset:2048
ds_read_b128 a[40:43], v12 offset:10240
ds_read_b128 a[44:47], v13 offset:10240
ds_read_b128 a[52:55], v13 offset:12288
ds_read_b128 a[48:51], v12 offset:12288
ds_read_b64_tr_b16 a[8:9], v15 offset:4096
ds_read_b64_tr_b16 a[10:11], v15 offset:14336
ds_read_b64_tr_b16 a[12:13], v15 offset:24576
ds_read_b64_tr_b16 a[14:15], v15 offset:34816
s_waitcnt lgkmcnt(10)
v_mfma_f32_16x16x32_bf16 v[32:35], a[0:3], a[24:27], 0
ds_read_b64_tr_b16 a[16:17], v14 offset:6144
s_add_u32 s23, s23, 40960
v_mfma_f32_16x16x32_bf16 v[32:35], a[4:7], a[28:31], v[32:35]
ds_read_b64_tr_b16 a[18:19], v14 offset:16384
s_add_u32 s21, s21, 128
s_waitcnt lgkmcnt(6)
v_mfma_f32_16x16x32_bf16 v[36:39], a[4:7], a[36:39], 0
ds_read_b64_tr_b16 a[20:21], v14 offset:26624
s_and_b32 s21, s21, 0x7ff
v_mfma_f32_16x16x32_bf16 v[36:39], a[0:3], a[32:35], v[36:39]
ds_read_b64_tr_b16 a[22:23], v14 offset:36864
s_mov_b32 m0, s23
v_mfma_f32_16x16x32_bf16 v[40:43], a[0:3], a[40:43], 0
buffer_load_dwordx4 v2, s[8:11], s21 offen offset:0 lds
v_mfma_f32_16x16x32_bf16 v[40:43], a[4:7], a[44:47], v[40:43]
s_cmp_eq_u32 s44, 81920
s_cselect_b32 s43, s42, s41
buffer_load_dwordx4 v3, s[8:11], s21 offen offset:1024 lds
v_mfma_f32_16x16x32_bf16 v[44:47], a[4:7], a[52:55], 0
buffer_load_dwordx4 v4, s[8:11], s21 offen offset:2048 lds
v_mfma_f32_16x16x32_bf16 v[44:47], a[0:3], a[48:51], v[44:47]
buffer_load_dwordx4 v5, s[8:11], s21 offen offset:3072 lds
s_waitcnt lgkmcnt(4)
v_mfma_f32_16x16x32_bf16 v[48:51], a[8:11], a[24:27], 0
ds_read_b64_tr_b16 a[120:121], v15 offset:6144
s_mul_i32 s22, s21, 3072
v_mfma_f32_16x16x32_bf16 v[48:51], a[12:15], a[28:31], v[48:51]
ds_read_b64_tr_b16 a[122:123], v15 offset:16384
s_add_u32 m0, s23, 4096
v_mfma_f32_16x16x32_bf16 v[52:55], a[12:15], a[36:39], 0
ds_read_b64_tr_b16 a[124:125], v15 offset:26624
buffer_load_dwordx4 v6, s[4:7], s22 offen offset:0 lds
v_mfma_f32_16x16x32_bf16 v[52:55], a[8:11], a[32:35], v[52:55]
ds_read_b64_tr_b16 a[126:127], v15 offset:36864
buffer_load_dwordx4 v7, s[4:7], s22 offen offset:1024 lds
v_mfma_f32_16x16x32_bf16 v[56:59], a[8:11], a[40:43], 0
buffer_load_dwordx4 v8, s[4:7], s22 offen offset:2048 lds
v_mfma_f32_16x16x32_bf16 v[56:59], a[12:15], a[44:47], v[56:59]
v_mfma_f32_16x16x32_bf16 v[60:63], a[12:15], a[52:55], 0
v_mfma_f32_16x16x32_bf16 v[60:63], a[8:11], a[48:51], v[60:63]
buffer_load_dwordx4 v9, s[4:7], s22 offen offset:3072 lds
s_waitcnt lgkmcnt(4)
v_mfma_f32_16x16x32_bf16 v[64:67], a[16:19], a[24:27], 0
ds_read_b64_tr_b16 a[128:129], v14 offset:8192
v_mfma_f32_16x16x32_bf16 v[64:67], a[20:23], a[28:31], v[64:67]
ds_read_b64_tr_b16 a[130:131], v14 offset:18432
v_mfma_f32_16x16x32_bf16 v[68:71], a[20:23], a[36:39], 0
ds_read_b64_tr_b16 a[132:133], v14 offset:28672
v_mfma_f32_16x16x32_bf16 v[68:71], a[16:19], a[32:35], v[68:71]
ds_read_b64_tr_b16 a[134:135], v14 offset:38912
s_add_u32 m0, s23, 8192
v_mfma_f32_16x16x32_bf16 v[72:75], a[16:19], a[40:43], 0
buffer_load_dwordx4 v10, s[4:7], s22 offen offset:0 lds
v_mfma_f32_16x16x32_bf16 v[72:75], a[20:23], a[44:47], v[72:75]
v_mfma_f32_16x16x32_bf16 v[76:79], a[20:23], a[52:55], 0
v_mfma_f32_16x16x32_bf16 v[76:79], a[16:19], a[48:51], v[76:79]
buffer_load_dwordx4 v11, s[4:7], s22 offen offset:1024 lds
s_waitcnt lgkmcnt(4)
v_mfma_f32_16x16x32_bf16 v[80:83], a[120:123], a[24:27], 0
ds_read_b64_tr_b16 a[136:137], v15 offset:8192
v_mfma_f32_16x16x32_bf16 v[80:83], a[124:127], a[28:31], v[80:83]
ds_read_b64_tr_b16 a[138:139], v15 offset:18432
v_mfma_f32_16x16x32_bf16 v[84:87], a[124:127], a[36:39], 0
ds_read_b64_tr_b16 a[140:141], v15 offset:28672
v_mfma_f32_16x16x32_bf16 v[84:87], a[120:123], a[32:35], v[84:87]
ds_read_b64_tr_b16 a[142:143], v15 offset:38912
v_mfma_f32_16x16x32_bf16 v[88:91], a[120:123], a[40:43], 0
v_add_u32 v12, s43, v12
v_mfma_f32_16x16x32_bf16 v[88:91], a[124:127], a[44:47], v[88:91]
v_add_u32 v13, s43, v13
v_mfma_f32_16x16x32_bf16 v[92:95], a[124:127], a[52:55], 0
s_add_u32 s23, s44, s45
s_add_u32 s44, s44, s43
v_add_u32 v14, s43, v14
v_mfma_f32_16x16x32_bf16 v[92:95], a[120:123], a[48:51], v[92:95]
v_add_u32 v15, s43, v15
s_waitcnt vmcnt(11) lgkmcnt(0)
s_barrier
s_cmp_eq_u32 s50, 1
s_cbranch_scc1 L_sh1
L_ns1:
v_mfma_f32_16x16x32_bf16 v[96:99], a[24:27], a[128:131], 0
ds_read_b64_tr_b16 a[0:1], v14 offset:4096
v_mfma_f32_16x16x32_bf16 v[96:99], a[28:31], a[132:135], v[96:99]
ds_read_b64_tr_b16 a[2:3], v14 offset:14336
s_add_u32 s21, s21, 128
v_mfma_f32_16x16x32_bf16 v[100:103], a[36:39], a[132:135], 0
ds_read_b128 a[56:59], v12 offset:0
s_and_b32 s21, s21, 0x7ff
v_mfma_f32_16x16x32_bf16 v[100:103], a[32:35], a[128:131], v[100:103]
ds_read_b64_tr_b16 a[4:5], v14 offset:24576
s_mov_b32 m0, s23
v_mfma_f32_16x16x32_bf16 v[104:107], a[40:43], a[128:131], 0
ds_read_b64_tr_b16 a[6:7], v14 offset:34816
buffer_load_dwordx4 v2, s[8:11], s21 offen offset:0 lds
v_mfma_f32_16x16x32_bf16 v[104:107], a[44:47], a[132:135], v[104:107]
ds_read_b128 a[60:63], v13 offset:0
v_mfma_f32_16x16x32_bf16 v[108:111], a[52:55], a[132:135], 0
ds_read_b128 a[68:71], v13 offset:2048
buffer_load_dwordx4 v3, s[8:11], s21 offen offset:1024 lds
v_mfma_f32_16x16x32_bf16 v[108:111], a[48:51], a[128:131], v[108:111]
ds_read_b128 a[64:67], v12 offset:2048
v_mfma_f32_16x16x32_bf16 v[112:115], a[24:27], a[136:139], 0
ds_read_b128 a[72:75], v12 offset:10240
v_mfma_f32_16x16x32_bf16 v[112:115], a[28:31], a[140:143], v[112:115]
ds_read_b128 a[76:79], v13 offset:10240
v_mfma_f32_16x16x32_bf16 v[116:119], a[36:39], a[140:143], 0
ds_read_b128 a[84:87], v13 offset:12288
buffer_load_dwordx4 v4, s[8:11], s21 offen offset:2048 lds
v_mfma_f32_16x16x32_bf16 v[116:119], a[32:35], a[136:139], v[116:119]
ds_read_b128 a[80:83], v12 offset:12288
v_mfma_f32_16x16x32_bf16 v[120:123], a[40:43], a[136:139], 0
ds_read_b64_tr_b16 a[8:9], v15 offset:4096
v_mfma_f32_16x16x32_bf16 v[120:123], a[44:47], a[140:143], v[120:123]
ds_read_b64_tr_b16 a[10:11], v15 offset:14336
v_mfma_f32_16x16x32_bf16 v[124:127], a[52:55], a[140:143], 0
ds_read_b64_tr_b16 a[12:13], v15 offset:24576
buffer_load_dwordx4 v5, s[8:11], s21 offen offset:3072 lds
v_mfma_f32_16x16x32_bf16 v[124:127], a[48:51], a[136:139], v[124:127]
ds_read_b64_tr_b16 a[14:15], v15 offset:34816
s_waitcnt lgkmcnt(10)
v_mfma_f32_16x16x32_bf16 v[32:35], a[0:3], a[56:59], v[32:35]
ds_read_b64_tr_b16 a[16:17], v14 offset:6144
v_mfma_f32_16x16x32_bf16 v[32:35], a[4:7], a[60:63], v[32:35]
ds_read_b64_tr_b16 a[18:19], v14 offset:16384
s_waitcnt lgkmcnt(6)
v_mfma_f32_16x16x32_bf16 v[36:39], a[4:7], a[68:71], v[36:39]
ds_read_b64_tr_b16 a[20:21], v14 offset:26624
s_mul_i32 s22, s21, 3072
v_mfma_f32_16x16x32_bf16 v[36:39], a[0:3], a[64:67], v[36:39]
ds_read_b64_tr_b16 a[22:23], v14 offset:36864
s_add_u32 m0, s23, 4096
v_mfma_f32_16x16x32_bf16 v[40:43], a[0:3], a[72:75], v[40:43]
buffer_load_dwordx4 v6, s[4:7], s22 offen offset:0 lds
v_mfma_f32_16x16x32_bf16 v[40:43], a[4:7], a[76:79], v[40:43]
s_cmp_eq_u32 s44, 81920
s_cselect_b32 s43, s42, s41
v_mfma_f32_16x16x32_bf16 v[44:47], a[4:7], a[84:87], v[44:47]
v_mfma_f32_16x16x32_bf16 v[44:47], a[0:3], a[80:83], v[44:47]
buffer_load_dwordx4 v7, s[4:7], s22 offen offset:1024 lds
s_waitcnt lgkmcnt(4)
v_mfma_f32_16x16x32_bf16 v[48:51], a[8:11], a[56:59], v[48:51]
ds_read_b64_tr_b16 a[120:121], v15 offset:6144
v_mfma_f32_16x16x32_bf16 v[48:51], a[12:15], a[60:63], v[48:51]
ds_read_b64_tr_b16 a[122:123], v15 offset:16384
v_mfma_f32_16x16x32_bf16 v[52:55], a[12:15], a[68:71], v[52:55]
ds_read_b64_tr_b16 a[124:125], v15 offset:26624
v_mfma_f32_16x16x32_bf16 v[52:55], a[8:11], a[64:67], v[52:55]
ds_read_b64_tr_b16 a[126:127], v15 offset:36864
v_mfma_f32_16x16x32_bf16 v[56:59], a[8:11], a[72:75], v[56:59]
buffer_load_dwordx4 v8, s[4:7], s22 offen offset:2048 lds
v_mfma_f32_16x16x32_bf16 v[56:59], a[12:15], a[76:79], v[56:59]
v_mfma_f32_16x16x32_bf16 v[60:63], a[12:15], a[84:87], v[60:63]
v_mfma_f32_16x16x32_bf16 v[60:63], a[8:11], a[80:83], v[60:63]
buffer_load_dwordx4 v9, s[4:7], s22 offen offset:3072 lds
s_waitcnt lgkmcnt(4)
v_mfma_f32_16x16x32_bf16 v[64:67], a[16:19], a[56:59], v[64:67]
ds_read_b64_tr_b16 a[128:129], v14 offset:8192
v_mfma_f32_16x16x32_bf16 v[64:67], a[20:23], a[60:63], v[64:67]
ds_read_b64_tr_b16 a[130:131], v14 offset:18432
v_mfma_f32_16x16x32_bf16 v[68:71], a[20:23], a[68:71], v[68:71]
ds_read_b64_tr_b16 a[132:133], v14 offset:28672
v_mfma_f32_16x16x32_bf16 v[68:71], a[16:19], a[64:67], v[68:71]
ds_read_b64_tr_b16 a[134:135], v14 offset:38912
s_add_u32 m0, s23, 8192
v_mfma_f32_16x16x32_bf16 v[72:75], a[16:19], a[72:75], v[72:75]
buffer_load_dwordx4 v10, s[4:7], s22 offen offset:0 lds
v_mfma_f32_16x16x32_bf16 v[72:75], a[20:23], a[76:79], v[72:75]
v_mfma_f32_16x16x32_bf16 v[76:79], a[20:23], a[84:87], v[76:79]
s_add_u32 s23, s44, s45
s_add_u32 s44, s44, s43
v_mfma_f32_16x16x32_bf16 v[76:79], a[16:19], a[80:83], v[76:79]
buffer_load_dwordx4 v11, s[4:7], s22 offen offset:1024 lds
s_waitcnt lgkmcnt(4)
v_mfma_f32_16x16x32_bf16 v[80:83], a[120:123], a[56:59], v[80:83]
ds_read_b64_tr_b16 a[136:137], v15 offset:8192
v_mfma_f32_16x16x32_bf16 v[80:83], a[124:127], a[60:63], v[80:83]
ds_read_b64_tr_b16 a[138:139], v15 offset:18432
v_mfma_f32_16x16x32_bf16 v[84:87], a[124:127], a[68:71], v[84:87]
ds_read_b64_tr_b16 a[140:141], v15 offset:28672
v_mfma_f32_16x16x32_bf16 v[84:87], a[120:123], a[64:67], v[84:87]
ds_read_b64_tr_b16 a[142:143], v15 offset:38912
v_mfma_f32_16x16x32_bf16 v[88:91], a[120:123], a[72:75], v[88:91]
v_add_u32 v12, s43, v12
v_mfma_f32_16x16x32_bf16 v[88:91], a[124:127], a[76:79], v[88:91]
v_add_u32 v13, s43, v13
v_mfma_f32_16x16x32_bf16 v[92:95], a[124:127], a[84:87], v[92:95]
v_add_u32 v14, s43, v14
v_mfma_f32_16x16x32_bf16 v[92:95], a[120:123], a[80:83], v[92:95]
v_add_u32 v15, s43, v15
v_lshrrev_b32 v16, 2, v0
v_lshlrev_b32 v16, 6, v16
v_and_b32 v17, 3, v0
v_lshl_add_u32 v16, v17, 3, v16
s_lshl_b32 s27, s47, 11
s_add_u32 s27, s27, 122880
v_add_u32 v16, s27, v16
ds_read_b64_tr_b16 v[128:129], v16 offset:0
ds_read_b64_tr_b16 v[130:131], v16 offset:1024
ds_read_b64_tr_b16 v[132:133], v16 offset:32
ds_read_b64_tr_b16 v[134:135], v16 offset:1056
s_call_b64 s[96:97], L_visit0
s_waitcnt vmcnt(10) lgkmcnt(0)
s_barrier
s_cmp_eq_u32 s50, 2
s_cbranch_scc1 L_sh2
L_ns2:
v_mfma_f32_16x16x32_bf16 v[96:99], a[56:59], a[128:131], v[96:99]
ds_read_b64_tr_b16 a[0:1], v14 offset:4096
buffer_store_dwordx4 a[96:99], v30, s[36:39], 0 offen offset:0 sc1
v_mfma_f32_16x16x32_bf16 v[96:99], a[60:63], a[132:135], v[96:99]
ds_read_b64_tr_b16 a[2:3], v14 offset:14336
s_add_u32 s21, s21, 128
v_mfma_f32_16x16x32_bf16 v[100:103], a[68:71], a[132:135], v[100:103]
ds_read_b128 a[24:27], v12 offset:0
s_and_b32 s21, s21, 0x7ff
v_mfma_f32_16x16x32_bf16 v[100:103], a[64:67], a[128:131], v[100:103]
ds_read_b64_tr_b16 a[4:5], v14 offset:24576
s_mov_b32 m0, s23
v_mfma_f32_16x16x32_bf16 v[104:107], a[72:75], a[128:131], v[104:107]
ds_read_b64_tr_b16 a[6:7], v14 offset:34816
buffer_load_dwordx4 v2, s[8:11], s21 offen offset:0 lds
v_mfma_f32_16x16x32_bf16 v[104:107], a[76:79], a[132:135], v[104:107]
ds_read_b128 a[28:31], v13 offset:0
v_mfma_f32_16x16x32_bf16 v[108:111], a[84:87], a[132:135], v[108:111]
ds_read_b128 a[36:39], v13 offset:2048
buffer_load_dwordx4 v3, s[8:11], s21 offen offset:1024 lds
v_mfma_f32_16x16x32_bf16 v[108:111], a[80:83], a[128:131], v[108:111]
ds_read_b128 a[32:35], v12 offset:2048
v_mfma_f32_16x16x32_bf16 v[112:115], a[56:59], a[136:139], v[112:115]
ds_read_b128 a[40:43], v12 offset:10240
v_mfma_f32_16x16x32_bf16 v[112:115], a[60:63], a[140:143], v[112:115]
ds_read_b128 a[44:47], v13 offset:10240
v_mfma_f32_16x16x32_bf16 v[116:119], a[68:71], a[140:143], v[116:119]
ds_read_b128 a[52:55], v13 offset:12288
buffer_load_dwordx4 v4, s[8:11], s21 offen offset:2048 lds
v_mfma_f32_16x16x32_bf16 v[116:119], a[64:67], a[136:139], v[116:119]
ds_read_b128 a[48:51], v12 offset:12288
v_mfma_f32_16x16x32_bf16 v[120:123], a[72:75], a[136:139], v[120:123]
ds_read_b64_tr_b16 a[8:9], v15 offset:4096
v_mfma_f32_16x16x32_bf16 v[120:123], a[76:79], a[140:143], v[120:123]
ds_read_b64_tr_b16 a[10:11], v15 offset:14336
v_mfma_f32_16x16x32_bf16 v[124:127], a[84:87], a[140:143], v[124:127]
ds_read_b64_tr_b16 a[12:13], v15 offset:24576
buffer_load_dwordx4 v5, s[8:11], s21 offen offset:3072 lds
v_mfma_f32_16x16x32_bf16 v[124:127], a[80:83], a[136:139], v[124:127]
ds_read_b64_tr_b16 a[14:15], v15 offset:34816
s_waitcnt lgkmcnt(10)
v_mfma_f32_16x16x32_bf16 v[32:35], a[0:3], a[24:27], v[32:35]
ds_read_b64_tr_b16 a[16:17], v14 offset:6144
v_mfma_f32_16x16x32_bf16 v[32:35], a[4:7], a[28:31], v[32:35]
ds_read_b64_tr_b16 a[18:19], v14 offset:16384
s_waitcnt lgkmcnt(6)
v_mfma_f32_16x16x32_bf16 v[36:39], a[4:7], a[36:39], v[36:39]
ds_read_b64_tr_b16 a[20:21], v14 offset:26624
s_mul_i32 s22, s21, 3072
v_mfma_f32_16x16x32_bf16 v[36:39], a[0:3], a[32:35], v[36:39]
ds_read_b64_tr_b16 a[22:23], v14 offset:36864
s_add_u32 m0, s23, 4096
v_mfma_f32_16x16x32_bf16 v[40:43], a[0:3], a[40:43], v[40:43]
buffer_load_dwordx4 v6, s[4:7], s22 offen offset:0 lds
v_mfma_f32_16x16x32_bf16 v[40:43], a[4:7], a[44:47], v[40:43]
s_cmp_eq_u32 s44, 81920
s_cselect_b32 s43, s42, s41
v_mfma_f32_16x16x32_bf16 v[44:47], a[4:7], a[52:55], v[44:47]
v_mfma_f32_16x16x32_bf16 v[44:47], a[0:3], a[48:51], v[44:47]
buffer_load_dwordx4 v7, s[4:7], s22 offen offset:1024 lds
s_waitcnt lgkmcnt(4)
v_mfma_f32_16x16x32_bf16 v[48:51], a[8:11], a[24:27], v[48:51]
ds_read_b64_tr_b16 a[120:121], v15 offset:6144
v_mfma_f32_16x16x32_bf16 v[48:51], a[12:15], a[28:31], v[48:51]
ds_read_b64_tr_b16 a[122:123], v15 offset:16384
v_mfma_f32_16x16x32_bf16 v[52:55], a[12:15], a[36:39], v[52:55]
ds_read_b64_tr_b16 a[124:125], v15 offset:26624
v_mfma_f32_16x16x32_bf16 v[52:55], a[8:11], a[32:35], v[52:55]
ds_read_b64_tr_b16 a[126:127], v15 offset:36864
v_mfma_f32_16x16x32_bf16 v[56:59], a[8:11], a[40:43], v[56:59]
buffer_load_dwordx4 v8, s[4:7], s22 offen offset:2048 lds
v_mfma_f32_16x16x32_bf16 v[56:59], a[12:15], a[44:47], v[56:59]
v_mfma_f32_16x16x32_bf16 v[60:63], a[12:15], a[52:55], v[60:63]
v_mfma_f32_16x16x32_bf16 v[60:63], a[8:11], a[48:51], v[60:63]
buffer_load_dwordx4 v9, s[4:7], s22 offen offset:3072 lds
s_waitcnt lgkmcnt(4)
v_mfma_f32_16x16x32_bf16 v[64:67], a[16:19], a[24:27], v[64:67]
ds_read_b64_tr_b16 a[128:129], v14 offset:8192
v_mfma_f32_16x16x32_bf16 v[64:67], a[20:23], a[28:31], v[64:67]
ds_read_b64_tr_b16 a[130:131], v14 offset:18432
v_mfma_f32_16x16x32_bf16 v[68:71], a[20:23], a[36:39], v[68:71]
ds_read_b64_tr_b16 a[132:133], v14 offset:28672
v_mfma_f32_16x16x32_bf16 v[68:71], a[16:19], a[32:35], v[68:71]
ds_read_b64_tr_b16 a[134:135], v14 offset:38912
s_add_u32 m0, s23, 8192
v_mfma_f32_16x16x32_bf16 v[72:75], a[16:19], a[40:43], v[72:75]
buffer_load_dwordx4 v10, s[4:7], s22 offen offset:0 lds
v_mfma_f32_16x16x32_bf16 v[72:75], a[20:23], a[44:47], v[72:75]
v_mfma_f32_16x16x32_bf16 v[76:79], a[20:23], a[52:55], v[76:79]
s_add_u32 s23, s44, s45
s_add_u32 s44, s44, s43
v_mfma_f32_16x16x32_bf16 v[76:79], a[16:19], a[48:51], v[76:79]
buffer_load_dwordx4 v11, s[4:7], s22 offen offset:1024 lds
s_waitcnt lgkmcnt(4)
v_mfma_f32_16x16x32_bf16 v[80:83], a[120:123], a[24:27], v[80:83]
ds_read_b64_tr_b16 a[136:137], v15 offset:8192
v_mfma_f32_16x16x32_bf16 v[80:83], a[124:127], a[28:31], v[80:83]
ds_read_b64_tr_b16 a[138:139], v15 offset:18432
v_mfma_f32_16x16x32_bf16 v[84:87], a[124:127], a[36:39], v[84:87]
ds_read_b64_tr_b16 a[140:141], v15 offset:28672
v_mfma_f32_16x16x32_bf16 v[84:87], a[120:123], a[32:35], v[84:87]
ds_read_b64_tr_b16 a[142:143], v15 offset:38912
v_mfma_f32_16x16x32_bf16 v[88:91], a[120:123], a[40:43], v[88:91]
v_add_u32 v12, s43, v12
v_mfma_f32_16x16x32_bf16 v[88:91], a[124:127], a[44:47], v[88:91]
v_add_u32 v13, s43, v13
v_mfma_f32_16x16x32_bf16 v[92:95], a[124:127], a[52:55], v[92:95]
v_add_u32 v14, s43, v14
v_mfma_f32_16x16x32_bf16 v[92:95], a[120:123], a[48:51], v[92:95]
v_add_u32 v15, s43, v15
s_waitcnt vmcnt(11) lgkmcnt(0)
s_barrier
s_cmp_eq_u32 s50, 3
s_cbranch_scc1 L_sh3
L_ns3:
v_mfma_f32_16x16x32_bf16 v[96:99], a[24:27], a[128:131], v[96:99]
ds_read_b64_tr_b16 a[0:1], v14 offset:4096
buffer_store_dwordx4 a[96:99], v30, s[36:39], 0 offen offset:1024 sc1
v_mfma_f32_16x16x32_bf16 v[96:99], a[28:31], a[132:135], v[96:99]
ds_read_b64_tr_b16 a[2:3], v14 offset:14336
s_add_u32 s21, s21, 128
v_mfma_f32_16x16x32_bf16 v[100:103], a[36:39], a[132:135], v[100:103]
ds_read_b128 a[56:59], v12 offset:0
s_and_b32 s21, s21, 0x7ff
v_mfma_f32_16x16x32_bf16 v[100:103], a[32:35], a[128:131], v[100:103]
ds_read_b64_tr_b16 a[4:5], v14 offset:24576
s_mov_b32 m0, s23
v_mfma_f32_16x16x32_bf16 v[104:107], a[40:43], a[128:131], v[104:107]
ds_read_b64_tr_b16 a[6:7], v14 offset:34816
buffer_load_dwordx4 v2, s[8:11], s21 offen offset:0 lds
v_mfma_f32_16x16x32_bf16 v[104:107], a[44:47], a[132:135], v[104:107]
ds_read_b128 a[60:63], v13 offset:0
v_mfma_f32_16x16x32_bf16 v[108:111], a[52:55], a[132:135], v[108:111]
ds_read_b128 a[68:71], v13 offset:2048
buffer_load_dwordx4 v3, s[8:11], s21 offen offset:1024 lds
v_mfma_f32_16x16x32_bf16 v[108:111], a[48:51], a[128:131], v[108:111]
ds_read_b128 a[64:67], v12 offset:2048
v_mfma_f32_16x16x32_bf16 v[112:115], a[24:27], a[136:139], v[112:115]
ds_read_b128 a[72:75], v12 offset:10240
v_mfma_f32_16x16x32_bf16 v[112:115], a[28:31], a[140:143], v[112:115]
ds_read_b128 a[76:79], v13 offset:10240
v_mfma_f32_16x16x32_bf16 v[116:119], a[36:39], a[140:143], v[116:119]
ds_read_b128 a[84:87], v13 offset:12288
buffer_load_dwordx4 v4, s[8:11], s21 offen offset:2048 lds
v_mfma_f32_16x16x32_bf16 v[116:119], a[32:35], a[136:139], v[116:119]
ds_read_b128 a[80:83], v12 offset:12288
v_mfma_f32_16x16x32_bf16 v[120:123], a[40:43], a[136:139], v[120:123]
ds_read_b64_tr_b16 a[8:9], v15 offset:4096
v_mfma_f32_16x16x32_bf16 v[120:123], a[44:47], a[140:143], v[120:123]
ds_read_b64_tr_b16 a[10:11], v15 offset:14336
v_mfma_f32_16x16x32_bf16 v[124:127], a[52:55], a[140:143], v[124:127]
ds_read_b64_tr_b16 a[12:13], v15 offset:24576
buffer_load_dwordx4 v5, s[8:11], s21 offen offset:3072 lds
v_mfma_f32_16x16x32_bf16 v[124:127], a[48:51], a[136:139], v[124:127]
ds_read_b64_tr_b16 a[14:15], v15 offset:34816
s_waitcnt lgkmcnt(10)
v_mfma_f32_16x16x32_bf16 v[32:35], a[0:3], a[56:59], v[32:35]
ds_read_b64_tr_b16 a[16:17], v14 offset:6144
v_mfma_f32_16x16x32_bf16 v[32:35], a[4:7], a[60:63], v[32:35]
ds_read_b64_tr_b16 a[18:19], v14 offset:16384
s_waitcnt lgkmcnt(6)
v_mfma_f32_16x16x32_bf16 v[36:39], a[4:7], a[68:71], v[36:39]
ds_read_b64_tr_b16 a[20:21], v14 offset:26624
s_mul_i32 s22, s21, 3072
v_mfma_f32_16x16x32_bf16 v[36:39], a[0:3], a[64:67], v[36:39]
ds_read_b64_tr_b16 a[22:23], v14 offset:36864
s_add_u32 m0, s23, 4096
v_mfma_f32_16x16x32_bf16 v[40:43], a[0:3], a[72:75], v[40:43]
buffer_load_dwordx4 v6, s[4:7], s22 offen offset:0 lds
v_mfma_f32_16x16x32_bf16 v[40:43], a[4:7], a[76:79], v[40:43]
s_cmp_eq_u32 s44, 81920
s_cselect_b32 s43, s42, s41
v_mfma_f32_16x16x32_bf16 v[44:47], a[4:7], a[84:87], v[44:47]
v_mfma_f32_16x16x32_bf16 v[44:47], a[0:3], a[80:83], v[44:47]
buffer_load_dwordx4 v7, s[4:7], s22 offen offset:1024 lds
s_waitcnt lgkmcnt(4)
v_mfma_f32_16x16x32_bf16 v[48:51], a[8:11], a[56:59], v[48:51]
ds_read_b64_tr_b16 a[120:121], v15 offset:6144
v_mfma_f32_16x16x32_bf16 v[48:51], a[12:15], a[60:63], v[48:51]
ds_read_b64_tr_b16 a[122:123], v15 offset:16384
v_mfma_f32_16x16x32_bf16 v[52:55], a[12:15], a[68:71], v[52:55]
ds_read_b64_tr_b16 a[124:125], v15 offset:26624
v_mfma_f32_16x16x32_bf16 v[52:55], a[8:11], a[64:67], v[52:55]
ds_read_b64_tr_b16 a[126:127], v15 offset:36864
v_mfma_f32_16x16x32_bf16 v[56:59], a[8:11], a[72:75], v[56:59]
buffer_load_dwordx4 v8, s[4:7], s22 offen offset:2048 lds
v_mfma_f32_16x16x32_bf16 v[56:59], a[12:15], a[76:79], v[56:59]
v_mfma_f32_16x16x32_bf16 v[60:63], a[12:15], a[84:87], v[60:63]
v_mfma_f32_16x16x32_bf16 v[60:63], a[8:11], a[80:83], v[60:63]
buffer_load_dwordx4 v9, s[4:7], s22 offen offset:3072 lds
s_waitcnt lgkmcnt(4)
v_mfma_f32_16x16x32_bf16 v[64:67], a[16:19], a[56:59], v[64:67]
ds_read_b64_tr_b16 a[128:129], v14 offset:8192
v_mfma_f32_16x16x32_bf16 v[64:67], a[20:23], a[60:63], v[64:67]
ds_read_b64_tr_b16 a[130:131], v14 offset:18432
v_mfma_f32_16x16x32_bf16 v[68:71], a[20:23], a[68:71], v[68:71]
ds_read_b64_tr_b16 a[132:133], v14 offset:28672
v_mfma_f32_16x16x32_bf16 v[68:71], a[16:19], a[64:67], v[68:71]
ds_read_b64_tr_b16 a[134:135], v14 offset:38912
s_add_u32 m0, s23, 8192
v_mfma_f32_16x16x32_bf16 v[72:75], a[16:19], a[72:75], v[72:75]
buffer_load_dwordx4 v10, s[4:7], s22 offen offset:0 lds
v_mfma_f32_16x16x32_bf16 v[72:75], a[20:23], a[76:79], v[72:75]
v_mfma_f32_16x16x32_bf16 v[76:79], a[20:23], a[84:87], v[76:79]
s_add_u32 s23, s44, s45
s_add_u32 s44, s44, s43
v_mfma_f32_16x16x32_bf16 v[76:79], a[16:19], a[80:83], v[76:79]
buffer_load_dwordx4 v11, s[4:7], s22 offen offset:1024 lds
s_waitcnt lgkmcnt(4)
v_mfma_f32_16x16x32_bf16 v[80:83], a[120:123], a[56:59], v[80:83]
ds_read_b64_tr_b16 a[136:137], v15 offset:8192
v_mfma_f32_16x16x32_bf16 v[80:83], a[124:127], a[60:63], v[80:83]
ds_read_b64_tr_b16 a[138:139], v15 offset:18432
v_mfma_f32_16x16x32_bf16 v[84:87], a[124:127], a[68:71], v[84:87]
ds_read_b64_tr_b16 a[140:141], v15 offset:28672
v_mfma_f32_16x16x32_bf16 v[84:87], a[120:123], a[64:67], v[84:87]
ds_read_b64_tr_b16 a[142:143], v15 offset:38912
v_mfma_f32_16x16x32_bf16 v[88:91], a[120:123], a[72:75], v[88:91]
v_add_u32 v12, s43, v12
v_mfma_f32_16x16x32_bf16 v[88:91], a[124:127], a[76:79], v[88:91]
v_add_u32 v13, s43, v13
v_mfma_f32_16x16x32_bf16 v[92:95], a[124:127], a[84:87], v[92:95]
v_add_u32 v14, s43, v14
v_mfma_f32_16x16x32_bf16 v[92:95], a[120:123], a[80:83], v[92:95]
v_add_u32 v15, s43, v15
s_waitcnt vmcnt(11) lgkmcnt(0)
s_barrier
v_mfma_f32_16x16x32_bf16 v[96:99], a[56:59], a[128:131], v[96:99]
s_mov_b32 s86, 0
s_buffer_load_dword s86, s[16:19], s24 glc
ds_read_b64_tr_b16 a[0:1], v14 offset:4096
v_mfma_f32_16x16x32_bf16 v[96:99], a[60:63], a[132:135], v[96:99]
ds_read_b64_tr_b16 a[2:3], v14 offset:14336
buffer_store_dwordx4 a[96:99], v30, s[36:39], 0 offen offset:2048 sc1
v_mfma_f32_16x16x32_bf16 v[100:103], a[68:71], a[132:135], v[100:103]
ds_read_b128 a[24:27], v12 offset:0
buffer_load_dword v20, v28, s[12:15], 0 offen sc1
v_mfma_f32_16x16x32_bf16 v[100:103], a[64:67], a[128:131], v[100:103]
ds_read_b64_tr_b16 a[4:5], v14 offset:24576
s_add_u32 s21, s21, 128
v_mfma_f32_16x16x32_bf16 v[104:107], a[72:75], a[128:131], v[104:107]
ds_read_b64_tr_b16 a[6:7], v14 offset:34816
s_and_b32 s21, s21, 0x7ff
v_mfma_f32_16x16x32_bf16 v[104:107], a[76:79], a[132:135], v[104:107]
ds_read_b128 a[28:31], v13 offset:0
s_mov_b32 m0, s23
v_mfma_f32_16x16x32_bf16 v[108:111], a[84:87], a[132:135], v[108:111]
ds_read_b128 a[36:39], v13 offset:2048
buffer_load_dwordx4 v2, s[8:11], s21 offen offset:0 lds
v_mfma_f32_16x16x32_bf16 v[108:111], a[80:83], a[128:131], v[108:111]
ds_read_b128 a[32:35], v12 offset:2048
v_mfma_f32_16x16x32_bf16 v[112:115], a[56:59], a[136:139], v[112:115]
ds_read_b128 a[40:43], v12 offset:10240
buffer_load_dwordx4 v3, s[8:11], s21 offen offset:1024 lds
v_mfma_f32_16x16x32_bf16 v[112:115], a[60:63], a[140:143], v[112:115]
ds_read_b128 a[44:47], v13 offset:10240
v_mfma_f32_16x16x32_bf16 v[116:119], a[68:71], a[140:143], v[116:119]
ds_read_b128 a[52:55], v13 offset:12288
buffer_load_dwordx4 v4, s[8:11], s21 offen offset:2048 lds
v_mfma_f32_16x16x32_bf16 v[116:119], a[64:67], a[136:139], v[116:119]
ds_read_b128 a[48:51], v12 offset:12288
v_mfma_f32_16x16x32_bf16 v[120:123], a[72:75], a[136:139], v[120:123]
ds_read_b64_tr_b16 a[8:9], v15 offset:4096
v_mfma_f32_16x16x32_bf16 v[120:123], a[76:79], a[140:143], v[120:123]
ds_read_b64_tr_b16 a[10:11], v15 offset:14336
v_mfma_f32_16x16x32_bf16 v[124:127], a[84:87], a[140:143], v[124:127]
ds_read_b64_tr_b16 a[12:13], v15 offset:24576
buffer_load_dwordx4 v5, s[8:11], s21 offen offset:3072 lds
v_mfma_f32_16x16x32_bf16 v[124:127], a[80:83], a[136:139], v[124:127]
ds_read_b64_tr_b16 a[14:15], v15 offset:34816
s_waitcnt lgkmcnt(10)
v_mfma_f32_16x16x32_bf16 v[32:35], a[0:3], a[24:27], v[32:35]
ds_read_b64_tr_b16 a[16:17], v14 offset:6144
v_mfma_f32_16x16x32_bf16 v[32:35], a[4:7], a[28:31], v[32:35]
s_add_u32 s28, s28, s86
ds_read_b64_tr_b16 a[18:19], v14 offset:16384
s_waitcnt lgkmcnt(6)
v_mfma_f32_16x16x32_bf16 v[36:39], a[4:7], a[36:39], v[36:39]
ds_read_b64_tr_b16 a[20:21], v14 offset:26624
s_mul_i32 s22, s21, 3072
v_mfma_f32_16x16x32_bf16 v[36:39], a[0:3], a[32:35], v[36:39]
ds_read_b64_tr_b16 a[22:23], v14 offset:36864
s_add_u32 m0, s23, 4096
v_mfma_f32_16x16x32_bf16 v[40:43], a[0:3], a[40:43], v[40:43]
s_add_u32 s28, s28, s86
buffer_load_dwordx4 v6, s[4:7], s22 offen offset:0 lds
v_mfma_f32_16x16x32_bf16 v[40:43], a[4:7], a[44:47], v[40:43]
s_cmp_eq_u32 s44, 81920
s_cselect_b32 s43, s42, s41
s_mov_b32 s36, s70
s_mov_b32 s37, s71
v_mfma_f32_16x16x32_bf16 v[44:47], a[4:7], a[52:55], v[44:47]
s_add_u32 s28, s28, s86
v_mfma_f32_16x16x32_bf16 v[44:47], a[0:3], a[48:51], v[44:47]
buffer_load_dwordx4 v7, s[4:7], s22 offen offset:1024 lds
s_waitcnt lgkmcnt(4)
v_mfma_f32_16x16x32_bf16 v[48:51], a[8:11], a[24:27], v[48:51]
ds_read_b64_tr_b16 a[120:121], v15 offset:6144
v_mfma_f32_16x16x32_bf16 v[48:51], a[12:15], a[28:31], v[48:51]
s_add_u32 s28, s28, s86
ds_read_b64_tr_b16 a[122:123], v15 offset:16384
v_mfma_f32_16x16x32_bf16 v[52:55], a[12:15], a[36:39], v[52:55]
ds_read_b64_tr_b16 a[124:125], v15 offset:26624
v_mfma_f32_16x16x32_bf16 v[52:55], a[8:11], a[32:35], v[52:55]
s_add_u32 s28, s28, s86
ds_read_b64_tr_b16 a[126:127], v15 offset:36864
v_mfma_f32_16x16x32_bf16 v[56:59], a[8:11], a[40:43], v[56:59]
buffer_load_dwordx4 v8, s[4:7], s22 offen offset:2048 lds
v_mfma_f32_16x16x32_bf16 v[56:59], a[12:15], a[44:47], v[56:59]
s_add_u32 s28, s28, s86
s_mov_b32 s38, 2097152
v_mfma_f32_16x16x32_bf16 v[60:63], a[12:15], a[52:55], v[60:63]
s_add_u32 s28, s28, s86
v_mfma_f32_16x16x32_bf16 v[60:63], a[8:11], a[48:51], v[60:63]
buffer_load_dwordx4 v9, s[4:7], s22 offen offset:3072 lds
s_waitcnt lgkmcnt(4)
v_mfma_f32_16x16x32_bf16 v[64:67], a[16:19], a[24:27], v[64:67]
ds_read_b64_tr_b16 a[128:129], v14 offset:8192
v_mfma_f32_16x16x32_bf16 v[64:67], a[20:23], a[28:31], v[64:67]
s_add_u32 s28, s28, s86
ds_read_b64_tr_b16 a[130:131], v14 offset:18432
v_mfma_f32_16x16x32_bf16 v[68:71], a[20:23], a[36:39], v[68:71]
ds_read_b64_tr_b16 a[132:133], v14 offset:28672
v_mfma_f32_16x16x32_bf16 v[68:71], a[16:19], a[32:35], v[68:71]
ds_read_b64_tr_b16 a[134:135], v14 offset:38912
s_add_u32 m0, s23, 8192
v_mfma_f32_16x16x32_bf16 v[72:75], a[16:19], a[40:43], v[72:75]
buffer_load_dwordx4 v10, s[4:7], s22 offen offset:0 lds
L_pg1:
s_cbranch_execz L_vret
v_mfma_f32_16x16x32_bf16 v[72:75], a[20:23], a[44:47], v[72:75]
s_add_u32 s28, s28, s86
v_mfma_f32_16x16x32_bf16 v[76:79], a[20:23], a[52:55], v[76:79]
s_add_u32 s23, s44, s45
s_add_u32 s44, s44, s43
v_mfma_f32_16x16x32_bf16 v[76:79], a[16:19], a[48:51], v[76:79]
buffer_load_dwordx4 v11, s[4:7], s22 offen offset:1024 lds
s_waitcnt lgkmcnt(4)
v_mfma_f32_16x16x32_bf16 v[80:83], a[120:123], a[24:27], v[80:83]
ds_read_b64_tr_b16 a[136:137], v15 offset:8192
v_mfma_f32_16x16x32_bf16 v[80:83], a[124:127], a[28:31], v[80:83]
s_add_u32 s28, s28, s86
ds_read_b64_tr_b16 a[138:139], v15 offset:18432
v_mfma_f32_16x16x32_bf16 v[84:87], a[124:127], a[36:39], v[84:87]
s_xor_b32 s24, s24, 8192
ds_read_b64_tr_b16 a[140:141], v15 offset:28672
v_mfma_f32_16x16x32_bf16 v[84:87], a[120:123], a[32:35], v[84:87]
s_add_u32 s28, s28, s86
ds_read_b64_tr_b16 a[142:143], v15 offset:38912
v_mfma_f32_16x16x32_bf16 v[88:91], a[120:123], a[40:43], v[88:91]
v_add_u32 v12, s43, v12
v_mfma_f32_16x16x32_bf16 v[88:91], a[124:127], a[44:47], v[88:91]
v_add_u32 v13, s43, v13
v_mfma_f32_16x16x32_bf16 v[92:95], a[124:127], a[52:55], v[92:95]
v_add_u32 v14, s43, v14
v_mfma_f32_16x16x32_bf16 v[92:95], a[120:123], a[48:51], v[92:95]
v_add_u32 v15, s43, v15
s_waitcnt vmcnt(12) lgkmcnt(0)
s_barrier
v_mfma_f32_16x16x32_bf16 v[96:99], a[24:27], a[128:131], v[96:99]
s_mov_b32 s86, 0
s_buffer_load_dword s86, s[16:19], s24 glc
ds_read_b64_tr_b16 a[0:1], v14 offset:4096
v_mfma_f32_16x16x32_bf16 v[96:99], a[28:31], a[132:135], v[96:99]
ds_read_b64_tr_b16 a[2:3], v14 offset:14336
s_add_u32 s21, s21, 128
v_mfma_f32_16x16x32_bf16 v[100:103], a[36:39], a[132:135], v[100:103]
ds_read_b128 a[56:59], v12 offset:0
s_and_b32 s21, s21, 0x7ff
v_mfma_f32_16x16x32_bf16 v[100:103], a[32:35], a[128:131], v[100:103]
ds_read_b64_tr_b16 a[4:5], v14 offset:24576
s_mov_b32 m0, s23
v_mfma_f32_16x16x32_bf16 v[104:107], a[40:43], a[128:131], v[104:107]
ds_read_b64_tr_b16 a[6:7], v14 offset:34816
buffer_load_dwordx4 v2, s[8:11], s21 offen offset:0 lds
v_mfma_f32_16x16x32_bf16 v[104:107], a[44:47], a[132:135], v[104:107]
ds_read_b128 a[60:63], v13 offset:0
v_mfma_f32_16x16x32_bf16 v[108:111], a[52:55], a[132:135], v[108:111]
ds_read_b128 a[68:71], v13 offset:2048
buffer_load_dwordx4 v3, s[8:11], s21 offen offset:1024 lds
v_mfma_f32_16x16x32_bf16 v[108:111], a[48:51], a[128:131], v[108:111]
ds_read_b128 a[64:67], v12 offset:2048
v_mfma_f32_16x16x32_bf16 v[112:115], a[24:27], a[136:139], v[112:115]
ds_read_b128 a[72:75], v12 offset:10240
v_mfma_f32_16x16x32_bf16 v[112:115], a[28:31], a[140:143], v[112:115]
ds_read_b128 a[76:79], v13 offset:10240
v_mfma_f32_16x16x32_bf16 v[116:119], a[36:39], a[140:143], v[116:119]
ds_read_b128 a[84:87], v13 offset:12288
buffer_load_dwordx4 v4, s[8:11], s21 offen offset:2048 lds
v_mfma_f32_16x16x32_bf16 v[116:119], a[32:35], a[136:139], v[116:119]
ds_read_b128 a[80:83], v12 offset:12288
v_mfma_f32_16x16x32_bf16 v[120:123], a[40:43], a[136:139], v[120:123]
ds_read_b64_tr_b16 a[8:9], v15 offset:4096
v_mfma_f32_16x16x32_bf16 v[120:123], a[44:47], a[140:143], v[120:123]
ds_read_b64_tr_b16 a[10:11], v15 offset:14336
v_mfma_f32_16x16x32_bf16 v[124:127], a[52:55], a[140:143], v[124:127]
ds_read_b64_tr_b16 a[12:13], v15 offset:24576
buffer_load_dwordx4 v5, s[8:11], s21 offen offset:3072 lds
v_mfma_f32_16x16x32_bf16 v[124:127], a[48:51], a[136:139], v[124:127]
ds_read_b64_tr_b16 a[14:15], v15 offset:34816
s_waitcnt lgkmcnt(10)
v_mfma_f32_16x16x32_bf16 v[32:35], a[0:3], a[56:59], v[32:35]
ds_read_b64_tr_b16 a[16:17], v14 offset:6144
v_mfma_f32_16x16x32_bf16 v[32:35], a[4:7], a[60:63], v[32:35]
s_sub_u32 s28, s28, s86
ds_read_b64_tr_b16 a[18:19], v14 offset:16384
s_waitcnt lgkmcnt(6)
v_mfma_f32_16x16x32_bf16 v[36:39], a[4:7], a[68:71], v[36:39]
ds_read_b64_tr_b16 a[20:21], v14 offset:26624
s_mul_i32 s22, s21, 3072
v_mfma_f32_16x16x32_bf16 v[36:39], a[0:3], a[64:67], v[36:39]
ds_read_b64_tr_b16 a[22:23], v14 offset:36864
s_add_u32 m0, s23, 4096
v_mfma_f32_16x16x32_bf16 v[40:43], a[0:3], a[72:75], v[40:43]
s_sub_u32 s28, s28, s86
buffer_load_dwordx4 v6, s[4:7], s22 offen offset:0 lds
v_mfma_f32_16x16x32_bf16 v[40:43], a[4:7], a[76:79], v[40:43]
s_cmp_eq_u32 s44, 81920
s_cselect_b32 s43, s42, s41
v_mfma_f32_16x16x32_bf16 v[44:47], a[4:7], a[84:87], v[44:47]
s_sub_u32 s28, s28, s86
v_mfma_f32_16x16x32_bf16 v[44:47], a[0:3], a[80:83], v[44:47]
buffer_load_dwordx4 v7, s[4:7], s22 offen offset:1024 lds
s_waitcnt lgkmcnt(4)
v_mfma_f32_16x16x32_bf16 v[48:51], a[8:11], a[56:59], v[48:51]
ds_read_b64_tr_b16 a[120:121], v15 offset:6144
v_mfma_f32_16x16x32_bf16 v[48:51], a[12:15], a[60:63], v[48:51]
s_sub_u32 s28, s28, s86
ds_read_b64_tr_b16 a[122:123], v15 offset:16384
v_mfma_f32_16x16x32_bf16 v[52:55], a[12:15], a[68:71], v[52:55]
ds_read_b64_tr_b16 a[124:125], v15 offset:26624
v_mfma_f32_16x16x32_bf16 v[52:55], a[8:11], a[64:67], v[52:55]
s_sub_u32 s28, s28, s86
ds_read_b64_tr_b16 a[126:127], v15 offset:36864
v_mfma_f32_16x16x32_bf16 v[56:59], a[8:11], a[72:75], v[56:59]
buffer_load_dwordx4 v8, s[4:7], s22 offen offset:2048 lds
v_mfma_f32_16x16x32_bf16 v[56:59], a[12:15], a[76:79], v[56:59]
s_sub_u32 s28, s28, s86
v_mfma_f32_16x16x32_bf16 v[60:63], a[12:15], a[84:87], v[60:63]
s_sub_u32 s28, s28, s86
v_mfma_f32_16x16x32_bf16 v[60:63], a[8:11], a[80:83], v[60:63]
buffer_load_dwordx4 v9, s[4:7], s22 offen offset:3072 lds
s_waitcnt lgkmcnt(4)
v_mfma_f32_16x16x32_bf16 v[64:67], a[16:19], a[56:59], v[64:67]
ds_read_b64_tr_b16 a[128:129], v14 offset:8192
v_mfma_f32_16x16x32_bf16 v[64:67], a[20:23], a[60:63], v[64:67]
s_sub_u32 s28, s28, s86
ds_read_b64_tr_b16 a[130:131], v14 offset:18432
v_mfma_f32_16x16x32_bf16 v[68:71], a[20:23], a[68:71], v[68:71]
ds_read_b64_tr_b16 a[132:133], v14 offset:28672
v_mfma_f32_16x16x32_bf16 v[68:71], a[16:19], a[64:67], v[68:71]
ds_read_b64_tr_b16 a[134:135], v14 offset:38912
s_add_u32 m0, s23, 8192
v_mfma_f32_16x16x32_bf16 v[72:75], a[16:19], a[72:75], v[72:75]
buffer_load_dwordx4 v10, s[4:7], s22 offen offset:0 lds
v_mfma_f32_16x16x32_bf16 v[72:75], a[20:23], a[76:79], v[72:75]
s_sub_u32 s28, s28, s86
v_mfma_f32_16x16x32_bf16 v[76:79], a[20:23], a[84:87], v[76:79]
s_add_u32 s23, s44, s45
s_add_u32 s44, s44, s43
v_mfma_f32_16x16x32_bf16 v[76:79], a[16:19], a[80:83], v[76:79]
buffer_load_dwordx4 v11, s[4:7], s22 offen offset:1024 lds
s_waitcnt lgkmcnt(4)
v_mfma_f32_16x16x32_bf16 v[80:83], a[120:123], a[56:59], v[80:83]
ds_read_b64_tr_b16 a[136:137], v15 offset:8192
v_mfma_f32_16x16x32_bf16 v[80:83], a[124:127], a[60:63], v[80:83]
s_sub_u32 s28, s28, s86
ds_read_b64_tr_b16 a[138:139], v15 offset:18432
v_mfma_f32_16x16x32_bf16 v[84:87], a[124:127], a[68:71], v[84:87]
ds_read_b64_tr_b16 a[140:141], v15 offset:28672
v_mfma_f32_16x16x32_bf16 v[84:87], a[120:123], a[64:67], v[84:87]
s_sub_u32 s28, s28, s86
ds_read_b64_tr_b16 a[142:143], v15 offset:38912
v_mfma_f32_16x16x32_bf16 v[88:91], a[120:123], a[72:75], v[88:91]
v_add_u32 v12, s43, v12
v_mfma_f32_16x16x32_bf16 v[88:91], a[124:127], a[76:79], v[88:91]
v_add_u32 v13, s43, v13
v_mfma_f32_16x16x32_bf16 v[92:95], a[124:127], a[84:87], v[92:95]
v_add_u32 v14, s43, v14
v_mfma_f32_16x16x32_bf16 v[92:95], a[120:123], a[80:83], v[92:95]
v_add_u32 v15, s43, v15
s_waitcnt vmcnt(10) lgkmcnt(0)
s_barrier
s_cmp_eq_u32 s20, 0
s_cbranch_scc1 L_flag
L_ret:
v_mfma_f32_16x16x32_bf16 v[96:99], a[56:59], a[128:131], v[96:99]
ds_read_b64_tr_b16 a[0:1], v14 offset:4096
v_mfma_f32_16x16x32_bf16 v[96:99], a[60:63], a[132:135], v[96:99]
ds_read_b64_tr_b16 a[2:3], v14 offset:14336
s_add_u32 s21, s21, 128
v_mfma_f32_16x16x32_bf16 v[100:103], a[68:71], a[132:135], v[100:103]
ds_read_b128 a[24:27], v12 offset:0
s_and_b32 s21, s21, 0x7ff
v_mfma_f32_16x16x32_bf16 v[100:103], a[64:67], a[128:131], v[100:103]
ds_read_b64_tr_b16 a[4:5], v14 offset:24576
s_mov_b32 m0, s23
v_mfma_f32_16x16x32_bf16 v[104:107], a[72:75], a[128:131], v[104:107]
ds_read_b64_tr_b16 a[6:7], v14 offset:34816
buffer_load_dwordx4 v2, s[8:11], s21 offen offset:0 lds
v_mfma_f32_16x16x32_bf16 v[104:107], a[76:79], a[132:135], v[104:107]
ds_read_b128 a[28:31], v13 offset:0
v_mfma_f32_16x16x32_bf16 v[108:111], a[84:87], a[132:135], v[108:111]
ds_read_b128 a[36:39], v13 offset:2048
buffer_load_dwordx4 v3, s[8:11], s21 offen offset:1024 lds
v_mfma_f32_16x16x32_bf16 v[108:111], a[80:83], a[128:131], v[108:111]
ds_read_b128 a[32:35], v12 offset:2048
v_mfma_f32_16x16x32_bf16 v[112:115], a[56:59], a[136:139], v[112:115]
ds_read_b128 a[40:43], v12 offset:10240
v_mfma_f32_16x16x32_bf16 v[112:115], a[60:63], a[140:143], v[112:115]
ds_read_b128 a[44:47], v13 offset:10240
v_mfma_f32_16x16x32_bf16 v[116:119], a[68:71], a[140:143], v[116:119]
ds_read_b128 a[52:55], v13 offset:12288
buffer_load_dwordx4 v4, s[8:11], s21 offen offset:2048 lds
v_mfma_f32_16x16x32_bf16 v[116:119], a[64:67], a[136:139], v[116:119]
ds_read_b128 a[48:51], v12 offset:12288
v_mfma_f32_16x16x32_bf16 v[120:123], a[72:75], a[136:139], v[120:123]
ds_read_b64_tr_b16 a[8:9], v15 offset:4096
v_mfma_f32_16x16x32_bf16 v[120:123], a[76:79], a[140:143], v[120:123]
ds_read_b64_tr_b16 a[10:11], v15 offset:14336
v_mfma_f32_16x16x32_bf16 v[124:127], a[84:87], a[140:143], v[124:127]
ds_read_b64_tr_b16 a[12:13], v15 offset:24576
buffer_load_dwordx4 v5, s[8:11], s21 offen offset:3072 lds
v_mfma_f32_16x16x32_bf16 v[124:127], a[80:83], a[136:139], v[124:127]
ds_read_b64_tr_b16 a[14:15], v15 offset:34816
s_mov_b32 s24, 3
L_loop1_3:
s_waitcnt lgkmcnt(10)
v_mfma_f32_16x16x32_bf16 v[32:35], a[0:3], a[24:27], v[32:35]
ds_read_b64_tr_b16 a[16:17], v14 offset:6144
v_mfma_f32_16x16x32_bf16 v[32:35], a[4:7], a[28:31], v[32:35]
ds_read_b64_tr_b16 a[18:19], v14 offset:16384
s_waitcnt lgkmcnt(6)
v_mfma_f32_16x16x32_bf16 v[36:39], a[4:7], a[36:39], v[36:39]
ds_read_b64_tr_b16 a[20:21], v14 offset:26624
s_mul_i32 s22, s21, 3072
v_mfma_f32_16x16x32_bf16 v[36:39], a[0:3], a[32:35], v[36:39]
ds_read_b64_tr_b16 a[22:23], v14 offset:36864
s_add_u32 m0, s23, 4096
v_mfma_f32_16x16x32_bf16 v[40:43], a[0:3], a[40:43], v[40:43]
buffer_load_dwordx4 v6, s[4:7], s22 offen offset:0 lds
v_mfma_f32_16x16x32_bf16 v[40:43], a[4:7], a[44:47], v[40:43]
s_cmp_eq_u32 s44, 81920
s_cselect_b32 s43, s42, s41
v_mfma_f32_16x16x32_bf16 v[44:47], a[4:7], a[52:55], v[44:47]
v_mfma_f32_16x16x32_bf16 v[44:47], a[0:3], a[48:51], v[44:47]
buffer_load_dwordx4 v7, s[4:7], s22 offen offset:1024 lds
s_waitcnt lgkmcnt(4)
v_mfma_f32_16x16x32_bf16 v[48:51], a[8:11], a[24:27], v[48:51]
ds_read_b64_tr_b16 a[120:121], v15 offset:6144
v_mfma_f32_16x16x32_bf16 v[48:51], a[12:15], a[28:31], v[48:51]
ds_read_b64_tr_b16 a[122:123], v15 offset:16384
v_mfma_f32_16x16x32_bf16 v[52:55], a[12:15], a[36:39], v[52:55]
ds_read_b64_tr_b16 a[124:125], v15 offset:26624
v_mfma_f32_16x16x32_bf16 v[52:55], a[8:11], a[32:35], v[52:55]
ds_read_b64_tr_b16 a[126:127], v15 offset:36864
v_mfma_f32_16x16x32_bf16 v[56:59], a[8:11], a[40:43], v[56:59]
buffer_load_dwordx4 v8, s[4:7], s22 offen offset:2048 lds
v_mfma_f32_16x16x32_bf16 v[56:59], a[12:15], a[44:47], v[56:59]
v_mfma_f32_16x16x32_bf16 v[60:63], a[12:15], a[52:55], v[60:63]
v_mfma_f32_16x16x32_bf16 v[60:63], a[8:11], a[48:51], v[60:63]
buffer_load_dwordx4 v9, s[4:7], s22 offen offset:3072 lds
s_waitcnt lgkmcnt(4)
v_mfma_f32_16x16x32_bf16 v[64:67], a[16:19], a[24:27], v[64:67]
ds_read_b64_tr_b16 a[128:129], v14 offset:8192
v_mfma_f32_16x16x32_bf16 v[64:67], a[20:23], a[28:31], v[64:67]
ds_read_b64_tr_b16 a[130:131], v14 offset:18432
v_mfma_f32_16x16x32_bf16 v[68:71], a[20:23], a[36:39], v[68:71]
ds_read_b64_tr_b16 a[132:133], v14 offset:28672
v_mfma_f32_16x16x32_bf16 v[68:71], a[16:19], a[32:35], v[68:71]
ds_read_b64_tr_b16 a[134:135], v14 offset:38912
s_add_u32 m0, s23, 8192
v_mfma_f32_16x16x32_bf16 v[72:75], a[16:19], a[40:43], v[72:75]
buffer_load_dwordx4 v10, s[4:7], s22 offen offset:0 lds
v_mfma_f32_16x16x32_bf16 v[72:75], a[20:23], a[44:47], v[72:75]
v_mfma_f32_16x16x32_bf16 v[76:79], a[20:23], a[52:55], v[76:79]
s_add_u32 s23, s44, s45
s_add_u32 s44, s44, s43
v_mfma_f32_16x16x32_bf16 v[76:79], a[16:19], a[48:51], v[76:79]
buffer_load_dwordx4 v11, s[4:7], s22 offen offset:1024 lds
s_waitcnt lgkmcnt(4)
v_mfma_f32_16x16x32_bf16 v[80:83], a[120:123], a[24:27], v[80:83]
ds_read_b64_tr_b16 a[136:137], v15 offset:8192
v_mfma_f32_16x16x32_bf16 v[80:83], a[124:127], a[28:31], v[80:83]
ds_read_b64_tr_b16 a[138:139], v15 offset:18432
v_mfma_f32_16x16x32_bf16 v[84:87], a[124:127], a[36:39], v[84:87]
ds_read_b64_tr_b16 a[140:141], v15 offset:28672
v_mfma_f32_16x16x32_bf16 v[84:87], a[120:123], a[32:35], v[84:87]
ds_read_b64_tr_b16 a[142:143], v15 offset:38912
v_mfma_f32_16x16x32_bf16 v[88:91], a[120:123], a[40:43], v[88:91]
v_add_u32 v12, s43, v12
v_mfma_f32_16x16x32_bf16 v[88:91], a[124:127], a[44:47], v[88:91]
v_add_u32 v13, s43, v13
v_mfma_f32_16x16x32_bf16 v[92:95], a[124:127], a[52:55], v[92:95]
v_add_u32 v14, s43, v14
v_mfma_f32_16x16x32_bf16 v[92:95], a[120:123], a[48:51], v[92:95]
v_add_u32 v15, s43, v15
s_waitcnt vmcnt(10) lgkmcnt(0)
s_barrier
v_mfma_f32_16x16x32_bf16 v[96:99], a[24:27], a[128:131], v[96:99]
ds_read_b64_tr_b16 a[0:1], v14 offset:4096
v_mfma_f32_16x16x32_bf16 v[96:99], a[28:31], a[132:135], v[96:99]
ds_read_b64_tr_b16 a[2:3], v14 offset:14336
s_add_u32 s21, s21, 128
v_mfma_f32_16x16x32_bf16 v[100:103], a[36:39], a[132:135], v[100:103]
ds_read_b128 a[56:59], v12 offset:0
s_and_b32 s21, s21, 0x7ff
v_mfma_f32_16x16x32_bf16 v[100:103], a[32:35], a[128:131], v[100:103]
ds_read_b64_tr_b16 a[4:5], v14 offset:24576
s_mov_b32 m0, s23
v_mfma_f32_16x16x32_bf16 v[104:107], a[40:43], a[128:131], v[104:107]
ds_read_b64_tr_b16 a[6:7], v14 offset:34816
buffer_load_dwordx4 v2, s[8:11], s21 offen offset:0 lds
v_mfma_f32_16x16x32_bf16 v[104:107], a[44:47], a[132:135], v[104:107]
ds_read_b128 a[60:63], v13 offset:0
v_mfma_f32_16x16x32_bf16 v[108:111], a[52:55], a[132:135], v[108:111]
ds_read_b128 a[68:71], v13 offset:2048
buffer_load_dwordx4 v3, s[8:11], s21 offen offset:1024 lds
v_mfma_f32_16x16x32_bf16 v[108:111], a[48:51], a[128:131], v[108:111]
ds_read_b128 a[64:67], v12 offset:2048
v_mfma_f32_16x16x32_bf16 v[112:115], a[24:27], a[136:139], v[112:115]
ds_read_b128 a[72:75], v12 offset:10240
v_mfma_f32_16x16x32_bf16 v[112:115], a[28:31], a[140:143], v[112:115]
ds_read_b128 a[76:79], v13 offset:10240
v_mfma_f32_16x16x32_bf16 v[116:119], a[36:39], a[140:143], v[116:119]
ds_read_b128 a[84:87], v13 offset:12288
buffer_load_dwordx4 v4, s[8:11], s21 offen offset:2048 lds
v_mfma_f32_16x16x32_bf16 v[116:119], a[32:35], a[136:139], v[116:119]
ds_read_b128 a[80:83], v12 offset:12288
v_mfma_f32_16x16x32_bf16 v[120:123], a[40:43], a[136:139], v[120:123]
ds_read_b64_tr_b16 a[8:9], v15 offset:4096
v_mfma_f32_16x16x32_bf16 v[120:123], a[44:47], a[140:143], v[120:123]
ds_read_b64_tr_b16 a[10:11], v15 offset:14336
v_mfma_f32_16x16x32_bf16 v[124:127], a[52:55], a[140:143], v[124:127]
ds_read_b64_tr_b16 a[12:13], v15 offset:24576
buffer_load_dwordx4 v5, s[8:11], s21 offen offset:3072 lds
v_mfma_f32_16x16x32_bf16 v[124:127], a[48:51], a[136:139], v[124:127]
ds_read_b64_tr_b16 a[14:15], v15 offset:34816
s_waitcnt lgkmcnt(10)
v_mfma_f32_16x16x32_bf16 v[32:35], a[0:3], a[56:59], v[32:35]
ds_read_b64_tr_b16 a[16:17], v14 offset:6144
v_mfma_f32_16x16x32_bf16 v[32:35], a[4:7], a[60:63], v[32:35]
ds_read_b64_tr_b16 a[18:19], v14 offset:16384
s_waitcnt lgkmcnt(6)
v_mfma_f32_16x16x32_bf16 v[36:39], a[4:7], a[68:71], v[36:39]
ds_read_b64_tr_b16 a[20:21], v14 offset:26624
s_mul_i32 s22, s21, 3072
v_mfma_f32_16x16x32_bf16 v[36:39], a[0:3], a[64:67], v[36:39]
ds_read_b64_tr_b16 a[22:23], v14 offset:36864
s_add_u32 m0, s23, 4096
v_mfma_f32_16x16x32_bf16 v[40:43], a[0:3], a[72:75], v[40:43]
buffer_load_dwordx4 v6, s[4:7], s22 offen offset:0 lds
v_mfma_f32_16x16x32_bf16 v[40:43], a[4:7], a[76:79], v[40:43]
s_cmp_eq_u32 s44, 81920
s_cselect_b32 s43, s42, s41
v_mfma_f32_16x16x32_bf16 v[44:47], a[4:7], a[84:87], v[44:47]
v_mfma_f32_16x16x32_bf16 v[44:47], a[0:3], a[80:83], v[44:47]
buffer_load_dwordx4 v7, s[4:7], s22 offen offset:1024 lds
s_waitcnt lgkmcnt(4)
v_mfma_f32_16x16x32_bf16 v[48:51], a[8:11], a[56:59], v[48:51]
ds_read_b64_tr_b16 a[120:121], v15 offset:6144
v_mfma_f32_16x16x32_bf16 v[48:51], a[12:15], a[60:63], v[48:51]
ds_read_b64_tr_b16 a[122:123], v15 offset:16384
v_mfma_f32_16x16x32_bf16 v[52:55], a[12:15], a[68:71], v[52:55]
ds_read_b64_tr_b16 a[124:125], v15 offset:26624
v_mfma_f32_16x16x32_bf16 v[52:55], a[8:11], a[64:67], v[52:55]
ds_read_b64_tr_b16 a[126:127], v15 offset:36864
v_mfma_f32_16x16x32_bf16 v[56:59], a[8:11], a[72:75], v[56:59]
buffer_load_dwordx4 v8, s[4:7], s22 offen offset:2048 lds
v_mfma_f32_16x16x32_bf16 v[56:59], a[12:15], a[76:79], v[56:59]
v_mfma_f32_16x16x32_bf16 v[60:63], a[12:15], a[84:87], v[60:63]
v_mfma_f32_16x16x32_bf16 v[60:63], a[8:11], a[80:83], v[60:63]
buffer_load_dwordx4 v9, s[4:7], s22 offen offset:3072 lds
s_waitcnt lgkmcnt(4)
v_mfma_f32_16x16x32_bf16 v[64:67], a[16:19], a[56:59], v[64:67]
ds_read_b64_tr_b16 a[128:129], v14 offset:8192
v_mfma_f32_16x16x32_bf16 v[64:67], a[20:23], a[60:63], v[64:67]
ds_read_b64_tr_b16 a[130:131], v14 offset:18432
v_mfma_f32_16x16x32_bf16 v[68:71], a[20:23], a[68:71], v[68:71]
ds_read_b64_tr_b16 a[132:133], v14 offset:28672
v_mfma_f32_16x16x32_bf16 v[68:71], a[16:19], a[64:67], v[68:71]
ds_read_b64_tr_b16 a[134:135], v14 offset:38912
s_add_u32 m0, s23, 8192
v_mfma_f32_16x16x32_bf16 v[72:75], a[16:19], a[72:75], v[72:75]
buffer_load_dwordx4 v10, s[4:7], s22 offen offset:0 lds
v_mfma_f32_16x16x32_bf16 v[72:75], a[20:23], a[76:79], v[72:75]
v_mfma_f32_16x16x32_bf16 v[76:79], a[20:23], a[84:87], v[76:79]
s_add_u32 s23, s44, s45
s_add_u32 s44, s44, s43
v_mfma_f32_16x16x32_bf16 v[76:79], a[16:19], a[80:83], v[76:79]
buffer_load_dwordx4 v11, s[4:7], s22 offen offset:1024 lds
s_waitcnt lgkmcnt(4)
v_mfma_f32_16x16x32_bf16 v[80:83], a[120:123], a[56:59], v[80:83]
ds_read_b64_tr_b16 a[136:137], v15 offset:8192
v_mfma_f32_16x16x32_bf16 v[80:83], a[124:127], a[60:63], v[80:83]
ds_read_b64_tr_b16 a[138:139], v15 offset:18432
v_mfma_f32_16x16x32_bf16 v[84:87], a[124:127], a[68:71], v[84:87]
ds_read_b64_tr_b16 a[140:141], v15 offset:28672
v_mfma_f32_16x16x32_bf16 v[84:87], a[120:123], a[64:67], v[84:87]
ds_read_b64_tr_b16 a[142:143], v15 offset:38912
v_mfma_f32_16x16x32_bf16 v[88:91], a[120:123], a[72:75], v[88:91]
v_add_u32 v12, s43, v12
v_mfma_f32_16x16x32_bf16 v[88:91], a[124:127], a[76:79], v[88:91]
v_add_u32 v13, s43, v13
v_mfma_f32_16x16x32_bf16 v[92:95], a[124:127], a[84:87], v[92:95]
v_add_u32 v14, s43, v14
v_mfma_f32_16x16x32_bf16 v[92:95], a[120:123], a[80:83], v[92:95]
v_add_u32 v15, s43, v15
s_waitcnt vmcnt(10) lgkmcnt(0)
s_barrier
v_mfma_f32_16x16x32_bf16 v[96:99], a[56:59], a[128:131], v[96:99]
ds_read_b64_tr_b16 a[0:1], v14 offset:4096
v_mfma_f32_16x16x32_bf16 v[96:99], a[60:63], a[132:135], v[96:99]
ds_read_b64_tr_b16 a[2:3], v14 offset:14336
s_add_u32 s21, s21, 128
v_mfma_f32_16x16x32_bf16 v[100:103], a[68:71], a[132:135], v[100:103]
ds_read_b128 a[24:27], v12 offset:0
s_and_b32 s21, s21, 0x7ff
v_mfma_f32_16x16x32_bf16 v[100:103], a[64:67], a[128:131], v[100:103]
ds_read_b64_tr_b16 a[4:5], v14 offset:24576
s_mov_b32 m0, s23
v_mfma_f32_16x16x32_bf16 v[104:107], a[72:75], a[128:131], v[104:107]
ds_read_b64_tr_b16 a[6:7], v14 offset:34816
buffer_load_dwordx4 v2, s[8:11], s21 offen offset:0 lds
v_mfma_f32_16x16x32_bf16 v[104:107], a[76:79], a[132:135], v[104:107]
ds_read_b128 a[28:31], v13 offset:0
v_mfma_f32_16x16x32_bf16 v[108:111], a[84:87], a[132:135], v[108:111]
ds_read_b128 a[36:39], v13 offset:2048
buffer_load_dwordx4 v3, s[8:11], s21 offen offset:1024 lds
v_mfma_f32_16x16x32_bf16 v[108:111], a[80:83], a[128:131], v[108:111]
ds_read_b128 a[32:35], v12 offset:2048
v_mfma_f32_16x16x32_bf16 v[112:115], a[56:59], a[136:139], v[112:115]
ds_read_b128 a[40:43], v12 offset:10240
v_mfma_f32_16x16x32_bf16 v[112:115], a[60:63], a[140:143], v[112:115]
ds_read_b128 a[44:47], v13 offset:10240
v_mfma_f32_16x16x32_bf16 v[116:119], a[68:71], a[140:143], v[116:119]
ds_read_b128 a[52:55], v13 offset:12288
buffer_load_dwordx4 v4, s[8:11], s21 offen offset:2048 lds
v_mfma_f32_16x16x32_bf16 v[116:119], a[64:67], a[136:139], v[116:119]
ds_read_b128 a[48:51], v12 offset:12288
v_mfma_f32_16x16x32_bf16 v[120:123], a[72:75], a[136:139], v[120:123]
ds_read_b64_tr_b16 a[8:9], v15 offset:4096
v_mfma_f32_16x16x32_bf16 v[120:123], a[76:79], a[140:143], v[120:123]
ds_read_b64_tr_b16 a[10:11], v15 offset:14336
v_mfma_f32_16x16x32_bf16 v[124:127], a[84:87], a[140:143], v[124:127]
ds_read_b64_tr_b16 a[12:13], v15 offset:24576
buffer_load_dwordx4 v5, s[8:11], s21 offen offset:3072 lds
v_mfma_f32_16x16x32_bf16 v[124:127], a[80:83], a[136:139], v[124:127]
ds_read_b64_tr_b16 a[14:15], v15 offset:34816
s_sub_u32 s24, s24, 1
s_cmp_lg_u32 s24, 0
s_cbranch_scc1 L_loop1_3
s_waitcnt lgkmcnt(10)
v_mfma_f32_16x16x32_bf16 v[32:35], a[0:3], a[24:27], v[32:35]
ds_read_b64_tr_b16 a[16:17], v14 offset:6144
v_and_b32 v28, 60, v31
v_mfma_f32_16x16x32_bf16 v[32:35], a[4:7], a[28:31], v[32:35]
ds_read_b64_tr_b16 a[18:19], v14 offset:16384
s_waitcnt lgkmcnt(6)
v_mfma_f32_16x16x32_bf16 v[36:39], a[4:7], a[36:39], v[36:39]
ds_read_b64_tr_b16 a[20:21], v14 offset:26624
s_mul_i32 s22, s21, 3072
v_mfma_f32_16x16x32_bf16 v[36:39], a[0:3], a[32:35], v[36:39]
ds_read_b64_tr_b16 a[22:23], v14 offset:36864
s_add_u32 m0, s23, 4096
v_mfma_f32_16x16x32_bf16 v[40:43], a[0:3], a[40:43], v[40:43]
buffer_load_dwordx4 v6, s[4:7], s22 offen offset:0 lds
v_mfma_f32_16x16x32_bf16 v[40:43], a[4:7], a[44:47], v[40:43]
s_cmp_eq_u32 s44, 81920
s_cselect_b32 s43, s42, s41
buffer_load_dword v20, v19, s[16:19], s40 offen sc1
v_mfma_f32_16x16x32_bf16 v[44:47], a[4:7], a[52:55], v[44:47]
buffer_load_dword v18, v28, s[12:15], 0 offen offset:128 sc1
v_mfma_f32_16x16x32_bf16 v[44:47], a[0:3], a[48:51], v[44:47]
buffer_load_dwordx4 v7, s[4:7], s22 offen offset:1024 lds
s_waitcnt lgkmcnt(4)
v_mfma_f32_16x16x32_bf16 v[48:51], a[8:11], a[24:27], v[48:51]
ds_read_b64_tr_b16 a[120:121], v15 offset:6144
v_mfma_f32_16x16x32_bf16 v[48:51], a[12:15], a[28:31], v[48:51]
ds_read_b64_tr_b16 a[122:123], v15 offset:16384
global_load_dword a250, v[24:25], off
v_mfma_f32_16x16x32_bf16 v[52:55], a[12:15], a[36:39], v[52:55]
ds_read_b64_tr_b16 a[124:125], v15 offset:26624
v_mfma_f32_16x16x32_bf16 v[52:55], a[8:11], a[32:35], v[52:55]
ds_read_b64_tr_b16 a[126:127], v15 offset:36864
v_mfma_f32_16x16x32_bf16 v[56:59], a[8:11], a[40:43], v[56:59]
buffer_load_dwordx4 v8, s[4:7], s22 offen offset:2048 lds
v_mfma_f32_16x16x32_bf16 v[56:59], a[12:15], a[44:47], v[56:59]
v_mfma_f32_16x16x32_bf16 v[60:63], a[12:15], a[52:55], v[60:63]
v_mfma_f32_16x16x32_bf16 v[60:63], a[8:11], a[48:51], v[60:63]
buffer_load_dwordx4 v9, s[4:7], s22 offen offset:3072 lds
s_waitcnt lgkmcnt(4)
v_mfma_f32_16x16x32_bf16 v[64:67], a[16:19], a[24:27], v[64:67]
ds_read_b64_tr_b16 a[128:129], v14 offset:8192
v_mfma_f32_16x16x32_bf16 v[64:67], a[20:23], a[28:31], v[64:67]
ds_read_b64_tr_b16 a[130:131], v14 offset:18432
v_mfma_f32_16x16x32_bf16 v[68:71], a[20:23], a[36:39], v[68:71]
ds_read_b64_tr_b16 a[132:133], v14 offset:28672
v_mfma_f32_16x16x32_bf16 v[68:71], a[16:19], a[32:35], v[68:71]
ds_read_b64_tr_b16 a[134:135], v14 offset:38912
s_add_u32 m0, s23, 8192
v_mfma_f32_16x16x32_bf16 v[72:75], a[16:19], a[40:43], v[72:75]
buffer_load_dwordx4 v10, s[4:7], s22 offen offset:0 lds
v_mfma_f32_16x16x32_bf16 v[72:75], a[20:23], a[44:47], v[72:75]
v_mfma_f32_16x16x32_bf16 v[76:79], a[20:23], a[52:55], v[76:79]
s_add_u32 s23, s44, s45
s_add_u32 s44, s44, s43
v_mfma_f32_16x16x32_bf16 v[76:79], a[16:19], a[48:51], v[76:79]
buffer_load_dwordx4 v11, s[4:7], s22 offen offset:1024 lds
s_waitcnt lgkmcnt(4)
v_mfma_f32_16x16x32_bf16 v[80:83], a[120:123], a[24:27], v[80:83]
ds_read_b64_tr_b16 a[136:137], v15 offset:8192
v_mfma_f32_16x16x32_bf16 v[80:83], a[124:127], a[28:31], v[80:83]
ds_read_b64_tr_b16 a[138:139], v15 offset:18432
v_mfma_f32_16x16x32_bf16 v[84:87], a[124:127], a[36:39], v[84:87]
ds_read_b64_tr_b16 a[140:141], v15 offset:28672
v_mfma_f32_16x16x32_bf16 v[84:87], a[120:123], a[32:35], v[84:87]
ds_read_b64_tr_b16 a[142:143], v15 offset:38912
v_mfma_f32_16x16x32_bf16 v[88:91], a[120:123], a[40:43], v[88:91]
v_add_u32 v12, s43, v12
v_mfma_f32_16x16x32_bf16 v[88:91], a[124:127], a[44:47], v[88:91]
v_add_u32 v13, s43, v13
v_mfma_f32_16x16x32_bf16 v[92:95], a[124:127], a[52:55], v[92:95]
v_add_u32 v14, s43, v14
v_mfma_f32_16x16x32_bf16 v[92:95], a[120:123], a[48:51], v[92:95]
v_add_u32 v15, s43, v15
s_waitcnt vmcnt(13) lgkmcnt(0)
s_barrier
v_mfma_f32_16x16x32_bf16 v[96:99], a[24:27], a[128:131], v[96:99]
ds_read_b64_tr_b16 a[0:1], v14 offset:4096
v_mfma_f32_16x16x32_bf16 v[96:99], a[28:31], a[132:135], v[96:99]
ds_read_b64_tr_b16 a[2:3], v14 offset:14336
s_add_u32 s21, s21, 128
v_mfma_f32_16x16x32_bf16 v[100:103], a[36:39], a[132:135], v[100:103]
ds_read_b128 a[56:59], v12 offset:0
s_and_b32 s21, s21, 0x7ff
v_mfma_f32_16x16x32_bf16 v[100:103], a[32:35], a[128:131], v[100:103]
ds_read_b64_tr_b16 a[4:5], v14 offset:24576
s_mov_b32 m0, s23
v_mfma_f32_16x16x32_bf16 v[104:107], a[40:43], a[128:131], v[104:107]
ds_read_b64_tr_b16 a[6:7], v14 offset:34816
buffer_load_dwordx4 v2, s[8:11], s21 offen offset:0 lds
v_mfma_f32_16x16x32_bf16 v[104:107], a[44:47], a[132:135], v[104:107]
ds_read_b128 a[60:63], v13 offset:0
v_mfma_f32_16x16x32_bf16 v[108:111], a[52:55], a[132:135], v[108:111]
ds_read_b128 a[68:71], v13 offset:2048
buffer_load_dwordx4 v3, s[8:11], s21 offen offset:1024 lds
v_mfma_f32_16x16x32_bf16 v[108:111], a[48:51], a[128:131], v[108:111]
ds_read_b128 a[64:67], v12 offset:2048
v_mfma_f32_16x16x32_bf16 v[112:115], a[24:27], a[136:139], v[112:115]
ds_read_b128 a[72:75], v12 offset:10240
v_mfma_f32_16x16x32_bf16 v[112:115], a[28:31], a[140:143], v[112:115]
ds_read_b128 a[76:79], v13 offset:10240
v_mfma_f32_16x16x32_bf16 v[116:119], a[36:39], a[140:143], v[116:119]
ds_read_b128 a[84:87], v13 offset:12288
buffer_load_dwordx4 v4, s[8:11], s21 offen offset:2048 lds
v_mfma_f32_16x16x32_bf16 v[116:119], a[32:35], a[136:139], v[116:119]
ds_read_b128 a[80:83], v12 offset:12288
v_mfma_f32_16x16x32_bf16 v[120:123], a[40:43], a[136:139], v[120:123]
ds_read_b64_tr_b16 a[8:9], v15 offset:4096
v_mfma_f32_16x16x32_bf16 v[120:123], a[44:47], a[140:143], v[120:123]
ds_read_b64_tr_b16 a[10:11], v15 offset:14336
v_mfma_f32_16x16x32_bf16 v[124:127], a[52:55], a[140:143], v[124:127]
ds_read_b64_tr_b16 a[12:13], v15 offset:24576
buffer_load_dwordx4 v5, s[8:11], s21 offen offset:3072 lds
v_mfma_f32_16x16x32_bf16 v[124:127], a[48:51], a[136:139], v[124:127]
ds_read_b64_tr_b16 a[14:15], v15 offset:34816
s_waitcnt lgkmcnt(10)
v_mfma_f32_16x16x32_bf16 v[32:35], a[0:3], a[56:59], v[32:35]
ds_read_b64_tr_b16 a[16:17], v14 offset:6144
v_mfma_f32_16x16x32_bf16 v[32:35], a[4:7], a[60:63], v[32:35]
ds_read_b64_tr_b16 a[18:19], v14 offset:16384
s_waitcnt lgkmcnt(6)
v_mfma_f32_16x16x32_bf16 v[36:39], a[4:7], a[68:71], v[36:39]
ds_read_b64_tr_b16 a[20:21], v14 offset:26624
s_mul_i32 s22, s21, 3072
v_mfma_f32_16x16x32_bf16 v[36:39], a[0:3], a[64:67], v[36:39]
ds_read_b64_tr_b16 a[22:23], v14 offset:36864
s_add_u32 m0, s23, 4096
v_mfma_f32_16x16x32_bf16 v[40:43], a[0:3], a[72:75], v[40:43]
buffer_load_dwordx4 v6, s[4:7], s22 offen offset:0 lds
v_mfma_f32_16x16x32_bf16 v[40:43], a[4:7], a[76:79], v[40:43]
s_cmp_eq_u32 s44, 81920
s_cselect_b32 s43, s42, s41
s_waitcnt vmcnt(11)
v_min_u32 v20, v20, v18
v_cmp_gt_u32 vcc, 1, v20
s_nop 0
s_cbranch_vccnz L_spin0
L_rdy0:
v_mfma_f32_16x16x32_bf16 v[44:47], a[4:7], a[84:87], v[44:47]
buffer_load_dwordx2 v[172:173], v22, s[16:19], s55 offen sc1
v_mfma_f32_16x16x32_bf16 v[44:47], a[0:3], a[80:83], v[44:47]
buffer_load_dwordx4 v7, s[4:7], s22 offen offset:1024 lds
L_pg2:
s_cbranch_execz L_vret
s_waitcnt lgkmcnt(4)
v_mfma_f32_16x16x32_bf16 v[48:51], a[8:11], a[56:59], v[48:51]
ds_read_b64_tr_b16 a[120:121], v15 offset:6144
v_mfma_f32_16x16x32_bf16 v[48:51], a[12:15], a[60:63], v[48:51]
ds_read_b64_tr_b16 a[122:123], v15 offset:16384
v_add_u32_dpp v18, v18, v18 quad_perm:[1,0,3,2] row_mask:0xf bank_mask:0xf
v_mfma_f32_16x16x32_bf16 v[52:55], a[12:15], a[68:71], v[52:55]
ds_read_b64_tr_b16 a[124:125], v15 offset:26624
buffer_load_dwordx4 v[156:159], v30, s[16:19], s53 offen offset:0 sc1
v_mfma_f32_16x16x32_bf16 v[52:55], a[8:11], a[64:67], v[52:55]
ds_read_b64_tr_b16 a[126:127], v15 offset:36864
v_add_u32_dpp v18, v18, v18 quad_perm:[2,3,0,1] row_mask:0xf bank_mask:0xf
v_mfma_f32_16x16x32_bf16 v[56:59], a[8:11], a[72:75], v[56:59]
buffer_load_dwordx4 v8, s[4:7], s22 offen offset:2048 lds
v_add_u32_dpp v18, v18, v18 row_half_mirror row_mask:0xf bank_mask:0xf
v_mfma_f32_16x16x32_bf16 v[56:59], a[12:15], a[76:79], v[56:59]
v_mfma_f32_16x16x32_bf16 v[60:63], a[12:15], a[84:87], v[60:63]
v_add_u32_dpp v18, v18, v18 row_mirror row_mask:0xf bank_mask:0xf
v_mfma_f32_16x16x32_bf16 v[60:63], a[8:11], a[80:83], v[60:63]
buffer_load_dwordx4 v9, s[4:7], s22 offen offset:3072 lds
s_waitcnt lgkmcnt(4)
v_mfma_f32_16x16x32_bf16 v[64:67], a[16:19], a[56:59], v[64:67]
ds_read_b64_tr_b16 a[128:129], v14 offset:8192
v_readfirstlane_b32 s30, v18
v_mfma_f32_16x16x32_bf16 v[64:67], a[20:23], a[60:63], v[64:67]
ds_read_b64_tr_b16 a[130:131], v14 offset:18432
buffer_load_dwordx4 v[160:163], v30, s[16:19], s53 offen offset:1024 sc1
v_mfma_f32_16x16x32_bf16 v[68:71], a[20:23], a[68:71], v[68:71]
ds_read_b64_tr_b16 a[132:133], v14 offset:28672
s_and_b32 s27, s2, 4
v_mfma_f32_16x16x32_bf16 v[68:71], a[16:19], a[64:67], v[68:71]
ds_read_b64_tr_b16 a[134:135], v14 offset:38912
s_add_u32 m0, s23, 8192
v_mfma_f32_16x16x32_bf16 v[72:75], a[16:19], a[72:75], v[72:75]
buffer_load_dwordx4 v10, s[4:7], s22 offen offset:0 lds
s_lshl_b32 s27, s27, 11
v_mfma_f32_16x16x32_bf16 v[72:75], a[20:23], a[76:79], v[72:75]
v_mfma_f32_16x16x32_bf16 v[76:79], a[20:23], a[84:87], v[76:79]
s_add_u32 s23, s44, s45
s_add_u32 s44, s44, s43
s_cmp_gt_u32 s30, 1024
s_cselect_b32 s30, 8192, 0
v_mfma_f32_16x16x32_bf16 v[76:79], a[16:19], a[80:83], v[76:79]
buffer_load_dwordx4 v11, s[4:7], s22 offen offset:1024 lds
s_waitcnt lgkmcnt(4)
v_mfma_f32_16x16x32_bf16 v[80:83], a[120:123], a[56:59], v[80:83]
ds_read_b64_tr_b16 a[136:137], v15 offset:8192
s_xor_b32 s30, s30, s27
v_mfma_f32_16x16x32_bf16 v[80:83], a[124:127], a[60:63], v[80:83]
ds_read_b64_tr_b16 a[138:139], v15 offset:18432
s_and_b32 s31, s25, 8
v_mfma_f32_16x16x32_bf16 v[84:87], a[124:127], a[68:71], v[84:87]
ds_read_b64_tr_b16 a[140:141], v15 offset:28672
buffer_load_dwordx4 v[164:167], v30, s[16:19], s53 offen offset:2048 sc1
v_mfma_f32_16x16x32_bf16 v[84:87], a[120:123], a[64:67], v[84:87]
ds_read_b64_tr_b16 a[142:143], v15 offset:38912
s_lshl_b32 s31, s31, 10
v_mfma_f32_16x16x32_bf16 v[88:91], a[120:123], a[72:75], v[88:91]
v_add_u32 v12, s43, v12
s_xor_b32 s31, s31, s30
v_mfma_f32_16x16x32_bf16 v[88:91], a[124:127], a[76:79], v[88:91]
v_add_u32 v13, s43, v13
s_lshr_b32 s3, s2, 3
v_mfma_f32_16x16x32_bf16 v[92:95], a[124:127], a[84:87], v[92:95]
v_add_u32 v14, s43, v14
buffer_load_dwordx4 v[168:171], v30, s[16:19], s53 offen offset:3072 sc1
v_mfma_f32_16x16x32_bf16 v[92:95], a[120:123], a[80:83], v[92:95]
v_add_u32 v15, s43, v15
s_waitcnt vmcnt(15) lgkmcnt(0)
s_barrier
v_mfma_f32_16x16x32_bf16 v[96:99], a[56:59], a[128:131], v[96:99]
ds_read_b64_tr_b16 a[0:1], v14 offset:4096
s_lshl_b32 s3, s3, 2
v_mfma_f32_16x16x32_bf16 v[96:99], a[60:63], a[132:135], v[96:99]
ds_read_b64_tr_b16 a[2:3], v14 offset:14336
s_and_b32 s27, s2, 3
v_mfma_f32_16x16x32_bf16 v[100:103], a[68:71], a[132:135], v[100:103]
ds_read_b128 a[24:27], v12 offset:0
s_add_u32 s3, s3, s27
v_mfma_f32_16x16x32_bf16 v[100:103], a[64:67], a[128:131], v[100:103]
ds_read_b64_tr_b16 a[4:5], v14 offset:24576
s_lshl_b32 s3, s3, 2
v_mfma_f32_16x16x32_bf16 v[104:107], a[72:75], a[128:131], v[104:107]
ds_read_b64_tr_b16 a[6:7], v14 offset:34816
buffer_load_dwordx4 a[88:91], v30, s[36:39], s95 offen offset:0
v_mfma_f32_16x16x32_bf16 v[104:107], a[76:79], a[132:135], v[104:107]
ds_read_b128 a[28:31], v13 offset:0
s_add_u32 s3, s3, s20
v_mfma_f32_16x16x32_bf16 v[108:111], a[84:87], a[132:135], v[108:111]
ds_read_b128 a[36:39], v13 offset:2048
s_lshl_b32 s3, s3, 10
v_mfma_f32_16x16x32_bf16 v[108:111], a[80:83], a[128:131], v[108:111]
ds_read_b128 a[32:35], v12 offset:2048
v_mfma_f32_16x16x32_bf16 v[112:115], a[56:59], a[136:139], v[112:115]
ds_read_b128 a[40:43], v12 offset:10240
buffer_load_dwordx4 a[92:95], v30, s[36:39], s95 offen offset:1024
v_mfma_f32_16x16x32_bf16 v[112:115], a[60:63], a[140:143], v[112:115]
ds_read_b128 a[44:47], v13 offset:10240
s_and_b32 s27, s3, 0xffffe000
v_mfma_f32_16x16x32_bf16 v[116:119], a[68:71], a[140:143], v[116:119]
ds_read_b128 a[52:55], v13 offset:12288
s_add_u32 s3, s3, s27
v_mfma_f32_16x16x32_bf16 v[116:119], a[64:67], a[136:139], v[116:119]
ds_read_b128 a[48:51], v12 offset:12288
s_lshr_b32 s27, s3, 8
v_mfma_f32_16x16x32_bf16 v[120:123], a[72:75], a[136:139], v[120:123]
ds_read_b64_tr_b16 a[8:9], v15 offset:4096
s_and_b32 s27, s27, 8192
v_mfma_f32_16x16x32_bf16 v[120:123], a[76:79], a[140:143], v[120:123]
ds_read_b64_tr_b16 a[10:11], v15 offset:14336
s_or_b32 s3, s3, s27
v_mfma_f32_16x16x32_bf16 v[124:127], a[84:87], a[140:143], v[124:127]
ds_read_b64_tr_b16 a[12:13], v15 offset:24576
s_xor_b32 s3, s3, s30
v_mfma_f32_16x16x32_bf16 v[124:127], a[80:83], a[136:139], v[124:127]
ds_read_b64_tr_b16 a[14:15], v15 offset:34816
s_waitcnt lgkmcnt(10)
v_mfma_f32_16x16x32_bf16 v[32:35], a[0:3], a[24:27], v[32:35]
ds_read_b64_tr_b16 a[16:17], v14 offset:6144
s_add_u32 s3, s3, 4194304
v_mfma_f32_16x16x32_bf16 v[32:35], a[4:7], a[28:31], v[32:35]
ds_read_b64_tr_b16 a[18:19], v14 offset:16384
s_lshl_b32 s27, s20, 9
s_waitcnt lgkmcnt(6)
v_mfma_f32_16x16x32_bf16 v[36:39], a[4:7], a[36:39], v[36:39]
ds_read_b64_tr_b16 a[20:21], v14 offset:26624
s_add_u32 s27, s27, 40960
v_mfma_f32_16x16x32_bf16 v[36:39], a[0:3], a[32:35], v[36:39]
ds_read_b64_tr_b16 a[22:23], v14 offset:36864
v_lshl_add_u32 v174, v0, 2, s27
v_mfma_f32_16x16x32_bf16 v[40:43], a[0:3], a[40:43], v[40:43]
v_and_b32 v175, 0xffffff3f, v174
v_and_b32 v176, 48, v0
v_mfma_f32_16x16x32_bf16 v[40:43], a[4:7], a[44:47], v[40:43]
s_cmp_eq_u32 s44, 81920
s_cselect_b32 s43, s42, s41
v_add_u32 v176, s27, v176
v_mfma_f32_16x16x32_bf16 v[44:47], a[4:7], a[52:55], v[44:47]
s_lshl_b32 s27, s20, 10
s_add_u32 s27, s27, 45056
v_mfma_f32_16x16x32_bf16 v[44:47], a[0:3], a[48:51], v[44:47]
v_add_u32 v177, s27, v30
s_waitcnt lgkmcnt(4)
v_mfma_f32_16x16x32_bf16 v[48:51], a[8:11], a[24:27], v[48:51]
ds_read_b64_tr_b16 a[120:121], v15 offset:6144
v_and_b32 v178, 0xfffffbff, v177
v_mfma_f32_16x16x32_bf16 v[48:51], a[12:15], a[28:31], v[48:51]
ds_read_b64_tr_b16 a[122:123], v15 offset:16384
v_mfma_f32_16x16x32_bf16 v[52:55], a[12:15], a[36:39], v[52:55]
ds_read_b64_tr_b16 a[124:125], v15 offset:26624
v_mfma_f32_16x16x32_bf16 v[52:55], a[8:11], a[32:35], v[52:55]
ds_read_b64_tr_b16 a[126:127], v15 offset:36864
v_mfma_f32_16x16x32_bf16 v[56:59], a[8:11], a[40:43], v[56:59]
v_mfma_f32_16x16x32_bf16 v[56:59], a[12:15], a[44:47], v[56:59]
v_mfma_f32_16x16x32_bf16 v[60:63], a[12:15], a[52:55], v[60:63]
s_waitcnt vmcnt(2)
ds_write2st64_b32 v174, v172, v173 offset0:0 offset1:1
v_mfma_f32_16x16x32_bf16 v[60:63], a[8:11], a[48:51], v[60:63]
v_add_f32 v156, v156, v160
s_waitcnt lgkmcnt(5)
v_mfma_f32_16x16x32_bf16 v[64:67], a[16:19], a[24:27], v[64:67]
ds_read_b64_tr_b16 a[128:129], v14 offset:8192
v_add_f32 v164, v164, v168
v_mfma_f32_16x16x32_bf16 v[64:67], a[20:23], a[28:31], v[64:67]
ds_read_b64_tr_b16 a[130:131], v14 offset:18432
v_add_f32 v156, v156, v164
v_mfma_f32_16x16x32_bf16 v[68:71], a[20:23], a[36:39], v[68:71]
ds_read_b64_tr_b16 a[132:133], v14 offset:28672
v_add_f32 v157, v157, v161
v_mfma_f32_16x16x32_bf16 v[68:71], a[16:19], a[32:35], v[68:71]
ds_read_b64_tr_b16 a[134:135], v14 offset:38912
v_add_f32 v165, v165, v169
v_mfma_f32_16x16x32_bf16 v[72:75], a[16:19], a[40:43], v[72:75]
v_add_f32 v157, v157, v165
v_add_f32 v158, v158, v162
v_mfma_f32_16x16x32_bf16 v[72:75], a[20:23], a[44:47], v[72:75]
v_add_f32 v166, v166, v170
v_add_f32 v158, v158, v166
v_mfma_f32_16x16x32_bf16 v[76:79], a[20:23], a[52:55], v[76:79]
s_add_u32 s23, s44, s45
s_add_u32 s44, s44, s43
ds_write_b128 v177, v[156:159]
v_mfma_f32_16x16x32_bf16 v[76:79], a[16:19], a[48:51], v[76:79]
s_waitcnt lgkmcnt(6)
v_mfma_f32_16x16x32_bf16 v[80:83], a[120:123], a[24:27], v[80:83]
ds_read_b64_tr_b16 a[136:137], v15 offset:8192
v_mfma_f32_16x16x32_bf16 v[80:83], a[124:127], a[28:31], v[80:83]
ds_read_b64_tr_b16 a[138:139], v15 offset:18432
v_mfma_f32_16x16x32_bf16 v[84:87], a[124:127], a[36:39], v[84:87]
ds_read_b64_tr_b16 a[140:141], v15 offset:28672
v_mfma_f32_16x16x32_bf16 v[84:87], a[120:123], a[32:35], v[84:87]
ds_read_b64_tr_b16 a[142:143], v15 offset:38912
v_mfma_f32_16x16x32_bf16 v[88:91], a[120:123], a[40:43], v[88:91]
v_add_u32 v12, s43, v12
v_mfma_f32_16x16x32_bf16 v[88:91], a[124:127], a[44:47], v[88:91]
v_add_u32 v13, s43, v13
v_mfma_f32_16x16x32_bf16 v[92:95], a[124:127], a[52:55], v[92:95]
v_add_u32 v14, s43, v14
v_mfma_f32_16x16x32_bf16 v[92:95], a[120:123], a[48:51], v[92:95]
v_add_u32 v15, s43, v15
s_waitcnt lgkmcnt(0)
s_barrier
v_mfma_f32_16x16x32_bf16 v[96:99], a[24:27], a[128:131], v[96:99]
ds_read_b64_tr_b16 a[0:1], v14 offset:4096
v_accvgpr_read_b32 v10, a100
v_mfma_f32_16x16x32_bf16 v[96:99], a[28:31], a[132:135], v[96:99]
ds_read_b64_tr_b16 a[2:3], v14 offset:14336
v_accvgpr_read_b32 v11, a101
v_mfma_f32_16x16x32_bf16 v[100:103], a[36:39], a[132:135], v[100:103]
ds_read_b128 a[56:59], v12 offset:0
v_accvgpr_read_b32 v16, a102
v_mfma_f32_16x16x32_bf16 v[100:103], a[32:35], a[128:131], v[100:103]
ds_read_b64_tr_b16 a[4:5], v14 offset:24576
v_accvgpr_read_b32 v17, a103
v_mfma_f32_16x16x32_bf16 v[104:107], a[40:43], a[128:131], v[104:107]
ds_read_b64_tr_b16 a[6:7], v14 offset:34816
v_accvgpr_read_b32 v21, a104
v_mfma_f32_16x16x32_bf16 v[104:107], a[44:47], a[132:135], v[104:107]
ds_read_b128 a[60:63], v13 offset:0
v_accvgpr_read_b32 v24, a105
v_mfma_f32_16x16x32_bf16 v[108:111], a[52:55], a[132:135], v[108:111]
ds_read_b128 a[68:71], v13 offset:2048
v_accvgpr_read_b32 v25, a106
v_mfma_f32_16x16x32_bf16 v[108:111], a[48:51], a[128:131], v[108:111]
ds_read_b128 a[64:67], v12 offset:2048
v_mfma_f32_16x16x32_bf16 v[112:115], a[24:27], a[136:139], v[112:115]
ds_read_b128 a[72:75], v12 offset:10240
v_accvgpr_read_b32 v28, a107
v_mfma_f32_16x16x32_bf16 v[112:115], a[28:31], a[140:143], v[112:115]
ds_read_b128 a[76:79], v13 offset:10240
v_accvgpr_read_b32 v31, a108
v_mfma_f32_16x16x32_bf16 v[116:119], a[36:39], a[140:143], v[116:119]
ds_read_b128 a[84:87], v13 offset:12288
v_accvgpr_read_b32 v22, a111
v_mfma_f32_16x16x32_bf16 v[116:119], a[32:35], a[136:139], v[116:119]
ds_read_b128 a[80:83], v12 offset:12288
v_mfma_f32_16x16x32_bf16 v[120:123], a[40:43], a[136:139], v[120:123]
ds_read_b64_tr_b16 a[8:9], v15 offset:4096
s_add_u32 s85, s83, 1572864
v_mfma_f32_16x16x32_bf16 v[120:123], a[44:47], a[140:143], v[120:123]
ds_read_b64_tr_b16 a[10:11], v15 offset:14336
s_add_u32 m0, s84, 131072
v_mfma_f32_16x16x32_bf16 v[124:127], a[52:55], a[140:143], v[124:127]
ds_read_b64_tr_b16 a[12:13], v15 offset:24576
buffer_load_dwordx4 v252, s[36:39], s85 offen offset:0 lds
v_mfma_f32_16x16x32_bf16 v[124:127], a[48:51], a[136:139], v[124:127]
ds_read_b64_tr_b16 a[14:15], v15 offset:34816
s_waitcnt lgkmcnt(10)
v_mfma_f32_16x16x32_bf16 v[32:35], a[0:3], a[56:59], v[32:35]
ds_read_b64_tr_b16 a[16:17], v14 offset:6144
buffer_load_dwordx4 v253, s[36:39], s85 offen offset:1024 lds
v_mfma_f32_16x16x32_bf16 v[32:35], a[4:7], a[60:63], v[32:35]
ds_read_b64_tr_b16 a[18:19], v14 offset:16384
s_waitcnt lgkmcnt(6)
v_mfma_f32_16x16x32_bf16 v[36:39], a[4:7], a[68:71], v[36:39]
ds_read_b64_tr_b16 a[20:21], v14 offset:26624
v_mfma_f32_16x16x32_bf16 v[36:39], a[0:3], a[64:67], v[36:39]
ds_read_b64_tr_b16 a[22:23], v14 offset:36864
v_mfma_f32_16x16x32_bf16 v[40:43], a[0:3], a[72:75], v[40:43]
buffer_load_dwordx4 v254, s[36:39], s85 offen offset:2048 lds
ds_read_b128 v[156:159], v178 offset:0
v_mfma_f32_16x16x32_bf16 v[40:43], a[4:7], a[76:79], v[40:43]
ds_read_b128 v[160:163], v178 offset:1024
ds_read2_b32 v[2:3], v175 offset0:0 offset1:64
v_mfma_f32_16x16x32_bf16 v[44:47], a[4:7], a[84:87], v[44:47]
ds_read2_b32 v[4:5], v175 offset0:16 offset1:80
ds_read2_b32 v[6:7], v175 offset0:32 offset1:96
v_mfma_f32_16x16x32_bf16 v[44:47], a[0:3], a[80:83], v[44:47]
ds_read2_b32 v[8:9], v175 offset0:48 offset1:112
s_waitcnt lgkmcnt(10)
v_mfma_f32_16x16x32_bf16 v[48:51], a[8:11], a[56:59], v[48:51]
ds_read_b64_tr_b16 a[120:121], v15 offset:6144
buffer_load_dwordx4 v255, s[36:39], s85 offen offset:3072 lds
v_mfma_f32_16x16x32_bf16 v[48:51], a[12:15], a[60:63], v[48:51]
ds_read_b64_tr_b16 a[122:123], v15 offset:16384
ds_read_b128 v[196:199], v176 offset:0
v_mfma_f32_16x16x32_bf16 v[52:55], a[12:15], a[68:71], v[52:55]
ds_read_b64_tr_b16 a[124:125], v15 offset:26624
ds_read_b128 v[200:203], v176 offset:256
v_mfma_f32_16x16x32_bf16 v[52:55], a[8:11], a[64:67], v[52:55]
ds_read_b64_tr_b16 a[126:127], v15 offset:36864
ds_read_b128 v[204:207], v176 offset:64
v_mfma_f32_16x16x32_bf16 v[56:59], a[8:11], a[72:75], v[56:59]
s_add_u32 s85, s83, 1835008
ds_read_b128 v[208:211], v176 offset:320
v_mfma_f32_16x16x32_bf16 v[56:59], a[12:15], a[76:79], v[56:59]
s_add_u32 m0, s84, 147456
ds_read_b128 v[212:215], v176 offset:128
v_mfma_f32_16x16x32_bf16 v[60:63], a[12:15], a[84:87], v[60:63]
buffer_load_dwordx4 v252, s[36:39], s85 offen offset:0 lds
ds_read_b128 v[216:219], v176 offset:384
v_mfma_f32_16x16x32_bf16 v[60:63], a[8:11], a[80:83], v[60:63]
ds_read_b128 v[220:223], v176 offset:192
s_waitcnt lgkmcnt(15)
v_mfma_f32_16x16x32_bf16 v[64:67], a[16:19], a[56:59], v[64:67]
ds_read_b64_tr_b16 a[128:129], v14 offset:8192
buffer_load_dwordx4 v253, s[36:39], s85 offen offset:1024 lds
v_mfma_f32_16x16x32_bf16 v[64:67], a[20:23], a[60:63], v[64:67]
ds_read_b64_tr_b16 a[130:131], v14 offset:18432
ds_read_b128 v[224:227], v176 offset:448
v_mfma_f32_16x16x32_bf16 v[68:71], a[20:23], a[68:71], v[68:71]
ds_read_b64_tr_b16 a[132:133], v14 offset:28672
v_mfma_f32_16x16x32_bf16 v[68:71], a[16:19], a[64:67], v[68:71]
ds_read_b64_tr_b16 a[134:135], v14 offset:38912
v_mfma_f32_16x16x4_f32 v[228:231], v157, v29, 0
v_mfma_f32_16x16x32_bf16 v[72:75], a[16:19], a[72:75], v[72:75]
buffer_load_dwordx4 v254, s[36:39], s85 offen offset:2048 lds
v_mfma_f32_16x16x4_f32 v[232:235], v161, v29, 0
v_mfma_f32_16x16x32_bf16 v[72:75], a[20:23], a[76:79], v[72:75]
v_mov_b32 v236, v158
v_mov_b32 v240, v162
v_mfma_f32_16x16x32_bf16 v[76:79], a[20:23], a[84:87], v[76:79]
v_mov_b32 v18, v156
v_mov_b32 v19, v160
v_mfma_f32_16x16x32_bf16 v[76:79], a[16:19], a[80:83], v[76:79]
s_waitcnt lgkmcnt(10)
v_mfma_f32_16x16x32_bf16 v[80:83], a[120:123], a[56:59], v[80:83]
ds_read_b64_tr_b16 a[136:137], v15 offset:8192
buffer_load_dwordx4 v255, s[36:39], s85 offen offset:3072 lds
v_mfma_f32_16x16x32_bf16 v[80:83], a[124:127], a[60:63], v[80:83]
ds_read_b64_tr_b16 a[138:139], v15 offset:18432
v_mfma_f32_16x16x32_bf16 v[84:87], a[124:127], a[68:71], v[84:87]
ds_read_b64_tr_b16 a[140:141], v15 offset:28672
v_mfma_f32_16x16x32_bf16 v[84:87], a[120:123], a[64:67], v[84:87]
ds_read_b64_tr_b16 a[142:143], v15 offset:38912
v_mfma_f32_16x16x32_bf16 v[88:91], a[120:123], a[72:75], v[88:91]
s_add_u32 s85, s83, 262144
v_mfma_f32_16x16x32_bf16 v[88:91], a[124:127], a[76:79], v[88:91]
s_add_u32 m0, s84, 49152
v_mfma_f32_16x16x32_bf16 v[92:95], a[124:127], a[84:87], v[92:95]
buffer_load_dwordx4 v252, s[36:39], s85 offen offset:0 lds
v_mfma_f32_16x16x32_bf16 v[92:95], a[120:123], a[80:83], v[92:95]
s_waitcnt lgkmcnt(4)
v_mfma_f32_16x16x32_bf16 v[96:99], a[56:59], a[128:131], v[96:99]
buffer_load_dwordx4 v253, s[36:39], s85 offen offset:1024 lds
v_mfma_f32_16x16x32_bf16 v[96:99], a[60:63], a[132:135], v[96:99]
v_permlane16_swap_b32 v236, v240
v_mfma_f32_16x16x32_bf16 v[100:103], a[68:71], a[132:135], v[100:103]
v_add_f32 v237, v236, v240
v_add_f32 v241, v236, v240
v_mfma_f32_16x16x32_bf16 v[100:103], a[64:67], a[128:131], v[100:103]
v_accvgpr_read_b32 v12, a109
v_accvgpr_read_b32 v13, a110
v_mfma_f32_16x16x32_bf16 v[104:107], a[72:75], a[128:131], v[104:107]
buffer_load_dwordx4 v254, s[36:39], s85 offen offset:2048 lds
v_mfma_f32_16x16x32_bf16 v[104:107], a[76:79], a[132:135], v[104:107]
v_permlane32_swap_b32 v237, v241
v_mfma_f32_16x16x32_bf16 v[108:111], a[84:87], a[132:135], v[108:111]
v_add_f32 v236, v237, v241
v_add_f32 v240, v237, v241
v_mfma_f32_16x16x32_bf16 v[108:111], a[80:83], a[128:131], v[108:111]
s_waitcnt lgkmcnt(0)
v_mfma_f32_16x16x32_bf16 v[112:115], a[56:59], a[136:139], v[112:115]
buffer_load_dwordx4 v255, s[36:39], s85 offen offset:3072 lds
v_mul_f32 v3, 0x3fb8aa3b, v3
v_mfma_f32_16x16x32_bf16 v[112:115], a[60:63], a[140:143], v[112:115]
v_mul_f32 v5, 0x3fb8aa3b, v5
v_mul_f32 v7, 0x3fb8aa3b, v7
v_mfma_f32_16x16x32_bf16 v[116:119], a[68:71], a[140:143], v[116:119]
v_mul_f32 v9, 0x3fb8aa3b, v9
v_mfma_f32_16x16x32_bf16 v[116:119], a[64:67], a[136:139], v[116:119]
v_permlane16_swap_b32 v236, v240
v_mfma_f32_16x16x32_bf16 v[120:123], a[72:75], a[136:139], v[120:123]
v_accvgpr_read_b32 v14, a112
v_accvgpr_read_b32 v15, a113
v_mfma_f32_16x16x32_bf16 v[120:123], a[76:79], a[140:143], v[120:123]
v_mfma_f32_16x16x32_bf16 v[124:127], a[84:87], a[140:143], v[124:127]
buffer_load_dword a251, v23, s[56:59], s60 offen
v_mfma_f32_16x16x32_bf16 v[124:127], a[80:83], a[136:139], v[124:127]
L_tail1:
s_nop 0
buffer_store_dwordx4 a[96:99], v30, s[16:19], s3 offen sc1
v_pk_fma_f32 v[64:65], v[2:3], v[228:229], v[64:65] op_sel_hi:[0,1,1] neg_lo:[1,0,0] neg_hi:[1,0,0]
v_pk_fma_f32 v[66:67], v[2:3], v[230:231], v[66:67] op_sel_hi:[0,1,1] neg_lo:[1,0,0] neg_hi:[1,0,0]
v_pk_fma_f32 v[80:81], v[2:3], v[232:233], v[80:81] op_sel_hi:[0,1,1] neg_lo:[1,0,0] neg_hi:[1,0,0]
v_pk_fma_f32 v[82:83], v[2:3], v[234:235], v[82:83] op_sel_hi:[0,1,1] neg_lo:[1,0,0] neg_hi:[1,0,0]
v_cvt_pk_bf16_f32 v140, v64, v65
v_cvt_pk_bf16_f32 v141, v66, v67
v_cvt_pk_bf16_f32 v142, v80, v81
v_cvt_pk_bf16_f32 v143, v82, v83
v_pk_fma_f32 v[68:69], v[4:5], v[228:229], v[68:69] op_sel_hi:[0,1,1] neg_lo:[1,0,0] neg_hi:[1,0,0]
v_pk_fma_f32 v[70:71], v[4:5], v[230:231], v[70:71] op_sel_hi:[0,1,1] neg_lo:[1,0,0] neg_hi:[1,0,0]
v_mfma_f32_16x16x32_bf16 v[156:159], v[128:131], v[140:143], 0
v_pk_fma_f32 v[84:85], v[4:5], v[232:233], v[84:85] op_sel_hi:[0,1,1] neg_lo:[1,0,0] neg_hi:[1,0,0]
v_pk_fma_f32 v[86:87], v[4:5], v[234:235], v[86:87] op_sel_hi:[0,1,1] neg_lo:[1,0,0] neg_hi:[1,0,0]
v_mfma_f32_16x16x32_bf16 v[160:163], v[132:135], v[140:143], 0
v_cvt_pk_bf16_f32 v144, v68, v69
v_cvt_pk_bf16_f32 v145, v70, v71
v_cvt_pk_bf16_f32 v146, v84, v85
v_cvt_pk_bf16_f32 v147, v86, v87
v_pk_fma_f32 v[72:73], v[6:7], v[228:229], v[72:73] op_sel_hi:[0,1,1] neg_lo:[1,0,0] neg_hi:[1,0,0]
v_pk_fma_f32 v[74:75], v[6:7], v[230:231], v[74:75] op_sel_hi:[0,1,1] neg_lo:[1,0,0] neg_hi:[1,0,0]
v_mfma_f32_16x16x32_bf16 v[164:167], v[128:131], v[144:147], 0
v_pk_fma_f32 v[88:89], v[6:7], v[232:233], v[88:89] op_sel_hi:[0,1,1] neg_lo:[1,0,0] neg_hi:[1,0,0]
v_pk_fma_f32 v[90:91], v[6:7], v[234:235], v[90:91] op_sel_hi:[0,1,1] neg_lo:[1,0,0] neg_hi:[1,0,0]
v_mfma_f32_16x16x32_bf16 v[168:171], v[132:135], v[144:147], 0
v_cvt_pk_bf16_f32 v148, v72, v73
v_cvt_pk_bf16_f32 v149, v74, v75
v_cvt_pk_bf16_f32 v150, v88, v89
v_cvt_pk_bf16_f32 v151, v90, v91
v_pk_fma_f32 v[76:77], v[8:9], v[228:229], v[76:77] op_sel_hi:[0,1,1] neg_lo:[1,0,0] neg_hi:[1,0,0]
v_pk_fma_f32 v[78:79], v[8:9], v[230:231], v[78:79] op_sel_hi:[0,1,1] neg_lo:[1,0,0] neg_hi:[1,0,0]
v_mfma_f32_16x16x32_bf16 v[172:175], v[128:131], v[148:151], 0
v_pk_fma_f32 v[92:93], v[8:9], v[232:233], v[92:93] op_sel_hi:[0,1,1] neg_lo:[1,0,0] neg_hi:[1,0,0]
v_pk_fma_f32 v[94:95], v[8:9], v[234:235], v[94:95] op_sel_hi:[0,1,1] neg_lo:[1,0,0] neg_hi:[1,0,0]
v_mfma_f32_16x16x32_bf16 v[176:179], v[132:135], v[148:151], 0
v_cvt_pk_bf16_f32 v152, v76, v77
v_cvt_pk_bf16_f32 v153, v78, v79
v_cvt_pk_bf16_f32 v154, v92, v93
v_cvt_pk_bf16_f32 v155, v94, v95
s_nop 1
v_mfma_f32_16x16x32_bf16 v[180:183], v[128:131], v[152:155], 0
s_add_u32 s3, s3, 1048576
buffer_store_dwordx4 a[96:99], v30, s[16:19], s3 offen sc1
v_mfma_f32_16x16x32_bf16 v[184:187], v[132:135], v[152:155], 0
v_pk_fma_f32 v[96:97], v[196:197], v[236:237], v[96:97] op_sel_hi:[1,0,1] neg_lo:[1,0,0] neg_hi:[1,0,0]
v_pk_mul_f32 v[96:97], v[96:97], v[200:201]
v_pk_fma_f32 v[98:99], v[198:199], v[236:237], v[98:99] op_sel_hi:[1,0,1] neg_lo:[1,0,0] neg_hi:[1,0,0]
v_pk_mul_f32 v[98:99], v[98:99], v[202:203]
v_pk_fma_f32 v[100:101], v[204:205], v[236:237], v[100:101] op_sel_hi:[1,0,1] neg_lo:[1,0,0] neg_hi:[1,0,0]
v_pk_mul_f32 v[100:101], v[100:101], v[208:209]
v_pk_fma_f32 v[102:103], v[206:207], v[236:237], v[102:103] op_sel_hi:[1,0,1] neg_lo:[1,0,0] neg_hi:[1,0,0]
v_pk_mul_f32 v[102:103], v[102:103], v[210:211]
v_pk_fma_f32 v[104:105], v[212:213], v[236:237], v[104:105] op_sel_hi:[1,0,1] neg_lo:[1,0,0] neg_hi:[1,0,0]
v_pk_mul_f32 v[104:105], v[104:105], v[216:217]
v_pk_fma_f32 v[106:107], v[214:215], v[236:237], v[106:107] op_sel_hi:[1,0,1] neg_lo:[1,0,0] neg_hi:[1,0,0]
v_pk_mul_f32 v[106:107], v[106:107], v[218:219]
v_pk_fma_f32 v[108:109], v[220:221], v[236:237], v[108:109] op_sel_hi:[1,0,1] neg_lo:[1,0,0] neg_hi:[1,0,0]
v_pk_mul_f32 v[108:109], v[108:109], v[224:225]
v_pk_fma_f32 v[110:111], v[222:223], v[236:237], v[110:111] op_sel_hi:[1,0,1] neg_lo:[1,0,0] neg_hi:[1,0,0]
v_pk_mul_f32 v[110:111], v[110:111], v[226:227]
v_cvt_pk_bf16_f32 v96, v96, v97
v_cvt_pk_bf16_f32 v97, v98, v99
v_cvt_pk_bf16_f32 v98, v100, v101
v_cvt_pk_bf16_f32 v99, v102, v103
v_cvt_pk_bf16_f32 v100, v104, v105
v_cvt_pk_bf16_f32 v101, v106, v107
v_cvt_pk_bf16_f32 v102, v108, v109
v_cvt_pk_bf16_f32 v103, v110, v111
s_barrier
ds_write_b128 v24, v[96:99] offset:0
ds_write_b128 v24, v[100:103] offset:1024
v_pk_fma_f32 v[112:113], v[196:197], v[240:241], v[112:113] op_sel_hi:[1,0,1] neg_lo:[1,0,0] neg_hi:[1,0,0]
v_pk_mul_f32 v[112:113], v[112:113], v[200:201]
v_pk_fma_f32 v[114:115], v[198:199], v[240:241], v[114:115] op_sel_hi:[1,0,1] neg_lo:[1,0,0] neg_hi:[1,0,0]
v_pk_mul_f32 v[114:115], v[114:115], v[202:203]
v_pk_fma_f32 v[116:117], v[204:205], v[240:241], v[116:117] op_sel_hi:[1,0,1] neg_lo:[1,0,0] neg_hi:[1,0,0]
v_pk_mul_f32 v[116:117], v[116:117], v[208:209]
v_pk_fma_f32 v[118:119], v[206:207], v[240:241], v[118:119] op_sel_hi:[1,0,1] neg_lo:[1,0,0] neg_hi:[1,0,0]
v_pk_mul_f32 v[118:119], v[118:119], v[210:211]
v_pk_fma_f32 v[120:121], v[212:213], v[240:241], v[120:121] op_sel_hi:[1,0,1] neg_lo:[1,0,0] neg_hi:[1,0,0]
v_pk_mul_f32 v[120:121], v[120:121], v[216:217]
v_pk_fma_f32 v[122:123], v[214:215], v[240:241], v[122:123] op_sel_hi:[1,0,1] neg_lo:[1,0,0] neg_hi:[1,0,0]
v_pk_mul_f32 v[122:123], v[122:123], v[218:219]
s_add_u32 s3, s3, 1048576
s_xor_b32 s3, s3, 8192
buffer_store_dwordx4 a[96:99], v30, s[16:19], s3 offen sc1
v_pk_fma_f32 v[124:125], v[220:221], v[240:241], v[124:125] op_sel_hi:[1,0,1] neg_lo:[1,0,0] neg_hi:[1,0,0]
v_pk_mul_f32 v[124:125], v[124:125], v[224:225]
v_pk_fma_f32 v[126:127], v[222:223], v[240:241], v[126:127] op_sel_hi:[1,0,1] neg_lo:[1,0,0] neg_hi:[1,0,0]
v_pk_mul_f32 v[126:127], v[126:127], v[226:227]
v_cvt_pk_bf16_f32 v104, v112, v113
v_cvt_pk_bf16_f32 v105, v114, v115
v_cvt_pk_bf16_f32 v106, v116, v117
v_cvt_pk_bf16_f32 v107, v118, v119
v_cvt_pk_bf16_f32 v108, v120, v121
v_cvt_pk_bf16_f32 v109, v122, v123
v_cvt_pk_bf16_f32 v110, v124, v125
v_cvt_pk_bf16_f32 v111, v126, v127
ds_write_b128 v24, v[104:107] offset:2048
ds_write_b128 v24, v[108:111] offset:3072
v_max3_f32 v188, v156, v157, v158
v_max3_f32 v188, v188, v159, v160
v_max3_f32 v188, v188, v161, v162
v_max_f32 v188, v188, v163
v_min3_f32 v192, v156, v157, v158
v_min3_f32 v192, v192, v159, v160
v_min3_f32 v192, v192, v161, v162
v_min_f32 v192, v192, v163
v_max3_f32 v189, v164, v165, v166
v_max3_f32 v189, v189, v167, v168
v_max3_f32 v189, v189, v169, v170
v_max_f32 v189, v189, v171
v_min3_f32 v193, v164, v165, v166
v_min3_f32 v193, v193, v167, v168
v_min3_f32 v193, v193, v169, v170
v_min_f32 v193, v193, v171
v_max3_f32 v190, v172, v173, v174
v_max3_f32 v190, v190, v175, v176
v_max3_f32 v190, v190, v177, v178
v_max_f32 v190, v190, v179
v_min3_f32 v194, v172, v173, v174
v_min3_f32 v194, v194, v175, v176
v_min3_f32 v194, v194, v177, v178
v_min_f32 v194, v194, v179
v_max3_f32 v191, v180, v181, v182
v_max3_f32 v191, v191, v183, v184
s_add_u32 s3, s3, 1048576
buffer_store_dwordx4 a[96:99], v30, s[16:19], s3 offen sc1
v_max3_f32 v191, v191, v185, v186
v_max_f32 v191, v191, v187
v_min3_f32 v195, v180, v181, v182
v_min3_f32 v195, v195, v183, v184
v_min3_f32 v195, v195, v185, v186
v_min_f32 v195, v195, v187
s_nop 0
v_permlane16_swap_b32 v188, v189
v_permlane16_swap_b32 v190, v191
v_permlane16_swap_b32 v192, v193
v_permlane16_swap_b32 v194, v195
v_max_f32 v188, v188, v189
v_max_f32 v190, v190, v191
v_min_f32 v192, v192, v193
v_min_f32 v194, v194, v195
s_nop 0
v_permlane32_swap_b32 v188, v190
v_permlane32_swap_b32 v192, v194
v_max_f32 v189, v188, v190
v_max_f32 v190, v188, v190
v_min_f32 v193, v192, v194
v_min_f32 v194, v192, v194
s_nop 0
v_permlane32_swap_b32 v189, v190
v_permlane32_swap_b32 v193, v194
v_mov_b32 v188, v189
v_mov_b32 v191, v190
v_mov_b32 v192, v193
v_mov_b32 v195, v194
v_permlane16_swap_b32 v188, v189
v_permlane16_swap_b32 v190, v191
v_permlane16_swap_b32 v192, v193
v_permlane16_swap_b32 v194, v195
v_mul_f32 v188, v188, v3
v_mul_f32 v192, v192, v3
v_mul_f32 v189, v189, v5
v_mul_f32 v193, v193, v5
v_mul_f32 v190, v190, v7
v_mul_f32 v194, v194, v7
v_mul_f32 v191, v191, v9
v_mul_f32 v195, v195, v9
v_pk_fma_f32 v[64:65], v[156:157], v[2:3], v[188:189] op_sel:[0,1,0] op_sel_hi:[1,1,0] neg_lo:[0,0,1] neg_hi:[0,0,1]
v_pk_fma_f32 v[66:67], v[158:159], v[2:3], v[188:189] op_sel:[0,1,0] op_sel_hi:[1,1,0] neg_lo:[0,0,1] neg_hi:[0,0,1]
v_pk_fma_f32 v[68:69], v[160:161], v[2:3], v[188:189] op_sel:[0,1,0] op_sel_hi:[1,1,0] neg_lo:[0,0,1] neg_hi:[0,0,1]
v_pk_fma_f32 v[70:71], v[162:163], v[2:3], v[188:189] op_sel:[0,1,0] op_sel_hi:[1,1,0] neg_lo:[0,0,1] neg_hi:[0,0,1]
v_pk_fma_f32 v[156:157], v[156:157], v[2:3], v[192:193] op_sel:[0,1,0] op_sel_hi:[1,1,0] neg_lo:[1,0,0] neg_hi:[1,0,0]
v_pk_fma_f32 v[158:159], v[158:159], v[2:3], v[192:193] op_sel:[0,1,0] op_sel_hi:[1,1,0] neg_lo:[1,0,0] neg_hi:[1,0,0]
v_pk_fma_f32 v[160:161], v[160:161], v[2:3], v[192:193] op_sel:[0,1,0] op_sel_hi:[1,1,0] neg_lo:[1,0,0] neg_hi:[1,0,0]
v_pk_fma_f32 v[162:163], v[162:163], v[2:3], v[192:193] op_sel:[0,1,0] op_sel_hi:[1,1,0] neg_lo:[1,0,0] neg_hi:[1,0,0]
v_exp_f32 v64, v64
v_exp_f32 v65, v65
v_exp_f32 v66, v66
v_exp_f32 v67, v67
v_exp_f32 v68, v68
v_exp_f32 v69, v69
v_exp_f32 v70, v70
v_exp_f32 v71, v71
v_exp_f32 v156, v156
v_exp_f32 v157, v157
v_exp_f32 v158, v158
v_exp_f32 v159, v159
v_exp_f32 v160, v160
v_exp_f32 v161, v161
v_exp_f32 v162, v162
v_exp_f32 v163, v163
v_cvt_pk_bf16_f32 v196, v64, v65
v_cvt_pk_bf16_f32 v197, v66, v67
v_cvt_pk_bf16_f32 v198, v68, v69
v_cvt_pk_bf16_f32 v199, v70, v71
v_cvt_pk_bf16_f32 v212, v156, v157
v_cvt_pk_bf16_f32 v213, v158, v159
v_cvt_pk_bf16_f32 v214, v160, v161
v_cvt_pk_bf16_f32 v215, v162, v163
v_pk_fma_f32 v[72:73], v[164:165], v[4:5], v[188:189] op_sel:[0,1,1] op_sel_hi:[1,1,1] neg_lo:[0,0,1] neg_hi:[0,0,1]
v_pk_fma_f32 v[74:75], v[166:167], v[4:5], v[188:189] op_sel:[0,1,1] op_sel_hi:[1,1,1] neg_lo:[0,0,1] neg_hi:[0,0,1]
v_pk_fma_f32 v[76:77], v[168:169], v[4:5], v[188:189] op_sel:[0,1,1] op_sel_hi:[1,1,1] neg_lo:[0,0,1] neg_hi:[0,0,1]
v_pk_fma_f32 v[78:79], v[170:171], v[4:5], v[188:189] op_sel:[0,1,1] op_sel_hi:[1,1,1] neg_lo:[0,0,1] neg_hi:[0,0,1]
v_pk_fma_f32 v[164:165], v[164:165], v[4:5], v[192:193] op_sel:[0,1,1] op_sel_hi:[1,1,1] neg_lo:[1,0,0] neg_hi:[1,0,0]
v_pk_fma_f32 v[166:167], v[166:167], v[4:5], v[192:193] op_sel:[0,1,1] op_sel_hi:[1,1,1] neg_lo:[1,0,0] neg_hi:[1,0,0]
v_pk_fma_f32 v[168:169], v[168:169], v[4:5], v[192:193] op_sel:[0,1,1] op_sel_hi:[1,1,1] neg_lo:[1,0,0] neg_hi:[1,0,0]
v_pk_fma_f32 v[170:171], v[170:171], v[4:5], v[192:193] op_sel:[0,1,1] op_sel_hi:[1,1,1] neg_lo:[1,0,0] neg_hi:[1,0,0]
v_exp_f32 v72, v72
v_mfma_f32_16x16x32_bf16 v[140:143], v[136:139], v[196:199], 0
L_pg3:
s_cbranch_execz L_vret
v_exp_f32 v73, v73
v_exp_f32 v74, v74
v_mfma_f32_16x16x32_bf16 v[228:231], v[136:139], v[212:215], 0
v_exp_f32 v75, v75
v_exp_f32 v76, v76
v_exp_f32 v77, v77
v_exp_f32 v78, v78
v_exp_f32 v79, v79
v_exp_f32 v164, v164
v_exp_f32 v165, v165
v_exp_f32 v166, v166
v_exp_f32 v167, v167
v_exp_f32 v168, v168
v_exp_f32 v169, v169
v_exp_f32 v170, v170
v_exp_f32 v171, v171
v_cvt_pk_bf16_f32 v200, v72, v73
v_cvt_pk_bf16_f32 v201, v74, v75
v_cvt_pk_bf16_f32 v202, v76, v77
v_cvt_pk_bf16_f32 v203, v78, v79
v_cvt_pk_bf16_f32 v216, v164, v165
v_cvt_pk_bf16_f32 v217, v166, v167
v_cvt_pk_bf16_f32 v218, v168, v169
v_cvt_pk_bf16_f32 v219, v170, v171
v_pk_fma_f32 v[80:81], v[172:173], v[6:7], v[190:191] op_sel:[0,1,0] op_sel_hi:[1,1,0] neg_lo:[0,0,1] neg_hi:[0,0,1]
v_pk_fma_f32 v[82:83], v[174:175], v[6:7], v[190:191] op_sel:[0,1,0] op_sel_hi:[1,1,0] neg_lo:[0,0,1] neg_hi:[0,0,1]
v_pk_fma_f32 v[84:85], v[176:177], v[6:7], v[190:191] op_sel:[0,1,0] op_sel_hi:[1,1,0] neg_lo:[0,0,1] neg_hi:[0,0,1]
v_pk_fma_f32 v[86:87], v[178:179], v[6:7], v[190:191] op_sel:[0,1,0] op_sel_hi:[1,1,0] neg_lo:[0,0,1] neg_hi:[0,0,1]
v_pk_fma_f32 v[172:173], v[172:173], v[6:7], v[194:195] op_sel:[0,1,0] op_sel_hi:[1,1,0] neg_lo:[1,0,0] neg_hi:[1,0,0]
v_pk_fma_f32 v[174:175], v[174:175], v[6:7], v[194:195] op_sel:[0,1,0] op_sel_hi:[1,1,0] neg_lo:[1,0,0] neg_hi:[1,0,0]
v_pk_fma_f32 v[176:177], v[176:177], v[6:7], v[194:195] op_sel:[0,1,0] op_sel_hi:[1,1,0] neg_lo:[1,0,0] neg_hi:[1,0,0]
v_pk_fma_f32 v[178:179], v[178:179], v[6:7], v[194:195] op_sel:[0,1,0] op_sel_hi:[1,1,0] neg_lo:[1,0,0] neg_hi:[1,0,0]
v_exp_f32 v80, v80
v_mfma_f32_16x16x32_bf16 v[144:147], v[136:139], v[200:203], 0
v_exp_f32 v81, v81
v_exp_f32 v82, v82
v_mfma_f32_16x16x32_bf16 v[232:235], v[136:139], v[216:219], 0
v_exp_f32 v83, v83
v_exp_f32 v84, v84
v_exp_f32 v85, v85
v_exp_f32 v86, v86
v_exp_f32 v87, v87
v_exp_f32 v172, v172
v_exp_f32 v173, v173
v_exp_f32 v174, v174
v_exp_f32 v175, v175
v_exp_f32 v176, v176
v_exp_f32 v177, v177
v_exp_f32 v178, v178
v_exp_f32 v179, v179
v_cvt_pk_bf16_f32 v204, v80, v81
v_cvt_pk_bf16_f32 v205, v82, v83
v_cvt_pk_bf16_f32 v206, v84, v85
v_cvt_pk_bf16_f32 v207, v86, v87
v_cvt_pk_bf16_f32 v220, v172, v173
v_cvt_pk_bf16_f32 v221, v174, v175
v_cvt_pk_bf16_f32 v222, v176, v177
v_cvt_pk_bf16_f32 v223, v178, v179
v_pk_fma_f32 v[88:89], v[180:181], v[8:9], v[190:191] op_sel:[0,1,1] op_sel_hi:[1,1,1] neg_lo:[0,0,1] neg_hi:[0,0,1]
v_pk_fma_f32 v[90:91], v[182:183], v[8:9], v[190:191] op_sel:[0,1,1] op_sel_hi:[1,1,1] neg_lo:[0,0,1] neg_hi:[0,0,1]
v_pk_fma_f32 v[92:93], v[184:185], v[8:9], v[190:191] op_sel:[0,1,1] op_sel_hi:[1,1,1] neg_lo:[0,0,1] neg_hi:[0,0,1]
v_pk_fma_f32 v[94:95], v[186:187], v[8:9], v[190:191] op_sel:[0,1,1] op_sel_hi:[1,1,1] neg_lo:[0,0,1] neg_hi:[0,0,1]
v_pk_fma_f32 v[180:181], v[180:181], v[8:9], v[194:195] op_sel:[0,1,1] op_sel_hi:[1,1,1] neg_lo:[1,0,0] neg_hi:[1,0,0]
v_pk_fma_f32 v[182:183], v[182:183], v[8:9], v[194:195] op_sel:[0,1,1] op_sel_hi:[1,1,1] neg_lo:[1,0,0] neg_hi:[1,0,0]
v_pk_fma_f32 v[184:185], v[184:185], v[8:9], v[194:195] op_sel:[0,1,1] op_sel_hi:[1,1,1] neg_lo:[1,0,0] neg_hi:[1,0,0]
v_pk_fma_f32 v[186:187], v[186:187], v[8:9], v[194:195] op_sel:[0,1,1] op_sel_hi:[1,1,1] neg_lo:[1,0,0] neg_hi:[1,0,0]
v_exp_f32 v88, v88
v_mfma_f32_16x16x32_bf16 v[148:151], v[136:139], v[204:207], 0
v_exp_f32 v89, v89
v_exp_f32 v90, v90
v_mfma_f32_16x16x32_bf16 v[236:239], v[136:139], v[220:223], 0
v_exp_f32 v91, v91
v_exp_f32 v92, v92
v_exp_f32 v93, v93
v_exp_f32 v94, v94
v_exp_f32 v95, v95
v_exp_f32 v180, v180
v_exp_f32 v181, v181
v_exp_f32 v182, v182
v_exp_f32 v183, v183
v_exp_f32 v184, v184
v_exp_f32 v185, v185
v_exp_f32 v186, v186
v_exp_f32 v187, v187
v_cvt_pk_bf16_f32 v208, v88, v89
v_cvt_pk_bf16_f32 v209, v90, v91
v_cvt_pk_bf16_f32 v210, v92, v93
v_cvt_pk_bf16_f32 v211, v94, v95
v_cvt_pk_bf16_f32 v224, v180, v181
v_cvt_pk_bf16_f32 v225, v182, v183
v_cvt_pk_bf16_f32 v226, v184, v185
v_cvt_pk_bf16_f32 v227, v186, v187
v_mfma_f32_16x16x32_bf16 v[152:155], v[136:139], v[208:211], 0
s_nop 0
v_mfma_f32_16x16x32_bf16 v[240:243], v[136:139], v[224:227], 0
v_rcp_f32 v140, v140
v_rcp_f32 v228, v228
v_rcp_f32 v144, v144
v_rcp_f32 v232, v232
v_rcp_f32 v148, v148
v_rcp_f32 v236, v236
v_accvgpr_read_b32 v1, a114
s_lshl_b32 s86, s82, 15
s_lshl_b32 s27, s81, 7
s_add_u32 s86, s86, s27
v_add_u32 v23, 32768, v1
buffer_load_dwordx4 a[144:147], v1, s[8:11], s86 offen offset:0
v_pk_mul_f32 v[64:65], v[64:65], v[140:141] op_sel_hi:[1,0]
v_pk_mul_f32 v[66:67], v[66:67], v[140:141] op_sel_hi:[1,0]
v_pk_mul_f32 v[68:69], v[68:69], v[140:141] op_sel_hi:[1,0]
v_pk_mul_f32 v[70:71], v[70:71], v[140:141] op_sel_hi:[1,0]
v_cvt_pk_bf16_f32 v196, v64, v65
v_cvt_pk_bf16_f32 v197, v66, v67
v_cvt_pk_bf16_f32 v198, v68, v69
v_cvt_pk_bf16_f32 v199, v70, v71
ds_write_b64 v10, v[196:197] offset:0
ds_write_b64 v11, v[198:199] offset:0
v_rcp_f32 v152, v152
v_rcp_f32 v240, v240
v_pk_mul_f32 v[156:157], v[156:157], v[228:229] op_sel_hi:[1,0]
v_pk_mul_f32 v[158:159], v[158:159], v[228:229] op_sel_hi:[1,0]
v_pk_mul_f32 v[160:161], v[160:161], v[228:229] op_sel_hi:[1,0]
buffer_load_dwordx4 a[148:151], v1, s[8:11], s86 offen offset:64
v_pk_mul_f32 v[162:163], v[162:163], v[228:229] op_sel_hi:[1,0]
v_cvt_pk_bf16_f32 v212, v156, v157
v_cvt_pk_bf16_f32 v213, v158, v159
v_cvt_pk_bf16_f32 v214, v160, v161
v_cvt_pk_bf16_f32 v215, v162, v163
ds_write_b64 v12, v[212:213] offset:0
ds_write_b64 v13, v[214:215] offset:0
v_pk_mul_f32 v[72:73], v[72:73], v[144:145] op_sel_hi:[1,0]
v_pk_mul_f32 v[74:75], v[74:75], v[144:145] op_sel_hi:[1,0]
v_pk_mul_f32 v[76:77], v[76:77], v[144:145] op_sel_hi:[1,0]
v_pk_mul_f32 v[78:79], v[78:79], v[144:145] op_sel_hi:[1,0]
v_cvt_pk_bf16_f32 v200, v72, v73
v_cvt_pk_bf16_f32 v201, v74, v75
v_cvt_pk_bf16_f32 v202, v76, v77
v_cvt_pk_bf16_f32 v203, v78, v79
ds_write_b64 v10, v[200:201] offset:2048
buffer_load_dwordx4 a[152:155], v23, s[8:11], s86 offen offset:0
ds_write_b64 v11, v[202:203] offset:2048
v_pk_mul_f32 v[164:165], v[164:165], v[232:233] op_sel_hi:[1,0]
v_pk_mul_f32 v[166:167], v[166:167], v[232:233] op_sel_hi:[1,0]
v_pk_mul_f32 v[168:169], v[168:169], v[232:233] op_sel_hi:[1,0]
v_pk_mul_f32 v[170:171], v[170:171], v[232:233] op_sel_hi:[1,0]
v_cvt_pk_bf16_f32 v216, v164, v165
v_cvt_pk_bf16_f32 v217, v166, v167
v_cvt_pk_bf16_f32 v218, v168, v169
v_cvt_pk_bf16_f32 v219, v170, v171
ds_write_b64 v12, v[216:217] offset:2048
ds_write_b64 v13, v[218:219] offset:2048
ds_read_b64_tr_b16 a[0:1], v14 offset:0
ds_read_b64_tr_b16 a[2:3], v14 offset:2048
ds_read_b64_tr_b16 a[8:9], v15 offset:0
ds_read_b64_tr_b16 a[10:11], v15 offset:2048
buffer_load_dwordx4 a[156:159], v23, s[8:11], s86 offen offset:64
v_pk_mul_f32 v[80:81], v[80:81], v[148:149] op_sel_hi:[1,0]
v_pk_mul_f32 v[82:83], v[82:83], v[148:149] op_sel_hi:[1,0]
v_pk_mul_f32 v[84:85], v[84:85], v[148:149] op_sel_hi:[1,0]
v_pk_mul_f32 v[86:87], v[86:87], v[148:149] op_sel_hi:[1,0]
v_cvt_pk_bf16_f32 v204, v80, v81
v_cvt_pk_bf16_f32 v205, v82, v83
v_cvt_pk_bf16_f32 v206, v84, v85
v_cvt_pk_bf16_f32 v207, v86, v87
ds_write_b64 v10, v[204:205] offset:4096
ds_write_b64 v11, v[206:207] offset:4096
s_waitcnt lgkmcnt(2)
v_mfma_f32_16x16x32_bf16 v[112:115], a[0:3], v[96:99], 0
v_mfma_f32_16x16x32_bf16 v[120:123], a[8:11], v[96:99], 0
v_pk_mul_f32 v[172:173], v[172:173], v[236:237] op_sel_hi:[1,0]
v_pk_mul_f32 v[174:175], v[174:175], v[236:237] op_sel_hi:[1,0]
v_pk_mul_f32 v[176:177], v[176:177], v[236:237] op_sel_hi:[1,0]
v_accvgpr_read_b32 v20, a115
buffer_load_dword a248, v20, s[36:39], 0 offen
v_pk_mul_f32 v[178:179], v[178:179], v[236:237] op_sel_hi:[1,0]
v_cvt_pk_bf16_f32 v220, v172, v173
v_cvt_pk_bf16_f32 v221, v174, v175
v_cvt_pk_bf16_f32 v222, v176, v177
v_cvt_pk_bf16_f32 v223, v178, v179
ds_write_b64 v12, v[220:221] offset:4096
ds_write_b64 v13, v[222:223] offset:4096
v_mfma_f32_16x16x32_bf16 v[116:119], a[0:3], v[104:107], 0
v_mfma_f32_16x16x32_bf16 v[124:127], a[8:11], v[104:107], 0
v_pk_mul_f32 v[88:89], v[88:89], v[152:153] op_sel_hi:[1,0]
v_pk_mul_f32 v[90:91], v[90:91], v[152:153] op_sel_hi:[1,0]
v_pk_mul_f32 v[92:93], v[92:93], v[152:153] op_sel_hi:[1,0]
v_pk_mul_f32 v[94:95], v[94:95], v[152:153] op_sel_hi:[1,0]
v_cvt_pk_bf16_f32 v208, v88, v89
v_cvt_pk_bf16_f32 v209, v90, v91
v_cvt_pk_bf16_f32 v210, v92, v93
v_cvt_pk_bf16_f32 v211, v94, v95
ds_write_b64 v10, v[208:209] offset:6144
ds_write_b64 v11, v[210:211] offset:6144
v_mfma_f32_16x16x32_bf16 v[244:247], v[136:139], a[0:3], 0
v_mfma_f32_16x16x32_bf16 v[248:251], v[136:139], a[8:11], 0
v_pk_mul_f32 v[180:181], v[180:181], v[240:241] op_sel_hi:[1,0]
v_pk_mul_f32 v[182:183], v[182:183], v[240:241] op_sel_hi:[1,0]
v_pk_mul_f32 v[184:185], v[184:185], v[240:241] op_sel_hi:[1,0]
v_pk_mul_f32 v[186:187], v[186:187], v[240:241] op_sel_hi:[1,0]
v_cvt_pk_bf16_f32 v224, v180, v181
v_cvt_pk_bf16_f32 v225, v182, v183
v_cvt_pk_bf16_f32 v226, v184, v185
v_cvt_pk_bf16_f32 v227, v186, v187
ds_write_b64 v12, v[224:225] offset:6144
ds_write_b64 v13, v[226:227] offset:6144
ds_read_b64_tr_b16 a[4:5], v14 offset:4096
ds_read_b64_tr_b16 a[6:7], v14 offset:6144
ds_read_b64_tr_b16 a[12:13], v15 offset:4096
ds_read_b64_tr_b16 a[14:15], v15 offset:6144
s_add_u32 s61, s61, s31
s_and_b32 s27, s26, 7
s_lshl_b32 s27, s27, 9
s_add_u32 s52, s61, s27
s_lshl_b32 s27, s47, 8
s_add_u32 s53, s61, s27
s_add_u32 s53, s53, 4096
s_waitcnt lgkmcnt(4)
s_barrier
ds_read_b64_tr_b16 a[16:17], v16 offset:0
ds_read_b64_tr_b16 a[18:19], v16 offset:2048
ds_read_b64_tr_b16 a[24:25], v17 offset:0
ds_read_b64_tr_b16 a[26:27], v17 offset:2048
ds_read_b128 a[32:35], v25 offset:0
ds_read_b128 a[36:39], v25 offset:1024
ds_read_b64_tr_b16 a[20:21], v16 offset:4096
ds_read_b64_tr_b16 a[22:23], v16 offset:6144
ds_read_b64_tr_b16 a[28:29], v17 offset:4096
ds_read_b64_tr_b16 a[30:31], v17 offset:6144
ds_read_b128 a[40:43], v25 offset:2048
ds_read_b128 a[44:47], v25 offset:3072
s_waitcnt lgkmcnt(12)
v_mfma_f32_16x16x32_bf16 v[112:115], a[4:7], v[100:103], v[112:115]
v_mfma_f32_16x16x32_bf16 v[120:123], a[12:15], v[100:103], v[120:123]
v_mfma_f32_16x16x32_bf16 v[116:119], a[4:7], v[108:111], v[116:119]
v_mfma_f32_16x16x32_bf16 v[124:127], a[12:15], v[108:111], v[124:127]
v_mfma_f32_16x16x32_bf16 v[244:247], v[136:139], a[4:7], v[244:247]
v_mfma_f32_16x16x32_bf16 v[248:251], v[136:139], a[12:15], v[248:251]
s_waitcnt lgkmcnt(2)
v_mfma_f32_16x16x32_bf16 v[112:115], a[16:19], a[32:35], v[112:115]
v_mfma_f32_16x16x32_bf16 v[112:115], a[20:23], a[36:39], v[112:115]
v_mfma_f32_16x16x32_bf16 v[120:123], a[24:27], a[32:35], v[120:123]
v_mfma_f32_16x16x32_bf16 v[120:123], a[28:31], a[36:39], v[120:123]
s_waitcnt lgkmcnt(0)
v_mfma_f32_16x16x32_bf16 v[116:119], a[16:19], a[40:43], v[116:119]
v_mfma_f32_16x16x32_bf16 v[116:119], a[20:23], a[44:47], v[116:119]
v_mfma_f32_16x16x32_bf16 v[124:127], a[24:27], a[40:43], v[124:127]
v_mfma_f32_16x16x32_bf16 v[124:127], a[28:31], a[44:47], v[124:127]
v_mfma_f32_16x16x32_bf16 v[244:247], v[136:139], a[16:19], v[244:247]
v_mfma_f32_16x16x32_bf16 v[244:247], v[136:139], a[20:23], v[244:247]
v_mfma_f32_16x16x32_bf16 v[248:251], v[136:139], a[24:27], v[248:251]
v_mfma_f32_16x16x32_bf16 v[248:251], v[136:139], a[28:31], v[248:251]
v_cvt_pk_bf16_f32 v72, v112, v113
v_cvt_pk_bf16_f32 v73, v114, v115
v_cvt_pk_bf16_f32 v74, v120, v121
v_cvt_pk_bf16_f32 v75, v122, v123
buffer_store_dwordx4 v[72:75], v30, s[16:19], s62 offen offset:0 sc1
v_cvt_pk_bf16_f32 v76, v116, v117
v_cvt_pk_bf16_f32 v77, v118, v119
v_cvt_pk_bf16_f32 v78, v124, v125
v_cvt_pk_bf16_f32 v79, v126, v127
buffer_store_dwordx4 v[76:79], v30, s[16:19], s62 offen offset:1024 sc1
v_mov_b32 v245, v248
s_mov_b32 exec_hi, 0
buffer_store_dwordx2 v[244:245], v26, s[16:19], s63 offen sc1
s_mov_b64 exec, -1
s_barrier
s_and_b32 s100, s2, 0x83
s_lshl_b32 s100, s100, 7
s_and_b32 s27, s2, 0x78
s_lshl_b32 s27, s27, 6
s_add_u32 s100, s100, s27
s_lshl_b32 s27, s20, 2
s_add_u32 s100, s100, s27
s_add_u32 s101, s30, 196624
s_add_u32 s100, s100, s101
s_waitcnt vmcnt(25)
v_mfma_f32_16x16x32_bf16 v[96:99], v[136:139], a[88:91], 0
v_mfma_f32_16x16x32_bf16 v[96:99], v[136:139], a[92:95], v[96:99]
s_lshl_b32 s27, s20, 2
s_add_u32 s54, s49, s27
s_sub_u32 s54, s54, 128
s_lshl_b32 s27, s20, 7
s_add_u32 s52, s52, s27
s_add_u32 s49, s49, s27
v_mfma_f32_16x16x4_f32 v[244:247], v18, v29, 0
v_mfma_f32_16x16x4_f32 v[248:251], v19, v29, 0
s_nop 1
v_add_f32_dpp v96, v96, v96 quad_perm:[1,0,3,2] row_mask:0xf bank_mask:0xf
s_nop 1
v_add_f32_dpp v96, v96, v96 quad_perm:[2,3,0,1] row_mask:0xf bank_mask:0xf
s_nop 1
v_add_f32_dpp v96, v96, v96 row_half_mirror row_mask:0xf bank_mask:0xf
s_nop 1
v_add_f32_dpp v96, v96, v96 row_mirror row_mask:0xf bank_mask:0xf
v_mul_f32 v96, 0x3a800000, v96
s_mov_b64 exec, 0x10001
buffer_store_dword v96, v26, s[16:19], s54 offen sc1
s_mov_b64 exec, -1
s_mul_i32 s27, s47, 132096
s_add_u32 s93, s61, s27
s_add_u32 s93, s93, 4608
s_lshr_b32 s27, s31, 13
s_xor_b32 s27, s27, s47
s_lshr_b32 s35, s26, 3
s_xor_b32 s27, s27, s35
s_mul_i32 s27, s27, 132096
s_add_u32 s92, s61, s27
s_add_u32 s92, s92, 4736
s_and_b32 s27, s26, 7
s_lshl_b32 s27, s27, 3
s_lshl_b32 s34, s46, 2
s_add_u32 s27, s27, s34
s_lshl_b32 s54, s27, 15
s_lshl_b32 s35, s48, 10
s_add_u32 s54, s54, s35
s_and_b32 s27, s54, 0xffffe000
s_add_u32 s54, s54, s27
s_lshr_b32 s27, s54, 8
s_and_b32 s27, s27, 8192
s_or_b32 s54, s54, s27
s_xor_b32 s54, s54, s30
s_and_b32 s55, s26, 7
s_lshl_b32 s55, s55, 1
s_add_u32 s55, s55, s46
s_lshl_b32 s55, s55, 6
s_add_u32 s55, s55, s48
s_lshl_b32 s55, s55, 8
s_add_u32 s55, s55, s30
s_add_u32 s55, s55, 491520
v_lshrrev_b32 v1, 3, v0
v_cmp_eq_u32 vcc, 3, v1
v_add_u32 v1, 0, v30
s_nop 0
v_cndmask_b32 v1, v30, v1, vcc
s_add_u32 s56, s32, 0
s_addc_u32 s57, s33, 0
s_mov_b32 s58, 4194304
s_mov_b32 s59, 0x20000
s_mov_b32 s94, 0x358637bd
v_pk_fma_f32 v[32:33], v[2:3], v[244:245], v[32:33] op_sel_hi:[0,1,1] neg_lo:[1,0,0] neg_hi:[1,0,0]
v_pk_fma_f32 v[34:35], v[2:3], v[246:247], v[34:35] op_sel_hi:[0,1,1] neg_lo:[1,0,0] neg_hi:[1,0,0]
v_pk_fma_f32 v[48:49], v[2:3], v[248:249], v[48:49] op_sel_hi:[0,1,1] neg_lo:[1,0,0] neg_hi:[1,0,0]
v_pk_fma_f32 v[50:51], v[2:3], v[250:251], v[50:51] op_sel_hi:[0,1,1] neg_lo:[1,0,0] neg_hi:[1,0,0]
v_cvt_pk_bf16_f32 v140, v32, v33
v_cvt_pk_bf16_f32 v141, v34, v35
v_cvt_pk_bf16_f32 v142, v48, v49
v_cvt_pk_bf16_f32 v143, v50, v51
v_pk_fma_f32 v[36:37], v[4:5], v[244:245], v[36:37] op_sel_hi:[0,1,1] neg_lo:[1,0,0] neg_hi:[1,0,0]
v_pk_fma_f32 v[38:39], v[4:5], v[246:247], v[38:39] op_sel_hi:[0,1,1] neg_lo:[1,0,0] neg_hi:[1,0,0]
v_mfma_f32_16x16x32_bf16 v[156:159], v[128:131], v[140:143], 0
v_pk_fma_f32 v[52:53], v[4:5], v[248:249], v[52:53] op_sel_hi:[0,1,1] neg_lo:[1,0,0] neg_hi:[1,0,0]
v_pk_fma_f32 v[54:55], v[4:5], v[250:251], v[54:55] op_sel_hi:[0,1,1] neg_lo:[1,0,0] neg_hi:[1,0,0]
v_mfma_f32_16x16x32_bf16 v[160:163], v[132:135], v[140:143], 0
v_cvt_pk_bf16_f32 v144, v36, v37
v_cvt_pk_bf16_f32 v145, v38, v39
v_cvt_pk_bf16_f32 v146, v52, v53
v_cvt_pk_bf16_f32 v147, v54, v55
v_pk_fma_f32 v[40:41], v[6:7], v[244:245], v[40:41] op_sel_hi:[0,1,1] neg_lo:[1,0,0] neg_hi:[1,0,0]
v_pk_fma_f32 v[42:43], v[6:7], v[246:247], v[42:43] op_sel_hi:[0,1,1] neg_lo:[1,0,0] neg_hi:[1,0,0]
v_mfma_f32_16x16x32_bf16 v[164:167], v[128:131], v[144:147], 0
v_pk_fma_f32 v[56:57], v[6:7], v[248:249], v[56:57] op_sel_hi:[0,1,1] neg_lo:[1,0,0] neg_hi:[1,0,0]
v_pk_fma_f32 v[58:59], v[6:7], v[250:251], v[58:59] op_sel_hi:[0,1,1] neg_lo:[1,0,0] neg_hi:[1,0,0]
v_mfma_f32_16x16x32_bf16 v[168:171], v[132:135], v[144:147], 0
v_cvt_pk_bf16_f32 v148, v40, v41
v_cvt_pk_bf16_f32 v149, v42, v43
v_cvt_pk_bf16_f32 v150, v56, v57
v_cvt_pk_bf16_f32 v151, v58, v59
v_pk_fma_f32 v[44:45], v[8:9], v[244:245], v[44:45] op_sel_hi:[0,1,1] neg_lo:[1,0,0] neg_hi:[1,0,0]
v_pk_fma_f32 v[46:47], v[8:9], v[246:247], v[46:47] op_sel_hi:[0,1,1] neg_lo:[1,0,0] neg_hi:[1,0,0]
s_mov_b32 s34, s52
buffer_load_dwordx4 v[64:67], v21, s[16:19], s34 offen sc1
v_mfma_f32_16x16x32_bf16 v[172:175], v[128:131], v[148:151], 0
v_pk_fma_f32 v[60:61], v[8:9], v[248:249], v[60:61] op_sel_hi:[0,1,1] neg_lo:[1,0,0] neg_hi:[1,0,0]
v_pk_fma_f32 v[62:63], v[8:9], v[250:251], v[62:63] op_sel_hi:[0,1,1] neg_lo:[1,0,0] neg_hi:[1,0,0]
v_mfma_f32_16x16x32_bf16 v[176:179], v[132:135], v[148:151], 0
v_cvt_pk_bf16_f32 v152, v44, v45
v_cvt_pk_bf16_f32 v153, v46, v47
s_add_u32 s34, s34, 132096
buffer_load_dwordx4 v[68:71], v21, s[16:19], s34 offen sc1
v_cvt_pk_bf16_f32 v154, v60, v61
v_cvt_pk_bf16_f32 v155, v62, v63
s_nop 1
v_mfma_f32_16x16x32_bf16 v[180:183], v[128:131], v[152:155], 0
v_mfma_f32_16x16x32_bf16 v[184:187], v[132:135], v[152:155], 0
v_max3_f32 v188, v156, v157, v158
v_max3_f32 v188, v188, v159, v160
v_max3_f32 v188, v188, v161, v162
v_max_f32 v188, v188, v163
v_min3_f32 v192, v156, v157, v158
v_min3_f32 v192, v192, v159, v160
v_min3_f32 v192, v192, v161, v162
v_min_f32 v192, v192, v163
v_max3_f32 v189, v164, v165, v166
v_max3_f32 v189, v189, v167, v168
v_max3_f32 v189, v189, v169, v170
v_max_f32 v189, v189, v171
v_min3_f32 v193, v164, v165, v166
v_min3_f32 v193, v193, v167, v168
v_min3_f32 v193, v193, v169, v170
v_min_f32 v193, v193, v171
v_max3_f32 v190, v172, v173, v174
v_max3_f32 v190, v190, v175, v176
v_max3_f32 v190, v190, v177, v178
v_max_f32 v190, v190, v179
v_min3_f32 v194, v172, v173, v174
v_min3_f32 v194, v194, v175, v176
v_min3_f32 v194, v194, v177, v178
v_min_f32 v194, v194, v179
v_max3_f32 v191, v180, v181, v182
v_max3_f32 v191, v191, v183, v184
v_max3_f32 v191, v191, v185, v186
v_max_f32 v191, v191, v187
v_min3_f32 v195, v180, v181, v182
v_min3_f32 v195, v195, v183, v184
v_min3_f32 v195, v195, v185, v186
v_min_f32 v195, v195, v187
s_nop 0
v_permlane16_swap_b32 v188, v189
v_permlane16_swap_b32 v190, v191
v_permlane16_swap_b32 v192, v193
v_permlane16_swap_b32 v194, v195
v_max_f32 v188, v188, v189
v_max_f32 v190, v190, v191
v_min_f32 v192, v192, v193
v_min_f32 v194, v194, v195
s_nop 0
v_permlane32_swap_b32 v188, v190
v_permlane32_swap_b32 v192, v194
v_max_f32 v189, v188, v190
v_max_f32 v190, v188, v190
v_min_f32 v193, v192, v194
v_min_f32 v194, v192, v194
s_nop 0
v_permlane32_swap_b32 v189, v190
v_permlane32_swap_b32 v193, v194
v_mov_b32 v188, v189
v_mov_b32 v191, v190
v_mov_b32 v192, v193
v_mov_b32 v195, v194
v_permlane16_swap_b32 v188, v189
v_permlane16_swap_b32 v190, v191
v_permlane16_swap_b32 v192, v193
v_permlane16_swap_b32 v194, v195
v_mul_f32 v188, v188, v3
v_mul_f32 v192, v192, v3
v_mul_f32 v189, v189, v5
v_mul_f32 v193, v193, v5
v_mul_f32 v190, v190, v7
v_mul_f32 v194, v194, v7
v_mul_f32 v191, v191, v9
v_mul_f32 v195, v195, v9
v_pk_fma_f32 v[32:33], v[156:157], v[2:3], v[188:189] op_sel:[0,1,0] op_sel_hi:[1,1,0] neg_lo:[0,0,1] neg_hi:[0,0,1]
v_pk_fma_f32 v[34:35], v[158:159], v[2:3], v[188:189] op_sel:[0,1,0] op_sel_hi:[1,1,0] neg_lo:[0,0,1] neg_hi:[0,0,1]
v_pk_fma_f32 v[36:37], v[160:161], v[2:3], v[188:189] op_sel:[0,1,0] op_sel_hi:[1,1,0] neg_lo:[0,0,1] neg_hi:[0,0,1]
v_pk_fma_f32 v[38:39], v[162:163], v[2:3], v[188:189] op_sel:[0,1,0] op_sel_hi:[1,1,0] neg_lo:[0,0,1] neg_hi:[0,0,1]
v_pk_fma_f32 v[156:157], v[156:157], v[2:3], v[192:193] op_sel:[0,1,0] op_sel_hi:[1,1,0] neg_lo:[1,0,0] neg_hi:[1,0,0]
v_pk_fma_f32 v[158:159], v[158:159], v[2:3], v[192:193] op_sel:[0,1,0] op_sel_hi:[1,1,0] neg_lo:[1,0,0] neg_hi:[1,0,0]
v_pk_fma_f32 v[160:161], v[160:161], v[2:3], v[192:193] op_sel:[0,1,0] op_sel_hi:[1,1,0] neg_lo:[1,0,0] neg_hi:[1,0,0]
v_pk_fma_f32 v[162:163], v[162:163], v[2:3], v[192:193] op_sel:[0,1,0] op_sel_hi:[1,1,0] neg_lo:[1,0,0] neg_hi:[1,0,0]
v_exp_f32 v32, v32
v_exp_f32 v33, v33
v_exp_f32 v34, v34
v_exp_f32 v35, v35
v_exp_f32 v36, v36
v_exp_f32 v37, v37
v_exp_f32 v38, v38
v_exp_f32 v39, v39
v_exp_f32 v156, v156
v_exp_f32 v157, v157
v_exp_f32 v158, v158
v_exp_f32 v159, v159
v_exp_f32 v160, v160
v_exp_f32 v161, v161
v_exp_f32 v162, v162
v_exp_f32 v163, v163
v_cvt_pk_bf16_f32 v196, v32, v33
v_cvt_pk_bf16_f32 v197, v34, v35
v_cvt_pk_bf16_f32 v198, v36, v37
v_cvt_pk_bf16_f32 v199, v38, v39
v_cvt_pk_bf16_f32 v212, v156, v157
v_cvt_pk_bf16_f32 v213, v158, v159
v_cvt_pk_bf16_f32 v214, v160, v161
v_cvt_pk_bf16_f32 v215, v162, v163
s_waitcnt vmcnt(0)
s_mov_b32 s27, 131072
L_chk1:
v_max3_u32 v20, v64, v65, v66
v_max3_u32 v20, v20, v67, v68
v_max3_u32 v20, v20, v69, v70
v_max_u32 v20, v20, v71
v_cmp_eq_u32 vcc, -1, v20
s_sub_u32 s27, s27, 1
s_cbranch_vccz L_ok1
s_cmp_eq_u32 s27, 0
s_cbranch_scc1 L_ok1
s_mov_b32 s34, s52
buffer_load_dwordx4 v[64:67], v21, s[16:19], s34 offen sc1
s_add_u32 s34, s34, 132096
buffer_load_dwordx4 v[68:71], v21, s[16:19], s34 offen sc1
s_waitcnt vmcnt(0)
s_branch L_chk1
L_ok1:
s_mov_b32 s34, s53
buffer_load_dwordx4 v[80:83], v27, s[16:19], s34 offen sc1
s_add_u32 s34, s34, 66048
buffer_load_dwordx4 v[84:87], v27, s[16:19], s34 offen sc1
s_add_u32 s34, s34, 66048
buffer_load_dwordx4 v[88:91], v27, s[16:19], s34 offen sc1
s_add_u32 s34, s34, 66048
buffer_load_dwordx4 v[92:95], v27, s[16:19], s34 offen sc1
v_lshlrev_b32 v96, 16, v64
v_and_b32 v104, 0xffff0000, v64
v_lshlrev_b32 v97, 16, v65
v_and_b32 v105, 0xffff0000, v65
v_lshlrev_b32 v98, 16, v66
v_and_b32 v106, 0xffff0000, v66
v_lshlrev_b32 v99, 16, v67
v_and_b32 v107, 0xffff0000, v67
v_lshlrev_b32 v100, 16, v68
v_and_b32 v108, 0xffff0000, v68
v_lshlrev_b32 v101, 16, v69
v_and_b32 v109, 0xffff0000, v69
v_lshlrev_b32 v102, 16, v70
v_and_b32 v110, 0xffff0000, v70
v_lshlrev_b32 v103, 16, v71
v_and_b32 v111, 0xffff0000, v71
v_pk_add_f32 v[96:97], v[96:97], v[100:101]
v_pk_add_f32 v[98:99], v[98:99], v[102:103]
v_pk_add_f32 v[104:105], v[104:105], v[108:109]
v_pk_add_f32 v[106:107], v[106:107], v[110:111]
s_nop 0
v_permlane16_swap_b32 v96, v97
v_permlane16_swap_b32 v98, v99
v_permlane16_swap_b32 v104, v105
v_permlane16_swap_b32 v106, v107
v_add_f32 v96, v96, v97
v_add_f32 v98, v98, v99
v_add_f32 v104, v104, v105
v_add_f32 v106, v106, v107
s_nop 0
v_permlane32_swap_b32 v96, v98
v_permlane32_swap_b32 v104, v106
v_add_f32 v96, v96, v98
v_add_f32 v104, v104, v106
s_nop 0
v_add_f32_dpp v96, v96, v96 row_ror:8 row_mask:0xf bank_mask:0xf
v_add_f32_dpp v104, v104, v104 row_ror:8 row_mask:0xf bank_mask:0xf
v_cvt_pk_bf16_f32 v72, v96, v104
buffer_store_dword v72, v31, s[16:19], s49 offen sc1
v_pk_fma_f32 v[40:41], v[164:165], v[4:5], v[188:189] op_sel:[0,1,1] op_sel_hi:[1,1,1] neg_lo:[0,0,1] neg_hi:[0,0,1]
v_pk_fma_f32 v[42:43], v[166:167], v[4:5], v[188:189] op_sel:[0,1,1] op_sel_hi:[1,1,1] neg_lo:[0,0,1] neg_hi:[0,0,1]
v_pk_fma_f32 v[44:45], v[168:169], v[4:5], v[188:189] op_sel:[0,1,1] op_sel_hi:[1,1,1] neg_lo:[0,0,1] neg_hi:[0,0,1]
v_pk_fma_f32 v[46:47], v[170:171], v[4:5], v[188:189] op_sel:[0,1,1] op_sel_hi:[1,1,1] neg_lo:[0,0,1] neg_hi:[0,0,1]
v_pk_fma_f32 v[164:165], v[164:165], v[4:5], v[192:193] op_sel:[0,1,1] op_sel_hi:[1,1,1] neg_lo:[1,0,0] neg_hi:[1,0,0]
v_pk_fma_f32 v[166:167], v[166:167], v[4:5], v[192:193] op_sel:[0,1,1] op_sel_hi:[1,1,1] neg_lo:[1,0,0] neg_hi:[1,0,0]
v_pk_fma_f32 v[168:169], v[168:169], v[4:5], v[192:193] op_sel:[0,1,1] op_sel_hi:[1,1,1] neg_lo:[1,0,0] neg_hi:[1,0,0]
v_pk_fma_f32 v[170:171], v[170:171], v[4:5], v[192:193] op_sel:[0,1,1] op_sel_hi:[1,1,1] neg_lo:[1,0,0] neg_hi:[1,0,0]
v_exp_f32 v40, v40
v_mfma_f32_16x16x32_bf16 v[140:143], v[136:139], v[196:199], 0
v_exp_f32 v41, v41
v_exp_f32 v42, v42
v_mfma_f32_16x16x32_bf16 v[228:231], v[136:139], v[212:215], 0
v_exp_f32 v43, v43
v_exp_f32 v44, v44
v_exp_f32 v45, v45
v_exp_f32 v46, v46
v_exp_f32 v47, v47
v_exp_f32 v164, v164
v_exp_f32 v165, v165
v_exp_f32 v166, v166
v_exp_f32 v167, v167
v_exp_f32 v168, v168
v_exp_f32 v169, v169
v_exp_f32 v170, v170
v_exp_f32 v171, v171
v_cvt_pk_bf16_f32 v200, v40, v41
v_cvt_pk_bf16_f32 v201, v42, v43
v_cvt_pk_bf16_f32 v202, v44, v45
v_cvt_pk_bf16_f32 v203, v46, v47
v_cvt_pk_bf16_f32 v216, v164, v165
v_cvt_pk_bf16_f32 v217, v166, v167
v_cvt_pk_bf16_f32 v218, v168, v169
v_cvt_pk_bf16_f32 v219, v170, v171
v_pk_fma_f32 v[48:49], v[172:173], v[6:7], v[190:191] op_sel:[0,1,0] op_sel_hi:[1,1,0] neg_lo:[0,0,1] neg_hi:[0,0,1]
v_pk_fma_f32 v[50:51], v[174:175], v[6:7], v[190:191] op_sel:[0,1,0] op_sel_hi:[1,1,0] neg_lo:[0,0,1] neg_hi:[0,0,1]
v_pk_fma_f32 v[52:53], v[176:177], v[6:7], v[190:191] op_sel:[0,1,0] op_sel_hi:[1,1,0] neg_lo:[0,0,1] neg_hi:[0,0,1]
v_pk_fma_f32 v[54:55], v[178:179], v[6:7], v[190:191] op_sel:[0,1,0] op_sel_hi:[1,1,0] neg_lo:[0,0,1] neg_hi:[0,0,1]
v_pk_fma_f32 v[172:173], v[172:173], v[6:7], v[194:195] op_sel:[0,1,0] op_sel_hi:[1,1,0] neg_lo:[1,0,0] neg_hi:[1,0,0]
v_pk_fma_f32 v[174:175], v[174:175], v[6:7], v[194:195] op_sel:[0,1,0] op_sel_hi:[1,1,0] neg_lo:[1,0,0] neg_hi:[1,0,0]
v_pk_fma_f32 v[176:177], v[176:177], v[6:7], v[194:195] op_sel:[0,1,0] op_sel_hi:[1,1,0] neg_lo:[1,0,0] neg_hi:[1,0,0]
v_pk_fma_f32 v[178:179], v[178:179], v[6:7], v[194:195] op_sel:[0,1,0] op_sel_hi:[1,1,0] neg_lo:[1,0,0] neg_hi:[1,0,0]
v_exp_f32 v48, v48
v_mfma_f32_16x16x32_bf16 v[144:147], v[136:139], v[200:203], 0
v_exp_f32 v49, v49
v_exp_f32 v50, v50
v_mfma_f32_16x16x32_bf16 v[232:235], v[136:139], v[216:219], 0
v_exp_f32 v51, v51
v_exp_f32 v52, v52
v_exp_f32 v53, v53
v_exp_f32 v54, v54
v_exp_f32 v55, v55
v_exp_f32 v172, v172
v_exp_f32 v173, v173
v_exp_f32 v174, v174
v_exp_f32 v175, v175
v_exp_f32 v176, v176
v_exp_f32 v177, v177
v_exp_f32 v178, v178
v_exp_f32 v179, v179
v_cvt_pk_bf16_f32 v204, v48, v49
v_cvt_pk_bf16_f32 v205, v50, v51
v_cvt_pk_bf16_f32 v206, v52, v53
v_cvt_pk_bf16_f32 v207, v54, v55
v_cvt_pk_bf16_f32 v220, v172, v173
v_cvt_pk_bf16_f32 v221, v174, v175
v_cvt_pk_bf16_f32 v222, v176, v177
v_cvt_pk_bf16_f32 v223, v178, v179
v_pk_fma_f32 v[56:57], v[180:181], v[8:9], v[190:191] op_sel:[0,1,1] op_sel_hi:[1,1,1] neg_lo:[0,0,1] neg_hi:[0,0,1]
v_pk_fma_f32 v[58:59], v[182:183], v[8:9], v[190:191] op_sel:[0,1,1] op_sel_hi:[1,1,1] neg_lo:[0,0,1] neg_hi:[0,0,1]
v_pk_fma_f32 v[60:61], v[184:185], v[8:9], v[190:191] op_sel:[0,1,1] op_sel_hi:[1,1,1] neg_lo:[0,0,1] neg_hi:[0,0,1]
v_pk_fma_f32 v[62:63], v[186:187], v[8:9], v[190:191] op_sel:[0,1,1] op_sel_hi:[1,1,1] neg_lo:[0,0,1] neg_hi:[0,0,1]
v_pk_fma_f32 v[180:181], v[180:181], v[8:9], v[194:195] op_sel:[0,1,1] op_sel_hi:[1,1,1] neg_lo:[1,0,0] neg_hi:[1,0,0]
v_pk_fma_f32 v[182:183], v[182:183], v[8:9], v[194:195] op_sel:[0,1,1] op_sel_hi:[1,1,1] neg_lo:[1,0,0] neg_hi:[1,0,0]
v_pk_fma_f32 v[184:185], v[184:185], v[8:9], v[194:195] op_sel:[0,1,1] op_sel_hi:[1,1,1] neg_lo:[1,0,0] neg_hi:[1,0,0]
v_pk_fma_f32 v[186:187], v[186:187], v[8:9], v[194:195] op_sel:[0,1,1] op_sel_hi:[1,1,1] neg_lo:[1,0,0] neg_hi:[1,0,0]
v_exp_f32 v56, v56
v_mfma_f32_16x16x32_bf16 v[148:151], v[136:139], v[204:207], 0
v_exp_f32 v57, v57
v_exp_f32 v58, v58
v_mfma_f32_16x16x32_bf16 v[236:239], v[136:139], v[220:223], 0
v_exp_f32 v59, v59
v_exp_f32 v60, v60
v_exp_f32 v61, v61
v_exp_f32 v62, v62
v_exp_f32 v63, v63
v_exp_f32 v180, v180
v_exp_f32 v181, v181
v_exp_f32 v182, v182
v_exp_f32 v183, v183
v_exp_f32 v184, v184
v_exp_f32 v185, v185
v_exp_f32 v186, v186
v_exp_f32 v187, v187
v_cvt_pk_bf16_f32 v208, v56, v57
v_cvt_pk_bf16_f32 v209, v58, v59
v_cvt_pk_bf16_f32 v210, v60, v61
v_cvt_pk_bf16_f32 v211, v62, v63
L_pg4:
s_cbranch_execz L_vret
v_cvt_pk_bf16_f32 v224, v180, v181
v_cvt_pk_bf16_f32 v225, v182, v183
v_cvt_pk_bf16_f32 v226, v184, v185
v_cvt_pk_bf16_f32 v227, v186, v187
v_mfma_f32_16x16x32_bf16 v[152:155], v[136:139], v[208:211], 0
s_nop 0
v_mfma_f32_16x16x32_bf16 v[240:243], v[136:139], v[224:227], 0
s_waitcnt vmcnt(1)
s_mov_b32 s27, 131072
L_chk2:
v_max3_u32 v20, v80, v81, v82
v_max3_u32 v20, v20, v83, v84
v_max3_u32 v20, v20, v85, v86
v_max3_u32 v20, v20, v87, v88
v_max3_u32 v20, v20, v89, v90
v_max3_u32 v20, v20, v91, v92
v_max3_u32 v20, v20, v93, v94
v_max_u32 v20, v20, v95
v_cmp_eq_u32 vcc, -1, v20
s_sub_u32 s27, s27, 1
s_cbranch_vccz L_ok2
s_cmp_eq_u32 s27, 0
s_cbranch_scc1 L_ok2
s_mov_b32 s34, s53
buffer_load_dwordx4 v[80:83], v27, s[16:19], s34 offen sc1
s_add_u32 s34, s34, 66048
buffer_load_dwordx4 v[84:87], v27, s[16:19], s34 offen sc1
s_add_u32 s34, s34, 66048
buffer_load_dwordx4 v[88:91], v27, s[16:19], s34 offen sc1
s_add_u32 s34, s34, 66048
buffer_load_dwordx4 v[92:95], v27, s[16:19], s34 offen sc1
s_waitcnt vmcnt(0)
s_branch L_chk2
L_ok2:
v_pk_add_f32 v[80:81], v[80:81], v[88:89]
v_pk_add_f32 v[82:83], v[82:83], v[90:91]
v_pk_add_f32 v[84:85], v[84:85], v[92:93]
v_pk_add_f32 v[86:87], v[86:87], v[94:95]
v_pk_add_f32 v[80:81], v[80:81], v[84:85]
v_pk_add_f32 v[82:83], v[82:83], v[86:87]
s_nop 0
v_mfma_f32_16x16x4_f32 v[100:103], v80, v29, 0
v_mfma_f32_16x16x4_f32 v[104:107], v81, v29, 0
v_mfma_f32_16x16x4_f32 v[108:111], v82, v29, 0
s_mov_b32 s34, s92
buffer_load_dwordx4 v[128:131], v22, s[16:19], s34 offen sc1
v_mfma_f32_16x16x4_f32 v[112:115], v83, v29, 0
s_nop 6
v_cvt_pk_bf16_f32 v120, v100, v101
s_add_u32 s34, s34, 33024
buffer_load_dwordx4 v[132:135], v22, s[16:19], s34 offen sc1
v_cvt_pk_bf16_f32 v121, v102, v103
v_cvt_pk_bf16_f32 v122, v104, v105
v_cvt_pk_bf16_f32 v123, v106, v107
s_add_u32 s34, s34, 33024
buffer_load_dwordx4 v[10:13], v22, s[16:19], s34 offen sc1
v_cvt_pk_bf16_f32 v124, v108, v109
v_cvt_pk_bf16_f32 v125, v110, v111
v_cvt_pk_bf16_f32 v126, v112, v113
s_add_u32 s34, s34, 33024
buffer_load_dwordx4 v[14:17], v22, s[16:19], s34 offen sc1
v_cvt_pk_bf16_f32 v127, v114, v115
s_nop 0
v_mfma_f32_16x16x32_bf16 v[64:67], v[120:123], v[196:199], 0
s_mov_b32 s34, s93
buffer_load_dwordx4 v[244:247], v28, s[16:19], s34 offen sc1
v_mfma_f32_16x16x32_bf16 v[80:83], v[124:127], v[212:215], 0
v_mfma_f32_16x16x32_bf16 v[68:71], v[120:123], v[200:203], 0
v_mfma_f32_16x16x32_bf16 v[84:87], v[124:127], v[216:219], 0
s_add_u32 s34, s34, 66048
buffer_load_dwordx4 v[248:251], v28, s[16:19], s34 offen sc1
v_mfma_f32_16x16x32_bf16 v[72:75], v[120:123], v[204:207], 0
v_mfma_f32_16x16x32_bf16 v[88:91], v[124:127], v[220:223], 0
v_mfma_f32_16x16x32_bf16 v[76:79], v[120:123], v[208:211], 0
s_barrier
v_mfma_f32_16x16x32_bf16 v[92:95], v[124:127], v[224:227], 0
s_nop 1
v_fma_f32 v64, v140, s94, v64
v_mul_f32 v64, v64, v228
s_add_u32 s85, s83, 0
s_add_u32 m0, s84, 32768
s_nop 0
buffer_load_dwordx4 v252, s[36:39], s85 offen offset:0 lds
v_fmac_f32 v64, v80, v140
v_rcp_f32 v64, v64
v_fma_f32 v68, v144, s94, v68
v_mul_f32 v68, v68, v232
buffer_load_dwordx4 v253, s[36:39], s85 offen offset:1024 lds
v_fmac_f32 v68, v84, v144
v_rcp_f32 v68, v68
v_fma_f32 v72, v148, s94, v72
v_mul_f32 v72, v72, v236
buffer_load_dwordx4 v254, s[36:39], s85 offen offset:2048 lds
v_fmac_f32 v72, v88, v148
v_rcp_f32 v72, v72
v_fma_f32 v76, v152, s94, v76
v_mul_f32 v76, v76, v240
buffer_load_dwordx4 v255, s[36:39], s85 offen offset:3072 lds
v_fmac_f32 v76, v92, v152
v_rcp_f32 v76, v76
v_mul_f32 v100, v64, v228
v_mul_f32 v108, v64, v140
v_mul_f32 v102, v68, v232
v_mul_f32 v110, v68, v144
v_mul_f32 v104, v72, v236
v_mul_f32 v112, v72, v148
v_mul_f32 v106, v76, v240
v_mul_f32 v114, v76, v152
s_waitcnt vmcnt(4)
s_mov_b32 s27, 131072
L_chk3:
v_max3_u32 v20, v128, v129, v130
v_max3_u32 v20, v20, v131, v132
v_max3_u32 v20, v20, v133, v134
v_max3_u32 v20, v20, v135, v10
v_max3_u32 v20, v20, v11, v12
v_max3_u32 v20, v20, v13, v14
v_max3_u32 v20, v20, v15, v16
v_max3_u32 v20, v20, v17, v244
v_max3_u32 v20, v20, v245, v246
v_max3_u32 v20, v20, v247, v248
v_max3_u32 v20, v20, v249, v250
v_max_u32 v20, v20, v251
v_cmp_eq_u32 vcc, -1, v20
s_sub_u32 s27, s27, 1
s_cbranch_vccz L_ok3
s_cmp_eq_u32 s27, 0
s_cbranch_scc1 L_ok3
s_mov_b32 s34, s92
buffer_load_dwordx4 v[128:131], v22, s[16:19], s34 offen sc1
s_add_u32 s34, s34, 33024
buffer_load_dwordx4 v[132:135], v22, s[16:19], s34 offen sc1
s_add_u32 s34, s34, 33024
buffer_load_dwordx4 v[10:13], v22, s[16:19], s34 offen sc1
s_add_u32 s34, s34, 33024
buffer_load_dwordx4 v[14:17], v22, s[16:19], s34 offen sc1
s_mov_b32 s34, s93
buffer_load_dwordx4 v[244:247], v28, s[16:19], s34 offen sc1
s_add_u32 s34, s34, 66048
buffer_load_dwordx4 v[248:251], v28, s[16:19], s34 offen sc1
s_waitcnt vmcnt(0)
s_branch L_chk3
L_ok3:
v_mfma_f32_16x16x32_bf16 v[32:35], v[128:131], v[196:199], 0
v_mfma_f32_16x16x32_bf16 v[156:159], v[10:13], v[212:215], 0
v_mfma_f32_16x16x32_bf16 v[36:39], v[132:135], v[196:199], 0
v_mfma_f32_16x16x32_bf16 v[160:163], v[14:17], v[212:215], 0
v_mfma_f32_16x16x32_bf16 v[40:43], v[128:131], v[200:203], 0
v_mfma_f32_16x16x32_bf16 v[164:167], v[10:13], v[216:219], 0
v_mfma_f32_16x16x32_bf16 v[44:47], v[132:135], v[200:203], 0
v_mfma_f32_16x16x32_bf16 v[168:171], v[14:17], v[216:219], 0
v_mfma_f32_16x16x32_bf16 v[48:51], v[128:131], v[204:207], 0
v_mfma_f32_16x16x32_bf16 v[172:175], v[10:13], v[220:223], 0
v_mfma_f32_16x16x32_bf16 v[52:55], v[132:135], v[204:207], 0
v_mfma_f32_16x16x32_bf16 v[176:179], v[14:17], v[220:223], 0
v_pk_mul_f32 v[32:33], v[32:33], v[100:101] op_sel_hi:[1,0]
v_pk_mul_f32 v[34:35], v[34:35], v[100:101] op_sel_hi:[1,0]
v_pk_mul_f32 v[36:37], v[36:37], v[100:101] op_sel_hi:[1,0]
v_pk_mul_f32 v[38:39], v[38:39], v[100:101] op_sel_hi:[1,0]
v_pk_fma_f32 v[32:33], v[156:157], v[108:109], v[32:33] op_sel_hi:[1,0,1]
v_pk_fma_f32 v[34:35], v[158:159], v[108:109], v[34:35] op_sel_hi:[1,0,1]
v_pk_fma_f32 v[36:37], v[160:161], v[108:109], v[36:37] op_sel_hi:[1,0,1]
v_pk_fma_f32 v[38:39], v[162:163], v[108:109], v[38:39] op_sel_hi:[1,0,1]
v_cvt_pk_bf16_f32 v64, v32, v33
v_cvt_pk_bf16_f32 v65, v34, v35
v_cvt_pk_bf16_f32 v66, v36, v37
v_cvt_pk_bf16_f32 v67, v38, v39
buffer_store_dwordx4 v[64:67], v1, s[56:59], s54 offen sc1
s_add_u32 s54, s54, 65536
v_mfma_f32_16x16x32_bf16 v[56:59], v[128:131], v[208:211], 0
v_mfma_f32_16x16x32_bf16 v[180:183], v[10:13], v[224:227], 0
v_mfma_f32_16x16x32_bf16 v[60:63], v[132:135], v[208:211], 0
v_mfma_f32_16x16x32_bf16 v[184:187], v[14:17], v[224:227], 0
v_pk_mul_f32 v[40:41], v[40:41], v[102:103] op_sel_hi:[1,0]
v_pk_mul_f32 v[42:43], v[42:43], v[102:103] op_sel_hi:[1,0]
v_pk_mul_f32 v[44:45], v[44:45], v[102:103] op_sel_hi:[1,0]
v_pk_mul_f32 v[46:47], v[46:47], v[102:103] op_sel_hi:[1,0]
v_pk_fma_f32 v[40:41], v[164:165], v[110:111], v[40:41] op_sel_hi:[1,0,1]
v_pk_fma_f32 v[42:43], v[166:167], v[110:111], v[42:43] op_sel_hi:[1,0,1]
v_pk_fma_f32 v[44:45], v[168:169], v[110:111], v[44:45] op_sel_hi:[1,0,1]
v_pk_fma_f32 v[46:47], v[170:171], v[110:111], v[46:47] op_sel_hi:[1,0,1]
v_cvt_pk_bf16_f32 v68, v40, v41
v_cvt_pk_bf16_f32 v69, v42, v43
v_cvt_pk_bf16_f32 v70, v44, v45
v_cvt_pk_bf16_f32 v71, v46, v47
buffer_store_dwordx4 v[68:71], v1, s[56:59], s54 offen sc1
s_add_u32 s54, s54, 65536
v_pk_mul_f32 v[48:49], v[48:49], v[104:105] op_sel_hi:[1,0]
v_pk_mul_f32 v[50:51], v[50:51], v[104:105] op_sel_hi:[1,0]
v_pk_mul_f32 v[52:53], v[52:53], v[104:105] op_sel_hi:[1,0]
v_pk_mul_f32 v[54:55], v[54:55], v[104:105] op_sel_hi:[1,0]
v_pk_fma_f32 v[48:49], v[172:173], v[112:113], v[48:49] op_sel_hi:[1,0,1]
v_pk_fma_f32 v[50:51], v[174:175], v[112:113], v[50:51] op_sel_hi:[1,0,1]
v_pk_fma_f32 v[52:53], v[176:177], v[112:113], v[52:53] op_sel_hi:[1,0,1]
v_pk_fma_f32 v[54:55], v[178:179], v[112:113], v[54:55] op_sel_hi:[1,0,1]
v_cvt_pk_bf16_f32 v72, v48, v49
v_cvt_pk_bf16_f32 v73, v50, v51
v_cvt_pk_bf16_f32 v74, v52, v53
v_cvt_pk_bf16_f32 v75, v54, v55
buffer_store_dwordx4 v[72:75], v1, s[56:59], s54 offen sc1
s_add_u32 s54, s54, 65536
v_pk_mul_f32 v[56:57], v[56:57], v[106:107] op_sel_hi:[1,0]
v_pk_mul_f32 v[58:59], v[58:59], v[106:107] op_sel_hi:[1,0]
v_pk_mul_f32 v[60:61], v[60:61], v[106:107] op_sel_hi:[1,0]
v_pk_mul_f32 v[62:63], v[62:63], v[106:107] op_sel_hi:[1,0]
v_pk_fma_f32 v[56:57], v[180:181], v[114:115], v[56:57] op_sel_hi:[1,0,1]
v_pk_fma_f32 v[58:59], v[182:183], v[114:115], v[58:59] op_sel_hi:[1,0,1]
v_pk_fma_f32 v[60:61], v[184:185], v[114:115], v[60:61] op_sel_hi:[1,0,1]
v_pk_fma_f32 v[62:63], v[186:187], v[114:115], v[62:63] op_sel_hi:[1,0,1]
v_cvt_pk_bf16_f32 v76, v56, v57
v_cvt_pk_bf16_f32 v77, v58, v59
v_cvt_pk_bf16_f32 v78, v60, v61
v_cvt_pk_bf16_f32 v79, v62, v63
buffer_store_dwordx4 v[76:79], v1, s[56:59], s54 offen sc1
v_pk_mul_f32 v[100:101], v[32:33], v[244:245]
v_pk_fma_f32 v[100:101], v[34:35], v[246:247], v[100:101]
v_pk_fma_f32 v[100:101], v[36:37], v[248:249], v[100:101]
v_pk_fma_f32 v[100:101], v[38:39], v[250:251], v[100:101]
v_pk_mul_f32 v[102:103], v[40:41], v[244:245]
v_pk_fma_f32 v[102:103], v[42:43], v[246:247], v[102:103]
v_pk_fma_f32 v[102:103], v[44:45], v[248:249], v[102:103]
v_pk_fma_f32 v[102:103], v[46:47], v[250:251], v[102:103]
v_pk_mul_f32 v[104:105], v[48:49], v[244:245]
v_pk_fma_f32 v[104:105], v[50:51], v[246:247], v[104:105]
v_pk_fma_f32 v[104:105], v[52:53], v[248:249], v[104:105]
v_pk_fma_f32 v[104:105], v[54:55], v[250:251], v[104:105]
v_pk_mul_f32 v[106:107], v[56:57], v[244:245]
v_pk_fma_f32 v[106:107], v[58:59], v[246:247], v[106:107]
v_pk_fma_f32 v[106:107], v[60:61], v[248:249], v[106:107]
v_pk_fma_f32 v[106:107], v[62:63], v[250:251], v[106:107]
v_add_f32 v96, v100, v101
v_add_f32 v97, v102, v103
v_add_f32 v98, v104, v105
v_add_f32 v99, v106, v107
s_nop 1
v_permlane16_swap_b32 v96, v97
v_permlane16_swap_b32 v98, v99
s_nop 0
v_add_f32 v96, v96, v97
v_add_f32 v98, v98, v99
s_nop 1
v_permlane32_swap_b32 v96, v98
s_nop 0
v_add_f32 v96, v96, v98
v_lshlrev_b32 v16, 2, v0
buffer_store_dword v96, v16, s[16:19], s55 offen sc1
L_ph2:
s_add_u32 s85, s83, 524288
s_add_u32 m0, s84, 65536
s_nop 0
buffer_load_dwordx4 v252, s[36:39], s85 offen offset:0 lds
v_accvgpr_read_b32 v140, a144
v_accvgpr_read_b32 v142, a146
v_accvgpr_read_b32 v141, a145
v_accvgpr_read_b32 v143, a147
s_nop 0
v_permlane16_swap_b32 v140, v142
v_permlane16_swap_b32 v141, v143
v_lshlrev_b32 v32, 16, v140
v_and_b32 v33, 0xffff0000, v140
v_lshlrev_b32 v34, 16, v141
v_and_b32 v35, 0xffff0000, v141
v_lshlrev_b32 v40, 16, v142
v_and_b32 v41, 0xffff0000, v142
v_lshlrev_b32 v42, 16, v143
v_and_b32 v43, 0xffff0000, v143
v_accvgpr_read_b32 v144, a148
v_accvgpr_read_b32 v146, a150
buffer_load_dwordx4 v253, s[36:39], s85 offen offset:1024 lds
v_accvgpr_read_b32 v145, a149
v_accvgpr_read_b32 v147, a151
s_nop 0
v_permlane16_swap_b32 v144, v146
v_permlane16_swap_b32 v145, v147
v_lshlrev_b32 v48, 16, v144
v_and_b32 v49, 0xffff0000, v144
v_lshlrev_b32 v50, 16, v145
v_and_b32 v51, 0xffff0000, v145
v_lshlrev_b32 v56, 16, v146
v_and_b32 v57, 0xffff0000, v146
v_lshlrev_b32 v58, 16, v147
v_and_b32 v59, 0xffff0000, v147
v_accvgpr_read_b32 v148, a152
v_accvgpr_read_b32 v150, a154
v_accvgpr_read_b32 v149, a153
v_accvgpr_read_b32 v151, a155
s_nop 0
buffer_load_dwordx4 v254, s[36:39], s85 offen offset:2048 lds
v_permlane16_swap_b32 v148, v150
v_permlane16_swap_b32 v149, v151
v_lshlrev_b32 v36, 16, v148
v_and_b32 v37, 0xffff0000, v148
v_lshlrev_b32 v38, 16, v149
v_and_b32 v39, 0xffff0000, v149
v_lshlrev_b32 v44, 16, v150
v_and_b32 v45, 0xffff0000, v150
v_lshlrev_b32 v46, 16, v151
v_and_b32 v47, 0xffff0000, v151
v_accvgpr_read_b32 v152, a156
v_accvgpr_read_b32 v154, a158
v_accvgpr_read_b32 v153, a157
v_accvgpr_read_b32 v155, a159
s_nop 0
v_permlane16_swap_b32 v152, v154
v_permlane16_swap_b32 v153, v155
v_lshlrev_b32 v52, 16, v152
buffer_load_dwordx4 v255, s[36:39], s85 offen offset:3072 lds
v_and_b32 v53, 0xffff0000, v152
v_lshlrev_b32 v54, 16, v153
v_and_b32 v55, 0xffff0000, v153
v_lshlrev_b32 v60, 16, v154
v_and_b32 v61, 0xffff0000, v154
v_lshlrev_b32 v62, 16, v155
v_and_b32 v63, 0xffff0000, v155
v_lshrrev_b32 v17, 2, v0
v_lshlrev_b32 v17, 7, v17
v_bfe_u32 v18, v0, 3, 2
v_lshlrev_b32 v18, 5, v18
v_and_b32 v19, 3, v0
v_lshlrev_b32 v19, 3, v19
v_add3_u32 v16, v17, v18, v19
v_xor_b32 v17, 32, v16
v_xor_b32 v18, 64, v16
v_xor_b32 v19, 96, v16
v_add_u32 v16, 32768, v16
s_add_u32 s85, s83, 786432
s_add_u32 m0, s84, 81920
s_nop 0
buffer_load_dwordx4 v252, s[36:39], s85 offen offset:0 lds
v_add_u32 v17, 32768, v17
v_add_u32 v18, 32768, v18
v_add_u32 v19, 32768, v19
v_and_b32 v23, 31, v0
v_lshlrev_b32 v22, 3, v23
v_lshlrev_b32 v23, 2, v23
v_lshrrev_b32 v20, 5, v0
v_lshl_add_u32 v20, v20, 8, v23
s_bfe_u32 s92, s82, 0x40002
s_lshl_b32 s92, s92, 14
s_lshl_b32 s27, s46, 7
s_add_u32 s92, s92, s27
s_add_u32 s92, s92, s30
s_add_u32 s92, s92, 491520
s_add_u32 s93, s92, 4096
s_lshl_b32 s94, s82, 7
s_add_u32 s94, s94, 131072
s_and_b32 s21, s82, 63
buffer_load_dwordx4 v253, s[36:39], s85 offen offset:1024 lds
s_lshl_b32 s21, s21, 15
s_and_b32 s27, s21, 0xffffe000
s_add_u32 s21, s21, s27
s_lshr_b32 s27, s21, 8
s_and_b32 s27, s27, 8192
s_or_b32 s21, s21, s27
s_xor_b32 s21, s21, s30
v_add_u32 v21, 65536, v1
v_accvgpr_write_b32 a223, v1
s_and_b32 s34, s80, 7
s_lshl_b32 s34, s34, 9
v_and_b32 v31, 3, v0
v_lshl_add_u32 v31, v31, 7, s34
v_and_b32 v29, 4, v0
v_lshl_or_b32 v31, v29, 10, v31
v_and_b32 v29, 8, v0
v_lshl_or_b32 v31, v29, 11, v31
s_and_b32 s25, s2, 3
buffer_load_dwordx4 v254, s[36:39], s85 offen offset:2048 lds
s_lshl_b32 s25, s25, 3
s_lshr_b32 s27, s2, 5
s_add_u32 s25, s25, s27
s_bfe_u32 s26, s2, 0x20003
s_movk_i32 s27, 6944
v_lshlrev_b32 v9, 4, v0
v_add_u32 v14, 0, v0
v_mul_u32_u24 v14, 4682, v14
v_lshrrev_b32 v14, 16, v14
v_mad_u32_u24 v2, v14, s27, v9
v_add_u32 v14, 64, v0
v_mul_u32_u24 v14, 4682, v14
v_lshrrev_b32 v14, 16, v14
v_mad_u32_u24 v3, v14, s27, v9
v_add_u32 v14, 128, v0
v_mul_u32_u24 v14, 4682, v14
v_lshrrev_b32 v14, 16, v14
v_mad_u32_u24 v4, v14, s27, v9
buffer_load_dwordx4 v255, s[36:39], s85 offen offset:3072 lds
v_add_u32 v14, 192, v0
v_mul_u32_u24 v14, 4682, v14
v_lshrrev_b32 v14, 16, v14
v_mad_u32_u24 v5, v14, s27, v9
v_add_u32 v14, 256, v0
v_mul_u32_u24 v14, 4682, v14
v_lshrrev_b32 v14, 16, v14
v_mad_u32_u24 v6, v14, s27, v9
v_add_u32 v6, 4096, v6
v_add_u32 v14, 320, v0
v_mul_u32_u24 v14, 4682, v14
v_lshrrev_b32 v14, 16, v14
v_mad_u32_u24 v7, v14, s27, v9
v_add_u32 v7, 4096, v7
v_add_u32 v14, 384, v0
v_mul_u32_u24 v14, 4682, v14
v_lshrrev_b32 v14, 16, v14
v_mad_u32_u24 v8, v14, s27, v9
v_add_u32 v8, 4096, v8
s_lshl_b32 s87, s26, 4
s_lshl_b32 s35, s20, 2
s_add_u32 s87, s87, s35
v_add_u32 v10, 65536, v9
v_add_u32 v11, 131072, v9
v_add_u32 v12, 196608, v9
s_mul_i32 s22, s47, 229376
s_mul_i32 s27, s25, 224
s_add_u32 s22, s22, s27
s_mul_i32 s27, s46, 14336
s_mul_i32 s23, s47, 7168
s_add_u32 s23, s23, s27
s_bitcmp1_b32 s20, 0
s_cselect_b32 s4, s74, s72
s_cselect_b32 s5, s75, s73
s_mov_b32 s6, 7340032
v_lshrrev_b32 v14, 2, v0
v_mul_u32_u24 v14, 224, v14
v_and_b32 v15, 3, v0
v_lshl_add_u32 v13, v15, 3, v14
v_mov_b32 v30, 2
s_sub_u32 s27, s100, 16
s_waitcnt vmcnt(8)
s_barrier
s_cmp_lg_u32 s20, 0
s_cbranch_scc1 L_sig2
buffer_store_dword v30, off, s[16:19], s27 sc1
L_sig2:
s_add_u32 s85, s83, 1048576
s_add_u32 m0, s84, 98304
s_nop 0
buffer_load_dwordx4 v252, s[36:39], s85 offen offset:0 lds
buffer_load_dwordx4 v253, s[36:39], s85 offen offset:1024 lds
buffer_load_dwordx4 v254, s[36:39], s85 offen offset:2048 lds
buffer_load_dwordx4 v255, s[36:39], s85 offen offset:3072 lds
s_add_u32 s85, s83, 1310720
s_add_u32 m0, s84, 114688
s_nop 0
buffer_load_dwordx4 v252, s[36:39], s85 offen offset:0 lds
buffer_load_dwordx4 v253, s[36:39], s85 offen offset:1024 lds
buffer_load_dwordx4 v254, s[36:39], s85 offen offset:2048 lds
buffer_load_dwordx4 v255, s[36:39], s85 offen offset:3072 lds
s_add_u32 s8, s32, 4194304
s_addc_u32 s9, s33, 0
s_mov_b32 s10, 4194304
s_mov_b32 s11, 0x20000
s_getpc_b64 s[52:53]
L_pc_b:
s_add_u32 s52, s52, L_ph3-L_pc_b
s_addc_u32 s53, s53, 0
s_lshr_b32 s54, s2, 3
s_lshl_b32 s54, s54, 2
s_add_u32 s54, s54, s20
s_mul_i32 s54, s54, 3
v_min_u32 v26, 2, v0
v_add_u32 v26, s54, v26
v_lshlrev_b32 v26, 7, v26
v_min_u32 v26, L_code_end-L_ph3-4, v26
v_mov_b32 v27, s53
v_add_co_u32 v26, vcc, s52, v26
s_nop 1
v_addc_co_u32 v27, vcc, 0, v27, vcc
global_load_dword a250, v[26:27], off
s_call_b64 s[96:97], L_visit1
s_cmp_lg_u32 s20, 0
s_cbranch_scc1 L_got2
s_mov_b32 s34, 196608
s_add_u32 s34, s34, s30
s_mov_b32 s27, 131072
L_poll2:
buffer_load_dword v30, v31, s[16:19], s34 offen sc1
s_sub_u32 s27, s27, 1
s_cmp_eq_u32 s27, 0
s_cbranch_scc1 L_got2
s_waitcnt vmcnt(0)
v_cmp_gt_u32 vcc, 2, v30
s_nop 0
s_cbranch_vccnz L_poll2
L_got2:
s_waitcnt vmcnt(0) lgkmcnt(0)
s_barrier
buffer_load_dwordx4 a[40:43], v1, s[56:59], s21 offen offset:0 sc1
buffer_load_dwordx4 a[44:47], v1, s[56:59], s21 offen offset:1024 sc1
buffer_load_dwordx4 a[48:51], v21, s[56:59], s21 offen offset:0 sc1
buffer_load_dwordx4 a[52:55], v21, s[56:59], s21 offen offset:1024 sc1
buffer_load_dwordx4 a[56:59], v1, s[56:59], s21 offen offset:2048 sc1
buffer_load_dwordx4 a[60:63], v1, s[56:59], s21 offen offset:3072 sc1
buffer_load_dwordx4 a[64:67], v21, s[56:59], s21 offen offset:2048 sc1
buffer_load_dwordx4 a[68:71], v21, s[56:59], s21 offen offset:3072 sc1
ds_read_b64_tr_b16 a[0:1], v16 offset:0
ds_read_b64_tr_b16 a[2:3], v16 offset:2048
ds_read_b64_tr_b16 a[4:5], v16 offset:4096
ds_read_b64_tr_b16 a[6:7], v16 offset:6144
ds_read_b64_tr_b16 a[8:9], v17 offset:0
ds_read_b64_tr_b16 a[10:11], v17 offset:2048
ds_read_b64_tr_b16 a[12:13], v17 offset:4096
ds_read_b64_tr_b16 a[14:15], v17 offset:6144
ds_read_b64_tr_b16 a[16:17], v18 offset:0
ds_read_b64_tr_b16 a[18:19], v18 offset:2048
ds_read_b64_tr_b16 a[20:21], v18 offset:4096
ds_read_b64_tr_b16 a[22:23], v18 offset:6144
s_waitcnt vmcnt(4) lgkmcnt(8)
v_mfma_f32_16x16x32_bf16 v[32:35], a[0:3], a[40:43], v[32:35]
ds_read_b64_tr_b16 a[24:25], v19 offset:0
s_add_u32 s21, s21, 4096
v_mfma_f32_16x16x32_bf16 v[32:35], a[4:7], a[44:47], v[32:35]
ds_read_b64_tr_b16 a[26:27], v19 offset:2048
buffer_load_dwordx4 a[72:75], v1, s[56:59], s21 offen offset:0 sc1
v_mfma_f32_16x16x32_bf16 v[36:39], a[4:7], a[52:55], v[36:39]
ds_read_b64_tr_b16 a[28:29], v19 offset:4096
buffer_load_dwordx4 a[76:79], v1, s[56:59], s21 offen offset:1024 sc1
v_mfma_f32_16x16x32_bf16 v[36:39], a[0:3], a[48:51], v[36:39]
ds_read_b64_tr_b16 a[30:31], v19 offset:6144
s_waitcnt lgkmcnt(8)
v_mfma_f32_16x16x32_bf16 v[40:43], a[8:11], a[40:43], v[40:43]
ds_read_b64_tr_b16 a[0:1], v16 offset:8192
buffer_load_dwordx4 a[80:83], v21, s[56:59], s21 offen offset:0 sc1
v_mfma_f32_16x16x32_bf16 v[40:43], a[12:15], a[44:47], v[40:43]
ds_read_b64_tr_b16 a[2:3], v16 offset:10240
buffer_load_dwordx4 a[84:87], v21, s[56:59], s21 offen offset:1024 sc1
v_mfma_f32_16x16x32_bf16 v[44:47], a[12:15], a[52:55], v[44:47]
ds_read_b64_tr_b16 a[4:5], v16 offset:12288
buffer_load_dwordx4 a[88:91], v1, s[56:59], s21 offen offset:2048 sc1
v_mfma_f32_16x16x32_bf16 v[44:47], a[8:11], a[48:51], v[44:47]
ds_read_b64_tr_b16 a[6:7], v16 offset:14336
s_waitcnt lgkmcnt(8)
v_mfma_f32_16x16x32_bf16 v[48:51], a[16:19], a[40:43], v[48:51]
ds_read_b64_tr_b16 a[8:9], v17 offset:8192
buffer_load_dwordx4 a[92:95], v1, s[56:59], s21 offen offset:3072 sc1
v_mfma_f32_16x16x32_bf16 v[48:51], a[20:23], a[44:47], v[48:51]
ds_read_b64_tr_b16 a[10:11], v17 offset:10240
buffer_load_dwordx4 a[96:99], v21, s[56:59], s21 offen offset:2048 sc1
v_mfma_f32_16x16x32_bf16 v[52:55], a[20:23], a[52:55], v[52:55]
ds_read_b64_tr_b16 a[12:13], v17 offset:12288
v_mfma_f32_16x16x32_bf16 v[52:55], a[16:19], a[48:51], v[52:55]
ds_read_b64_tr_b16 a[14:15], v17 offset:14336
s_waitcnt lgkmcnt(8)
v_mfma_f32_16x16x32_bf16 v[56:59], a[24:27], a[40:43], v[56:59]
ds_read_b64_tr_b16 a[16:17], v18 offset:8192
buffer_load_dwordx4 a[100:103], v21, s[56:59], s21 offen offset:3072 sc1
v_mfma_f32_16x16x32_bf16 v[56:59], a[28:31], a[44:47], v[56:59]
ds_read_b64_tr_b16 a[18:19], v18 offset:10240
v_mfma_f32_16x16x32_bf16 v[60:63], a[28:31], a[52:55], v[60:63]
ds_read_b64_tr_b16 a[20:21], v18 offset:12288
v_mfma_f32_16x16x32_bf16 v[60:63], a[24:27], a[48:51], v[60:63]
ds_read_b64_tr_b16 a[22:23], v18 offset:14336
s_waitcnt vmcnt(8) lgkmcnt(8)
v_mfma_f32_16x16x32_bf16 v[32:35], a[0:3], a[56:59], v[32:35]
ds_read_b64_tr_b16 a[24:25], v19 offset:8192
s_add_u32 s21, s21, 12288
v_mfma_f32_16x16x32_bf16 v[32:35], a[4:7], a[60:63], v[32:35]
ds_read_b64_tr_b16 a[26:27], v19 offset:10240
buffer_load_dwordx4 a[40:43], v1, s[56:59], s21 offen offset:0 sc1
v_mfma_f32_16x16x32_bf16 v[36:39], a[4:7], a[68:71], v[36:39]
ds_read_b64_tr_b16 a[28:29], v19 offset:12288
v_mfma_f32_16x16x32_bf16 v[36:39], a[0:3], a[64:67], v[36:39]
ds_read_b64_tr_b16 a[30:31], v19 offset:14336
s_waitcnt lgkmcnt(8)
v_mfma_f32_16x16x32_bf16 v[40:43], a[8:11], a[56:59], v[40:43]
ds_read_b64_tr_b16 a[0:1], v16 offset:16384
buffer_load_dwordx4 a[44:47], v1, s[56:59], s21 offen offset:1024 sc1
v_mfma_f32_16x16x32_bf16 v[40:43], a[12:15], a[60:63], v[40:43]
ds_read_b64_tr_b16 a[2:3], v16 offset:18432
v_mfma_f32_16x16x32_bf16 v[44:47], a[12:15], a[68:71], v[44:47]
ds_read_b64_tr_b16 a[4:5], v16 offset:20480
v_mfma_f32_16x16x32_bf16 v[44:47], a[8:11], a[64:67], v[44:47]
ds_read_b64_tr_b16 a[6:7], v16 offset:22528
s_waitcnt lgkmcnt(8)
v_mfma_f32_16x16x32_bf16 v[48:51], a[16:19], a[56:59], v[48:51]
ds_read_b64_tr_b16 a[8:9], v17 offset:16384
buffer_load_dwordx4 a[48:51], v21, s[56:59], s21 offen offset:0 sc1
v_mfma_f32_16x16x32_bf16 v[48:51], a[20:23], a[60:63], v[48:51]
ds_read_b64_tr_b16 a[10:11], v17 offset:18432
v_mfma_f32_16x16x32_bf16 v[52:55], a[20:23], a[68:71], v[52:55]
ds_read_b64_tr_b16 a[12:13], v17 offset:20480
v_mfma_f32_16x16x32_bf16 v[52:55], a[16:19], a[64:67], v[52:55]
ds_read_b64_tr_b16 a[14:15], v17 offset:22528
s_waitcnt lgkmcnt(8)
v_mfma_f32_16x16x32_bf16 v[56:59], a[24:27], a[56:59], v[56:59]
ds_read_b64_tr_b16 a[16:17], v18 offset:16384
buffer_load_dwordx4 a[52:55], v21, s[56:59], s21 offen offset:1024 sc1
v_mfma_f32_16x16x32_bf16 v[56:59], a[28:31], a[60:63], v[56:59]
ds_read_b64_tr_b16 a[18:19], v18 offset:18432
v_mfma_f32_16x16x32_bf16 v[60:63], a[28:31], a[68:71], v[60:63]
ds_read_b64_tr_b16 a[20:21], v18 offset:20480
v_mfma_f32_16x16x32_bf16 v[60:63], a[24:27], a[64:67], v[60:63]
ds_read_b64_tr_b16 a[22:23], v18 offset:22528
s_waitcnt vmcnt(8) lgkmcnt(8)
v_mfma_f32_16x16x32_bf16 v[32:35], a[0:3], a[72:75], v[32:35]
ds_read_b64_tr_b16 a[24:25], v19 offset:16384
buffer_load_dwordx4 a[56:59], v1, s[56:59], s21 offen offset:2048 sc1
v_mfma_f32_16x16x32_bf16 v[32:35], a[4:7], a[76:79], v[32:35]
ds_read_b64_tr_b16 a[26:27], v19 offset:18432
v_mfma_f32_16x16x32_bf16 v[36:39], a[4:7], a[84:87], v[36:39]
ds_read_b64_tr_b16 a[28:29], v19 offset:20480
buffer_load_dword v64, v20, s[16:19], s92 offen offset:0 sc1
v_mfma_f32_16x16x32_bf16 v[36:39], a[0:3], a[80:83], v[36:39]
ds_read_b64_tr_b16 a[30:31], v19 offset:22528
s_waitcnt lgkmcnt(8)
v_mfma_f32_16x16x32_bf16 v[40:43], a[8:11], a[72:75], v[40:43]
ds_read_b64_tr_b16 a[0:1], v16 offset:24576
buffer_load_dwordx4 a[60:63], v1, s[56:59], s21 offen offset:3072 sc1
v_mfma_f32_16x16x32_bf16 v[40:43], a[12:15], a[76:79], v[40:43]
ds_read_b64_tr_b16 a[2:3], v16 offset:26624
v_mfma_f32_16x16x32_bf16 v[44:47], a[12:15], a[84:87], v[44:47]
ds_read_b64_tr_b16 a[4:5], v16 offset:28672
v_mfma_f32_16x16x32_bf16 v[44:47], a[8:11], a[80:83], v[44:47]
ds_read_b64_tr_b16 a[6:7], v16 offset:30720
s_waitcnt lgkmcnt(8)
v_mfma_f32_16x16x32_bf16 v[48:51], a[16:19], a[72:75], v[48:51]
ds_read_b64_tr_b16 a[8:9], v17 offset:24576
buffer_load_dwordx4 a[64:67], v21, s[56:59], s21 offen offset:2048 sc1
L_pg5:
s_cbranch_execz L_vret
v_mfma_f32_16x16x32_bf16 v[48:51], a[20:23], a[76:79], v[48:51]
ds_read_b64_tr_b16 a[10:11], v17 offset:26624
v_mfma_f32_16x16x32_bf16 v[52:55], a[20:23], a[84:87], v[52:55]
ds_read_b64_tr_b16 a[12:13], v17 offset:28672
buffer_load_dword v65, v20, s[16:19], s92 offen offset:512 sc1
v_mfma_f32_16x16x32_bf16 v[52:55], a[16:19], a[80:83], v[52:55]
ds_read_b64_tr_b16 a[14:15], v17 offset:30720
s_waitcnt lgkmcnt(8)
v_mfma_f32_16x16x32_bf16 v[56:59], a[24:27], a[72:75], v[56:59]
ds_read_b64_tr_b16 a[16:17], v18 offset:24576
buffer_load_dwordx4 a[68:71], v21, s[56:59], s21 offen offset:3072 sc1
v_mfma_f32_16x16x32_bf16 v[56:59], a[28:31], a[76:79], v[56:59]
ds_read_b64_tr_b16 a[18:19], v18 offset:26624
v_mfma_f32_16x16x32_bf16 v[60:63], a[28:31], a[84:87], v[60:63]
ds_read_b64_tr_b16 a[20:21], v18 offset:28672
v_mfma_f32_16x16x32_bf16 v[60:63], a[24:27], a[80:83], v[60:63]
ds_read_b64_tr_b16 a[22:23], v18 offset:30720
s_waitcnt vmcnt(10) lgkmcnt(8)
v_mfma_f32_16x16x32_bf16 v[32:35], a[0:3], a[88:91], v[32:35]
ds_read_b64_tr_b16 a[24:25], v19 offset:24576
s_add_u32 s21, s21, 4096
v_mfma_f32_16x16x32_bf16 v[32:35], a[4:7], a[92:95], v[32:35]
ds_read_b64_tr_b16 a[26:27], v19 offset:26624
buffer_load_dwordx4 a[72:75], v1, s[56:59], s21 offen offset:0 sc1
v_mfma_f32_16x16x32_bf16 v[36:39], a[4:7], a[100:103], v[36:39]
ds_read_b64_tr_b16 a[28:29], v19 offset:28672
buffer_load_dword v66, v20, s[16:19], s92 offen offset:1024 sc1
v_mfma_f32_16x16x32_bf16 v[36:39], a[0:3], a[96:99], v[36:39]
ds_read_b64_tr_b16 a[30:31], v19 offset:30720
v_add_u32 v16, 32768, v16
v_add_u32 v17, 32768, v17
v_add_u32 v18, 32768, v18
v_add_u32 v19, 32768, v19
s_waitcnt lgkmcnt(8)
v_mfma_f32_16x16x32_bf16 v[40:43], a[8:11], a[88:91], v[40:43]
ds_read_b64_tr_b16 a[0:1], v16 offset:0
buffer_load_dwordx4 a[76:79], v1, s[56:59], s21 offen offset:1024 sc1
v_mfma_f32_16x16x32_bf16 v[40:43], a[12:15], a[92:95], v[40:43]
ds_read_b64_tr_b16 a[2:3], v16 offset:2048
v_mfma_f32_16x16x32_bf16 v[44:47], a[12:15], a[100:103], v[44:47]
ds_read_b64_tr_b16 a[4:5], v16 offset:4096
v_mfma_f32_16x16x32_bf16 v[44:47], a[8:11], a[96:99], v[44:47]
ds_read_b64_tr_b16 a[6:7], v16 offset:6144
s_waitcnt lgkmcnt(8)
v_mfma_f32_16x16x32_bf16 v[48:51], a[16:19], a[88:91], v[48:51]
ds_read_b64_tr_b16 a[8:9], v17 offset:0
buffer_load_dwordx4 a[80:83], v21, s[56:59], s21 offen offset:0 sc1
v_mfma_f32_16x16x32_bf16 v[48:51], a[20:23], a[92:95], v[48:51]
ds_read_b64_tr_b16 a[10:11], v17 offset:2048
v_mfma_f32_16x16x32_bf16 v[52:55], a[20:23], a[100:103], v[52:55]
ds_read_b64_tr_b16 a[12:13], v17 offset:4096
buffer_load_dword v67, v20, s[16:19], s92 offen offset:1536 sc1
v_mfma_f32_16x16x32_bf16 v[52:55], a[16:19], a[96:99], v[52:55]
ds_read_b64_tr_b16 a[14:15], v17 offset:6144
s_waitcnt lgkmcnt(8)
v_mfma_f32_16x16x32_bf16 v[56:59], a[24:27], a[88:91], v[56:59]
ds_read_b64_tr_b16 a[16:17], v18 offset:0
buffer_load_dwordx4 a[84:87], v21, s[56:59], s21 offen offset:1024 sc1
v_mfma_f32_16x16x32_bf16 v[56:59], a[28:31], a[92:95], v[56:59]
ds_read_b64_tr_b16 a[18:19], v18 offset:2048
v_mfma_f32_16x16x32_bf16 v[60:63], a[28:31], a[100:103], v[60:63]
ds_read_b64_tr_b16 a[20:21], v18 offset:4096
v_mfma_f32_16x16x32_bf16 v[60:63], a[24:27], a[96:99], v[60:63]
ds_read_b64_tr_b16 a[22:23], v18 offset:6144
s_waitcnt vmcnt(12) lgkmcnt(8)
v_mfma_f32_16x16x32_bf16 v[32:35], a[0:3], a[40:43], v[32:35]
ds_read_b64_tr_b16 a[24:25], v19 offset:0
buffer_load_dwordx4 a[88:91], v1, s[56:59], s21 offen offset:2048 sc1
v_mfma_f32_16x16x32_bf16 v[32:35], a[4:7], a[44:47], v[32:35]
ds_read_b64_tr_b16 a[26:27], v19 offset:2048
s_and_b32 s34, s82, 63
v_mfma_f32_16x16x32_bf16 v[36:39], a[4:7], a[52:55], v[36:39]
ds_read_b64_tr_b16 a[28:29], v19 offset:4096
buffer_load_dword v68, v20, s[16:19], s92 offen offset:2048 sc1
v_mfma_f32_16x16x32_bf16 v[36:39], a[0:3], a[48:51], v[36:39]
ds_read_b64_tr_b16 a[30:31], v19 offset:6144
s_waitcnt lgkmcnt(8)
v_mfma_f32_16x16x32_bf16 v[40:43], a[8:11], a[40:43], v[40:43]
ds_read_b64_tr_b16 a[0:1], v16 offset:8192
buffer_load_dwordx4 a[92:95], v1, s[56:59], s21 offen offset:3072 sc1
v_mfma_f32_16x16x32_bf16 v[40:43], a[12:15], a[44:47], v[40:43]
ds_read_b64_tr_b16 a[2:3], v16 offset:10240
s_lshl_b32 s34, s34, 15
v_mfma_f32_16x16x32_bf16 v[44:47], a[12:15], a[52:55], v[44:47]
ds_read_b64_tr_b16 a[4:5], v16 offset:12288
s_lshl_b32 s27, s81, 11
v_mfma_f32_16x16x32_bf16 v[44:47], a[8:11], a[48:51], v[44:47]
ds_read_b64_tr_b16 a[6:7], v16 offset:14336
s_waitcnt lgkmcnt(8)
v_mfma_f32_16x16x32_bf16 v[48:51], a[16:19], a[40:43], v[48:51]
ds_read_b64_tr_b16 a[8:9], v17 offset:8192
buffer_load_dwordx4 a[96:99], v21, s[56:59], s21 offen offset:2048 sc1
v_mfma_f32_16x16x32_bf16 v[48:51], a[20:23], a[44:47], v[48:51]
ds_read_b64_tr_b16 a[10:11], v17 offset:10240
s_add_u32 s34, s34, s27
v_mfma_f32_16x16x32_bf16 v[52:55], a[20:23], a[52:55], v[52:55]
ds_read_b64_tr_b16 a[12:13], v17 offset:12288
buffer_load_dword v69, v20, s[16:19], s92 offen offset:2560 sc1
v_mfma_f32_16x16x32_bf16 v[52:55], a[16:19], a[48:51], v[52:55]
ds_read_b64_tr_b16 a[14:15], v17 offset:14336
s_waitcnt lgkmcnt(8)
v_mfma_f32_16x16x32_bf16 v[56:59], a[24:27], a[40:43], v[56:59]
ds_read_b64_tr_b16 a[16:17], v18 offset:8192
buffer_load_dwordx4 a[100:103], v21, s[56:59], s21 offen offset:3072 sc1
v_mfma_f32_16x16x32_bf16 v[56:59], a[28:31], a[44:47], v[56:59]
ds_read_b64_tr_b16 a[18:19], v18 offset:10240
s_and_b32 s27, s34, 0xffffe000
v_mfma_f32_16x16x32_bf16 v[60:63], a[28:31], a[52:55], v[60:63]
ds_read_b64_tr_b16 a[20:21], v18 offset:12288
s_add_u32 s34, s34, s27
v_mfma_f32_16x16x32_bf16 v[60:63], a[24:27], a[48:51], v[60:63]
ds_read_b64_tr_b16 a[22:23], v18 offset:14336
s_waitcnt vmcnt(12) lgkmcnt(8)
v_mfma_f32_16x16x32_bf16 v[32:35], a[0:3], a[56:59], v[32:35]
ds_read_b64_tr_b16 a[24:25], v19 offset:8192
s_add_u32 s21, s21, 12288
v_mfma_f32_16x16x32_bf16 v[32:35], a[4:7], a[60:63], v[32:35]
ds_read_b64_tr_b16 a[26:27], v19 offset:10240
buffer_load_dwordx4 a[40:43], v1, s[56:59], s21 offen offset:0 sc1
v_mfma_f32_16x16x32_bf16 v[36:39], a[4:7], a[68:71], v[36:39]
ds_read_b64_tr_b16 a[28:29], v19 offset:12288
buffer_load_dword v70, v20, s[16:19], s92 offen offset:3072 sc1
v_mfma_f32_16x16x32_bf16 v[36:39], a[0:3], a[64:67], v[36:39]
ds_read_b64_tr_b16 a[30:31], v19 offset:14336
s_waitcnt lgkmcnt(8)
v_mfma_f32_16x16x32_bf16 v[40:43], a[8:11], a[56:59], v[40:43]
ds_read_b64_tr_b16 a[0:1], v16 offset:16384
buffer_load_dwordx4 a[44:47], v1, s[56:59], s21 offen offset:1024 sc1
v_mfma_f32_16x16x32_bf16 v[40:43], a[12:15], a[60:63], v[40:43]
ds_read_b64_tr_b16 a[2:3], v16 offset:18432
s_lshr_b32 s27, s34, 8
v_mfma_f32_16x16x32_bf16 v[44:47], a[12:15], a[68:71], v[44:47]
ds_read_b64_tr_b16 a[4:5], v16 offset:20480
s_and_b32 s27, s27, 8192
v_mfma_f32_16x16x32_bf16 v[44:47], a[8:11], a[64:67], v[44:47]
ds_read_b64_tr_b16 a[6:7], v16 offset:22528
s_waitcnt lgkmcnt(8)
v_mfma_f32_16x16x32_bf16 v[48:51], a[16:19], a[56:59], v[48:51]
ds_read_b64_tr_b16 a[8:9], v17 offset:16384
buffer_load_dwordx4 a[48:51], v21, s[56:59], s21 offen offset:0 sc1
v_mfma_f32_16x16x32_bf16 v[48:51], a[20:23], a[60:63], v[48:51]
ds_read_b64_tr_b16 a[10:11], v17 offset:18432
s_or_b32 s34, s34, s27
v_mfma_f32_16x16x32_bf16 v[52:55], a[20:23], a[68:71], v[52:55]
ds_read_b64_tr_b16 a[12:13], v17 offset:20480
buffer_load_dword v71, v20, s[16:19], s92 offen offset:3584 sc1
v_mfma_f32_16x16x32_bf16 v[52:55], a[16:19], a[64:67], v[52:55]
ds_read_b64_tr_b16 a[14:15], v17 offset:22528
s_waitcnt lgkmcnt(8)
v_mfma_f32_16x16x32_bf16 v[56:59], a[24:27], a[56:59], v[56:59]
ds_read_b64_tr_b16 a[16:17], v18 offset:16384
buffer_load_dwordx4 a[52:55], v21, s[56:59], s21 offen offset:1024 sc1
v_mfma_f32_16x16x32_bf16 v[56:59], a[28:31], a[60:63], v[56:59]
ds_read_b64_tr_b16 a[18:19], v18 offset:18432
s_xor_b32 s34, s34, s30
v_mfma_f32_16x16x32_bf16 v[60:63], a[28:31], a[68:71], v[60:63]
ds_read_b64_tr_b16 a[20:21], v18 offset:20480
s_bfe_u32 s35, s82, 0x40002
v_mfma_f32_16x16x32_bf16 v[60:63], a[24:27], a[64:67], v[60:63]
ds_read_b64_tr_b16 a[22:23], v18 offset:22528
s_waitcnt vmcnt(12) lgkmcnt(8)
v_mfma_f32_16x16x32_bf16 v[32:35], a[0:3], a[72:75], v[32:35]
ds_read_b64_tr_b16 a[24:25], v19 offset:16384
buffer_load_dwordx4 a[56:59], v1, s[56:59], s21 offen offset:2048 sc1
v_mfma_f32_16x16x32_bf16 v[32:35], a[4:7], a[76:79], v[32:35]
ds_read_b64_tr_b16 a[26:27], v19 offset:18432
s_lshl_b32 s35, s35, 4
v_mfma_f32_16x16x32_bf16 v[36:39], a[4:7], a[84:87], v[36:39]
ds_read_b64_tr_b16 a[28:29], v19 offset:20480
buffer_load_dword v72, v20, s[16:19], s93 offen offset:0 sc1
v_mfma_f32_16x16x32_bf16 v[36:39], a[0:3], a[80:83], v[36:39]
ds_read_b64_tr_b16 a[30:31], v19 offset:22528
s_waitcnt lgkmcnt(8)
v_mfma_f32_16x16x32_bf16 v[40:43], a[8:11], a[72:75], v[40:43]
ds_read_b64_tr_b16 a[0:1], v16 offset:24576
buffer_load_dwordx4 a[60:63], v1, s[56:59], s21 offen offset:3072 sc1
v_mfma_f32_16x16x32_bf16 v[40:43], a[12:15], a[76:79], v[40:43]
ds_read_b64_tr_b16 a[2:3], v16 offset:26624
s_add_u32 s35, s35, s81
v_mfma_f32_16x16x32_bf16 v[44:47], a[12:15], a[84:87], v[44:47]
ds_read_b64_tr_b16 a[4:5], v16 offset:28672
s_lshl_b32 s35, s35, 1
v_mfma_f32_16x16x32_bf16 v[44:47], a[8:11], a[80:83], v[44:47]
ds_read_b64_tr_b16 a[6:7], v16 offset:30720
s_waitcnt lgkmcnt(8)
v_mfma_f32_16x16x32_bf16 v[48:51], a[16:19], a[72:75], v[48:51]
ds_read_b64_tr_b16 a[8:9], v17 offset:24576
buffer_load_dwordx4 a[64:67], v21, s[56:59], s21 offen offset:2048 sc1
v_mfma_f32_16x16x32_bf16 v[48:51], a[20:23], a[76:79], v[48:51]
ds_read_b64_tr_b16 a[10:11], v17 offset:26624
s_add_u32 s35, s35, s46
v_mfma_f32_16x16x32_bf16 v[52:55], a[20:23], a[84:87], v[52:55]
ds_read_b64_tr_b16 a[12:13], v17 offset:28672
buffer_load_dword v73, v20, s[16:19], s93 offen offset:512 sc1
v_mfma_f32_16x16x32_bf16 v[52:55], a[16:19], a[80:83], v[52:55]
ds_read_b64_tr_b16 a[14:15], v17 offset:30720
s_waitcnt lgkmcnt(8)
v_mfma_f32_16x16x32_bf16 v[56:59], a[24:27], a[72:75], v[56:59]
ds_read_b64_tr_b16 a[16:17], v18 offset:24576
buffer_load_dwordx4 a[68:71], v21, s[56:59], s21 offen offset:3072 sc1
v_mfma_f32_16x16x32_bf16 v[56:59], a[28:31], a[76:79], v[56:59]
ds_read_b64_tr_b16 a[18:19], v18 offset:26624
s_lshl_b32 s35, s35, 7
v_mfma_f32_16x16x32_bf16 v[60:63], a[28:31], a[84:87], v[60:63]
ds_read_b64_tr_b16 a[20:21], v18 offset:28672
s_and_b32 s27, s35, 0xffffe000
v_mfma_f32_16x16x32_bf16 v[60:63], a[24:27], a[80:83], v[60:63]
ds_read_b64_tr_b16 a[22:23], v18 offset:30720
s_waitcnt vmcnt(12) lgkmcnt(8)
v_mfma_f32_16x16x32_bf16 v[32:35], a[0:3], a[88:91], v[32:35]
ds_read_b64_tr_b16 a[24:25], v19 offset:24576
s_add_u32 s21, s21, 4096
v_mfma_f32_16x16x32_bf16 v[32:35], a[4:7], a[92:95], v[32:35]
ds_read_b64_tr_b16 a[26:27], v19 offset:26624
buffer_load_dwordx4 a[72:75], v1, s[56:59], s21 offen offset:0 sc1
v_mfma_f32_16x16x32_bf16 v[36:39], a[4:7], a[100:103], v[36:39]
ds_read_b64_tr_b16 a[28:29], v19 offset:28672
buffer_load_dword v74, v20, s[16:19], s93 offen offset:1024 sc1
v_mfma_f32_16x16x32_bf16 v[36:39], a[0:3], a[96:99], v[36:39]
ds_read_b64_tr_b16 a[30:31], v19 offset:30720
v_add_u32 v16, 32768, v16
v_add_u32 v17, 32768, v17
v_add_u32 v18, 32768, v18
v_add_u32 v19, 32768, v19
s_waitcnt lgkmcnt(8)
v_mfma_f32_16x16x32_bf16 v[40:43], a[8:11], a[88:91], v[40:43]
ds_read_b64_tr_b16 a[0:1], v16 offset:0
buffer_load_dwordx4 a[76:79], v1, s[56:59], s21 offen offset:1024 sc1
v_mfma_f32_16x16x32_bf16 v[40:43], a[12:15], a[92:95], v[40:43]
ds_read_b64_tr_b16 a[2:3], v16 offset:2048
s_add_u32 s35, s35, s27
v_mfma_f32_16x16x32_bf16 v[44:47], a[12:15], a[100:103], v[44:47]
ds_read_b64_tr_b16 a[4:5], v16 offset:4096
s_lshr_b32 s27, s35, 8
v_mfma_f32_16x16x32_bf16 v[44:47], a[8:11], a[96:99], v[44:47]
ds_read_b64_tr_b16 a[6:7], v16 offset:6144
s_waitcnt lgkmcnt(8)
v_mfma_f32_16x16x32_bf16 v[48:51], a[16:19], a[88:91], v[48:51]
ds_read_b64_tr_b16 a[8:9], v17 offset:0
buffer_load_dwordx4 a[80:83], v21, s[56:59], s21 offen offset:0 sc1
v_mfma_f32_16x16x32_bf16 v[48:51], a[20:23], a[92:95], v[48:51]
ds_read_b64_tr_b16 a[10:11], v17 offset:2048
s_and_b32 s27, s27, 8192
v_mfma_f32_16x16x32_bf16 v[52:55], a[20:23], a[100:103], v[52:55]
ds_read_b64_tr_b16 a[12:13], v17 offset:4096
buffer_load_dword v75, v20, s[16:19], s93 offen offset:1536 sc1
v_mfma_f32_16x16x32_bf16 v[52:55], a[16:19], a[96:99], v[52:55]
ds_read_b64_tr_b16 a[14:15], v17 offset:6144
s_waitcnt lgkmcnt(8)
v_mfma_f32_16x16x32_bf16 v[56:59], a[24:27], a[88:91], v[56:59]
ds_read_b64_tr_b16 a[16:17], v18 offset:0
buffer_load_dwordx4 a[84:87], v21, s[56:59], s21 offen offset:1024 sc1
v_mfma_f32_16x16x32_bf16 v[56:59], a[28:31], a[92:95], v[56:59]
ds_read_b64_tr_b16 a[18:19], v18 offset:2048
s_or_b32 s35, s35, s27
v_mfma_f32_16x16x32_bf16 v[60:63], a[28:31], a[100:103], v[60:63]
ds_read_b64_tr_b16 a[20:21], v18 offset:4096
s_xor_b32 s35, s35, s30
v_mfma_f32_16x16x32_bf16 v[60:63], a[24:27], a[96:99], v[60:63]
ds_read_b64_tr_b16 a[22:23], v18 offset:6144
s_waitcnt vmcnt(12) lgkmcnt(8)
v_mfma_f32_16x16x32_bf16 v[32:35], a[0:3], a[40:43], v[32:35]
ds_read_b64_tr_b16 a[24:25], v19 offset:0
buffer_load_dwordx4 a[88:91], v1, s[56:59], s21 offen offset:2048 sc1
v_mfma_f32_16x16x32_bf16 v[32:35], a[4:7], a[44:47], v[32:35]
ds_read_b64_tr_b16 a[26:27], v19 offset:2048
v_mfma_f32_16x16x32_bf16 v[36:39], a[4:7], a[52:55], v[36:39]
ds_read_b64_tr_b16 a[28:29], v19 offset:4096
buffer_load_dword v76, v20, s[16:19], s93 offen offset:2048 sc1
v_mfma_f32_16x16x32_bf16 v[36:39], a[0:3], a[48:51], v[36:39]
ds_read_b64_tr_b16 a[30:31], v19 offset:6144
s_waitcnt lgkmcnt(8)
v_mfma_f32_16x16x32_bf16 v[40:43], a[8:11], a[40:43], v[40:43]
ds_read_b64_tr_b16 a[0:1], v16 offset:8192
buffer_load_dwordx4 a[92:95], v1, s[56:59], s21 offen offset:3072 sc1
v_mfma_f32_16x16x32_bf16 v[40:43], a[12:15], a[44:47], v[40:43]
ds_read_b64_tr_b16 a[2:3], v16 offset:10240
v_mfma_f32_16x16x32_bf16 v[44:47], a[12:15], a[52:55], v[44:47]
ds_read_b64_tr_b16 a[4:5], v16 offset:12288
v_mfma_f32_16x16x32_bf16 v[44:47], a[8:11], a[48:51], v[44:47]
ds_read_b64_tr_b16 a[6:7], v16 offset:14336
s_waitcnt lgkmcnt(8)
v_mfma_f32_16x16x32_bf16 v[48:51], a[16:19], a[40:43], v[48:51]
ds_read_b64_tr_b16 a[8:9], v17 offset:8192
buffer_load_dwordx4 a[96:99], v21, s[56:59], s21 offen offset:2048 sc1
v_mfma_f32_16x16x32_bf16 v[48:51], a[20:23], a[44:47], v[48:51]
ds_read_b64_tr_b16 a[10:11], v17 offset:10240
v_mfma_f32_16x16x32_bf16 v[52:55], a[20:23], a[52:55], v[52:55]
ds_read_b64_tr_b16 a[12:13], v17 offset:12288
buffer_load_dword v77, v20, s[16:19], s93 offen offset:2560 sc1
v_mfma_f32_16x16x32_bf16 v[52:55], a[16:19], a[48:51], v[52:55]
ds_read_b64_tr_b16 a[14:15], v17 offset:14336
s_waitcnt lgkmcnt(8)
v_mfma_f32_16x16x32_bf16 v[56:59], a[24:27], a[40:43], v[56:59]
ds_read_b64_tr_b16 a[16:17], v18 offset:8192
buffer_load_dwordx4 a[100:103], v21, s[56:59], s21 offen offset:3072 sc1
v_mfma_f32_16x16x32_bf16 v[56:59], a[28:31], a[44:47], v[56:59]
ds_read_b64_tr_b16 a[18:19], v18 offset:10240
v_mfma_f32_16x16x32_bf16 v[60:63], a[28:31], a[52:55], v[60:63]
ds_read_b64_tr_b16 a[20:21], v18 offset:12288
v_mfma_f32_16x16x32_bf16 v[60:63], a[24:27], a[48:51], v[60:63]
ds_read_b64_tr_b16 a[22:23], v18 offset:14336
s_waitcnt vmcnt(12) lgkmcnt(8)
v_mfma_f32_16x16x32_bf16 v[32:35], a[0:3], a[56:59], v[32:35]
ds_read_b64_tr_b16 a[24:25], v19 offset:8192
s_add_u32 s21, s21, 12288
v_mfma_f32_16x16x32_bf16 v[32:35], a[4:7], a[60:63], v[32:35]
ds_read_b64_tr_b16 a[26:27], v19 offset:10240
buffer_load_dwordx4 a[40:43], v1, s[56:59], s21 offen offset:0 sc1
v_mfma_f32_16x16x32_bf16 v[36:39], a[4:7], a[68:71], v[36:39]
ds_read_b64_tr_b16 a[28:29], v19 offset:12288
buffer_load_dword v78, v20, s[16:19], s93 offen offset:3072 sc1
v_mfma_f32_16x16x32_bf16 v[36:39], a[0:3], a[64:67], v[36:39]
ds_read_b64_tr_b16 a[30:31], v19 offset:14336
s_barrier
s_waitcnt lgkmcnt(8)
v_mfma_f32_16x16x32_bf16 v[40:43], a[8:11], a[56:59], v[40:43]
ds_read_b64_tr_b16 a[0:1], v16 offset:16384
buffer_load_dwordx4 a[44:47], v1, s[56:59], s21 offen offset:1024 sc1
v_mfma_f32_16x16x32_bf16 v[40:43], a[12:15], a[60:63], v[40:43]
ds_read_b64_tr_b16 a[2:3], v16 offset:18432
v_mfma_f32_16x16x32_bf16 v[44:47], a[12:15], a[68:71], v[44:47]
ds_read_b64_tr_b16 a[4:5], v16 offset:20480
v_mfma_f32_16x16x32_bf16 v[44:47], a[8:11], a[64:67], v[44:47]
ds_read_b64_tr_b16 a[6:7], v16 offset:22528
s_waitcnt lgkmcnt(8)
v_mfma_f32_16x16x32_bf16 v[48:51], a[16:19], a[56:59], v[48:51]
ds_read_b64_tr_b16 a[8:9], v17 offset:16384
buffer_load_dwordx4 a[48:51], v21, s[56:59], s21 offen offset:0 sc1
v_mfma_f32_16x16x32_bf16 v[48:51], a[20:23], a[60:63], v[48:51]
ds_read_b64_tr_b16 a[10:11], v17 offset:18432
v_mfma_f32_16x16x32_bf16 v[52:55], a[20:23], a[68:71], v[52:55]
ds_read_b64_tr_b16 a[12:13], v17 offset:20480
buffer_load_dword v79, v20, s[16:19], s93 offen offset:3584 sc1
v_mfma_f32_16x16x32_bf16 v[52:55], a[16:19], a[64:67], v[52:55]
ds_read_b64_tr_b16 a[14:15], v17 offset:22528
s_waitcnt lgkmcnt(8)
v_mfma_f32_16x16x32_bf16 v[56:59], a[24:27], a[56:59], v[56:59]
ds_read_b64_tr_b16 a[16:17], v18 offset:16384
buffer_load_dwordx4 a[52:55], v21, s[56:59], s21 offen offset:1024 sc1
v_mfma_f32_16x16x32_bf16 v[56:59], a[28:31], a[60:63], v[56:59]
ds_read_b64_tr_b16 a[18:19], v18 offset:18432
v_mfma_f32_16x16x32_bf16 v[60:63], a[28:31], a[68:71], v[60:63]
ds_read_b64_tr_b16 a[20:21], v18 offset:20480
v_mfma_f32_16x16x32_bf16 v[60:63], a[24:27], a[64:67], v[60:63]
ds_read_b64_tr_b16 a[22:23], v18 offset:22528
s_waitcnt vmcnt(12) lgkmcnt(8)
v_mfma_f32_16x16x32_bf16 v[32:35], a[0:3], a[72:75], v[32:35]
ds_read_b64_tr_b16 a[24:25], v19 offset:16384
buffer_load_dwordx4 a[56:59], v1, s[56:59], s21 offen offset:2048 sc1
v_mfma_f32_16x16x32_bf16 v[32:35], a[4:7], a[76:79], v[32:35]
ds_read_b64_tr_b16 a[26:27], v19 offset:18432
v_mfma_f32_16x16x32_bf16 v[36:39], a[4:7], a[84:87], v[36:39]
ds_read_b64_tr_b16 a[28:29], v19 offset:20480
buffer_load_dword v24, v22, s[16:19], s94 offen sc1
v_mfma_f32_16x16x32_bf16 v[36:39], a[0:3], a[80:83], v[36:39]
ds_read_b64_tr_b16 a[30:31], v19 offset:22528
s_waitcnt lgkmcnt(8)
v_mfma_f32_16x16x32_bf16 v[40:43], a[8:11], a[72:75], v[40:43]
ds_read_b64_tr_b16 a[0:1], v16 offset:24576
buffer_load_dwordx4 a[60:63], v1, s[56:59], s21 offen offset:3072 sc1
v_mfma_f32_16x16x32_bf16 v[40:43], a[12:15], a[76:79], v[40:43]
ds_read_b64_tr_b16 a[2:3], v16 offset:26624
v_mfma_f32_16x16x32_bf16 v[44:47], a[12:15], a[84:87], v[44:47]
ds_read_b64_tr_b16 a[4:5], v16 offset:28672
v_mfma_f32_16x16x32_bf16 v[44:47], a[8:11], a[80:83], v[44:47]
ds_read_b64_tr_b16 a[6:7], v16 offset:30720
s_waitcnt lgkmcnt(8)
v_mfma_f32_16x16x32_bf16 v[48:51], a[16:19], a[72:75], v[48:51]
ds_read_b64_tr_b16 a[8:9], v17 offset:24576
buffer_load_dwordx4 a[64:67], v21, s[56:59], s21 offen offset:2048 sc1
v_mfma_f32_16x16x32_bf16 v[48:51], a[20:23], a[76:79], v[48:51]
ds_read_b64_tr_b16 a[10:11], v17 offset:26624
v_mfma_f32_16x16x32_bf16 v[52:55], a[20:23], a[84:87], v[52:55]
ds_read_b64_tr_b16 a[12:13], v17 offset:28672
v_mfma_f32_16x16x32_bf16 v[52:55], a[16:19], a[80:83], v[52:55]
ds_read_b64_tr_b16 a[14:15], v17 offset:30720
s_waitcnt lgkmcnt(8)
v_mfma_f32_16x16x32_bf16 v[56:59], a[24:27], a[72:75], v[56:59]
ds_read_b64_tr_b16 a[16:17], v18 offset:24576
buffer_load_dwordx4 a[68:71], v21, s[56:59], s21 offen offset:3072 sc1
v_mfma_f32_16x16x32_bf16 v[56:59], a[28:31], a[76:79], v[56:59]
ds_read_b64_tr_b16 a[18:19], v18 offset:26624
v_mfma_f32_16x16x32_bf16 v[60:63], a[28:31], a[84:87], v[60:63]
ds_read_b64_tr_b16 a[20:21], v18 offset:28672
v_mfma_f32_16x16x32_bf16 v[60:63], a[24:27], a[80:83], v[60:63]
ds_read_b64_tr_b16 a[22:23], v18 offset:30720
s_waitcnt vmcnt(11) lgkmcnt(8)
v_mfma_f32_16x16x32_bf16 v[32:35], a[0:3], a[88:91], v[32:35]
ds_read_b64_tr_b16 a[24:25], v19 offset:24576
s_add_u32 s21, s21, 4096
v_mfma_f32_16x16x32_bf16 v[32:35], a[4:7], a[92:95], v[32:35]
ds_read_b64_tr_b16 a[26:27], v19 offset:26624
buffer_load_dwordx4 a[72:75], v1, s[56:59], s21 offen offset:0 sc1
v_mfma_f32_16x16x32_bf16 v[36:39], a[4:7], a[100:103], v[36:39]
ds_read_b64_tr_b16 a[28:29], v19 offset:28672
v_mfma_f32_16x16x32_bf16 v[36:39], a[0:3], a[96:99], v[36:39]
ds_read_b64_tr_b16 a[30:31], v19 offset:30720
v_add_u32 v16, 32768, v16
v_add_u32 v17, 32768, v17
v_add_u32 v18, 32768, v18
v_add_u32 v19, 32768, v19
s_waitcnt lgkmcnt(8)
v_mfma_f32_16x16x32_bf16 v[40:43], a[8:11], a[88:91], v[40:43]
ds_read_b64_tr_b16 a[0:1], v16 offset:0
buffer_load_dwordx4 a[76:79], v1, s[56:59], s21 offen offset:1024 sc1
v_mfma_f32_16x16x32_bf16 v[40:43], a[12:15], a[92:95], v[40:43]
ds_read_b64_tr_b16 a[2:3], v16 offset:2048
v_mfma_f32_16x16x32_bf16 v[44:47], a[12:15], a[100:103], v[44:47]
ds_read_b64_tr_b16 a[4:5], v16 offset:4096
v_mfma_f32_16x16x32_bf16 v[44:47], a[8:11], a[96:99], v[44:47]
ds_read_b64_tr_b16 a[6:7], v16 offset:6144
s_waitcnt lgkmcnt(8)
v_mfma_f32_16x16x32_bf16 v[48:51], a[16:19], a[88:91], v[48:51]
ds_read_b64_tr_b16 a[8:9], v17 offset:0
buffer_load_dwordx4 a[80:83], v21, s[56:59], s21 offen offset:0 sc1
v_mfma_f32_16x16x32_bf16 v[48:51], a[20:23], a[92:95], v[48:51]
ds_read_b64_tr_b16 a[10:11], v17 offset:2048
v_mfma_f32_16x16x32_bf16 v[52:55], a[20:23], a[100:103], v[52:55]
ds_read_b64_tr_b16 a[12:13], v17 offset:4096
v_mfma_f32_16x16x32_bf16 v[52:55], a[16:19], a[96:99], v[52:55]
ds_read_b64_tr_b16 a[14:15], v17 offset:6144
s_waitcnt lgkmcnt(8)
v_mfma_f32_16x16x32_bf16 v[56:59], a[24:27], a[88:91], v[56:59]
ds_read_b64_tr_b16 a[16:17], v18 offset:0
buffer_load_dwordx4 a[84:87], v21, s[56:59], s21 offen offset:1024 sc1
v_mfma_f32_16x16x32_bf16 v[56:59], a[28:31], a[92:95], v[56:59]
ds_read_b64_tr_b16 a[18:19], v18 offset:2048
v_mfma_f32_16x16x32_bf16 v[60:63], a[28:31], a[100:103], v[60:63]
ds_read_b64_tr_b16 a[20:21], v18 offset:4096
v_mfma_f32_16x16x32_bf16 v[60:63], a[24:27], a[96:99], v[60:63]
ds_read_b64_tr_b16 a[22:23], v18 offset:6144
s_waitcnt vmcnt(9) lgkmcnt(8)
v_mfma_f32_16x16x32_bf16 v[32:35], a[0:3], a[40:43], v[32:35]
ds_read_b64_tr_b16 a[24:25], v19 offset:0
buffer_load_dwordx4 a[88:91], v1, s[56:59], s21 offen offset:2048 sc1
v_mfma_f32_16x16x32_bf16 v[32:35], a[4:7], a[44:47], v[32:35]
ds_read_b64_tr_b16 a[26:27], v19 offset:2048
v_mfma_f32_16x16x32_bf16 v[36:39], a[4:7], a[52:55], v[36:39]
ds_read_b64_tr_b16 a[28:29], v19 offset:4096
v_mfma_f32_16x16x32_bf16 v[36:39], a[0:3], a[48:51], v[36:39]
ds_read_b64_tr_b16 a[30:31], v19 offset:6144
s_waitcnt lgkmcnt(8)
v_mfma_f32_16x16x32_bf16 v[40:43], a[8:11], a[40:43], v[40:43]
ds_read_b64_tr_b16 a[0:1], v16 offset:8192
buffer_load_dwordx4 a[92:95], v1, s[56:59], s21 offen offset:3072 sc1
v_mfma_f32_16x16x32_bf16 v[40:43], a[12:15], a[44:47], v[40:43]
ds_read_b64_tr_b16 a[2:3], v16 offset:10240
v_mfma_f32_16x16x32_bf16 v[44:47], a[12:15], a[52:55], v[44:47]
ds_read_b64_tr_b16 a[4:5], v16 offset:12288
v_mfma_f32_16x16x32_bf16 v[44:47], a[8:11], a[48:51], v[44:47]
ds_read_b64_tr_b16 a[6:7], v16 offset:14336
s_waitcnt lgkmcnt(8)
v_mfma_f32_16x16x32_bf16 v[48:51], a[16:19], a[40:43], v[48:51]
ds_read_b64_tr_b16 a[8:9], v17 offset:8192
buffer_load_dwordx4 a[96:99], v21, s[56:59], s21 offen offset:2048 sc1
v_mfma_f32_16x16x32_bf16 v[48:51], a[20:23], a[44:47], v[48:51]
ds_read_b64_tr_b16 a[10:11], v17 offset:10240
v_mfma_f32_16x16x32_bf16 v[52:55], a[20:23], a[52:55], v[52:55]
ds_read_b64_tr_b16 a[12:13], v17 offset:12288
v_mfma_f32_16x16x32_bf16 v[52:55], a[16:19], a[48:51], v[52:55]
ds_read_b64_tr_b16 a[14:15], v17 offset:14336
s_waitcnt lgkmcnt(8)
v_mfma_f32_16x16x32_bf16 v[56:59], a[24:27], a[40:43], v[56:59]
ds_read_b64_tr_b16 a[16:17], v18 offset:8192
buffer_load_dwordx4 a[100:103], v21, s[56:59], s21 offen offset:3072 sc1
v_mfma_f32_16x16x32_bf16 v[56:59], a[28:31], a[44:47], v[56:59]
ds_read_b64_tr_b16 a[18:19], v18 offset:10240
v_mfma_f32_16x16x32_bf16 v[60:63], a[28:31], a[52:55], v[60:63]
ds_read_b64_tr_b16 a[20:21], v18 offset:12288
v_mfma_f32_16x16x32_bf16 v[60:63], a[24:27], a[48:51], v[60:63]
ds_read_b64_tr_b16 a[22:23], v18 offset:14336
s_waitcnt vmcnt(8) lgkmcnt(8)
v_mfma_f32_16x16x32_bf16 v[32:35], a[0:3], a[56:59], v[32:35]
ds_read_b64_tr_b16 a[24:25], v19 offset:8192
v_mfma_f32_16x16x32_bf16 v[32:35], a[4:7], a[60:63], v[32:35]
ds_read_b64_tr_b16 a[26:27], v19 offset:10240
v_mfma_f32_16x16x32_bf16 v[36:39], a[4:7], a[68:71], v[36:39]
ds_read_b64_tr_b16 a[28:29], v19 offset:12288
s_add_u32 m0, s23, 0
v_mfma_f32_16x16x32_bf16 v[36:39], a[0:3], a[64:67], v[36:39]
ds_read_b64_tr_b16 a[30:31], v19 offset:14336
s_waitcnt lgkmcnt(8)
v_mfma_f32_16x16x32_bf16 v[40:43], a[8:11], a[56:59], v[40:43]
ds_read_b64_tr_b16 a[0:1], v16 offset:16384
buffer_load_dwordx4 v2, s[4:7], s22 offen offset:0 lds
v_mfma_f32_16x16x32_bf16 v[40:43], a[12:15], a[60:63], v[40:43]
ds_read_b64_tr_b16 a[2:3], v16 offset:18432
v_mfma_f32_16x16x32_bf16 v[44:47], a[12:15], a[68:71], v[44:47]
ds_read_b64_tr_b16 a[4:5], v16 offset:20480
v_mfma_f32_16x16x32_bf16 v[44:47], a[8:11], a[64:67], v[44:47]
ds_read_b64_tr_b16 a[6:7], v16 offset:22528
s_waitcnt lgkmcnt(8)
v_mfma_f32_16x16x32_bf16 v[48:51], a[16:19], a[56:59], v[48:51]
ds_read_b64_tr_b16 a[8:9], v17 offset:16384
buffer_load_dwordx4 v3, s[4:7], s22 offen offset:1024 lds
v_mfma_f32_16x16x32_bf16 v[48:51], a[20:23], a[60:63], v[48:51]
ds_read_b64_tr_b16 a[10:11], v17 offset:18432
v_mfma_f32_16x16x32_bf16 v[52:55], a[20:23], a[68:71], v[52:55]
ds_read_b64_tr_b16 a[12:13], v17 offset:20480
v_mfma_f32_16x16x32_bf16 v[52:55], a[16:19], a[64:67], v[52:55]
ds_read_b64_tr_b16 a[14:15], v17 offset:22528
s_waitcnt lgkmcnt(8)
v_mfma_f32_16x16x32_bf16 v[56:59], a[24:27], a[56:59], v[56:59]
ds_read_b64_tr_b16 a[16:17], v18 offset:16384
buffer_load_dwordx4 v4, s[4:7], s22 offen offset:2048 lds
v_mfma_f32_16x16x32_bf16 v[56:59], a[28:31], a[60:63], v[56:59]
ds_read_b64_tr_b16 a[18:19], v18 offset:18432
v_mfma_f32_16x16x32_bf16 v[60:63], a[28:31], a[68:71], v[60:63]
ds_read_b64_tr_b16 a[20:21], v18 offset:20480
v_mfma_f32_16x16x32_bf16 v[60:63], a[24:27], a[64:67], v[60:63]
ds_read_b64_tr_b16 a[22:23], v18 offset:22528
s_waitcnt vmcnt(7) lgkmcnt(8)
v_mfma_f32_16x16x32_bf16 v[32:35], a[0:3], a[72:75], v[32:35]
ds_read_b64_tr_b16 a[24:25], v19 offset:16384
v_mfma_f32_16x16x32_bf16 v[32:35], a[4:7], a[76:79], v[32:35]
ds_read_b64_tr_b16 a[26:27], v19 offset:18432
buffer_load_dwordx4 v5, s[4:7], s22 offen offset:3072 lds
v_mfma_f32_16x16x32_bf16 v[36:39], a[4:7], a[84:87], v[36:39]
ds_read_b64_tr_b16 a[28:29], v19 offset:20480
v_mfma_f32_16x16x32_bf16 v[36:39], a[0:3], a[80:83], v[36:39]
ds_read_b64_tr_b16 a[30:31], v19 offset:22528
s_waitcnt lgkmcnt(8)
v_mfma_f32_16x16x32_bf16 v[40:43], a[8:11], a[72:75], v[40:43]
ds_read_b64_tr_b16 a[0:1], v16 offset:24576
v_mfma_f32_16x16x32_bf16 v[40:43], a[12:15], a[76:79], v[40:43]
ds_read_b64_tr_b16 a[2:3], v16 offset:26624
v_mfma_f32_16x16x32_bf16 v[44:47], a[12:15], a[84:87], v[44:47]
ds_read_b64_tr_b16 a[4:5], v16 offset:28672
s_add_u32 m0, s23, 4096
v_mfma_f32_16x16x32_bf16 v[44:47], a[8:11], a[80:83], v[44:47]
ds_read_b64_tr_b16 a[6:7], v16 offset:30720
s_waitcnt lgkmcnt(8)
v_mfma_f32_16x16x32_bf16 v[48:51], a[16:19], a[72:75], v[48:51]
ds_read_b64_tr_b16 a[8:9], v17 offset:24576
v_mfma_f32_16x16x32_bf16 v[48:51], a[20:23], a[76:79], v[48:51]
v_add_f32 v64, v64, v72
ds_read_b64_tr_b16 a[10:11], v17 offset:26624
v_mfma_f32_16x16x32_bf16 v[52:55], a[20:23], a[84:87], v[52:55]
v_add_f32 v65, v65, v73
ds_read_b64_tr_b16 a[12:13], v17 offset:28672
v_mfma_f32_16x16x32_bf16 v[52:55], a[16:19], a[80:83], v[52:55]
v_add_f32 v66, v66, v74
s_waitcnt lgkmcnt(7)
v_mfma_f32_16x16x32_bf16 v[56:59], a[24:27], a[72:75], v[56:59]
v_add_f32 v67, v67, v75
ds_read_b64_tr_b16 a[14:15], v17 offset:30720
v_mfma_f32_16x16x32_bf16 v[56:59], a[28:31], a[76:79], v[56:59]
L_pg6:
s_cbranch_execz L_vret
v_add_f32 v68, v68, v76
ds_read_b64_tr_b16 a[16:17], v18 offset:24576
v_mfma_f32_16x16x32_bf16 v[60:63], a[28:31], a[84:87], v[60:63]
v_add_f32 v69, v69, v77
ds_read_b64_tr_b16 a[18:19], v18 offset:26624
v_mfma_f32_16x16x32_bf16 v[60:63], a[24:27], a[80:83], v[60:63]
v_add_f32 v70, v70, v78
s_waitcnt vmcnt(4) lgkmcnt(6)
v_mfma_f32_16x16x32_bf16 v[32:35], a[0:3], a[88:91], v[32:35]
v_add_f32 v71, v71, v79
ds_read_b64_tr_b16 a[20:21], v18 offset:28672
v_mfma_f32_16x16x32_bf16 v[32:35], a[4:7], a[92:95], v[32:35]
v_add_f32 v64, v64, v68
ds_read_b64_tr_b16 a[22:23], v18 offset:30720
v_mfma_f32_16x16x32_bf16 v[36:39], a[4:7], a[100:103], v[36:39]
v_add_f32 v65, v65, v69
ds_read_b64_tr_b16 a[24:25], v19 offset:24576
v_mfma_f32_16x16x32_bf16 v[36:39], a[0:3], a[96:99], v[36:39]
v_add_f32 v66, v66, v70
s_waitcnt lgkmcnt(5)
v_mfma_f32_16x16x32_bf16 v[40:43], a[8:11], a[88:91], v[40:43]
v_add_f32 v67, v67, v71
ds_read_b64_tr_b16 a[26:27], v19 offset:26624
v_mfma_f32_16x16x32_bf16 v[40:43], a[12:15], a[92:95], v[40:43]
v_add_f32 v64, v64, v66
ds_read_b64_tr_b16 a[28:29], v19 offset:28672
v_mfma_f32_16x16x32_bf16 v[44:47], a[12:15], a[100:103], v[44:47]
v_add_f32 v65, v65, v67
ds_read_b64_tr_b16 a[30:31], v19 offset:30720
v_mfma_f32_16x16x32_bf16 v[44:47], a[8:11], a[96:99], v[44:47]
v_add_f32 v64, v64, v65
s_waitcnt lgkmcnt(4)
v_mfma_f32_16x16x32_bf16 v[48:51], a[16:19], a[88:91], v[48:51]
v_mov_b32 v65, v64
s_nop 0
buffer_load_dwordx4 v6, s[4:7], s22 offen offset:0 lds
v_mfma_f32_16x16x32_bf16 v[48:51], a[20:23], a[92:95], v[48:51]
v_permlane32_swap_b32 v64, v65
buffer_load_dwordx4 v7, s[4:7], s22 offen offset:1024 lds
v_mfma_f32_16x16x32_bf16 v[52:55], a[20:23], a[100:103], v[52:55]
v_add_f32 v64, v64, v65
buffer_load_dwordx4 v8, s[4:7], s22 offen offset:2048 lds
v_mfma_f32_16x16x32_bf16 v[52:55], a[16:19], a[96:99], v[52:55]
v_add_f32 v24, v24, v64
s_waitcnt lgkmcnt(0)
v_mfma_f32_16x16x32_bf16 v[56:59], a[24:27], a[88:91], v[56:59]
v_mov_b32 v25, v24
s_nop 0
v_mfma_f32_16x16x32_bf16 v[56:59], a[28:31], a[92:95], v[56:59]
v_permlane16_swap_b32 v24, v25
v_mfma_f32_16x16x32_bf16 v[60:63], a[28:31], a[100:103], v[60:63]
v_mfma_f32_16x16x32_bf16 v[60:63], a[24:27], a[96:99], v[60:63]
s_nop 3
v_pk_add_f32 v[96:97], v[32:33], v[24:25] op_sel:[0,0] op_sel_hi:[1,0] neg_lo:[0,1] neg_hi:[0,1]
v_pk_add_f32 v[98:99], v[34:35], v[24:25] op_sel:[0,0] op_sel_hi:[1,0] neg_lo:[0,1] neg_hi:[0,1]
v_pk_add_f32 v[104:105], v[40:41], v[24:25] op_sel:[0,0] op_sel_hi:[1,0] neg_lo:[0,1] neg_hi:[0,1]
v_pk_add_f32 v[106:107], v[42:43], v[24:25] op_sel:[0,0] op_sel_hi:[1,0] neg_lo:[0,1] neg_hi:[0,1]
v_cvt_pk_bf16_f32 v72, v96, v97
v_cvt_pk_bf16_f32 v73, v98, v99
v_cvt_pk_bf16_f32 v74, v104, v105
v_cvt_pk_bf16_f32 v75, v106, v107
buffer_store_dwordx4 v[72:75], v9, s[8:11], s34 offen offset:0 sc1
v_pk_add_f32 v[112:113], v[48:49], v[24:25] op_sel:[0,0] op_sel_hi:[1,0] neg_lo:[0,1] neg_hi:[0,1]
v_pk_add_f32 v[114:115], v[50:51], v[24:25] op_sel:[0,0] op_sel_hi:[1,0] neg_lo:[0,1] neg_hi:[0,1]
v_pk_add_f32 v[120:121], v[56:57], v[24:25] op_sel:[0,0] op_sel_hi:[1,0] neg_lo:[0,1] neg_hi:[0,1]
v_pk_add_f32 v[122:123], v[58:59], v[24:25] op_sel:[0,0] op_sel_hi:[1,0] neg_lo:[0,1] neg_hi:[0,1]
v_cvt_pk_bf16_f32 v76, v112, v113
v_cvt_pk_bf16_f32 v77, v114, v115
v_cvt_pk_bf16_f32 v78, v120, v121
v_cvt_pk_bf16_f32 v79, v122, v123
buffer_store_dwordx4 v[76:79], v9, s[8:11], s34 offen offset:1024 sc1
v_pk_add_f32 v[100:101], v[36:37], v[24:25] op_sel:[0,1] op_sel_hi:[1,1] neg_lo:[0,1] neg_hi:[0,1]
v_pk_add_f32 v[102:103], v[38:39], v[24:25] op_sel:[0,1] op_sel_hi:[1,1] neg_lo:[0,1] neg_hi:[0,1]
v_pk_add_f32 v[108:109], v[44:45], v[24:25] op_sel:[0,1] op_sel_hi:[1,1] neg_lo:[0,1] neg_hi:[0,1]
v_pk_add_f32 v[110:111], v[46:47], v[24:25] op_sel:[0,1] op_sel_hi:[1,1] neg_lo:[0,1] neg_hi:[0,1]
v_cvt_pk_bf16_f32 v80, v100, v101
v_cvt_pk_bf16_f32 v81, v102, v103
v_cvt_pk_bf16_f32 v82, v108, v109
v_cvt_pk_bf16_f32 v83, v110, v111
buffer_store_dwordx4 v[80:83], v10, s[8:11], s34 offen offset:0 sc1
v_pk_add_f32 v[116:117], v[52:53], v[24:25] op_sel:[0,1] op_sel_hi:[1,1] neg_lo:[0,1] neg_hi:[0,1]
v_pk_add_f32 v[118:119], v[54:55], v[24:25] op_sel:[0,1] op_sel_hi:[1,1] neg_lo:[0,1] neg_hi:[0,1]
v_pk_add_f32 v[124:125], v[60:61], v[24:25] op_sel:[0,1] op_sel_hi:[1,1] neg_lo:[0,1] neg_hi:[0,1]
v_pk_add_f32 v[126:127], v[62:63], v[24:25] op_sel:[0,1] op_sel_hi:[1,1] neg_lo:[0,1] neg_hi:[0,1]
v_cvt_pk_bf16_f32 v84, v116, v117
v_cvt_pk_bf16_f32 v85, v118, v119
v_cvt_pk_bf16_f32 v86, v124, v125
v_cvt_pk_bf16_f32 v87, v126, v127
buffer_store_dwordx4 v[84:87], v10, s[8:11], s34 offen offset:1024 sc1
v_pk_mul_f32 v[26:27], v[96:97], v[96:97]
v_pk_fma_f32 v[26:27], v[98:99], v[98:99], v[26:27]
v_pk_fma_f32 v[26:27], v[104:105], v[104:105], v[26:27]
v_pk_fma_f32 v[26:27], v[106:107], v[106:107], v[26:27]
v_pk_fma_f32 v[26:27], v[112:113], v[112:113], v[26:27]
v_pk_fma_f32 v[26:27], v[114:115], v[114:115], v[26:27]
v_pk_fma_f32 v[26:27], v[120:121], v[120:121], v[26:27]
v_pk_fma_f32 v[26:27], v[122:123], v[122:123], v[26:27]
v_pk_mul_f32 v[28:29], v[100:101], v[100:101]
v_pk_fma_f32 v[28:29], v[102:103], v[102:103], v[28:29]
v_pk_fma_f32 v[28:29], v[108:109], v[108:109], v[28:29]
v_pk_fma_f32 v[28:29], v[110:111], v[110:111], v[28:29]
v_pk_fma_f32 v[28:29], v[116:117], v[116:117], v[28:29]
v_pk_fma_f32 v[28:29], v[118:119], v[118:119], v[28:29]
v_pk_fma_f32 v[28:29], v[124:125], v[124:125], v[28:29]
v_pk_fma_f32 v[28:29], v[126:127], v[126:127], v[28:29]
v_add_f32 v26, v26, v27
v_add_f32 v28, v28, v29
s_nop 1
v_permlane16_swap_b32 v26, v28
s_nop 0
v_add_f32 v26, v26, v28
v_mov_b32 v28, v26
s_nop 1
v_permlane32_swap_b32 v26, v28
s_nop 0
v_add_f32 v26, v26, v28
buffer_store_dword v26, v23, s[16:19], s35 offen sc1
L_ph3:
v_accvgpr_write_b32 a184, v32
v_accvgpr_write_b32 a185, v33
v_accvgpr_write_b32 a186, v34
v_accvgpr_write_b32 a187, v35
v_accvgpr_write_b32 a188, v36
v_accvgpr_write_b32 a189, v37
v_accvgpr_write_b32 a190, v38
v_accvgpr_write_b32 a191, v39
v_accvgpr_write_b32 a192, v40
v_accvgpr_write_b32 a193, v41
v_accvgpr_write_b32 a194, v42
v_accvgpr_write_b32 a195, v43
v_accvgpr_write_b32 a196, v44
v_accvgpr_write_b32 a197, v45
v_accvgpr_write_b32 a198, v46
v_accvgpr_write_b32 a199, v47
v_accvgpr_write_b32 a200, v48
v_accvgpr_write_b32 a201, v49
v_accvgpr_write_b32 a202, v50
v_accvgpr_write_b32 a203, v51
v_accvgpr_write_b32 a204, v52
v_accvgpr_write_b32 a205, v53
v_accvgpr_write_b32 a206, v54
v_accvgpr_write_b32 a207, v55
v_accvgpr_write_b32 a208, v56
v_accvgpr_write_b32 a209, v57
v_accvgpr_write_b32 a210, v58
v_accvgpr_write_b32 a211, v59
v_accvgpr_write_b32 a212, v60
v_accvgpr_write_b32 a213, v61
v_accvgpr_write_b32 a214, v62
v_accvgpr_write_b32 a215, v63
s_lshl_b32 s21, s87, 15
s_and_b32 s27, s21, 0xffffe000
s_add_u32 s21, s21, s27
s_lshr_b32 s27, s21, 8
s_and_b32 s27, s27, 8192
s_or_b32 s21, s21, s27
s_xor_b32 s21, s21, s30
s_mov_b32 s51, 4096
s_add_u32 s12, s32, 8388608
s_addc_u32 s13, s33, 0
s_mov_b32 s14, 16777216
s_mov_b32 s15, 0x20000
s_mov_b32 s40, s76
s_mov_b32 s41, s77
s_mov_b32 s42, 7340032
s_mov_b32 s43, 0x20000
s_lshl_b32 s38, s87, 10
s_and_b32 s27, s38, 0xffffe000
s_add_u32 s38, s38, s27
s_lshr_b32 s27, s38, 8
s_and_b32 s27, s27, 8192
s_or_b32 s38, s38, s27
s_xor_b32 s38, s38, s30
v_lshlrev_b32 v14, 2, v0
s_lshr_b32 s36, s2, 3
s_lshl_b32 s36, s36, 1
s_add_u32 s36, s36, s47
s_add_u32 s36, s36, 256
s_mul_i32 s36, s36, 7168
s_and_b32 s37, s2, 3
s_mul_i32 s37, s37, 1792
s_add_u32 s36, s36, s37
s_and_b32 s37, s2, 4
s_mul_i32 s37, s37, 224
s_add_u32 s36, s36, s37
s_lshr_b32 s37, s2, 3
s_mul_i32 s37, s37, 229376
s_and_b32 s27, s2, 7
s_lshl_b32 s27, s27, 2
s_add_u32 s27, s27, s20
s_lshl_b32 s27, s27, 10
s_add_u32 s37, s37, s27
s_add_u32 s48, s36, 5046272
s_mov_b32 s49, s37
s_add_u32 s50, s37, 196608
s_sub_u32 s37, s37, 163840
v_min_u32 v1, 6, v0
v_lshlrev_b32 v1, 7, v1
v_min_u32 v15, 7, v0
v_lshlrev_b32 v15, 7, v15
s_and_b32 s35, s2, 1
s_mul_i32 s92, s35, 3670016
s_lshl_b32 s27, s81, 7
s_add_u32 s92, s92, s27
s_mul_i32 s27, s20, 229376
s_add_u32 s92, s92, s27
s_add_u32 s93, s92, s27
s_lshl_b32 s95, s20, 13
s_and_b32 s28, s82, 63
s_lshl_b32 s28, s28, 17
s_mul_i32 s27, s35, 57344
s_add_u32 s28, s28, s27
s_and_b32 s27, s28, 0xffffe000
s_add_u32 s28, s28, s27
s_lshr_b32 s27, s28, 8
s_and_b32 s27, s27, 8192
s_or_b32 s28, s28, s27
s_xor_b32 s28, s28, s30
s_and_b32 s34, s80, 6
s_add_u32 s34, s34, s35
s_lshl_b32 s34, s34, 8
s_bfe_u32 s27, s82, 0x20002
s_lshl_b32 s27, s27, 2
s_add_u32 s34, s34, s27
v_and_b32 v20, 1, v0
v_lshl_add_u32 v20, v20, 7, s34
v_and_b32 v21, 6, v0
v_lshl_or_b32 v20, v21, 10, v20
v_and_b32 v21, 8, v0
v_lshl_or_b32 v20, v21, 11, v20
s_xor_b32 s27, s100, 128
s_sub_u32 s27, s27, s101
v_mov_b32 v21, s27
v_cmp_gt_u32 vcc, 16, v0
s_nop 1
v_cndmask_b32 v20, v21, v20, vcc
v_accvgpr_write_b32 a222, v20
s_mov_b32 s63, s3
s_sub_u32 s62, s3, 1048576
s_xor_b32 s61, s3, 2105344
s_xor_b32 s60, s62, 2105344
v_mov_b32 v30, 3
s_sub_u32 s27, s100, 16
s_waitcnt vmcnt(0)
s_barrier
s_cmp_lg_u32 s20, 0
s_cbranch_scc1 L_sig3
buffer_store_dword v30, off, s[16:19], s27 sc1
L_sig3:
s_add_u32 s22, s22, 458752
s_add_u32 m0, s23, 32768
s_nop 0
buffer_load_dwordx4 v2, s[4:7], s22 offen offset:0 lds
buffer_load_dwordx4 v3, s[4:7], s22 offen offset:1024 lds
buffer_load_dwordx4 v4, s[4:7], s22 offen offset:2048 lds
buffer_load_dwordx4 v5, s[4:7], s22 offen offset:3072 lds
s_add_u32 m0, s23, 36864
s_nop 0
buffer_load_dwordx4 v6, s[4:7], s22 offen offset:0 lds
buffer_load_dwordx4 v7, s[4:7], s22 offen offset:1024 lds
buffer_load_dwordx4 v8, s[4:7], s22 offen offset:2048 lds
s_call_b64 s[96:97], L_visit2
s_lshr_b32 s27, s76, 7
s_sub_u32 s27, 3, s27
s_and_b32 s27, s27, 7
s_lshl_b32 s55, s27, 7
s_and_b32 s35, s2, 1
s_mul_i32 s35, s35, 3670016
s_add_u32 s55, s55, s35
s_lshr_b32 s27, s27, 1
s_lshr_b32 s35, s81, 1
s_sub_u32 s27, s35, s27
s_sub_u32 s27, s27, 1
s_and_b32 s27, s27, 3
s_lshl_b32 s27, s27, 1
s_lshr_b32 s35, s35, 2
s_add_u32 s27, s27, s35
s_lshl_b32 s27, s27, 2
s_and_b32 s35, s80, 3
s_add_u32 s27, s27, s35
s_lshl_b32 s27, s27, 2
s_add_u32 s27, s27, s20
s_cmp_ge_u32 s27, 96
s_cselect_b32 s27, 256, s27
v_mul_u32_u24 v28, 96, v0
v_add_u32 v28, s27, v28
v_cmp_gt_u32 vcc, 256, v28
v_bfe_u32 v29, v28, 5, 2
v_mul_u32_u24 v29, 112, v29
v_and_b32 v30, 31, v28
v_add_u32 v29, v29, v30
v_lshlrev_b32 v29, 11, v29
v_bfe_u32 v30, v28, 4, 3
v_mul_u32_u24 v30, 112, v30
v_and_b32 v31, 15, v28
v_add_u32 v30, v30, v31
v_lshlrev_b32 v30, 11, v30
v_bfe_u32 v28, v28, 7, 1
v_lshl_add_u32 v29, v28, 10, v29
v_lshl_add_u32 v30, v28, 10, v30
v_mov_b32 v31, 0x7ffffff0
v_cndmask_b32 v28, v31, v29, vcc
v_cndmask_b32 v29, v31, v30, vcc
v_lshrrev_b32 v17, 2, v0
v_lshlrev_b32 v17, 7, v17
v_bfe_u32 v18, v0, 3, 2
v_lshlrev_b32 v18, 5, v18
v_and_b32 v19, 3, v0
v_lshlrev_b32 v19, 3, v19
v_add3_u32 v16, v17, v18, v19
v_xor_b32 v17, 32, v16
v_xor_b32 v18, 64, v16
v_xor_b32 v19, 96, v16
v_accvgpr_write_b32 a216, v16
v_accvgpr_write_b32 a217, v17
v_accvgpr_write_b32 a218, v18
v_accvgpr_write_b32 a219, v19
v_accvgpr_write_b32 a220, v28
v_accvgpr_write_b32 a221, v29
s_lshr_b32 s34, s26, 1
s_lshl_b32 s34, s34, 8
s_and_b32 s35, s26, 1
s_lshl_b32 s35, s35, 10
s_or_b32 s34, s34, s35
v_and_b32 v31, 1, v0
v_lshl_add_u32 v31, v31, 7, s34
v_and_b32 v29, 2, v0
v_lshl_or_b32 v31, v29, 8, v31
v_and_b32 v29, 12, v0
v_lshl_or_b32 v31, v29, 9, v31
v_and_b32 v29, 16, v0
v_lshl_or_b32 v31, v29, 10, v31
s_cmp_lg_u32 s20, 0
s_cbranch_scc1 L_got3
s_mov_b32 s34, 196608
s_add_u32 s34, s34, s30
s_mov_b32 s27, 131072
L_poll3:
buffer_load_dword v30, v31, s[16:19], s34 offen sc1
s_sub_u32 s27, s27, 1
s_cmp_eq_u32 s27, 0
s_cbranch_scc1 L_got3
s_waitcnt vmcnt(0)
v_cmp_gt_u32 vcc, 3, v30
s_nop 0
s_cbranch_vccnz L_poll3
L_got3:
s_waitcnt vmcnt(0) lgkmcnt(0)
s_barrier
buffer_load_dwordx4 a[32:35], v9, s[8:11], s21 offen offset:0 sc1
buffer_load_dwordx4 a[36:39], v9, s[8:11], s21 offen offset:1024 sc1
buffer_load_dwordx4 a[40:43], v10, s[8:11], s21 offen offset:0 sc1
buffer_load_dwordx4 a[44:47], v10, s[8:11], s21 offen offset:1024 sc1
buffer_load_dwordx4 a[48:51], v11, s[8:11], s21 offen offset:0 sc1
buffer_load_dwordx4 a[52:55], v11, s[8:11], s21 offen offset:1024 sc1
buffer_load_dwordx4 a[56:59], v12, s[8:11], s21 offen offset:0 sc1
buffer_load_dwordx4 a[60:63], v12, s[8:11], s21 offen offset:1024 sc1
s_lshl_b32 s99, s87, 17
s_lshr_b32 s27, s25, 4
s_mul_i32 s27, s27, 57344
s_add_u32 s99, s99, s27
s_and_b32 s27, s25, 15
s_lshl_b32 s27, s27, 9
s_add_u32 s99, s99, s27
s_add_u32 s96, s99, s27
s_add_u32 s99, s99, 49152
s_and_b32 s27, s96, 0xffffe000
s_add_u32 s96, s96, s27
s_lshr_b32 s27, s96, 8
s_and_b32 s27, s27, 8192
s_or_b32 s96, s96, s27
s_xor_b32 s96, s96, s30
s_and_b32 s27, s99, 0xffffe000
s_add_u32 s99, s99, s27
s_lshr_b32 s27, s99, 8
s_and_b32 s27, s27, 8192
s_or_b32 s99, s99, s27
s_xor_b32 s99, s99, s30
s_add_u32 s97, s96, 32768
s_add_u32 s98, s96, 65536
ds_read_b64_tr_b16 a[0:1], v13 offset:0
ds_read_b64_tr_b16 a[2:3], v13 offset:3584
ds_read_b64_tr_b16 a[4:5], v13 offset:7168
ds_read_b64_tr_b16 a[6:7], v13 offset:10752
ds_read_b64_tr_b16 a[8:9], v13 offset:14336
ds_read_b64_tr_b16 a[10:11], v13 offset:17920
ds_read_b64_tr_b16 a[12:13], v13 offset:21504
ds_read_b64_tr_b16 a[14:15], v13 offset:25088
s_waitcnt vmcnt(6) lgkmcnt(4)
v_mfma_f32_16x16x32_bf16 v[32:35], a[0:3], a[32:35], 0
ds_read_b64_tr_b16 a[16:17], v13 offset:32
v_mfma_f32_16x16x32_bf16 v[32:35], a[4:7], a[36:39], v[32:35]
ds_read_b64_tr_b16 a[18:19], v13 offset:3616
s_waitcnt vmcnt(4)
v_mfma_f32_16x16x32_bf16 v[36:39], a[4:7], a[44:47], 0
ds_read_b64_tr_b16 a[20:21], v13 offset:7200
v_mfma_f32_16x16x32_bf16 v[36:39], a[0:3], a[40:43], v[36:39]
ds_read_b64_tr_b16 a[22:23], v13 offset:10784
s_waitcnt vmcnt(2)
v_mfma_f32_16x16x32_bf16 v[40:43], a[0:3], a[48:51], 0
buffer_load_dwordx4 a[64:67], v9, s[8:11], s21 offen offset:2048 sc1
v_mfma_f32_16x16x32_bf16 v[40:43], a[4:7], a[52:55], v[40:43]
s_waitcnt vmcnt(1)
v_mfma_f32_16x16x32_bf16 v[44:47], a[4:7], a[60:63], 0
v_mfma_f32_16x16x32_bf16 v[44:47], a[0:3], a[56:59], v[44:47]
s_waitcnt lgkmcnt(4)
v_mfma_f32_16x16x32_bf16 v[48:51], a[8:11], a[32:35], 0
ds_read_b64_tr_b16 a[24:25], v13 offset:14368
buffer_load_dwordx4 a[68:71], v9, s[8:11], s21 offen offset:3072 sc1
v_mfma_f32_16x16x32_bf16 v[48:51], a[12:15], a[36:39], v[48:51]
ds_read_b64_tr_b16 a[26:27], v13 offset:17952
v_mfma_f32_16x16x32_bf16 v[52:55], a[12:15], a[44:47], 0
ds_read_b64_tr_b16 a[28:29], v13 offset:21536
v_mfma_f32_16x16x32_bf16 v[52:55], a[8:11], a[40:43], v[52:55]
ds_read_b64_tr_b16 a[30:31], v13 offset:25120
v_mfma_f32_16x16x32_bf16 v[56:59], a[8:11], a[48:51], 0
buffer_load_dwordx4 a[72:75], v10, s[8:11], s21 offen offset:2048 sc1
v_mfma_f32_16x16x32_bf16 v[56:59], a[12:15], a[52:55], v[56:59]
v_mfma_f32_16x16x32_bf16 v[60:63], a[12:15], a[60:63], 0
v_mfma_f32_16x16x32_bf16 v[60:63], a[8:11], a[56:59], v[60:63]
s_waitcnt lgkmcnt(4)
v_mfma_f32_16x16x32_bf16 v[64:67], a[16:19], a[32:35], 0
ds_read_b64_tr_b16 a[0:1], v13 offset:64
buffer_load_dwordx4 a[76:79], v10, s[8:11], s21 offen offset:3072 sc1
v_mfma_f32_16x16x32_bf16 v[64:67], a[20:23], a[36:39], v[64:67]
ds_read_b64_tr_b16 a[2:3], v13 offset:3648
v_mfma_f32_16x16x32_bf16 v[68:71], a[20:23], a[44:47], 0
ds_read_b64_tr_b16 a[4:5], v13 offset:7232
v_mfma_f32_16x16x32_bf16 v[68:71], a[16:19], a[40:43], v[68:71]
ds_read_b64_tr_b16 a[6:7], v13 offset:10816
v_mfma_f32_16x16x32_bf16 v[72:75], a[16:19], a[48:51], 0
buffer_load_dwordx4 a[80:83], v11, s[8:11], s21 offen offset:2048 sc1
v_mfma_f32_16x16x32_bf16 v[72:75], a[20:23], a[52:55], v[72:75]
v_mfma_f32_16x16x32_bf16 v[76:79], a[20:23], a[60:63], 0
v_mfma_f32_16x16x32_bf16 v[76:79], a[16:19], a[56:59], v[76:79]
s_waitcnt lgkmcnt(4)
v_mfma_f32_16x16x32_bf16 v[80:83], a[24:27], a[32:35], 0
ds_read_b64_tr_b16 a[8:9], v13 offset:14400
buffer_load_dwordx4 a[84:87], v11, s[8:11], s21 offen offset:3072 sc1
v_mfma_f32_16x16x32_bf16 v[80:83], a[28:31], a[36:39], v[80:83]
ds_read_b64_tr_b16 a[10:11], v13 offset:17984
v_mfma_f32_16x16x32_bf16 v[84:87], a[28:31], a[44:47], 0
ds_read_b64_tr_b16 a[12:13], v13 offset:21568
v_mfma_f32_16x16x32_bf16 v[84:87], a[24:27], a[40:43], v[84:87]
ds_read_b64_tr_b16 a[14:15], v13 offset:25152
v_mfma_f32_16x16x32_bf16 v[88:91], a[24:27], a[48:51], 0
buffer_load_dwordx4 a[88:91], v12, s[8:11], s21 offen offset:2048 sc1
v_mfma_f32_16x16x32_bf16 v[88:91], a[28:31], a[52:55], v[88:91]
v_mfma_f32_16x16x32_bf16 v[92:95], a[28:31], a[60:63], 0
v_mfma_f32_16x16x32_bf16 v[92:95], a[24:27], a[56:59], v[92:95]
s_waitcnt lgkmcnt(4)
v_mfma_f32_16x16x32_bf16 v[96:99], a[0:3], a[32:35], 0
ds_read_b64_tr_b16 a[16:17], v13 offset:96
buffer_load_dwordx4 a[92:95], v12, s[8:11], s21 offen offset:3072 sc1
v_mfma_f32_16x16x32_bf16 v[96:99], a[4:7], a[36:39], v[96:99]
ds_read_b64_tr_b16 a[18:19], v13 offset:3680
v_mfma_f32_16x16x32_bf16 v[100:103], a[4:7], a[44:47], 0
ds_read_b64_tr_b16 a[20:21], v13 offset:7264
v_mfma_f32_16x16x32_bf16 v[100:103], a[0:3], a[40:43], v[100:103]
ds_read_b64_tr_b16 a[22:23], v13 offset:10848
v_mfma_f32_16x16x32_bf16 v[104:107], a[0:3], a[48:51], 0
s_xor_b32 s23, s23, 0x10000
v_mfma_f32_16x16x32_bf16 v[104:107], a[4:7], a[52:55], v[104:107]
s_add_u32 s22, s22, 458752
v_mfma_f32_16x16x32_bf16 v[108:111], a[4:7], a[60:63], 0
s_add_u32 m0, s23, 0
v_mfma_f32_16x16x32_bf16 v[108:111], a[0:3], a[56:59], v[108:111]
buffer_load_dwordx4 v2, s[4:7], s22 offen offset:0 lds
s_waitcnt lgkmcnt(4)
v_mfma_f32_16x16x32_bf16 v[112:115], a[8:11], a[32:35], 0
ds_read_b64_tr_b16 a[24:25], v13 offset:14432
buffer_load_dword v16, v14, s[16:19], s38 offen offset:0 sc1
v_mfma_f32_16x16x32_bf16 v[112:115], a[12:15], a[36:39], v[112:115]
ds_read_b64_tr_b16 a[26:27], v13 offset:18016
v_mfma_f32_16x16x32_bf16 v[116:119], a[12:15], a[44:47], 0
ds_read_b64_tr_b16 a[28:29], v13 offset:21600
buffer_load_dword v17, v14, s[16:19], s38 offen offset:256 sc1
v_mfma_f32_16x16x32_bf16 v[116:119], a[8:11], a[40:43], v[116:119]
ds_read_b64_tr_b16 a[30:31], v13 offset:25184
v_mfma_f32_16x16x32_bf16 v[120:123], a[8:11], a[48:51], 0
buffer_load_dwordx4 v3, s[4:7], s22 offen offset:1024 lds
v_mfma_f32_16x16x32_bf16 v[120:123], a[12:15], a[52:55], v[120:123]
v_mfma_f32_16x16x32_bf16 v[124:127], a[12:15], a[60:63], 0
buffer_load_dword v18, v14, s[16:19], s38 offen offset:512 sc1
v_mfma_f32_16x16x32_bf16 v[124:127], a[8:11], a[56:59], v[124:127]
s_waitcnt lgkmcnt(4)
v_mfma_f32_16x16x32_bf16 v[128:131], a[16:19], a[32:35], 0
ds_read_b64_tr_b16 a[0:1], v13 offset:128
v_mfma_f32_16x16x32_bf16 v[128:131], a[20:23], a[36:39], v[128:131]
ds_read_b64_tr_b16 a[2:3], v13 offset:3712
v_mfma_f32_16x16x32_bf16 v[132:135], a[20:23], a[44:47], 0
ds_read_b64_tr_b16 a[4:5], v13 offset:7296
buffer_load_dword v19, v14, s[16:19], s38 offen offset:768 sc1
v_mfma_f32_16x16x32_bf16 v[132:135], a[16:19], a[40:43], v[132:135]
ds_read_b64_tr_b16 a[6:7], v13 offset:10880
v_mfma_f32_16x16x32_bf16 v[136:139], a[16:19], a[48:51], 0
buffer_load_dwordx4 v4, s[4:7], s22 offen offset:2048 lds
v_mfma_f32_16x16x32_bf16 v[136:139], a[20:23], a[52:55], v[136:139]
v_mfma_f32_16x16x32_bf16 v[140:143], a[20:23], a[60:63], 0
buffer_load_dword v20, v14, s[16:19], s38 offen offset:1024 sc1
v_mfma_f32_16x16x32_bf16 v[140:143], a[16:19], a[56:59], v[140:143]
s_waitcnt lgkmcnt(4)
v_mfma_f32_16x16x32_bf16 v[144:147], a[24:27], a[32:35], 0
ds_read_b64_tr_b16 a[8:9], v13 offset:14464
v_mfma_f32_16x16x32_bf16 v[144:147], a[28:31], a[36:39], v[144:147]
ds_read_b64_tr_b16 a[10:11], v13 offset:18048
v_mfma_f32_16x16x32_bf16 v[148:151], a[28:31], a[44:47], 0
ds_read_b64_tr_b16 a[12:13], v13 offset:21632
buffer_load_dword v21, v14, s[16:19], s38 offen offset:1280 sc1
v_mfma_f32_16x16x32_bf16 v[148:151], a[24:27], a[40:43], v[148:151]
ds_read_b64_tr_b16 a[14:15], v13 offset:25216
v_mfma_f32_16x16x32_bf16 v[152:155], a[24:27], a[48:51], 0
buffer_load_dwordx4 v5, s[4:7], s22 offen offset:3072 lds
v_mfma_f32_16x16x32_bf16 v[152:155], a[28:31], a[52:55], v[152:155]
v_mfma_f32_16x16x32_bf16 v[156:159], a[28:31], a[60:63], 0
buffer_load_dword v22, v14, s[16:19], s38 offen offset:1536 sc1
v_mfma_f32_16x16x32_bf16 v[156:159], a[24:27], a[56:59], v[156:159]
s_waitcnt lgkmcnt(4)
v_mfma_f32_16x16x32_bf16 v[160:163], a[0:3], a[32:35], 0
ds_read_b64_tr_b16 a[16:17], v13 offset:160
v_mfma_f32_16x16x32_bf16 v[160:163], a[4:7], a[36:39], v[160:163]
ds_read_b64_tr_b16 a[18:19], v13 offset:3744
v_mfma_f32_16x16x32_bf16 v[164:167], a[4:7], a[44:47], 0
ds_read_b64_tr_b16 a[20:21], v13 offset:7328
buffer_load_dword v23, v14, s[16:19], s38 offen offset:1792 sc1
v_mfma_f32_16x16x32_bf16 v[164:167], a[0:3], a[40:43], v[164:167]
ds_read_b64_tr_b16 a[22:23], v13 offset:10912
v_mfma_f32_16x16x32_bf16 v[168:171], a[0:3], a[48:51], 0
s_add_u32 m0, s23, 4096
v_mfma_f32_16x16x32_bf16 v[168:171], a[4:7], a[52:55], v[168:171]
buffer_load_dwordx4 v6, s[4:7], s22 offen offset:0 lds
v_mfma_f32_16x16x32_bf16 v[172:175], a[4:7], a[60:63], 0
buffer_load_dword v24, v14, s[16:19], s38 offen offset:2048 sc1
v_mfma_f32_16x16x32_bf16 v[172:175], a[0:3], a[56:59], v[172:175]
s_waitcnt lgkmcnt(4)
v_mfma_f32_16x16x32_bf16 v[176:179], a[8:11], a[32:35], 0
ds_read_b64_tr_b16 a[24:25], v13 offset:14496
v_mfma_f32_16x16x32_bf16 v[176:179], a[12:15], a[36:39], v[176:179]
ds_read_b64_tr_b16 a[26:27], v13 offset:18080
v_mfma_f32_16x16x32_bf16 v[180:183], a[12:15], a[44:47], 0
ds_read_b64_tr_b16 a[28:29], v13 offset:21664
buffer_load_dword v25, v14, s[16:19], s38 offen offset:2304 sc1
v_mfma_f32_16x16x32_bf16 v[180:183], a[8:11], a[40:43], v[180:183]
ds_read_b64_tr_b16 a[30:31], v13 offset:25248
v_mfma_f32_16x16x32_bf16 v[184:187], a[8:11], a[48:51], 0
buffer_load_dwordx4 v7, s[4:7], s22 offen offset:1024 lds
v_mfma_f32_16x16x32_bf16 v[184:187], a[12:15], a[52:55], v[184:187]
v_mfma_f32_16x16x32_bf16 v[188:191], a[12:15], a[60:63], 0
buffer_load_dword v26, v14, s[16:19], s38 offen offset:2560 sc1
v_mfma_f32_16x16x32_bf16 v[188:191], a[8:11], a[56:59], v[188:191]
s_waitcnt lgkmcnt(4)
v_mfma_f32_16x16x32_bf16 v[192:195], a[16:19], a[32:35], 0
ds_read_b64_tr_b16 a[0:1], v13 offset:192
v_mfma_f32_16x16x32_bf16 v[192:195], a[20:23], a[36:39], v[192:195]
ds_read_b64_tr_b16 a[2:3], v13 offset:3776
v_mfma_f32_16x16x32_bf16 v[196:199], a[20:23], a[44:47], 0
ds_read_b64_tr_b16 a[4:5], v13 offset:7360
buffer_load_dword v27, v14, s[16:19], s38 offen offset:2816 sc1
v_mfma_f32_16x16x32_bf16 v[196:199], a[16:19], a[40:43], v[196:199]
ds_read_b64_tr_b16 a[6:7], v13 offset:10944
v_mfma_f32_16x16x32_bf16 v[200:203], a[16:19], a[48:51], 0
buffer_load_dwordx4 v8, s[4:7], s22 offen offset:2048 lds
v_mfma_f32_16x16x32_bf16 v[200:203], a[20:23], a[52:55], v[200:203]
v_mfma_f32_16x16x32_bf16 v[204:207], a[20:23], a[60:63], 0
buffer_load_dword v28, v14, s[16:19], s38 offen offset:3072 sc1
v_mfma_f32_16x16x32_bf16 v[204:207], a[16:19], a[56:59], v[204:207]
s_waitcnt lgkmcnt(4)
v_mfma_f32_16x16x32_bf16 v[208:211], a[24:27], a[32:35], 0
ds_read_b64_tr_b16 a[8:9], v13 offset:14528
v_mfma_f32_16x16x32_bf16 v[208:211], a[28:31], a[36:39], v[208:211]
ds_read_b64_tr_b16 a[10:11], v13 offset:18112
v_mfma_f32_16x16x32_bf16 v[212:215], a[28:31], a[44:47], 0
ds_read_b64_tr_b16 a[12:13], v13 offset:21696
buffer_load_dword a250, v1, s[4:7], s36 offen
v_mfma_f32_16x16x32_bf16 v[212:215], a[24:27], a[40:43], v[212:215]
ds_read_b64_tr_b16 a[14:15], v13 offset:25280
buffer_load_dword v29, v14, s[16:19], s38 offen offset:3328 sc1
v_mfma_f32_16x16x32_bf16 v[216:219], a[24:27], a[48:51], 0
s_add_u32 s36, s36, 458752
v_mfma_f32_16x16x32_bf16 v[216:219], a[28:31], a[52:55], v[216:219]
s_min_u32 s36, s36, s48
v_mfma_f32_16x16x32_bf16 v[220:223], a[28:31], a[60:63], 0
buffer_load_dword v30, v14, s[16:19], s38 offen offset:3584 sc1
v_mfma_f32_16x16x32_bf16 v[220:223], a[24:27], a[56:59], v[220:223]
s_barrier
s_waitcnt lgkmcnt(4)
v_mfma_f32_16x16x32_bf16 v[224:227], a[0:3], a[32:35], 0
ds_read_b64_tr_b16 a[16:17], v13 offset:32768
v_mfma_f32_16x16x32_bf16 v[224:227], a[4:7], a[36:39], v[224:227]
ds_read_b64_tr_b16 a[18:19], v13 offset:36352
v_mfma_f32_16x16x32_bf16 v[228:231], a[4:7], a[44:47], 0
ds_read_b64_tr_b16 a[20:21], v13 offset:39936
buffer_load_dword v31, v14, s[16:19], s38 offen offset:3840 sc1
v_mfma_f32_16x16x32_bf16 v[228:231], a[0:3], a[40:43], v[228:231]
ds_read_b64_tr_b16 a[22:23], v13 offset:43520
v_mfma_f32_16x16x32_bf16 v[232:235], a[0:3], a[48:51], 0
v_mfma_f32_16x16x32_bf16 v[232:235], a[4:7], a[52:55], v[232:235]
v_mfma_f32_16x16x32_bf16 v[236:239], a[4:7], a[60:63], 0
v_mfma_f32_16x16x32_bf16 v[236:239], a[0:3], a[56:59], v[236:239]
s_waitcnt lgkmcnt(4)
v_mfma_f32_16x16x32_bf16 v[240:243], a[8:11], a[32:35], 0
ds_read_b64_tr_b16 a[24:25], v13 offset:47104
v_mfma_f32_16x16x32_bf16 v[240:243], a[12:15], a[36:39], v[240:243]
ds_read_b64_tr_b16 a[26:27], v13 offset:50688
v_mfma_f32_16x16x32_bf16 v[244:247], a[12:15], a[44:47], 0
ds_read_b64_tr_b16 a[28:29], v13 offset:54272
v_mfma_f32_16x16x32_bf16 v[244:247], a[8:11], a[40:43], v[244:247]
ds_read_b64_tr_b16 a[30:31], v13 offset:57856
v_mfma_f32_16x16x32_bf16 v[248:251], a[8:11], a[48:51], 0
v_mfma_f32_16x16x32_bf16 v[248:251], a[12:15], a[52:55], v[248:251]
v_mfma_f32_16x16x32_bf16 v[252:255], a[12:15], a[60:63], 0
v_mfma_f32_16x16x32_bf16 v[252:255], a[8:11], a[56:59], v[252:255]
L_pg7:
s_cbranch_execz L_vret
s_waitcnt vmcnt(24) lgkmcnt(4)
v_mfma_f32_16x16x32_bf16 v[32:35], a[16:19], a[64:67], v[32:35]
ds_read_b64_tr_b16 a[0:1], v13 offset:32800
v_mfma_f32_16x16x32_bf16 v[32:35], a[20:23], a[68:71], v[32:35]
ds_read_b64_tr_b16 a[2:3], v13 offset:36384
v_mfma_f32_16x16x32_bf16 v[36:39], a[20:23], a[76:79], v[36:39]
ds_read_b64_tr_b16 a[4:5], v13 offset:39968
v_mfma_f32_16x16x32_bf16 v[36:39], a[16:19], a[72:75], v[36:39]
ds_read_b64_tr_b16 a[6:7], v13 offset:43552
v_mfma_f32_16x16x32_bf16 v[40:43], a[16:19], a[80:83], v[40:43]
s_add_u32 s21, s21, s51
s_xor_b32 s51, s51, 8192
v_mfma_f32_16x16x32_bf16 v[40:43], a[20:23], a[84:87], v[40:43]
buffer_load_dwordx4 a[32:35], v9, s[8:11], s21 offen offset:0 sc1
v_mfma_f32_16x16x32_bf16 v[44:47], a[20:23], a[92:95], v[44:47]
v_mfma_f32_16x16x32_bf16 v[44:47], a[16:19], a[88:91], v[44:47]
s_waitcnt lgkmcnt(4)
v_mfma_f32_16x16x32_bf16 v[48:51], a[24:27], a[64:67], v[48:51]
ds_read_b64_tr_b16 a[8:9], v13 offset:47136
buffer_load_dwordx4 a[36:39], v9, s[8:11], s21 offen offset:1024 sc1
v_mfma_f32_16x16x32_bf16 v[48:51], a[28:31], a[68:71], v[48:51]
ds_read_b64_tr_b16 a[10:11], v13 offset:50720
v_mfma_f32_16x16x32_bf16 v[52:55], a[28:31], a[76:79], v[52:55]
ds_read_b64_tr_b16 a[12:13], v13 offset:54304
v_mfma_f32_16x16x32_bf16 v[52:55], a[24:27], a[72:75], v[52:55]
ds_read_b64_tr_b16 a[14:15], v13 offset:57888
v_mfma_f32_16x16x32_bf16 v[56:59], a[24:27], a[80:83], v[56:59]
buffer_load_dwordx4 a[40:43], v10, s[8:11], s21 offen offset:0 sc1
v_mfma_f32_16x16x32_bf16 v[56:59], a[28:31], a[84:87], v[56:59]
v_mfma_f32_16x16x32_bf16 v[60:63], a[28:31], a[92:95], v[60:63]
v_mfma_f32_16x16x32_bf16 v[60:63], a[24:27], a[88:91], v[60:63]
s_waitcnt lgkmcnt(4)
v_mfma_f32_16x16x32_bf16 v[64:67], a[0:3], a[64:67], v[64:67]
ds_read_b64_tr_b16 a[16:17], v13 offset:32832
buffer_load_dwordx4 a[44:47], v10, s[8:11], s21 offen offset:1024 sc1
v_mfma_f32_16x16x32_bf16 v[64:67], a[4:7], a[68:71], v[64:67]
ds_read_b64_tr_b16 a[18:19], v13 offset:36416
v_mfma_f32_16x16x32_bf16 v[68:71], a[4:7], a[76:79], v[68:71]
ds_read_b64_tr_b16 a[20:21], v13 offset:40000
v_mfma_f32_16x16x32_bf16 v[68:71], a[0:3], a[72:75], v[68:71]
ds_read_b64_tr_b16 a[22:23], v13 offset:43584
v_mfma_f32_16x16x32_bf16 v[72:75], a[0:3], a[80:83], v[72:75]
buffer_load_dwordx4 a[48:51], v11, s[8:11], s21 offen offset:0 sc1
v_mfma_f32_16x16x32_bf16 v[72:75], a[4:7], a[84:87], v[72:75]
v_mfma_f32_16x16x32_bf16 v[76:79], a[4:7], a[92:95], v[76:79]
v_mfma_f32_16x16x32_bf16 v[76:79], a[0:3], a[88:91], v[76:79]
s_waitcnt lgkmcnt(4)
v_mfma_f32_16x16x32_bf16 v[80:83], a[8:11], a[64:67], v[80:83]
ds_read_b64_tr_b16 a[24:25], v13 offset:47168
buffer_load_dwordx4 a[52:55], v11, s[8:11], s21 offen offset:1024 sc1
v_mfma_f32_16x16x32_bf16 v[80:83], a[12:15], a[68:71], v[80:83]
ds_read_b64_tr_b16 a[26:27], v13 offset:50752
v_mfma_f32_16x16x32_bf16 v[84:87], a[12:15], a[76:79], v[84:87]
ds_read_b64_tr_b16 a[28:29], v13 offset:54336
v_mfma_f32_16x16x32_bf16 v[84:87], a[8:11], a[72:75], v[84:87]
ds_read_b64_tr_b16 a[30:31], v13 offset:57920
v_mfma_f32_16x16x32_bf16 v[88:91], a[8:11], a[80:83], v[88:91]
buffer_load_dwordx4 a[56:59], v12, s[8:11], s21 offen offset:0 sc1
v_mfma_f32_16x16x32_bf16 v[88:91], a[12:15], a[84:87], v[88:91]
v_mfma_f32_16x16x32_bf16 v[92:95], a[12:15], a[92:95], v[92:95]
v_mfma_f32_16x16x32_bf16 v[92:95], a[8:11], a[88:91], v[92:95]
s_waitcnt lgkmcnt(4)
v_mfma_f32_16x16x32_bf16 v[96:99], a[16:19], a[64:67], v[96:99]
ds_read_b64_tr_b16 a[0:1], v13 offset:32864
buffer_load_dwordx4 a[60:63], v12, s[8:11], s21 offen offset:1024 sc1
v_mfma_f32_16x16x32_bf16 v[96:99], a[20:23], a[68:71], v[96:99]
ds_read_b64_tr_b16 a[2:3], v13 offset:36448
v_mfma_f32_16x16x32_bf16 v[100:103], a[20:23], a[76:79], v[100:103]
ds_read_b64_tr_b16 a[4:5], v13 offset:40032
v_mfma_f32_16x16x32_bf16 v[100:103], a[16:19], a[72:75], v[100:103]
ds_read_b64_tr_b16 a[6:7], v13 offset:43616
v_mfma_f32_16x16x32_bf16 v[104:107], a[16:19], a[80:83], v[104:107]
s_add_u32 s22, s22, 458752
v_mfma_f32_16x16x32_bf16 v[104:107], a[20:23], a[84:87], v[104:107]
s_add_u32 m0, s23, 32768
v_mfma_f32_16x16x32_bf16 v[108:111], a[20:23], a[92:95], v[108:111]
buffer_load_dwordx4 v2, s[4:7], s22 offen offset:0 lds
v_mfma_f32_16x16x32_bf16 v[108:111], a[16:19], a[88:91], v[108:111]
s_waitcnt lgkmcnt(4)
v_mfma_f32_16x16x32_bf16 v[112:115], a[24:27], a[64:67], v[112:115]
ds_read_b64_tr_b16 a[8:9], v13 offset:47200
v_mfma_f32_16x16x32_bf16 v[112:115], a[28:31], a[68:71], v[112:115]
ds_read_b64_tr_b16 a[10:11], v13 offset:50784
v_mfma_f32_16x16x32_bf16 v[116:119], a[28:31], a[76:79], v[116:119]
ds_read_b64_tr_b16 a[12:13], v13 offset:54368
v_mfma_f32_16x16x32_bf16 v[116:119], a[24:27], a[72:75], v[116:119]
ds_read_b64_tr_b16 a[14:15], v13 offset:57952
v_mfma_f32_16x16x32_bf16 v[120:123], a[24:27], a[80:83], v[120:123]
buffer_load_dwordx4 v3, s[4:7], s22 offen offset:1024 lds
v_mfma_f32_16x16x32_bf16 v[120:123], a[28:31], a[84:87], v[120:123]
v_mfma_f32_16x16x32_bf16 v[124:127], a[28:31], a[92:95], v[124:127]
v_mfma_f32_16x16x32_bf16 v[124:127], a[24:27], a[88:91], v[124:127]
s_waitcnt lgkmcnt(4)
v_mfma_f32_16x16x32_bf16 v[128:131], a[0:3], a[64:67], v[128:131]
ds_read_b64_tr_b16 a[16:17], v13 offset:32896
v_mfma_f32_16x16x32_bf16 v[128:131], a[4:7], a[68:71], v[128:131]
ds_read_b64_tr_b16 a[18:19], v13 offset:36480
v_mfma_f32_16x16x32_bf16 v[132:135], a[4:7], a[76:79], v[132:135]
ds_read_b64_tr_b16 a[20:21], v13 offset:40064
v_mfma_f32_16x16x32_bf16 v[132:135], a[0:3], a[72:75], v[132:135]
ds_read_b64_tr_b16 a[22:23], v13 offset:43648
v_mfma_f32_16x16x32_bf16 v[136:139], a[0:3], a[80:83], v[136:139]
buffer_load_dwordx4 v4, s[4:7], s22 offen offset:2048 lds
v_mfma_f32_16x16x32_bf16 v[136:139], a[4:7], a[84:87], v[136:139]
v_mfma_f32_16x16x32_bf16 v[140:143], a[4:7], a[92:95], v[140:143]
v_mfma_f32_16x16x32_bf16 v[140:143], a[0:3], a[88:91], v[140:143]
s_waitcnt lgkmcnt(4)
v_mfma_f32_16x16x32_bf16 v[144:147], a[8:11], a[64:67], v[144:147]
ds_read_b64_tr_b16 a[24:25], v13 offset:47232
v_mfma_f32_16x16x32_bf16 v[144:147], a[12:15], a[68:71], v[144:147]
ds_read_b64_tr_b16 a[26:27], v13 offset:50816
v_mfma_f32_16x16x32_bf16 v[148:151], a[12:15], a[76:79], v[148:151]
ds_read_b64_tr_b16 a[28:29], v13 offset:54400
v_mfma_f32_16x16x32_bf16 v[148:151], a[8:11], a[72:75], v[148:151]
ds_read_b64_tr_b16 a[30:31], v13 offset:57984
v_mfma_f32_16x16x32_bf16 v[152:155], a[8:11], a[80:83], v[152:155]
buffer_load_dwordx4 v5, s[4:7], s22 offen offset:3072 lds
v_mfma_f32_16x16x32_bf16 v[152:155], a[12:15], a[84:87], v[152:155]
v_mfma_f32_16x16x32_bf16 v[156:159], a[12:15], a[92:95], v[156:159]
v_mfma_f32_16x16x32_bf16 v[156:159], a[8:11], a[88:91], v[156:159]
s_waitcnt lgkmcnt(4)
v_mfma_f32_16x16x32_bf16 v[160:163], a[16:19], a[64:67], v[160:163]
ds_read_b64_tr_b16 a[0:1], v13 offset:32928
v_mfma_f32_16x16x32_bf16 v[160:163], a[20:23], a[68:71], v[160:163]
ds_read_b64_tr_b16 a[2:3], v13 offset:36512
v_mfma_f32_16x16x32_bf16 v[164:167], a[20:23], a[76:79], v[164:167]
ds_read_b64_tr_b16 a[4:5], v13 offset:40096
v_mfma_f32_16x16x32_bf16 v[164:167], a[16:19], a[72:75], v[164:167]
ds_read_b64_tr_b16 a[6:7], v13 offset:43680
v_mfma_f32_16x16x32_bf16 v[168:171], a[16:19], a[80:83], v[168:171]
s_add_u32 m0, s23, 36864
v_mfma_f32_16x16x32_bf16 v[168:171], a[20:23], a[84:87], v[168:171]
buffer_load_dwordx4 v6, s[4:7], s22 offen offset:0 lds
v_mfma_f32_16x16x32_bf16 v[172:175], a[20:23], a[92:95], v[172:175]
v_mfma_f32_16x16x32_bf16 v[172:175], a[16:19], a[88:91], v[172:175]
s_waitcnt lgkmcnt(4)
v_mfma_f32_16x16x32_bf16 v[176:179], a[24:27], a[64:67], v[176:179]
ds_read_b64_tr_b16 a[8:9], v13 offset:47264
v_mfma_f32_16x16x32_bf16 v[176:179], a[28:31], a[68:71], v[176:179]
ds_read_b64_tr_b16 a[10:11], v13 offset:50848
v_mfma_f32_16x16x32_bf16 v[180:183], a[28:31], a[76:79], v[180:183]
ds_read_b64_tr_b16 a[12:13], v13 offset:54432
v_mfma_f32_16x16x32_bf16 v[180:183], a[24:27], a[72:75], v[180:183]
ds_read_b64_tr_b16 a[14:15], v13 offset:58016
v_mfma_f32_16x16x32_bf16 v[184:187], a[24:27], a[80:83], v[184:187]
buffer_load_dwordx4 v7, s[4:7], s22 offen offset:1024 lds
v_mfma_f32_16x16x32_bf16 v[184:187], a[28:31], a[84:87], v[184:187]
v_mfma_f32_16x16x32_bf16 v[188:191], a[28:31], a[92:95], v[188:191]
v_mfma_f32_16x16x32_bf16 v[188:191], a[24:27], a[88:91], v[188:191]
s_waitcnt lgkmcnt(4)
v_mfma_f32_16x16x32_bf16 v[192:195], a[0:3], a[64:67], v[192:195]
ds_read_b64_tr_b16 a[16:17], v13 offset:32960
v_mfma_f32_16x16x32_bf16 v[192:195], a[4:7], a[68:71], v[192:195]
ds_read_b64_tr_b16 a[18:19], v13 offset:36544
v_mfma_f32_16x16x32_bf16 v[196:199], a[4:7], a[76:79], v[196:199]
ds_read_b64_tr_b16 a[20:21], v13 offset:40128
v_mfma_f32_16x16x32_bf16 v[196:199], a[0:3], a[72:75], v[196:199]
ds_read_b64_tr_b16 a[22:23], v13 offset:43712
v_mfma_f32_16x16x32_bf16 v[200:203], a[0:3], a[80:83], v[200:203]
buffer_load_dwordx4 v8, s[4:7], s22 offen offset:2048 lds
v_mfma_f32_16x16x32_bf16 v[200:203], a[4:7], a[84:87], v[200:203]
v_mfma_f32_16x16x32_bf16 v[204:207], a[4:7], a[92:95], v[204:207]
s_add_u32 s37, s37, 32768
v_mfma_f32_16x16x32_bf16 v[204:207], a[0:3], a[88:91], v[204:207]
s_max_i32 s39, s37, s49
s_waitcnt lgkmcnt(4)
v_mfma_f32_16x16x32_bf16 v[208:211], a[8:11], a[64:67], v[208:211]
ds_read_b64_tr_b16 a[24:25], v13 offset:47296
s_min_u32 s39, s39, s50
v_mfma_f32_16x16x32_bf16 v[208:211], a[12:15], a[68:71], v[208:211]
ds_read_b64_tr_b16 a[26:27], v13 offset:50880
v_mfma_f32_16x16x32_bf16 v[212:215], a[12:15], a[76:79], v[212:215]
ds_read_b64_tr_b16 a[28:29], v13 offset:54464
buffer_load_dword a250, v1, s[4:7], s36 offen
v_mfma_f32_16x16x32_bf16 v[212:215], a[8:11], a[72:75], v[212:215]
ds_read_b64_tr_b16 a[30:31], v13 offset:58048
buffer_load_dword a251, v15, s[40:43], s39 offen
v_mfma_f32_16x16x32_bf16 v[216:219], a[8:11], a[80:83], v[216:219]
s_add_u32 s36, s36, 458752
v_mfma_f32_16x16x32_bf16 v[216:219], a[12:15], a[84:87], v[216:219]
s_min_u32 s36, s36, s48
v_mfma_f32_16x16x32_bf16 v[220:223], a[12:15], a[92:95], v[220:223]
v_mfma_f32_16x16x32_bf16 v[220:223], a[8:11], a[88:91], v[220:223]
s_waitcnt vmcnt(22)
s_barrier
v_xor_b32 v13, 0x10000, v13
s_waitcnt lgkmcnt(4)
v_mfma_f32_16x16x32_bf16 v[224:227], a[16:19], a[64:67], v[224:227]
ds_read_b64_tr_b16 a[0:1], v13 offset:0
v_mfma_f32_16x16x32_bf16 v[224:227], a[20:23], a[68:71], v[224:227]
ds_read_b64_tr_b16 a[2:3], v13 offset:3584
v_mfma_f32_16x16x32_bf16 v[228:231], a[20:23], a[76:79], v[228:231]
ds_read_b64_tr_b16 a[4:5], v13 offset:7168
v_mfma_f32_16x16x32_bf16 v[228:231], a[16:19], a[72:75], v[228:231]
ds_read_b64_tr_b16 a[6:7], v13 offset:10752
v_mfma_f32_16x16x32_bf16 v[232:235], a[16:19], a[80:83], v[232:235]
v_mfma_f32_16x16x32_bf16 v[232:235], a[20:23], a[84:87], v[232:235]
v_mfma_f32_16x16x32_bf16 v[236:239], a[20:23], a[92:95], v[236:239]
v_mfma_f32_16x16x32_bf16 v[236:239], a[16:19], a[88:91], v[236:239]
s_waitcnt lgkmcnt(4)
v_mfma_f32_16x16x32_bf16 v[240:243], a[24:27], a[64:67], v[240:243]
ds_read_b64_tr_b16 a[8:9], v13 offset:14336
v_mfma_f32_16x16x32_bf16 v[240:243], a[28:31], a[68:71], v[240:243]
ds_read_b64_tr_b16 a[10:11], v13 offset:17920
v_mfma_f32_16x16x32_bf16 v[244:247], a[28:31], a[76:79], v[244:247]
ds_read_b64_tr_b16 a[12:13], v13 offset:21504
v_mfma_f32_16x16x32_bf16 v[244:247], a[24:27], a[72:75], v[244:247]
ds_read_b64_tr_b16 a[14:15], v13 offset:25088
v_mfma_f32_16x16x32_bf16 v[248:251], a[24:27], a[80:83], v[248:251]
v_mfma_f32_16x16x32_bf16 v[248:251], a[28:31], a[84:87], v[248:251]
v_mfma_f32_16x16x32_bf16 v[252:255], a[28:31], a[92:95], v[252:255]
v_mfma_f32_16x16x32_bf16 v[252:255], a[24:27], a[88:91], v[252:255]
s_mov_b32 s24, 5
L_loop3:
s_waitcnt vmcnt(9) lgkmcnt(4)
v_mfma_f32_16x16x32_bf16 v[32:35], a[0:3], a[32:35], v[32:35]
ds_read_b64_tr_b16 a[16:17], v13 offset:32
v_mfma_f32_16x16x32_bf16 v[32:35], a[4:7], a[36:39], v[32:35]
ds_read_b64_tr_b16 a[18:19], v13 offset:3616
v_mfma_f32_16x16x32_bf16 v[36:39], a[4:7], a[44:47], v[36:39]
ds_read_b64_tr_b16 a[20:21], v13 offset:7200
v_mfma_f32_16x16x32_bf16 v[36:39], a[0:3], a[40:43], v[36:39]
ds_read_b64_tr_b16 a[22:23], v13 offset:10784
v_mfma_f32_16x16x32_bf16 v[40:43], a[0:3], a[48:51], v[40:43]
buffer_load_dwordx4 a[64:67], v9, s[8:11], s21 offen offset:2048 sc1
v_mfma_f32_16x16x32_bf16 v[40:43], a[4:7], a[52:55], v[40:43]
v_mfma_f32_16x16x32_bf16 v[44:47], a[4:7], a[60:63], v[44:47]
v_mfma_f32_16x16x32_bf16 v[44:47], a[0:3], a[56:59], v[44:47]
s_waitcnt lgkmcnt(4)
v_mfma_f32_16x16x32_bf16 v[48:51], a[8:11], a[32:35], v[48:51]
ds_read_b64_tr_b16 a[24:25], v13 offset:14368
buffer_load_dwordx4 a[68:71], v9, s[8:11], s21 offen offset:3072 sc1
v_mfma_f32_16x16x32_bf16 v[48:51], a[12:15], a[36:39], v[48:51]
ds_read_b64_tr_b16 a[26:27], v13 offset:17952
v_mfma_f32_16x16x32_bf16 v[52:55], a[12:15], a[44:47], v[52:55]
ds_read_b64_tr_b16 a[28:29], v13 offset:21536
v_mfma_f32_16x16x32_bf16 v[52:55], a[8:11], a[40:43], v[52:55]
ds_read_b64_tr_b16 a[30:31], v13 offset:25120
v_mfma_f32_16x16x32_bf16 v[56:59], a[8:11], a[48:51], v[56:59]
buffer_load_dwordx4 a[72:75], v10, s[8:11], s21 offen offset:2048 sc1
v_mfma_f32_16x16x32_bf16 v[56:59], a[12:15], a[52:55], v[56:59]
v_mfma_f32_16x16x32_bf16 v[60:63], a[12:15], a[60:63], v[60:63]
v_mfma_f32_16x16x32_bf16 v[60:63], a[8:11], a[56:59], v[60:63]
s_waitcnt lgkmcnt(4)
v_mfma_f32_16x16x32_bf16 v[64:67], a[16:19], a[32:35], v[64:67]
ds_read_b64_tr_b16 a[0:1], v13 offset:64
buffer_load_dwordx4 a[76:79], v10, s[8:11], s21 offen offset:3072 sc1
v_mfma_f32_16x16x32_bf16 v[64:67], a[20:23], a[36:39], v[64:67]
ds_read_b64_tr_b16 a[2:3], v13 offset:3648
v_mfma_f32_16x16x32_bf16 v[68:71], a[20:23], a[44:47], v[68:71]
ds_read_b64_tr_b16 a[4:5], v13 offset:7232
v_mfma_f32_16x16x32_bf16 v[68:71], a[16:19], a[40:43], v[68:71]
ds_read_b64_tr_b16 a[6:7], v13 offset:10816
v_mfma_f32_16x16x32_bf16 v[72:75], a[16:19], a[48:51], v[72:75]
buffer_load_dwordx4 a[80:83], v11, s[8:11], s21 offen offset:2048 sc1
v_mfma_f32_16x16x32_bf16 v[72:75], a[20:23], a[52:55], v[72:75]
v_mfma_f32_16x16x32_bf16 v[76:79], a[20:23], a[60:63], v[76:79]
v_mfma_f32_16x16x32_bf16 v[76:79], a[16:19], a[56:59], v[76:79]
s_waitcnt lgkmcnt(4)
v_mfma_f32_16x16x32_bf16 v[80:83], a[24:27], a[32:35], v[80:83]
ds_read_b64_tr_b16 a[8:9], v13 offset:14400
buffer_load_dwordx4 a[84:87], v11, s[8:11], s21 offen offset:3072 sc1
v_mfma_f32_16x16x32_bf16 v[80:83], a[28:31], a[36:39], v[80:83]
ds_read_b64_tr_b16 a[10:11], v13 offset:17984
v_mfma_f32_16x16x32_bf16 v[84:87], a[28:31], a[44:47], v[84:87]
ds_read_b64_tr_b16 a[12:13], v13 offset:21568
v_mfma_f32_16x16x32_bf16 v[84:87], a[24:27], a[40:43], v[84:87]
ds_read_b64_tr_b16 a[14:15], v13 offset:25152
v_mfma_f32_16x16x32_bf16 v[88:91], a[24:27], a[48:51], v[88:91]
buffer_load_dwordx4 a[88:91], v12, s[8:11], s21 offen offset:2048 sc1
v_mfma_f32_16x16x32_bf16 v[88:91], a[28:31], a[52:55], v[88:91]
v_mfma_f32_16x16x32_bf16 v[92:95], a[28:31], a[60:63], v[92:95]
v_mfma_f32_16x16x32_bf16 v[92:95], a[24:27], a[56:59], v[92:95]
s_waitcnt lgkmcnt(4)
v_mfma_f32_16x16x32_bf16 v[96:99], a[0:3], a[32:35], v[96:99]
ds_read_b64_tr_b16 a[16:17], v13 offset:96
buffer_load_dwordx4 a[92:95], v12, s[8:11], s21 offen offset:3072 sc1
v_mfma_f32_16x16x32_bf16 v[96:99], a[4:7], a[36:39], v[96:99]
ds_read_b64_tr_b16 a[18:19], v13 offset:3680
v_mfma_f32_16x16x32_bf16 v[100:103], a[4:7], a[44:47], v[100:103]
ds_read_b64_tr_b16 a[20:21], v13 offset:7264
v_mfma_f32_16x16x32_bf16 v[100:103], a[0:3], a[40:43], v[100:103]
ds_read_b64_tr_b16 a[22:23], v13 offset:10848
v_mfma_f32_16x16x32_bf16 v[104:107], a[0:3], a[48:51], v[104:107]
s_xor_b32 s23, s23, 0x10000
v_mfma_f32_16x16x32_bf16 v[104:107], a[4:7], a[52:55], v[104:107]
s_add_u32 s22, s22, 458752
v_mfma_f32_16x16x32_bf16 v[108:111], a[4:7], a[60:63], v[108:111]
s_add_u32 m0, s23, 0
v_mfma_f32_16x16x32_bf16 v[108:111], a[0:3], a[56:59], v[108:111]
buffer_load_dwordx4 v2, s[4:7], s22 offen offset:0 lds
s_waitcnt lgkmcnt(4)
v_mfma_f32_16x16x32_bf16 v[112:115], a[8:11], a[32:35], v[112:115]
ds_read_b64_tr_b16 a[24:25], v13 offset:14432
v_mfma_f32_16x16x32_bf16 v[112:115], a[12:15], a[36:39], v[112:115]
ds_read_b64_tr_b16 a[26:27], v13 offset:18016
v_mfma_f32_16x16x32_bf16 v[116:119], a[12:15], a[44:47], v[116:119]
ds_read_b64_tr_b16 a[28:29], v13 offset:21600
v_mfma_f32_16x16x32_bf16 v[116:119], a[8:11], a[40:43], v[116:119]
ds_read_b64_tr_b16 a[30:31], v13 offset:25184
v_mfma_f32_16x16x32_bf16 v[120:123], a[8:11], a[48:51], v[120:123]
buffer_load_dwordx4 v3, s[4:7], s22 offen offset:1024 lds
v_mfma_f32_16x16x32_bf16 v[120:123], a[12:15], a[52:55], v[120:123]
v_mfma_f32_16x16x32_bf16 v[124:127], a[12:15], a[60:63], v[124:127]
v_mfma_f32_16x16x32_bf16 v[124:127], a[8:11], a[56:59], v[124:127]
s_waitcnt lgkmcnt(4)
v_mfma_f32_16x16x32_bf16 v[128:131], a[16:19], a[32:35], v[128:131]
ds_read_b64_tr_b16 a[0:1], v13 offset:128
v_mfma_f32_16x16x32_bf16 v[128:131], a[20:23], a[36:39], v[128:131]
ds_read_b64_tr_b16 a[2:3], v13 offset:3712
v_mfma_f32_16x16x32_bf16 v[132:135], a[20:23], a[44:47], v[132:135]
ds_read_b64_tr_b16 a[4:5], v13 offset:7296
v_mfma_f32_16x16x32_bf16 v[132:135], a[16:19], a[40:43], v[132:135]
ds_read_b64_tr_b16 a[6:7], v13 offset:10880
v_mfma_f32_16x16x32_bf16 v[136:139], a[16:19], a[48:51], v[136:139]
buffer_load_dwordx4 v4, s[4:7], s22 offen offset:2048 lds
v_mfma_f32_16x16x32_bf16 v[136:139], a[20:23], a[52:55], v[136:139]
v_mfma_f32_16x16x32_bf16 v[140:143], a[20:23], a[60:63], v[140:143]
v_mfma_f32_16x16x32_bf16 v[140:143], a[16:19], a[56:59], v[140:143]
s_waitcnt lgkmcnt(4)
v_mfma_f32_16x16x32_bf16 v[144:147], a[24:27], a[32:35], v[144:147]
ds_read_b64_tr_b16 a[8:9], v13 offset:14464
v_mfma_f32_16x16x32_bf16 v[144:147], a[28:31], a[36:39], v[144:147]
ds_read_b64_tr_b16 a[10:11], v13 offset:18048
v_mfma_f32_16x16x32_bf16 v[148:151], a[28:31], a[44:47], v[148:151]
ds_read_b64_tr_b16 a[12:13], v13 offset:21632
v_mfma_f32_16x16x32_bf16 v[148:151], a[24:27], a[40:43], v[148:151]
ds_read_b64_tr_b16 a[14:15], v13 offset:25216
v_mfma_f32_16x16x32_bf16 v[152:155], a[24:27], a[48:51], v[152:155]
buffer_load_dwordx4 v5, s[4:7], s22 offen offset:3072 lds
v_mfma_f32_16x16x32_bf16 v[152:155], a[28:31], a[52:55], v[152:155]
v_mfma_f32_16x16x32_bf16 v[156:159], a[28:31], a[60:63], v[156:159]
v_mfma_f32_16x16x32_bf16 v[156:159], a[24:27], a[56:59], v[156:159]
s_waitcnt lgkmcnt(4)
v_mfma_f32_16x16x32_bf16 v[160:163], a[0:3], a[32:35], v[160:163]
ds_read_b64_tr_b16 a[16:17], v13 offset:160
v_mfma_f32_16x16x32_bf16 v[160:163], a[4:7], a[36:39], v[160:163]
ds_read_b64_tr_b16 a[18:19], v13 offset:3744
v_mfma_f32_16x16x32_bf16 v[164:167], a[4:7], a[44:47], v[164:167]
ds_read_b64_tr_b16 a[20:21], v13 offset:7328
v_mfma_f32_16x16x32_bf16 v[164:167], a[0:3], a[40:43], v[164:167]
ds_read_b64_tr_b16 a[22:23], v13 offset:10912
v_mfma_f32_16x16x32_bf16 v[168:171], a[0:3], a[48:51], v[168:171]
s_add_u32 m0, s23, 4096
v_mfma_f32_16x16x32_bf16 v[168:171], a[4:7], a[52:55], v[168:171]
buffer_load_dwordx4 v6, s[4:7], s22 offen offset:0 lds
v_mfma_f32_16x16x32_bf16 v[172:175], a[4:7], a[60:63], v[172:175]
v_mfma_f32_16x16x32_bf16 v[172:175], a[0:3], a[56:59], v[172:175]
s_waitcnt lgkmcnt(4)
v_mfma_f32_16x16x32_bf16 v[176:179], a[8:11], a[32:35], v[176:179]
ds_read_b64_tr_b16 a[24:25], v13 offset:14496
v_mfma_f32_16x16x32_bf16 v[176:179], a[12:15], a[36:39], v[176:179]
ds_read_b64_tr_b16 a[26:27], v13 offset:18080
v_mfma_f32_16x16x32_bf16 v[180:183], a[12:15], a[44:47], v[180:183]
ds_read_b64_tr_b16 a[28:29], v13 offset:21664
v_mfma_f32_16x16x32_bf16 v[180:183], a[8:11], a[40:43], v[180:183]
ds_read_b64_tr_b16 a[30:31], v13 offset:25248
v_mfma_f32_16x16x32_bf16 v[184:187], a[8:11], a[48:51], v[184:187]
buffer_load_dwordx4 v7, s[4:7], s22 offen offset:1024 lds
v_mfma_f32_16x16x32_bf16 v[184:187], a[12:15], a[52:55], v[184:187]
v_mfma_f32_16x16x32_bf16 v[188:191], a[12:15], a[60:63], v[188:191]
v_mfma_f32_16x16x32_bf16 v[188:191], a[8:11], a[56:59], v[188:191]
s_waitcnt lgkmcnt(4)
v_mfma_f32_16x16x32_bf16 v[192:195], a[16:19], a[32:35], v[192:195]
ds_read_b64_tr_b16 a[0:1], v13 offset:192
v_mfma_f32_16x16x32_bf16 v[192:195], a[20:23], a[36:39], v[192:195]
ds_read_b64_tr_b16 a[2:3], v13 offset:3776
v_mfma_f32_16x16x32_bf16 v[196:199], a[20:23], a[44:47], v[196:199]
ds_read_b64_tr_b16 a[4:5], v13 offset:7360
v_mfma_f32_16x16x32_bf16 v[196:199], a[16:19], a[40:43], v[196:199]
ds_read_b64_tr_b16 a[6:7], v13 offset:10944
v_mfma_f32_16x16x32_bf16 v[200:203], a[16:19], a[48:51], v[200:203]
buffer_load_dwordx4 v8, s[4:7], s22 offen offset:2048 lds
v_mfma_f32_16x16x32_bf16 v[200:203], a[20:23], a[52:55], v[200:203]
v_mfma_f32_16x16x32_bf16 v[204:207], a[20:23], a[60:63], v[204:207]
s_add_u32 s37, s37, 32768
v_mfma_f32_16x16x32_bf16 v[204:207], a[16:19], a[56:59], v[204:207]
s_max_i32 s39, s37, s49
s_waitcnt lgkmcnt(4)
v_mfma_f32_16x16x32_bf16 v[208:211], a[24:27], a[32:35], v[208:211]
ds_read_b64_tr_b16 a[8:9], v13 offset:14528
s_min_u32 s39, s39, s50
v_mfma_f32_16x16x32_bf16 v[208:211], a[28:31], a[36:39], v[208:211]
ds_read_b64_tr_b16 a[10:11], v13 offset:18112
v_mfma_f32_16x16x32_bf16 v[212:215], a[28:31], a[44:47], v[212:215]
ds_read_b64_tr_b16 a[12:13], v13 offset:21696
buffer_load_dword a250, v1, s[4:7], s36 offen
v_mfma_f32_16x16x32_bf16 v[212:215], a[24:27], a[40:43], v[212:215]
ds_read_b64_tr_b16 a[14:15], v13 offset:25280
buffer_load_dword a251, v15, s[40:43], s39 offen
v_mfma_f32_16x16x32_bf16 v[216:219], a[24:27], a[48:51], v[216:219]
s_add_u32 s36, s36, 458752
v_mfma_f32_16x16x32_bf16 v[216:219], a[28:31], a[52:55], v[216:219]
s_min_u32 s36, s36, s48
v_mfma_f32_16x16x32_bf16 v[220:223], a[28:31], a[60:63], v[220:223]
v_mfma_f32_16x16x32_bf16 v[220:223], a[24:27], a[56:59], v[220:223]
s_waitcnt vmcnt(19)
s_barrier
s_waitcnt lgkmcnt(4)
v_mfma_f32_16x16x32_bf16 v[224:227], a[0:3], a[32:35], v[224:227]
ds_read_b64_tr_b16 a[16:17], v13 offset:32768
v_mfma_f32_16x16x32_bf16 v[224:227], a[4:7], a[36:39], v[224:227]
ds_read_b64_tr_b16 a[18:19], v13 offset:36352
v_mfma_f32_16x16x32_bf16 v[228:231], a[4:7], a[44:47], v[228:231]
ds_read_b64_tr_b16 a[20:21], v13 offset:39936
v_mfma_f32_16x16x32_bf16 v[228:231], a[0:3], a[40:43], v[228:231]
ds_read_b64_tr_b16 a[22:23], v13 offset:43520
v_mfma_f32_16x16x32_bf16 v[232:235], a[0:3], a[48:51], v[232:235]
v_mfma_f32_16x16x32_bf16 v[232:235], a[4:7], a[52:55], v[232:235]
v_mfma_f32_16x16x32_bf16 v[236:239], a[4:7], a[60:63], v[236:239]
v_mfma_f32_16x16x32_bf16 v[236:239], a[0:3], a[56:59], v[236:239]
s_waitcnt lgkmcnt(4)
v_mfma_f32_16x16x32_bf16 v[240:243], a[8:11], a[32:35], v[240:243]
ds_read_b64_tr_b16 a[24:25], v13 offset:47104
v_mfma_f32_16x16x32_bf16 v[240:243], a[12:15], a[36:39], v[240:243]
ds_read_b64_tr_b16 a[26:27], v13 offset:50688
v_mfma_f32_16x16x32_bf16 v[244:247], a[12:15], a[44:47], v[244:247]
ds_read_b64_tr_b16 a[28:29], v13 offset:54272
v_mfma_f32_16x16x32_bf16 v[244:247], a[8:11], a[40:43], v[244:247]
ds_read_b64_tr_b16 a[30:31], v13 offset:57856
v_mfma_f32_16x16x32_bf16 v[248:251], a[8:11], a[48:51], v[248:251]
v_mfma_f32_16x16x32_bf16 v[248:251], a[12:15], a[52:55], v[248:251]
v_mfma_f32_16x16x32_bf16 v[252:255], a[12:15], a[60:63], v[252:255]
v_mfma_f32_16x16x32_bf16 v[252:255], a[8:11], a[56:59], v[252:255]
s_waitcnt vmcnt(9) lgkmcnt(4)
v_mfma_f32_16x16x32_bf16 v[32:35], a[16:19], a[64:67], v[32:35]
ds_read_b64_tr_b16 a[0:1], v13 offset:32800
v_mfma_f32_16x16x32_bf16 v[32:35], a[20:23], a[68:71], v[32:35]
ds_read_b64_tr_b16 a[2:3], v13 offset:36384
v_mfma_f32_16x16x32_bf16 v[36:39], a[20:23], a[76:79], v[36:39]
ds_read_b64_tr_b16 a[4:5], v13 offset:39968
v_mfma_f32_16x16x32_bf16 v[36:39], a[16:19], a[72:75], v[36:39]
ds_read_b64_tr_b16 a[6:7], v13 offset:43552
v_mfma_f32_16x16x32_bf16 v[40:43], a[16:19], a[80:83], v[40:43]
s_add_u32 s21, s21, s51
s_xor_b32 s51, s51, 8192
v_mfma_f32_16x16x32_bf16 v[40:43], a[20:23], a[84:87], v[40:43]
buffer_load_dwordx4 a[32:35], v9, s[8:11], s21 offen offset:0 sc1
v_mfma_f32_16x16x32_bf16 v[44:47], a[20:23], a[92:95], v[44:47]
v_mfma_f32_16x16x32_bf16 v[44:47], a[16:19], a[88:91], v[44:47]
s_waitcnt lgkmcnt(4)
v_mfma_f32_16x16x32_bf16 v[48:51], a[24:27], a[64:67], v[48:51]
ds_read_b64_tr_b16 a[8:9], v13 offset:47136
buffer_load_dwordx4 a[36:39], v9, s[8:11], s21 offen offset:1024 sc1
v_mfma_f32_16x16x32_bf16 v[48:51], a[28:31], a[68:71], v[48:51]
ds_read_b64_tr_b16 a[10:11], v13 offset:50720
v_mfma_f32_16x16x32_bf16 v[52:55], a[28:31], a[76:79], v[52:55]
ds_read_b64_tr_b16 a[12:13], v13 offset:54304
v_mfma_f32_16x16x32_bf16 v[52:55], a[24:27], a[72:75], v[52:55]
ds_read_b64_tr_b16 a[14:15], v13 offset:57888
v_mfma_f32_16x16x32_bf16 v[56:59], a[24:27], a[80:83], v[56:59]
buffer_load_dwordx4 a[40:43], v10, s[8:11], s21 offen offset:0 sc1
v_mfma_f32_16x16x32_bf16 v[56:59], a[28:31], a[84:87], v[56:59]
v_mfma_f32_16x16x32_bf16 v[60:63], a[28:31], a[92:95], v[60:63]
v_mfma_f32_16x16x32_bf16 v[60:63], a[24:27], a[88:91], v[60:63]
s_waitcnt lgkmcnt(4)
v_mfma_f32_16x16x32_bf16 v[64:67], a[0:3], a[64:67], v[64:67]
ds_read_b64_tr_b16 a[16:17], v13 offset:32832
buffer_load_dwordx4 a[44:47], v10, s[8:11], s21 offen offset:1024 sc1
v_mfma_f32_16x16x32_bf16 v[64:67], a[4:7], a[68:71], v[64:67]
ds_read_b64_tr_b16 a[18:19], v13 offset:36416
v_mfma_f32_16x16x32_bf16 v[68:71], a[4:7], a[76:79], v[68:71]
ds_read_b64_tr_b16 a[20:21], v13 offset:40000
v_mfma_f32_16x16x32_bf16 v[68:71], a[0:3], a[72:75], v[68:71]
ds_read_b64_tr_b16 a[22:23], v13 offset:43584
v_mfma_f32_16x16x32_bf16 v[72:75], a[0:3], a[80:83], v[72:75]
buffer_load_dwordx4 a[48:51], v11, s[8:11], s21 offen offset:0 sc1
v_mfma_f32_16x16x32_bf16 v[72:75], a[4:7], a[84:87], v[72:75]
v_mfma_f32_16x16x32_bf16 v[76:79], a[4:7], a[92:95], v[76:79]
v_mfma_f32_16x16x32_bf16 v[76:79], a[0:3], a[88:91], v[76:79]
s_waitcnt lgkmcnt(4)
v_mfma_f32_16x16x32_bf16 v[80:83], a[8:11], a[64:67], v[80:83]
ds_read_b64_tr_b16 a[24:25], v13 offset:47168
buffer_load_dwordx4 a[52:55], v11, s[8:11], s21 offen offset:1024 sc1
v_mfma_f32_16x16x32_bf16 v[80:83], a[12:15], a[68:71], v[80:83]
ds_read_b64_tr_b16 a[26:27], v13 offset:50752
v_mfma_f32_16x16x32_bf16 v[84:87], a[12:15], a[76:79], v[84:87]
ds_read_b64_tr_b16 a[28:29], v13 offset:54336
v_mfma_f32_16x16x32_bf16 v[84:87], a[8:11], a[72:75], v[84:87]
ds_read_b64_tr_b16 a[30:31], v13 offset:57920
v_mfma_f32_16x16x32_bf16 v[88:91], a[8:11], a[80:83], v[88:91]
buffer_load_dwordx4 a[56:59], v12, s[8:11], s21 offen offset:0 sc1
v_mfma_f32_16x16x32_bf16 v[88:91], a[12:15], a[84:87], v[88:91]
v_mfma_f32_16x16x32_bf16 v[92:95], a[12:15], a[92:95], v[92:95]
v_mfma_f32_16x16x32_bf16 v[92:95], a[8:11], a[88:91], v[92:95]
s_waitcnt lgkmcnt(4)
v_mfma_f32_16x16x32_bf16 v[96:99], a[16:19], a[64:67], v[96:99]
ds_read_b64_tr_b16 a[0:1], v13 offset:32864
buffer_load_dwordx4 a[60:63], v12, s[8:11], s21 offen offset:1024 sc1
v_mfma_f32_16x16x32_bf16 v[96:99], a[20:23], a[68:71], v[96:99]
ds_read_b64_tr_b16 a[2:3], v13 offset:36448
v_mfma_f32_16x16x32_bf16 v[100:103], a[20:23], a[76:79], v[100:103]
ds_read_b64_tr_b16 a[4:5], v13 offset:40032
v_mfma_f32_16x16x32_bf16 v[100:103], a[16:19], a[72:75], v[100:103]
ds_read_b64_tr_b16 a[6:7], v13 offset:43616
v_mfma_f32_16x16x32_bf16 v[104:107], a[16:19], a[80:83], v[104:107]
s_add_u32 s22, s22, 458752
v_mfma_f32_16x16x32_bf16 v[104:107], a[20:23], a[84:87], v[104:107]
s_add_u32 m0, s23, 32768
v_mfma_f32_16x16x32_bf16 v[108:111], a[20:23], a[92:95], v[108:111]
buffer_load_dwordx4 v2, s[4:7], s22 offen offset:0 lds
v_mfma_f32_16x16x32_bf16 v[108:111], a[16:19], a[88:91], v[108:111]
s_waitcnt lgkmcnt(4)
v_mfma_f32_16x16x32_bf16 v[112:115], a[24:27], a[64:67], v[112:115]
ds_read_b64_tr_b16 a[8:9], v13 offset:47200
v_mfma_f32_16x16x32_bf16 v[112:115], a[28:31], a[68:71], v[112:115]
ds_read_b64_tr_b16 a[10:11], v13 offset:50784
v_mfma_f32_16x16x32_bf16 v[116:119], a[28:31], a[76:79], v[116:119]
ds_read_b64_tr_b16 a[12:13], v13 offset:54368
v_mfma_f32_16x16x32_bf16 v[116:119], a[24:27], a[72:75], v[116:119]
ds_read_b64_tr_b16 a[14:15], v13 offset:57952
v_mfma_f32_16x16x32_bf16 v[120:123], a[24:27], a[80:83], v[120:123]
buffer_load_dwordx4 v3, s[4:7], s22 offen offset:1024 lds
v_mfma_f32_16x16x32_bf16 v[120:123], a[28:31], a[84:87], v[120:123]
v_mfma_f32_16x16x32_bf16 v[124:127], a[28:31], a[92:95], v[124:127]
v_mfma_f32_16x16x32_bf16 v[124:127], a[24:27], a[88:91], v[124:127]
s_waitcnt lgkmcnt(4)
v_mfma_f32_16x16x32_bf16 v[128:131], a[0:3], a[64:67], v[128:131]
ds_read_b64_tr_b16 a[16:17], v13 offset:32896
v_mfma_f32_16x16x32_bf16 v[128:131], a[4:7], a[68:71], v[128:131]
ds_read_b64_tr_b16 a[18:19], v13 offset:36480
v_mfma_f32_16x16x32_bf16 v[132:135], a[4:7], a[76:79], v[132:135]
ds_read_b64_tr_b16 a[20:21], v13 offset:40064
v_mfma_f32_16x16x32_bf16 v[132:135], a[0:3], a[72:75], v[132:135]
ds_read_b64_tr_b16 a[22:23], v13 offset:43648
v_mfma_f32_16x16x32_bf16 v[136:139], a[0:3], a[80:83], v[136:139]
buffer_load_dwordx4 v4, s[4:7], s22 offen offset:2048 lds
v_mfma_f32_16x16x32_bf16 v[136:139], a[4:7], a[84:87], v[136:139]
v_mfma_f32_16x16x32_bf16 v[140:143], a[4:7], a[92:95], v[140:143]
v_mfma_f32_16x16x32_bf16 v[140:143], a[0:3], a[88:91], v[140:143]
s_waitcnt lgkmcnt(4)
v_mfma_f32_16x16x32_bf16 v[144:147], a[8:11], a[64:67], v[144:147]
ds_read_b64_tr_b16 a[24:25], v13 offset:47232
v_mfma_f32_16x16x32_bf16 v[144:147], a[12:15], a[68:71], v[144:147]
ds_read_b64_tr_b16 a[26:27], v13 offset:50816
v_mfma_f32_16x16x32_bf16 v[148:151], a[12:15], a[76:79], v[148:151]
ds_read_b64_tr_b16 a[28:29], v13 offset:54400
v_mfma_f32_16x16x32_bf16 v[148:151], a[8:11], a[72:75], v[148:151]
L_pg8:
s_cbranch_execz L_vret
ds_read_b64_tr_b16 a[30:31], v13 offset:57984
v_mfma_f32_16x16x32_bf16 v[152:155], a[8:11], a[80:83], v[152:155]
buffer_load_dwordx4 v5, s[4:7], s22 offen offset:3072 lds
v_mfma_f32_16x16x32_bf16 v[152:155], a[12:15], a[84:87], v[152:155]
v_mfma_f32_16x16x32_bf16 v[156:159], a[12:15], a[92:95], v[156:159]
v_mfma_f32_16x16x32_bf16 v[156:159], a[8:11], a[88:91], v[156:159]
s_waitcnt lgkmcnt(4)
v_mfma_f32_16x16x32_bf16 v[160:163], a[16:19], a[64:67], v[160:163]
ds_read_b64_tr_b16 a[0:1], v13 offset:32928
v_mfma_f32_16x16x32_bf16 v[160:163], a[20:23], a[68:71], v[160:163]
ds_read_b64_tr_b16 a[2:3], v13 offset:36512
v_mfma_f32_16x16x32_bf16 v[164:167], a[20:23], a[76:79], v[164:167]
ds_read_b64_tr_b16 a[4:5], v13 offset:40096
v_mfma_f32_16x16x32_bf16 v[164:167], a[16:19], a[72:75], v[164:167]
ds_read_b64_tr_b16 a[6:7], v13 offset:43680
v_mfma_f32_16x16x32_bf16 v[168:171], a[16:19], a[80:83], v[168:171]
s_add_u32 m0, s23, 36864
v_mfma_f32_16x16x32_bf16 v[168:171], a[20:23], a[84:87], v[168:171]
buffer_load_dwordx4 v6, s[4:7], s22 offen offset:0 lds
v_mfma_f32_16x16x32_bf16 v[172:175], a[20:23], a[92:95], v[172:175]
v_mfma_f32_16x16x32_bf16 v[172:175], a[16:19], a[88:91], v[172:175]
s_waitcnt lgkmcnt(4)
v_mfma_f32_16x16x32_bf16 v[176:179], a[24:27], a[64:67], v[176:179]
ds_read_b64_tr_b16 a[8:9], v13 offset:47264
v_mfma_f32_16x16x32_bf16 v[176:179], a[28:31], a[68:71], v[176:179]
ds_read_b64_tr_b16 a[10:11], v13 offset:50848
v_mfma_f32_16x16x32_bf16 v[180:183], a[28:31], a[76:79], v[180:183]
ds_read_b64_tr_b16 a[12:13], v13 offset:54432
v_mfma_f32_16x16x32_bf16 v[180:183], a[24:27], a[72:75], v[180:183]
ds_read_b64_tr_b16 a[14:15], v13 offset:58016
v_mfma_f32_16x16x32_bf16 v[184:187], a[24:27], a[80:83], v[184:187]
buffer_load_dwordx4 v7, s[4:7], s22 offen offset:1024 lds
v_mfma_f32_16x16x32_bf16 v[184:187], a[28:31], a[84:87], v[184:187]
v_mfma_f32_16x16x32_bf16 v[188:191], a[28:31], a[92:95], v[188:191]
v_mfma_f32_16x16x32_bf16 v[188:191], a[24:27], a[88:91], v[188:191]
s_waitcnt lgkmcnt(4)
v_mfma_f32_16x16x32_bf16 v[192:195], a[0:3], a[64:67], v[192:195]
ds_read_b64_tr_b16 a[16:17], v13 offset:32960
v_mfma_f32_16x16x32_bf16 v[192:195], a[4:7], a[68:71], v[192:195]
ds_read_b64_tr_b16 a[18:19], v13 offset:36544
v_mfma_f32_16x16x32_bf16 v[196:199], a[4:7], a[76:79], v[196:199]
ds_read_b64_tr_b16 a[20:21], v13 offset:40128
v_mfma_f32_16x16x32_bf16 v[196:199], a[0:3], a[72:75], v[196:199]
ds_read_b64_tr_b16 a[22:23], v13 offset:43712
v_mfma_f32_16x16x32_bf16 v[200:203], a[0:3], a[80:83], v[200:203]
buffer_load_dwordx4 v8, s[4:7], s22 offen offset:2048 lds
v_mfma_f32_16x16x32_bf16 v[200:203], a[4:7], a[84:87], v[200:203]
v_mfma_f32_16x16x32_bf16 v[204:207], a[4:7], a[92:95], v[204:207]
s_add_u32 s37, s37, 32768
v_mfma_f32_16x16x32_bf16 v[204:207], a[0:3], a[88:91], v[204:207]
s_max_i32 s39, s37, s49
s_waitcnt lgkmcnt(4)
v_mfma_f32_16x16x32_bf16 v[208:211], a[8:11], a[64:67], v[208:211]
ds_read_b64_tr_b16 a[24:25], v13 offset:47296
s_min_u32 s39, s39, s50
v_mfma_f32_16x16x32_bf16 v[208:211], a[12:15], a[68:71], v[208:211]
ds_read_b64_tr_b16 a[26:27], v13 offset:50880
v_mfma_f32_16x16x32_bf16 v[212:215], a[12:15], a[76:79], v[212:215]
ds_read_b64_tr_b16 a[28:29], v13 offset:54464
buffer_load_dword a250, v1, s[4:7], s36 offen
v_mfma_f32_16x16x32_bf16 v[212:215], a[8:11], a[72:75], v[212:215]
ds_read_b64_tr_b16 a[30:31], v13 offset:58048
buffer_load_dword a251, v15, s[40:43], s39 offen
v_mfma_f32_16x16x32_bf16 v[216:219], a[8:11], a[80:83], v[216:219]
s_add_u32 s36, s36, 458752
v_mfma_f32_16x16x32_bf16 v[216:219], a[12:15], a[84:87], v[216:219]
s_min_u32 s36, s36, s48
v_mfma_f32_16x16x32_bf16 v[220:223], a[12:15], a[92:95], v[220:223]
v_mfma_f32_16x16x32_bf16 v[220:223], a[8:11], a[88:91], v[220:223]
s_waitcnt vmcnt(19)
s_barrier
v_xor_b32 v13, 0x10000, v13
s_waitcnt lgkmcnt(4)
v_mfma_f32_16x16x32_bf16 v[224:227], a[16:19], a[64:67], v[224:227]
ds_read_b64_tr_b16 a[0:1], v13 offset:0
v_mfma_f32_16x16x32_bf16 v[224:227], a[20:23], a[68:71], v[224:227]
ds_read_b64_tr_b16 a[2:3], v13 offset:3584
v_mfma_f32_16x16x32_bf16 v[228:231], a[20:23], a[76:79], v[228:231]
ds_read_b64_tr_b16 a[4:5], v13 offset:7168
v_mfma_f32_16x16x32_bf16 v[228:231], a[16:19], a[72:75], v[228:231]
ds_read_b64_tr_b16 a[6:7], v13 offset:10752
v_mfma_f32_16x16x32_bf16 v[232:235], a[16:19], a[80:83], v[232:235]
v_mfma_f32_16x16x32_bf16 v[232:235], a[20:23], a[84:87], v[232:235]
v_mfma_f32_16x16x32_bf16 v[236:239], a[20:23], a[92:95], v[236:239]
v_mfma_f32_16x16x32_bf16 v[236:239], a[16:19], a[88:91], v[236:239]
s_waitcnt lgkmcnt(4)
v_mfma_f32_16x16x32_bf16 v[240:243], a[24:27], a[64:67], v[240:243]
ds_read_b64_tr_b16 a[8:9], v13 offset:14336
v_mfma_f32_16x16x32_bf16 v[240:243], a[28:31], a[68:71], v[240:243]
ds_read_b64_tr_b16 a[10:11], v13 offset:17920
v_mfma_f32_16x16x32_bf16 v[244:247], a[28:31], a[76:79], v[244:247]
ds_read_b64_tr_b16 a[12:13], v13 offset:21504
v_mfma_f32_16x16x32_bf16 v[244:247], a[24:27], a[72:75], v[244:247]
ds_read_b64_tr_b16 a[14:15], v13 offset:25088
v_mfma_f32_16x16x32_bf16 v[248:251], a[24:27], a[80:83], v[248:251]
v_mfma_f32_16x16x32_bf16 v[248:251], a[28:31], a[84:87], v[248:251]
v_mfma_f32_16x16x32_bf16 v[252:255], a[28:31], a[92:95], v[252:255]
v_mfma_f32_16x16x32_bf16 v[252:255], a[24:27], a[88:91], v[252:255]
s_sub_u32 s24, s24, 1
s_cmp_lg_u32 s24, 0
s_cbranch_scc1 L_loop3
s_waitcnt vmcnt(9) lgkmcnt(4)
v_mfma_f32_16x16x32_bf16 v[32:35], a[0:3], a[32:35], v[32:35]
ds_read_b64_tr_b16 a[16:17], v13 offset:32
v_mfma_f32_16x16x32_bf16 v[32:35], a[4:7], a[36:39], v[32:35]
ds_read_b64_tr_b16 a[18:19], v13 offset:3616
v_mfma_f32_16x16x32_bf16 v[36:39], a[4:7], a[44:47], v[36:39]
ds_read_b64_tr_b16 a[20:21], v13 offset:7200
v_mfma_f32_16x16x32_bf16 v[36:39], a[0:3], a[40:43], v[36:39]
ds_read_b64_tr_b16 a[22:23], v13 offset:10784
v_mfma_f32_16x16x32_bf16 v[40:43], a[0:3], a[48:51], v[40:43]
buffer_load_dwordx4 a[64:67], v9, s[8:11], s21 offen offset:2048 sc1
v_mfma_f32_16x16x32_bf16 v[40:43], a[4:7], a[52:55], v[40:43]
v_mfma_f32_16x16x32_bf16 v[44:47], a[4:7], a[60:63], v[44:47]
v_add_f32 v16, v16, v24
v_add_f32 v17, v17, v25
v_mfma_f32_16x16x32_bf16 v[44:47], a[0:3], a[56:59], v[44:47]
v_add_f32 v18, v18, v26
v_add_f32 v19, v19, v27
s_waitcnt lgkmcnt(4)
v_mfma_f32_16x16x32_bf16 v[48:51], a[8:11], a[32:35], v[48:51]
ds_read_b64_tr_b16 a[24:25], v13 offset:14368
buffer_load_dwordx4 a[68:71], v9, s[8:11], s21 offen offset:3072 sc1
v_mfma_f32_16x16x32_bf16 v[48:51], a[12:15], a[36:39], v[48:51]
ds_read_b64_tr_b16 a[26:27], v13 offset:17952
v_mfma_f32_16x16x32_bf16 v[52:55], a[12:15], a[44:47], v[52:55]
ds_read_b64_tr_b16 a[28:29], v13 offset:21536
v_mfma_f32_16x16x32_bf16 v[52:55], a[8:11], a[40:43], v[52:55]
ds_read_b64_tr_b16 a[30:31], v13 offset:25120
v_mfma_f32_16x16x32_bf16 v[56:59], a[8:11], a[48:51], v[56:59]
buffer_load_dwordx4 a[72:75], v10, s[8:11], s21 offen offset:2048 sc1
v_mfma_f32_16x16x32_bf16 v[56:59], a[12:15], a[52:55], v[56:59]
v_add_f32 v20, v20, v28
v_add_f32 v21, v21, v29
v_mfma_f32_16x16x32_bf16 v[60:63], a[12:15], a[60:63], v[60:63]
v_add_f32 v22, v22, v30
v_add_f32 v23, v23, v31
v_mfma_f32_16x16x32_bf16 v[60:63], a[8:11], a[56:59], v[60:63]
v_add_f32 v16, v16, v20
v_add_f32 v17, v17, v21
s_waitcnt lgkmcnt(4)
v_mfma_f32_16x16x32_bf16 v[64:67], a[16:19], a[32:35], v[64:67]
ds_read_b64_tr_b16 a[0:1], v13 offset:64
buffer_load_dwordx4 a[76:79], v10, s[8:11], s21 offen offset:3072 sc1
v_mfma_f32_16x16x32_bf16 v[64:67], a[20:23], a[36:39], v[64:67]
ds_read_b64_tr_b16 a[2:3], v13 offset:3648
v_mfma_f32_16x16x32_bf16 v[68:71], a[20:23], a[44:47], v[68:71]
ds_read_b64_tr_b16 a[4:5], v13 offset:7232
v_mfma_f32_16x16x32_bf16 v[68:71], a[16:19], a[40:43], v[68:71]
ds_read_b64_tr_b16 a[6:7], v13 offset:10816
v_mfma_f32_16x16x32_bf16 v[72:75], a[16:19], a[48:51], v[72:75]
buffer_load_dwordx4 a[80:83], v11, s[8:11], s21 offen offset:2048 sc1
v_mfma_f32_16x16x32_bf16 v[72:75], a[20:23], a[52:55], v[72:75]
v_add_f32 v18, v18, v22
v_add_f32 v19, v19, v23
v_mfma_f32_16x16x32_bf16 v[76:79], a[20:23], a[60:63], v[76:79]
v_add_f32 v16, v16, v18
v_add_f32 v17, v17, v19
v_mfma_f32_16x16x32_bf16 v[76:79], a[16:19], a[56:59], v[76:79]
v_add_f32 v16, v16, v17
s_waitcnt lgkmcnt(4)
v_mfma_f32_16x16x32_bf16 v[80:83], a[24:27], a[32:35], v[80:83]
ds_read_b64_tr_b16 a[8:9], v13 offset:14400
buffer_load_dwordx4 a[84:87], v11, s[8:11], s21 offen offset:3072 sc1
v_mfma_f32_16x16x32_bf16 v[80:83], a[28:31], a[36:39], v[80:83]
ds_read_b64_tr_b16 a[10:11], v13 offset:17984
v_mfma_f32_16x16x32_bf16 v[84:87], a[28:31], a[44:47], v[84:87]
ds_read_b64_tr_b16 a[12:13], v13 offset:21568
v_mfma_f32_16x16x32_bf16 v[84:87], a[24:27], a[40:43], v[84:87]
ds_read_b64_tr_b16 a[14:15], v13 offset:25152
v_mfma_f32_16x16x32_bf16 v[88:91], a[24:27], a[48:51], v[88:91]
buffer_load_dwordx4 a[88:91], v12, s[8:11], s21 offen offset:2048 sc1
v_mfma_f32_16x16x32_bf16 v[88:91], a[28:31], a[52:55], v[88:91]
v_mov_b32 v17, 0x3727c5ac
s_nop 0
v_mfma_f32_16x16x32_bf16 v[92:95], a[28:31], a[60:63], v[92:95]
v_fmac_f32 v17, 0x3a800000, v16
v_mfma_f32_16x16x32_bf16 v[92:95], a[24:27], a[56:59], v[92:95]
v_sqrt_f32 v24, v17
s_waitcnt lgkmcnt(4)
v_mfma_f32_16x16x32_bf16 v[96:99], a[0:3], a[32:35], v[96:99]
ds_read_b64_tr_b16 a[16:17], v13 offset:96
buffer_load_dwordx4 a[92:95], v12, s[8:11], s21 offen offset:3072 sc1
v_mfma_f32_16x16x32_bf16 v[96:99], a[4:7], a[36:39], v[96:99]
ds_read_b64_tr_b16 a[18:19], v13 offset:3680
v_mfma_f32_16x16x32_bf16 v[100:103], a[4:7], a[44:47], v[100:103]
ds_read_b64_tr_b16 a[20:21], v13 offset:7264
v_mfma_f32_16x16x32_bf16 v[100:103], a[0:3], a[40:43], v[100:103]
ds_read_b64_tr_b16 a[22:23], v13 offset:10848
v_mfma_f32_16x16x32_bf16 v[104:107], a[0:3], a[48:51], v[104:107]
s_xor_b32 s23, s23, 0x10000
v_mfma_f32_16x16x32_bf16 v[104:107], a[4:7], a[52:55], v[104:107]
s_add_u32 s22, s22, 458752
v_mfma_f32_16x16x32_bf16 v[108:111], a[4:7], a[60:63], v[108:111]
s_add_u32 m0, s23, 0
v_mfma_f32_16x16x32_bf16 v[108:111], a[0:3], a[56:59], v[108:111]
buffer_load_dwordx4 v2, s[4:7], s22 offen offset:0 lds
s_waitcnt lgkmcnt(4)
v_mfma_f32_16x16x32_bf16 v[112:115], a[8:11], a[32:35], v[112:115]
ds_read_b64_tr_b16 a[24:25], v13 offset:14432
v_mfma_f32_16x16x32_bf16 v[112:115], a[12:15], a[36:39], v[112:115]
ds_read_b64_tr_b16 a[26:27], v13 offset:18016
v_mfma_f32_16x16x32_bf16 v[116:119], a[12:15], a[44:47], v[116:119]
ds_read_b64_tr_b16 a[28:29], v13 offset:21600
v_mfma_f32_16x16x32_bf16 v[116:119], a[8:11], a[40:43], v[116:119]
ds_read_b64_tr_b16 a[30:31], v13 offset:25184
v_mfma_f32_16x16x32_bf16 v[120:123], a[8:11], a[48:51], v[120:123]
buffer_load_dwordx4 v3, s[4:7], s22 offen offset:1024 lds
v_mfma_f32_16x16x32_bf16 v[120:123], a[12:15], a[52:55], v[120:123]
v_rsq_f32 v16, v17
v_mfma_f32_16x16x32_bf16 v[124:127], a[12:15], a[60:63], v[124:127]
v_mul_f32 v16, 0xbfb8aa3b, v16
v_mfma_f32_16x16x32_bf16 v[124:127], a[8:11], a[56:59], v[124:127]
v_mov_b32 v20, v16
s_nop 0
s_waitcnt lgkmcnt(4)
v_mfma_f32_16x16x32_bf16 v[128:131], a[16:19], a[32:35], v[128:131]
ds_read_b64_tr_b16 a[0:1], v13 offset:128
v_mfma_f32_16x16x32_bf16 v[128:131], a[20:23], a[36:39], v[128:131]
ds_read_b64_tr_b16 a[2:3], v13 offset:3712
v_mfma_f32_16x16x32_bf16 v[132:135], a[20:23], a[44:47], v[132:135]
ds_read_b64_tr_b16 a[4:5], v13 offset:7296
v_mfma_f32_16x16x32_bf16 v[132:135], a[16:19], a[40:43], v[132:135]
ds_read_b64_tr_b16 a[6:7], v13 offset:10880
v_mfma_f32_16x16x32_bf16 v[136:139], a[16:19], a[48:51], v[136:139]
buffer_load_dwordx4 v4, s[4:7], s22 offen offset:2048 lds
v_mfma_f32_16x16x32_bf16 v[136:139], a[20:23], a[52:55], v[136:139]
v_permlane32_swap_b32 v16, v20
v_mfma_f32_16x16x32_bf16 v[140:143], a[20:23], a[60:63], v[140:143]
v_mov_b32 v18, v16
s_nop 0
v_mfma_f32_16x16x32_bf16 v[140:143], a[16:19], a[56:59], v[140:143]
v_mov_b32 v22, v20
s_nop 0
s_waitcnt lgkmcnt(4)
v_mfma_f32_16x16x32_bf16 v[144:147], a[24:27], a[32:35], v[144:147]
ds_read_b64_tr_b16 a[8:9], v13 offset:14464
v_mfma_f32_16x16x32_bf16 v[144:147], a[28:31], a[36:39], v[144:147]
ds_read_b64_tr_b16 a[10:11], v13 offset:18048
v_mfma_f32_16x16x32_bf16 v[148:151], a[28:31], a[44:47], v[148:151]
ds_read_b64_tr_b16 a[12:13], v13 offset:21632
v_mfma_f32_16x16x32_bf16 v[148:151], a[24:27], a[40:43], v[148:151]
ds_read_b64_tr_b16 a[14:15], v13 offset:25216
v_mfma_f32_16x16x32_bf16 v[152:155], a[24:27], a[48:51], v[152:155]
buffer_load_dwordx4 v5, s[4:7], s22 offen offset:3072 lds
v_mfma_f32_16x16x32_bf16 v[152:155], a[28:31], a[52:55], v[152:155]
v_permlane16_swap_b32 v16, v18
v_mfma_f32_16x16x32_bf16 v[156:159], a[28:31], a[60:63], v[156:159]
v_permlane16_swap_b32 v20, v22
v_mfma_f32_16x16x32_bf16 v[156:159], a[24:27], a[56:59], v[156:159]
v_mov_b32 v28, v24
s_nop 0
s_waitcnt lgkmcnt(4)
v_mfma_f32_16x16x32_bf16 v[160:163], a[0:3], a[32:35], v[160:163]
ds_read_b64_tr_b16 a[16:17], v13 offset:160
v_mfma_f32_16x16x32_bf16 v[160:163], a[4:7], a[36:39], v[160:163]
ds_read_b64_tr_b16 a[18:19], v13 offset:3744
v_mfma_f32_16x16x32_bf16 v[164:167], a[4:7], a[44:47], v[164:167]
ds_read_b64_tr_b16 a[20:21], v13 offset:7328
v_mfma_f32_16x16x32_bf16 v[164:167], a[0:3], a[40:43], v[164:167]
ds_read_b64_tr_b16 a[22:23], v13 offset:10912
v_mfma_f32_16x16x32_bf16 v[168:171], a[0:3], a[48:51], v[168:171]
s_add_u32 m0, s23, 4096
v_mfma_f32_16x16x32_bf16 v[168:171], a[4:7], a[52:55], v[168:171]
buffer_load_dwordx4 v6, s[4:7], s22 offen offset:0 lds
v_mfma_f32_16x16x32_bf16 v[172:175], a[4:7], a[60:63], v[172:175]
v_permlane32_swap_b32 v24, v28
v_mfma_f32_16x16x32_bf16 v[172:175], a[0:3], a[56:59], v[172:175]
v_mov_b32 v26, v24
s_nop 0
s_waitcnt lgkmcnt(4)
v_mfma_f32_16x16x32_bf16 v[176:179], a[8:11], a[32:35], v[176:179]
ds_read_b64_tr_b16 a[24:25], v13 offset:14496
v_mfma_f32_16x16x32_bf16 v[176:179], a[12:15], a[36:39], v[176:179]
ds_read_b64_tr_b16 a[26:27], v13 offset:18080
v_mfma_f32_16x16x32_bf16 v[180:183], a[12:15], a[44:47], v[180:183]
ds_read_b64_tr_b16 a[28:29], v13 offset:21664
v_mfma_f32_16x16x32_bf16 v[180:183], a[8:11], a[40:43], v[180:183]
ds_read_b64_tr_b16 a[30:31], v13 offset:25248
v_mfma_f32_16x16x32_bf16 v[184:187], a[8:11], a[48:51], v[184:187]
buffer_load_dwordx4 v7, s[4:7], s22 offen offset:1024 lds
v_mfma_f32_16x16x32_bf16 v[184:187], a[12:15], a[52:55], v[184:187]
v_mov_b32 v30, v28
s_nop 0
v_mfma_f32_16x16x32_bf16 v[188:191], a[12:15], a[60:63], v[188:191]
v_permlane16_swap_b32 v24, v26
v_mfma_f32_16x16x32_bf16 v[188:191], a[8:11], a[56:59], v[188:191]
v_permlane16_swap_b32 v28, v30
s_waitcnt lgkmcnt(4)
v_mfma_f32_16x16x32_bf16 v[192:195], a[16:19], a[32:35], v[192:195]
ds_read_b64_tr_b16 a[0:1], v13 offset:192
v_mfma_f32_16x16x32_bf16 v[192:195], a[20:23], a[36:39], v[192:195]
ds_read_b64_tr_b16 a[2:3], v13 offset:3776
v_mfma_f32_16x16x32_bf16 v[196:199], a[20:23], a[44:47], v[196:199]
ds_read_b64_tr_b16 a[4:5], v13 offset:7360
v_mfma_f32_16x16x32_bf16 v[196:199], a[16:19], a[40:43], v[196:199]
ds_read_b64_tr_b16 a[6:7], v13 offset:10944
v_mfma_f32_16x16x32_bf16 v[200:203], a[16:19], a[48:51], v[200:203]
buffer_load_dwordx4 v8, s[4:7], s22 offen offset:2048 lds
v_mfma_f32_16x16x32_bf16 v[200:203], a[20:23], a[52:55], v[200:203]
v_mfma_f32_16x16x32_bf16 v[204:207], a[20:23], a[60:63], v[204:207]
v_mfma_f32_16x16x32_bf16 v[204:207], a[16:19], a[56:59], v[204:207]
s_waitcnt lgkmcnt(4)
v_mfma_f32_16x16x32_bf16 v[208:211], a[24:27], a[32:35], v[208:211]
ds_read_b64_tr_b16 a[8:9], v13 offset:14528
v_mfma_f32_16x16x32_bf16 v[208:211], a[28:31], a[36:39], v[208:211]
ds_read_b64_tr_b16 a[10:11], v13 offset:18112
v_mfma_f32_16x16x32_bf16 v[212:215], a[28:31], a[44:47], v[212:215]
ds_read_b64_tr_b16 a[12:13], v13 offset:21696
s_getpc_b64 s[56:57]
L_pc_c:
s_add_u32 s56, s56, L_ph4-L_pc_c
s_addc_u32 s57, s57, 0
v_mfma_f32_16x16x32_bf16 v[212:215], a[24:27], a[40:43], v[212:215]
ds_read_b64_tr_b16 a[14:15], v13 offset:25280
s_lshr_b32 s58, s2, 3
v_mfma_f32_16x16x32_bf16 v[216:219], a[24:27], a[48:51], v[216:219]
s_lshl_b32 s58, s58, 2
v_mfma_f32_16x16x32_bf16 v[216:219], a[28:31], a[52:55], v[216:219]
s_add_u32 s58, s58, s20
v_mfma_f32_16x16x32_bf16 v[220:223], a[28:31], a[60:63], v[220:223]
s_mul_i32 s58, s58, 2
v_mfma_f32_16x16x32_bf16 v[220:223], a[24:27], a[56:59], v[220:223]
v_min_u32 v14, 1, v0
s_waitcnt vmcnt(17)
s_barrier
s_waitcnt lgkmcnt(4)
v_mfma_f32_16x16x32_bf16 v[224:227], a[0:3], a[32:35], v[224:227]
ds_read_b64_tr_b16 a[16:17], v13 offset:32768
v_add_u32 v14, s58, v14
v_mfma_f32_16x16x32_bf16 v[224:227], a[4:7], a[36:39], v[224:227]
ds_read_b64_tr_b16 a[18:19], v13 offset:36352
v_lshlrev_b32 v14, 7, v14
v_mfma_f32_16x16x32_bf16 v[228:231], a[4:7], a[44:47], v[228:231]
ds_read_b64_tr_b16 a[20:21], v13 offset:39936
v_min_u32 v14, L_code_end-L_ph4-4, v14
v_mfma_f32_16x16x32_bf16 v[228:231], a[0:3], a[40:43], v[228:231]
ds_read_b64_tr_b16 a[22:23], v13 offset:43520
v_mov_b32 v15, s57
v_mfma_f32_16x16x32_bf16 v[232:235], a[0:3], a[48:51], v[232:235]
v_add_co_u32 v14, vcc, s56, v14
s_nop 1
v_addc_co_u32 v15, vcc, 0, v15, vcc
v_mfma_f32_16x16x32_bf16 v[232:235], a[4:7], a[52:55], v[232:235]
global_load_dword a250, v[14:15], off
v_mfma_f32_16x16x32_bf16 v[236:239], a[4:7], a[60:63], v[236:239]
v_mfma_f32_16x16x32_bf16 v[236:239], a[0:3], a[56:59], v[236:239]
s_waitcnt lgkmcnt(4)
v_mfma_f32_16x16x32_bf16 v[240:243], a[8:11], a[32:35], v[240:243]
ds_read_b64_tr_b16 a[24:25], v13 offset:47104
v_mfma_f32_16x16x32_bf16 v[240:243], a[12:15], a[36:39], v[240:243]
ds_read_b64_tr_b16 a[26:27], v13 offset:50688
v_mfma_f32_16x16x32_bf16 v[244:247], a[12:15], a[44:47], v[244:247]
ds_read_b64_tr_b16 a[28:29], v13 offset:54272
v_mfma_f32_16x16x32_bf16 v[244:247], a[8:11], a[40:43], v[244:247]
ds_read_b64_tr_b16 a[30:31], v13 offset:57856
v_mfma_f32_16x16x32_bf16 v[248:251], a[8:11], a[48:51], v[248:251]
v_mfma_f32_16x16x32_bf16 v[248:251], a[12:15], a[52:55], v[248:251]
v_mfma_f32_16x16x32_bf16 v[252:255], a[12:15], a[60:63], v[252:255]
v_mfma_f32_16x16x32_bf16 v[252:255], a[8:11], a[56:59], v[252:255]
s_waitcnt vmcnt(8) lgkmcnt(4)
v_mfma_f32_16x16x32_bf16 v[32:35], a[16:19], a[64:67], v[32:35]
ds_read_b64_tr_b16 a[0:1], v13 offset:32800
s_add_u32 s22, s22, 458752
v_mfma_f32_16x16x32_bf16 v[32:35], a[20:23], a[68:71], v[32:35]
ds_read_b64_tr_b16 a[2:3], v13 offset:36384
s_add_u32 m0, s23, 32768
v_mfma_f32_16x16x32_bf16 v[36:39], a[20:23], a[76:79], v[36:39]
ds_read_b64_tr_b16 a[4:5], v13 offset:39968
buffer_load_dwordx4 v2, s[4:7], s22 offen offset:0 lds
v_mfma_f32_16x16x32_bf16 v[36:39], a[16:19], a[72:75], v[36:39]
ds_read_b64_tr_b16 a[6:7], v13 offset:43552
v_mfma_f32_16x16x32_bf16 v[40:43], a[16:19], a[80:83], v[40:43]
buffer_load_dwordx4 v3, s[4:7], s22 offen offset:1024 lds
v_mfma_f32_16x16x32_bf16 v[40:43], a[20:23], a[84:87], v[40:43]
v_mfma_f32_16x16x32_bf16 v[44:47], a[20:23], a[92:95], v[44:47]
v_mfma_f32_16x16x32_bf16 v[44:47], a[16:19], a[88:91], v[44:47]
s_waitcnt lgkmcnt(4)
v_mfma_f32_16x16x32_bf16 v[48:51], a[24:27], a[64:67], v[48:51]
ds_read_b64_tr_b16 a[8:9], v13 offset:47136
buffer_load_dwordx4 v4, s[4:7], s22 offen offset:2048 lds
v_mfma_f32_16x16x32_bf16 v[48:51], a[28:31], a[68:71], v[48:51]
ds_read_b64_tr_b16 a[10:11], v13 offset:50720
v_mfma_f32_16x16x32_bf16 v[52:55], a[28:31], a[76:79], v[52:55]
ds_read_b64_tr_b16 a[12:13], v13 offset:54304
v_mfma_f32_16x16x32_bf16 v[52:55], a[24:27], a[72:75], v[52:55]
ds_read_b64_tr_b16 a[14:15], v13 offset:57888
v_mfma_f32_16x16x32_bf16 v[56:59], a[24:27], a[80:83], v[56:59]
buffer_load_dwordx4 v5, s[4:7], s22 offen offset:3072 lds
v_mfma_f32_16x16x32_bf16 v[56:59], a[28:31], a[84:87], v[56:59]
v_mfma_f32_16x16x32_bf16 v[60:63], a[28:31], a[92:95], v[60:63]
v_mfma_f32_16x16x32_bf16 v[60:63], a[24:27], a[88:91], v[60:63]
s_waitcnt lgkmcnt(4)
v_mfma_f32_16x16x32_bf16 v[64:67], a[0:3], a[64:67], v[64:67]
ds_read_b64_tr_b16 a[16:17], v13 offset:32832
s_add_u32 m0, s23, 36864
v_mfma_f32_16x16x32_bf16 v[64:67], a[4:7], a[68:71], v[64:67]
ds_read_b64_tr_b16 a[18:19], v13 offset:36416
buffer_load_dwordx4 v6, s[4:7], s22 offen offset:0 lds
v_mfma_f32_16x16x32_bf16 v[68:71], a[4:7], a[76:79], v[68:71]
ds_read_b64_tr_b16 a[20:21], v13 offset:40000
v_mfma_f32_16x16x32_bf16 v[68:71], a[0:3], a[72:75], v[68:71]
ds_read_b64_tr_b16 a[22:23], v13 offset:43584
v_mfma_f32_16x16x32_bf16 v[72:75], a[0:3], a[80:83], v[72:75]
buffer_load_dwordx4 v7, s[4:7], s22 offen offset:1024 lds
v_mfma_f32_16x16x32_bf16 v[72:75], a[4:7], a[84:87], v[72:75]
v_mfma_f32_16x16x32_bf16 v[76:79], a[4:7], a[92:95], v[76:79]
v_mfma_f32_16x16x32_bf16 v[76:79], a[0:3], a[88:91], v[76:79]
s_waitcnt lgkmcnt(4)
v_mfma_f32_16x16x32_bf16 v[80:83], a[8:11], a[64:67], v[80:83]
ds_read_b64_tr_b16 a[24:25], v13 offset:47168
buffer_load_dwordx4 v8, s[4:7], s22 offen offset:2048 lds
v_mfma_f32_16x16x32_bf16 v[80:83], a[12:15], a[68:71], v[80:83]
ds_read_b64_tr_b16 a[26:27], v13 offset:50752
v_mfma_f32_16x16x32_bf16 v[84:87], a[12:15], a[76:79], v[84:87]
ds_read_b64_tr_b16 a[28:29], v13 offset:54336
v_mfma_f32_16x16x32_bf16 v[84:87], a[8:11], a[72:75], v[84:87]
ds_read_b64_tr_b16 a[30:31], v13 offset:57920
v_mfma_f32_16x16x32_bf16 v[88:91], a[8:11], a[80:83], v[88:91]
v_mfma_f32_16x16x32_bf16 v[88:91], a[12:15], a[84:87], v[88:91]
v_mfma_f32_16x16x32_bf16 v[92:95], a[12:15], a[92:95], v[92:95]
s_add_u32 s21, s21, s51
s_xor_b32 s51, s51, 8192
v_mfma_f32_16x16x32_bf16 v[92:95], a[8:11], a[88:91], v[92:95]
buffer_load_dwordx4 a[32:35], v9, s[8:11], s21 offen offset:0 sc1
s_waitcnt lgkmcnt(4)
v_mfma_f32_16x16x32_bf16 v[96:99], a[16:19], a[64:67], v[96:99]
ds_read_b64_tr_b16 a[0:1], v13 offset:32864
v_mfma_f32_16x16x32_bf16 v[96:99], a[20:23], a[68:71], v[96:99]
ds_read_b64_tr_b16 a[2:3], v13 offset:36448
buffer_load_dwordx4 a[36:39], v9, s[8:11], s21 offen offset:1024 sc1
v_mfma_f32_16x16x32_bf16 v[100:103], a[20:23], a[76:79], v[100:103]
ds_read_b64_tr_b16 a[4:5], v13 offset:40032
v_mfma_f32_16x16x32_bf16 v[100:103], a[16:19], a[72:75], v[100:103]
ds_read_b64_tr_b16 a[6:7], v13 offset:43616
v_mfma_f32_16x16x32_bf16 v[104:107], a[16:19], a[80:83], v[104:107]
buffer_load_dwordx4 a[40:43], v10, s[8:11], s21 offen offset:0 sc1
v_mfma_f32_16x16x32_bf16 v[104:107], a[20:23], a[84:87], v[104:107]
v_mfma_f32_16x16x32_bf16 v[108:111], a[20:23], a[92:95], v[108:111]
v_mfma_f32_16x16x32_bf16 v[108:111], a[16:19], a[88:91], v[108:111]
buffer_load_dwordx4 a[44:47], v10, s[8:11], s21 offen offset:1024 sc1
s_waitcnt lgkmcnt(4)
v_mfma_f32_16x16x32_bf16 v[112:115], a[24:27], a[64:67], v[112:115]
ds_read_b64_tr_b16 a[8:9], v13 offset:47200
v_mfma_f32_16x16x32_bf16 v[112:115], a[28:31], a[68:71], v[112:115]
ds_read_b64_tr_b16 a[10:11], v13 offset:50784
v_mfma_f32_16x16x32_bf16 v[116:119], a[28:31], a[76:79], v[116:119]
ds_read_b64_tr_b16 a[12:13], v13 offset:54368
buffer_load_dwordx4 a[48:51], v11, s[8:11], s21 offen offset:0 sc1
v_mfma_f32_16x16x32_bf16 v[116:119], a[24:27], a[72:75], v[116:119]
ds_read_b64_tr_b16 a[14:15], v13 offset:57952
v_mfma_f32_16x16x32_bf16 v[120:123], a[24:27], a[80:83], v[120:123]
v_and_b32 v2, 15, v0
v_lshlrev_b32 v2, 4, v2
v_mfma_f32_16x16x32_bf16 v[120:123], a[28:31], a[84:87], v[120:123]
buffer_load_dwordx4 a[52:55], v11, s[8:11], s21 offen offset:1024 sc1
v_mfma_f32_16x16x32_bf16 v[124:127], a[28:31], a[92:95], v[124:127]
v_bfe_u32 v3, v0, 4, 1
v_lshlrev_b32 v3, 18, v3
v_mfma_f32_16x16x32_bf16 v[124:127], a[24:27], a[88:91], v[124:127]
v_lshrrev_b32 v4, 5, v0
v_lshlrev_b32 v4, 8, v4
s_waitcnt lgkmcnt(4)
v_mfma_f32_16x16x32_bf16 v[128:131], a[0:3], a[64:67], v[128:131]
ds_read_b64_tr_b16 a[16:17], v13 offset:32896
buffer_load_dwordx4 a[56:59], v12, s[8:11], s21 offen offset:0 sc1
v_mfma_f32_16x16x32_bf16 v[128:131], a[4:7], a[68:71], v[128:131]
ds_read_b64_tr_b16 a[18:19], v13 offset:36480
v_mfma_f32_16x16x32_bf16 v[132:135], a[4:7], a[76:79], v[132:135]
ds_read_b64_tr_b16 a[20:21], v13 offset:40064
v_mfma_f32_16x16x32_bf16 v[132:135], a[0:3], a[72:75], v[132:135]
ds_read_b64_tr_b16 a[22:23], v13 offset:43648
buffer_load_dwordx4 a[60:63], v12, s[8:11], s21 offen offset:1024 sc1
v_mfma_f32_16x16x32_bf16 v[136:139], a[0:3], a[80:83], v[136:139]
v_add3_u32 v2, v2, v3, v4
v_add_u32 v3, 524288, v2
v_mfma_f32_16x16x32_bf16 v[136:139], a[4:7], a[84:87], v[136:139]
v_accvgpr_read_b32 v8, a222
v_accvgpr_read_b32 v1, a223
v_mfma_f32_16x16x32_bf16 v[140:143], a[4:7], a[92:95], v[140:143]
v_add_u32 v15, 262144, v1
v_bfe_u32 v5, v0, 4, 2
v_mfma_f32_16x16x32_bf16 v[140:143], a[0:3], a[88:91], v[140:143]
v_lshlrev_b32 v5, 1, v5
v_and_b32 v6, 7, v0
s_waitcnt lgkmcnt(4)
v_mfma_f32_16x16x32_bf16 v[144:147], a[8:11], a[64:67], v[144:147]
ds_read_b64_tr_b16 a[24:25], v13 offset:47232
buffer_load_dwordx4 a[96:99], v9, s[8:11], s21 offen offset:2048 sc1
v_mfma_f32_16x16x32_bf16 v[144:147], a[12:15], a[68:71], v[144:147]
ds_read_b64_tr_b16 a[26:27], v13 offset:50816
v_mfma_f32_16x16x32_bf16 v[148:151], a[12:15], a[76:79], v[148:151]
ds_read_b64_tr_b16 a[28:29], v13 offset:54400
v_mfma_f32_16x16x32_bf16 v[148:151], a[8:11], a[72:75], v[148:151]
ds_read_b64_tr_b16 a[30:31], v13 offset:57984
buffer_load_dwordx4 a[100:103], v9, s[8:11], s21 offen offset:3072 sc1
v_mfma_f32_16x16x32_bf16 v[152:155], a[8:11], a[80:83], v[152:155]
v_xor_b32 v5, v5, v6
v_lshlrev_b32 v5, 4, v5
v_mfma_f32_16x16x32_bf16 v[152:155], a[12:15], a[84:87], v[152:155]
v_lshrrev_b32 v6, 5, v0
v_lshlrev_b32 v6, 3, v6
v_mfma_f32_16x16x32_bf16 v[156:159], a[12:15], a[92:95], v[156:159]
buffer_load_dwordx4 a[104:107], v10, s[8:11], s21 offen offset:2048 sc1
v_mfma_f32_16x16x32_bf16 v[156:159], a[8:11], a[88:91], v[156:159]
v_bfe_u32 v7, v0, 3, 2
v_add_u32 v6, v6, v7
s_waitcnt lgkmcnt(4)
v_mfma_f32_16x16x32_bf16 v[160:163], a[16:19], a[64:67], v[160:163]
ds_read_b64_tr_b16 a[0:1], v13 offset:32928
v_mfma_f32_16x16x32_bf16 v[160:163], a[20:23], a[68:71], v[160:163]
ds_read_b64_tr_b16 a[2:3], v13 offset:36512
buffer_load_dwordx4 a[108:111], v10, s[8:11], s21 offen offset:3072 sc1
v_mfma_f32_16x16x32_bf16 v[164:167], a[20:23], a[76:79], v[164:167]
ds_read_b64_tr_b16 a[4:5], v13 offset:40096
v_mfma_f32_16x16x32_bf16 v[164:167], a[16:19], a[72:75], v[164:167]
ds_read_b64_tr_b16 a[6:7], v13 offset:43680
v_mfma_f32_16x16x32_bf16 v[168:171], a[16:19], a[80:83], v[168:171]
buffer_load_dwordx4 a[112:115], v11, s[8:11], s21 offen offset:2048 sc1
v_mfma_f32_16x16x32_bf16 v[168:171], a[20:23], a[84:87], v[168:171]
v_lshl_add_u32 v4, v6, 11, v5
v_add_u32 v5, 31744, v4
v_mfma_f32_16x16x32_bf16 v[172:175], a[20:23], a[92:95], v[172:175]
v_add_u32 v6, 6144, v4
v_add_u32 v7, 37888, v4
v_mfma_f32_16x16x32_bf16 v[172:175], a[16:19], a[88:91], v[172:175]
buffer_load_dwordx4 a[116:119], v11, s[8:11], s21 offen offset:3072 sc1
s_waitcnt lgkmcnt(4)
v_mfma_f32_16x16x32_bf16 v[176:179], a[24:27], a[64:67], v[176:179]
ds_read_b64_tr_b16 a[8:9], v13 offset:47264
v_mfma_f32_16x16x32_bf16 v[176:179], a[28:31], a[68:71], v[176:179]
ds_read_b64_tr_b16 a[10:11], v13 offset:50848
v_mfma_f32_16x16x32_bf16 v[180:183], a[28:31], a[76:79], v[180:183]
ds_read_b64_tr_b16 a[12:13], v13 offset:54432
buffer_load_dwordx4 a[120:123], v12, s[8:11], s21 offen offset:2048 sc1
v_mfma_f32_16x16x32_bf16 v[180:183], a[24:27], a[72:75], v[180:183]
ds_read_b64_tr_b16 a[14:15], v13 offset:58016
v_mfma_f32_16x16x32_bf16 v[184:187], a[24:27], a[80:83], v[184:187]
v_mfma_f32_16x16x32_bf16 v[184:187], a[28:31], a[84:87], v[184:187]
buffer_load_dwordx4 a[124:127], v12, s[8:11], s21 offen offset:3072 sc1
v_mfma_f32_16x16x32_bf16 v[188:191], a[28:31], a[92:95], v[188:191]
v_mfma_f32_16x16x32_bf16 v[188:191], a[24:27], a[88:91], v[188:191]
s_waitcnt lgkmcnt(4)
v_mfma_f32_16x16x32_bf16 v[192:195], a[0:3], a[64:67], v[192:195]
ds_read_b64_tr_b16 a[16:17], v13 offset:32960
v_mfma_f32_16x16x32_bf16 v[192:195], a[4:7], a[68:71], v[192:195]
ds_read_b64_tr_b16 a[18:19], v13 offset:36544
v_mfma_f32_16x16x32_bf16 v[196:199], a[4:7], a[76:79], v[196:199]
ds_read_b64_tr_b16 a[20:21], v13 offset:40128
v_mfma_f32_16x16x32_bf16 v[196:199], a[0:3], a[72:75], v[196:199]
ds_read_b64_tr_b16 a[22:23], v13 offset:43712
v_mfma_f32_16x16x32_bf16 v[200:203], a[0:3], a[80:83], v[200:203]
v_mfma_f32_16x16x32_bf16 v[200:203], a[4:7], a[84:87], v[200:203]
v_mfma_f32_16x16x32_bf16 v[204:207], a[4:7], a[92:95], v[204:207]
v_mfma_f32_16x16x32_bf16 v[204:207], a[0:3], a[88:91], v[204:207]
s_waitcnt lgkmcnt(4)
v_mfma_f32_16x16x32_bf16 v[208:211], a[8:11], a[64:67], v[208:211]
ds_read_b64_tr_b16 a[24:25], v13 offset:47296
v_mfma_f32_16x16x32_bf16 v[208:211], a[12:15], a[68:71], v[208:211]
ds_read_b64_tr_b16 a[26:27], v13 offset:50880
v_mfma_f32_16x16x32_bf16 v[212:215], a[12:15], a[76:79], v[212:215]
ds_read_b64_tr_b16 a[28:29], v13 offset:54464
v_mfma_f32_16x16x32_bf16 v[212:215], a[8:11], a[72:75], v[212:215]
ds_read_b64_tr_b16 a[30:31], v13 offset:58048
v_mfma_f32_16x16x32_bf16 v[216:219], a[8:11], a[80:83], v[216:219]
L_pg9:
s_cbranch_execz L_vret
v_mfma_f32_16x16x32_bf16 v[216:219], a[12:15], a[84:87], v[216:219]
v_mfma_f32_16x16x32_bf16 v[220:223], a[12:15], a[92:95], v[220:223]
v_mfma_f32_16x16x32_bf16 v[220:223], a[8:11], a[88:91], v[220:223]
s_waitcnt vmcnt(16) lgkmcnt(0)
s_barrier
v_xor_b32 v13, 0x10000, v13
v_mfma_f32_16x16x32_bf16 v[224:227], a[16:19], a[64:67], v[224:227]
ds_read_b64_tr_b16 a[132:133], v13 offset:0
v_mfma_f32_16x16x32_bf16 v[224:227], a[20:23], a[68:71], v[224:227]
ds_read_b64_tr_b16 a[134:135], v13 offset:3584
v_mfma_f32_16x16x32_bf16 v[228:231], a[20:23], a[76:79], v[228:231]
ds_read_b64_tr_b16 a[136:137], v13 offset:7168
v_mfma_f32_16x16x32_bf16 v[228:231], a[16:19], a[72:75], v[228:231]
ds_read_b64_tr_b16 a[138:139], v13 offset:10752
v_mfma_f32_16x16x32_bf16 v[232:235], a[16:19], a[80:83], v[232:235]
ds_read_b64_tr_b16 a[140:141], v13 offset:32768
v_mfma_f32_16x16x32_bf16 v[232:235], a[20:23], a[84:87], v[232:235]
ds_read_b64_tr_b16 a[142:143], v13 offset:36352
v_mfma_f32_16x16x32_bf16 v[236:239], a[20:23], a[92:95], v[236:239]
ds_read_b64_tr_b16 a[144:145], v13 offset:39936
v_mfma_f32_16x16x32_bf16 v[236:239], a[16:19], a[88:91], v[236:239]
ds_read_b64_tr_b16 a[146:147], v13 offset:43520
v_mfma_f32_16x16x32_bf16 v[240:243], a[24:27], a[64:67], v[240:243]
v_mfma_f32_16x16x32_bf16 v[240:243], a[28:31], a[68:71], v[240:243]
v_mfma_f32_16x16x32_bf16 v[244:247], a[28:31], a[76:79], v[244:247]
v_mfma_f32_16x16x32_bf16 v[244:247], a[24:27], a[72:75], v[244:247]
v_mfma_f32_16x16x32_bf16 v[248:251], a[24:27], a[80:83], v[248:251]
v_mfma_f32_16x16x32_bf16 v[248:251], a[28:31], a[84:87], v[248:251]
v_mfma_f32_16x16x32_bf16 v[252:255], a[28:31], a[92:95], v[252:255]
v_mfma_f32_16x16x32_bf16 v[252:255], a[24:27], a[88:91], v[252:255]
s_waitcnt vmcnt(0) lgkmcnt(0)
v_mfma_f32_16x16x32_bf16 v[32:35], a[132:135], a[32:35], v[32:35]
ds_read_b64_tr_b16 a[148:149], v13 offset:14336
v_mfma_f32_16x16x32_bf16 v[32:35], a[136:139], a[36:39], v[32:35]
ds_read_b64_tr_b16 a[150:151], v13 offset:17920
v_mfma_f32_16x16x32_bf16 v[32:35], a[140:143], a[96:99], v[32:35]
s_add_u32 s94, s92, 0
v_mfma_f32_16x16x32_bf16 v[32:35], a[144:147], a[100:103], v[32:35]
ds_read_b64_tr_b16 a[152:153], v13 offset:21504
v_mfma_f32_16x16x32_bf16 v[36:39], a[144:147], a[108:111], v[36:39]
ds_read_b64_tr_b16 a[154:155], v13 offset:25088
v_mfma_f32_16x16x32_bf16 v[36:39], a[140:143], a[104:107], v[36:39]
s_xor_b32 s85, s94, 128
v_mfma_f32_16x16x32_bf16 v[36:39], a[136:139], a[44:47], v[36:39]
ds_read_b64_tr_b16 a[156:157], v13 offset:47104
v_mfma_f32_16x16x32_bf16 v[36:39], a[132:135], a[40:43], v[36:39]
ds_read_b64_tr_b16 a[158:159], v13 offset:50688
v_mul_f32 v32, v16, v32
v_mul_f32 v33, v16, v33
v_mul_f32 v34, v16, v34
v_mfma_f32_16x16x32_bf16 v[40:43], a[132:135], a[48:51], v[40:43]
s_add_u32 m0, s95, 0
v_mul_f32 v35, v16, v35
v_exp_f32 v32, v32
v_mfma_f32_16x16x32_bf16 v[40:43], a[136:139], a[52:55], v[40:43]
ds_read_b64_tr_b16 a[160:161], v13 offset:54272
v_exp_f32 v33, v33
v_mfma_f32_16x16x32_bf16 v[40:43], a[140:143], a[112:115], v[40:43]
ds_read_b64_tr_b16 a[162:163], v13 offset:57856
v_exp_f32 v34, v34
v_mfma_f32_16x16x32_bf16 v[40:43], a[144:147], a[116:119], v[40:43]
v_exp_f32 v35, v35
v_fma_f32 v32, v32, v24, v24
v_fma_f32 v33, v33, v24, v24
v_mfma_f32_16x16x32_bf16 v[44:47], a[144:147], a[124:127], v[44:47]
v_fma_f32 v34, v34, v24, v24
v_fma_f32 v35, v35, v24, v24
v_rcp_f32 v32, v32
v_mfma_f32_16x16x32_bf16 v[44:47], a[140:143], a[120:123], v[44:47]
buffer_load_dwordx4 v4, s[40:43], s85 offen offset:0 lds
v_rcp_f32 v33, v33
v_mfma_f32_16x16x32_bf16 v[44:47], a[136:139], a[60:63], v[44:47]
v_rcp_f32 v34, v34
v_rcp_f32 v35, v35
v_mfma_f32_16x16x32_bf16 v[44:47], a[132:135], a[56:59], v[44:47]
v_mul_f32 v36, v18, v36
v_mul_f32 v37, v18, v37
v_mul_f32 v38, v18, v38
s_waitcnt lgkmcnt(0)
v_mfma_f32_16x16x32_bf16 v[48:51], a[148:151], a[32:35], v[48:51]
ds_read_b64_tr_b16 a[164:165], v13 offset:32
v_mul_f32 v39, v18, v39
v_exp_f32 v36, v36
v_mfma_f32_16x16x32_bf16 v[48:51], a[152:155], a[36:39], v[48:51]
ds_read_b64_tr_b16 a[166:167], v13 offset:3616
v_exp_f32 v37, v37
v_mfma_f32_16x16x32_bf16 v[48:51], a[156:159], a[96:99], v[48:51]
buffer_load_dwordx4 v5, s[40:43], s85 offen offset:1024 lds
v_exp_f32 v38, v38
v_mfma_f32_16x16x32_bf16 v[48:51], a[160:163], a[100:103], v[48:51]
ds_read_b64_tr_b16 a[168:169], v13 offset:7200
v_exp_f32 v39, v39
v_fma_f32 v36, v36, v26, v26
v_mfma_f32_16x16x32_bf16 v[52:55], a[160:163], a[108:111], v[52:55]
ds_read_b64_tr_b16 a[170:171], v13 offset:10784
v_fma_f32 v37, v37, v26, v26
v_fma_f32 v38, v38, v26, v26
v_fma_f32 v39, v39, v26, v26
v_mfma_f32_16x16x32_bf16 v[52:55], a[156:159], a[104:107], v[52:55]
buffer_load_dwordx4 v6, s[40:43], s85 offen offset:2048 lds
v_rcp_f32 v36, v36
v_mfma_f32_16x16x32_bf16 v[52:55], a[152:155], a[44:47], v[52:55]
ds_read_b64_tr_b16 a[172:173], v13 offset:32800
v_rcp_f32 v37, v37
v_mfma_f32_16x16x32_bf16 v[52:55], a[148:151], a[40:43], v[52:55]
ds_read_b64_tr_b16 a[174:175], v13 offset:36384
v_rcp_f32 v38, v38
v_mfma_f32_16x16x32_bf16 v[56:59], a[148:151], a[48:51], v[56:59]
buffer_load_dwordx4 v7, s[40:43], s85 offen offset:3072 lds
v_rcp_f32 v39, v39
v_mul_f32 v40, v20, v40
v_mfma_f32_16x16x32_bf16 v[56:59], a[152:155], a[52:55], v[56:59]
ds_read_b64_tr_b16 a[176:177], v13 offset:39968
v_mul_f32 v41, v20, v41
v_mul_f32 v42, v20, v42
v_mul_f32 v43, v20, v43
v_mfma_f32_16x16x32_bf16 v[56:59], a[156:159], a[112:115], v[56:59]
ds_read_b64_tr_b16 a[178:179], v13 offset:43552
v_exp_f32 v40, v40
v_mfma_f32_16x16x32_bf16 v[56:59], a[160:163], a[116:119], v[56:59]
v_exp_f32 v41, v41
v_exp_f32 v42, v42
v_mfma_f32_16x16x32_bf16 v[60:63], a[160:163], a[124:127], v[60:63]
v_exp_f32 v43, v43
v_fma_f32 v40, v40, v28, v28
v_fma_f32 v41, v41, v28, v28
v_mfma_f32_16x16x32_bf16 v[60:63], a[156:159], a[120:123], v[60:63]
s_add_u32 m0, s95, 4096
v_fma_f32 v42, v42, v28, v28
v_fma_f32 v43, v43, v28, v28
v_mfma_f32_16x16x32_bf16 v[60:63], a[152:155], a[60:63], v[60:63]
v_rcp_f32 v40, v40
v_rcp_f32 v41, v41
v_mfma_f32_16x16x32_bf16 v[60:63], a[148:151], a[56:59], v[60:63]
v_rcp_f32 v42, v42
s_waitcnt lgkmcnt(0)
v_mfma_f32_16x16x32_bf16 v[64:67], a[164:167], a[32:35], v[64:67]
ds_read_b64_tr_b16 a[132:133], v13 offset:14368
v_rcp_f32 v43, v43
v_mul_f32 v44, v22, v44
v_mfma_f32_16x16x32_bf16 v[64:67], a[168:171], a[36:39], v[64:67]
ds_read_b64_tr_b16 a[134:135], v13 offset:17952
v_mul_f32 v45, v22, v45
v_mul_f32 v46, v22, v46
v_mul_f32 v47, v22, v47
v_mfma_f32_16x16x32_bf16 v[64:67], a[172:175], a[96:99], v[64:67]
buffer_load_dwordx4 v4, s[40:43], s94 offen offset:0 lds
v_exp_f32 v44, v44
v_mfma_f32_16x16x32_bf16 v[64:67], a[176:179], a[100:103], v[64:67]
ds_read_b64_tr_b16 a[136:137], v13 offset:21536
v_exp_f32 v45, v45
v_mfma_f32_16x16x32_bf16 v[68:71], a[176:179], a[108:111], v[68:71]
ds_read_b64_tr_b16 a[138:139], v13 offset:25120
v_exp_f32 v46, v46
v_mfma_f32_16x16x32_bf16 v[68:71], a[172:175], a[104:107], v[68:71]
buffer_load_dwordx4 v5, s[40:43], s94 offen offset:1024 lds
v_exp_f32 v47, v47
v_fma_f32 v44, v44, v30, v30
v_mfma_f32_16x16x32_bf16 v[68:71], a[168:171], a[44:47], v[68:71]
ds_read_b64_tr_b16 a[140:141], v13 offset:47136
v_fma_f32 v45, v45, v30, v30
v_fma_f32 v46, v46, v30, v30
v_fma_f32 v47, v47, v30, v30
v_mfma_f32_16x16x32_bf16 v[68:71], a[164:167], a[40:43], v[68:71]
ds_read_b64_tr_b16 a[142:143], v13 offset:50720
v_rcp_f32 v44, v44
v_mfma_f32_16x16x32_bf16 v[72:75], a[164:167], a[48:51], v[72:75]
buffer_load_dwordx4 v6, s[40:43], s94 offen offset:2048 lds
v_rcp_f32 v45, v45
v_mfma_f32_16x16x32_bf16 v[72:75], a[168:171], a[52:55], v[72:75]
ds_read_b64_tr_b16 a[144:145], v13 offset:54304
v_rcp_f32 v46, v46
v_mfma_f32_16x16x32_bf16 v[72:75], a[172:175], a[112:115], v[72:75]
ds_read_b64_tr_b16 a[146:147], v13 offset:57888
v_rcp_f32 v47, v47
v_mul_f32 v32, v32, v48
v_mfma_f32_16x16x32_bf16 v[72:75], a[176:179], a[116:119], v[72:75]
v_mul_f32 v33, v33, v49
v_mul_f32 v34, v34, v50
v_mul_f32 v35, v35, v51
v_mul_f32 v36, v36, v52
v_mfma_f32_16x16x32_bf16 v[76:79], a[176:179], a[124:127], v[76:79]
v_mul_f32 v37, v37, v53
v_mul_f32 v38, v38, v54
v_mul_f32 v39, v39, v55
v_cvt_pk_bf16_f32 v48, v32, v33
v_mfma_f32_16x16x32_bf16 v[76:79], a[172:175], a[120:123], v[76:79]
buffer_load_dwordx4 v7, s[40:43], s94 offen offset:3072 lds
v_cvt_pk_bf16_f32 v50, v36, v37
v_cvt_pk_bf16_f32 v49, v34, v35
v_cvt_pk_bf16_f32 v51, v38, v39
v_mfma_f32_16x16x32_bf16 v[76:79], a[168:171], a[60:63], v[76:79]
s_nop 0
v_permlane16_swap_b32 v48, v50
v_mfma_f32_16x16x32_bf16 v[76:79], a[164:167], a[56:59], v[76:79]
v_permlane16_swap_b32 v49, v51
buffer_store_dwordx4 v[48:51], v2, s[12:15], s96 offen offset:0 sc1
s_waitcnt lgkmcnt(0)
v_mfma_f32_16x16x32_bf16 v[80:83], a[132:135], a[32:35], v[80:83]
ds_read_b64_tr_b16 a[148:149], v13 offset:64
v_mul_f32 v40, v40, v56
v_mul_f32 v41, v41, v57
v_mul_f32 v42, v42, v58
v_mfma_f32_16x16x32_bf16 v[80:83], a[136:139], a[36:39], v[80:83]
ds_read_b64_tr_b16 a[150:151], v13 offset:3648
v_mul_f32 v43, v43, v59
v_mul_f32 v44, v44, v60
v_mul_f32 v45, v45, v61
v_mfma_f32_16x16x32_bf16 v[80:83], a[140:143], a[96:99], v[80:83]
s_add_u32 s94, s92, 917504
v_mul_f32 v46, v46, v62
v_mul_f32 v47, v47, v63
v_cvt_pk_bf16_f32 v56, v40, v41
v_mfma_f32_16x16x32_bf16 v[80:83], a[144:147], a[100:103], v[80:83]
ds_read_b64_tr_b16 a[152:153], v13 offset:7232
v_cvt_pk_bf16_f32 v58, v44, v45
v_cvt_pk_bf16_f32 v57, v42, v43
v_cvt_pk_bf16_f32 v59, v46, v47
v_mfma_f32_16x16x32_bf16 v[84:87], a[144:147], a[108:111], v[84:87]
ds_read_b64_tr_b16 a[154:155], v13 offset:10816
s_nop 0
v_permlane16_swap_b32 v56, v58
v_mfma_f32_16x16x32_bf16 v[84:87], a[140:143], a[104:107], v[84:87]
s_xor_b32 s85, s94, 128
v_permlane16_swap_b32 v57, v59
buffer_store_dwordx4 v[56:59], v3, s[12:15], s96 offen offset:0 sc1
v_mfma_f32_16x16x32_bf16 v[84:87], a[136:139], a[44:47], v[84:87]
ds_read_b64_tr_b16 a[156:157], v13 offset:32832
v_mul_f32 v64, v16, v64
v_mul_f32 v65, v16, v65
v_mul_f32 v66, v16, v66
v_mfma_f32_16x16x32_bf16 v[84:87], a[132:135], a[40:43], v[84:87]
ds_read_b64_tr_b16 a[158:159], v13 offset:36416
v_mul_f32 v67, v16, v67
v_exp_f32 v64, v64
v_mfma_f32_16x16x32_bf16 v[88:91], a[132:135], a[48:51], v[88:91]
s_add_u32 m0, s95, 32768
v_exp_f32 v65, v65
v_mfma_f32_16x16x32_bf16 v[88:91], a[136:139], a[52:55], v[88:91]
ds_read_b64_tr_b16 a[160:161], v13 offset:40000
v_exp_f32 v66, v66
v_mfma_f32_16x16x32_bf16 v[88:91], a[140:143], a[112:115], v[88:91]
ds_read_b64_tr_b16 a[162:163], v13 offset:43584
v_exp_f32 v67, v67
v_fma_f32 v64, v64, v24, v24
v_mfma_f32_16x16x32_bf16 v[88:91], a[144:147], a[116:119], v[88:91]
v_fma_f32 v65, v65, v24, v24
v_fma_f32 v66, v66, v24, v24
v_fma_f32 v67, v67, v24, v24
v_mfma_f32_16x16x32_bf16 v[92:95], a[144:147], a[124:127], v[92:95]
v_rcp_f32 v64, v64
v_rcp_f32 v65, v65
v_mfma_f32_16x16x32_bf16 v[92:95], a[140:143], a[120:123], v[92:95]
buffer_load_dwordx4 v4, s[40:43], s85 offen offset:0 lds
v_rcp_f32 v66, v66
v_mfma_f32_16x16x32_bf16 v[92:95], a[136:139], a[60:63], v[92:95]
v_rcp_f32 v67, v67
v_mul_f32 v68, v18, v68
v_mul_f32 v69, v18, v69
v_mfma_f32_16x16x32_bf16 v[92:95], a[132:135], a[56:59], v[92:95]
v_mul_f32 v70, v18, v70
v_mul_f32 v71, v18, v71
s_waitcnt lgkmcnt(0)
v_mfma_f32_16x16x32_bf16 v[96:99], a[148:151], a[32:35], v[96:99]
ds_read_b64_tr_b16 a[164:165], v13 offset:14400
v_exp_f32 v68, v68
v_mfma_f32_16x16x32_bf16 v[96:99], a[152:155], a[36:39], v[96:99]
ds_read_b64_tr_b16 a[166:167], v13 offset:17984
v_exp_f32 v69, v69
v_mfma_f32_16x16x32_bf16 v[96:99], a[156:159], a[96:99], v[96:99]
buffer_load_dwordx4 v5, s[40:43], s85 offen offset:1024 lds
v_exp_f32 v70, v70
v_mfma_f32_16x16x32_bf16 v[96:99], a[160:163], a[100:103], v[96:99]
ds_read_b64_tr_b16 a[168:169], v13 offset:21568
v_exp_f32 v71, v71
v_fma_f32 v68, v68, v26, v26
v_mfma_f32_16x16x32_bf16 v[100:103], a[160:163], a[108:111], v[100:103]
ds_read_b64_tr_b16 a[170:171], v13 offset:25152
v_fma_f32 v69, v69, v26, v26
v_fma_f32 v70, v70, v26, v26
v_fma_f32 v71, v71, v26, v26
v_mfma_f32_16x16x32_bf16 v[100:103], a[156:159], a[104:107], v[100:103]
buffer_load_dwordx4 v6, s[40:43], s85 offen offset:2048 lds
v_rcp_f32 v68, v68
v_mfma_f32_16x16x32_bf16 v[100:103], a[152:155], a[44:47], v[100:103]
ds_read_b64_tr_b16 a[172:173], v13 offset:47168
v_rcp_f32 v69, v69
v_mfma_f32_16x16x32_bf16 v[100:103], a[148:151], a[40:43], v[100:103]
ds_read_b64_tr_b16 a[174:175], v13 offset:50752
v_rcp_f32 v70, v70
v_mfma_f32_16x16x32_bf16 v[104:107], a[148:151], a[48:51], v[104:107]
buffer_load_dwordx4 v7, s[40:43], s85 offen offset:3072 lds
v_rcp_f32 v71, v71
v_mul_f32 v72, v20, v72
v_mfma_f32_16x16x32_bf16 v[104:107], a[152:155], a[52:55], v[104:107]
ds_read_b64_tr_b16 a[176:177], v13 offset:54336
v_mul_f32 v73, v20, v73
v_mul_f32 v74, v20, v74
v_mul_f32 v75, v20, v75
v_mfma_f32_16x16x32_bf16 v[104:107], a[156:159], a[112:115], v[104:107]
ds_read_b64_tr_b16 a[178:179], v13 offset:57920
v_exp_f32 v72, v72
v_mfma_f32_16x16x32_bf16 v[104:107], a[160:163], a[116:119], v[104:107]
v_exp_f32 v73, v73
v_exp_f32 v74, v74
v_mfma_f32_16x16x32_bf16 v[108:111], a[160:163], a[124:127], v[108:111]
v_exp_f32 v75, v75
v_fma_f32 v72, v72, v28, v28
v_fma_f32 v73, v73, v28, v28
v_mfma_f32_16x16x32_bf16 v[108:111], a[156:159], a[120:123], v[108:111]
s_add_u32 m0, s95, 36864
v_fma_f32 v74, v74, v28, v28
v_fma_f32 v75, v75, v28, v28
v_mfma_f32_16x16x32_bf16 v[108:111], a[152:155], a[60:63], v[108:111]
v_rcp_f32 v72, v72
v_rcp_f32 v73, v73
v_mfma_f32_16x16x32_bf16 v[108:111], a[148:151], a[56:59], v[108:111]
v_rcp_f32 v74, v74
s_waitcnt lgkmcnt(0)
v_mfma_f32_16x16x32_bf16 v[112:115], a[164:167], a[32:35], v[112:115]
ds_read_b64_tr_b16 a[132:133], v13 offset:96
v_rcp_f32 v75, v75
v_mul_f32 v76, v22, v76
v_mfma_f32_16x16x32_bf16 v[112:115], a[168:171], a[36:39], v[112:115]
ds_read_b64_tr_b16 a[134:135], v13 offset:3680
v_mul_f32 v77, v22, v77
v_mul_f32 v78, v22, v78
v_mul_f32 v79, v22, v79
v_mfma_f32_16x16x32_bf16 v[112:115], a[172:175], a[96:99], v[112:115]
buffer_load_dwordx4 v4, s[40:43], s94 offen offset:0 lds
v_exp_f32 v76, v76
v_mfma_f32_16x16x32_bf16 v[112:115], a[176:179], a[100:103], v[112:115]
ds_read_b64_tr_b16 a[136:137], v13 offset:7264
v_exp_f32 v77, v77
v_mfma_f32_16x16x32_bf16 v[116:119], a[176:179], a[108:111], v[116:119]
ds_read_b64_tr_b16 a[138:139], v13 offset:10848
v_exp_f32 v78, v78
v_mfma_f32_16x16x32_bf16 v[116:119], a[172:175], a[104:107], v[116:119]
buffer_load_dwordx4 v5, s[40:43], s94 offen offset:1024 lds
v_exp_f32 v79, v79
v_fma_f32 v76, v76, v30, v30
v_mfma_f32_16x16x32_bf16 v[116:119], a[168:171], a[44:47], v[116:119]
ds_read_b64_tr_b16 a[140:141], v13 offset:32864
v_fma_f32 v77, v77, v30, v30
v_fma_f32 v78, v78, v30, v30
v_fma_f32 v79, v79, v30, v30
v_mfma_f32_16x16x32_bf16 v[116:119], a[164:167], a[40:43], v[116:119]
ds_read_b64_tr_b16 a[142:143], v13 offset:36448
v_rcp_f32 v76, v76
v_mfma_f32_16x16x32_bf16 v[120:123], a[164:167], a[48:51], v[120:123]
buffer_load_dwordx4 v6, s[40:43], s94 offen offset:2048 lds
v_rcp_f32 v77, v77
v_mfma_f32_16x16x32_bf16 v[120:123], a[168:171], a[52:55], v[120:123]
ds_read_b64_tr_b16 a[144:145], v13 offset:40032
v_rcp_f32 v78, v78
v_mfma_f32_16x16x32_bf16 v[120:123], a[172:175], a[112:115], v[120:123]
ds_read_b64_tr_b16 a[146:147], v13 offset:43616
v_rcp_f32 v79, v79
v_mul_f32 v64, v64, v80
v_mfma_f32_16x16x32_bf16 v[120:123], a[176:179], a[116:119], v[120:123]
v_mul_f32 v65, v65, v81
v_mul_f32 v66, v66, v82
v_mul_f32 v67, v67, v83
v_mul_f32 v68, v68, v84
v_mfma_f32_16x16x32_bf16 v[124:127], a[176:179], a[124:127], v[124:127]
v_mul_f32 v69, v69, v85
v_mul_f32 v70, v70, v86
v_mul_f32 v71, v71, v87
v_cvt_pk_bf16_f32 v80, v64, v65
v_mfma_f32_16x16x32_bf16 v[124:127], a[172:175], a[120:123], v[124:127]
buffer_load_dwordx4 v7, s[40:43], s94 offen offset:3072 lds
v_cvt_pk_bf16_f32 v82, v68, v69
v_cvt_pk_bf16_f32 v81, v66, v67
v_cvt_pk_bf16_f32 v83, v70, v71
v_mfma_f32_16x16x32_bf16 v[124:127], a[168:171], a[60:63], v[124:127]
s_nop 0
v_permlane16_swap_b32 v80, v82
v_mfma_f32_16x16x32_bf16 v[124:127], a[164:167], a[56:59], v[124:127]
v_permlane16_swap_b32 v81, v83
buffer_store_dwordx4 v[80:83], v2, s[12:15], s96 offen offset:512 sc1
s_waitcnt lgkmcnt(0)
v_mfma_f32_16x16x32_bf16 v[128:131], a[132:135], a[32:35], v[128:131]
ds_read_b64_tr_b16 a[148:149], v13 offset:14432
v_mul_f32 v72, v72, v88
v_mul_f32 v73, v73, v89
v_mul_f32 v74, v74, v90
v_mfma_f32_16x16x32_bf16 v[128:131], a[136:139], a[36:39], v[128:131]
ds_read_b64_tr_b16 a[150:151], v13 offset:18016
v_mul_f32 v75, v75, v91
v_mul_f32 v76, v76, v92
v_mul_f32 v77, v77, v93
v_mfma_f32_16x16x32_bf16 v[128:131], a[140:143], a[96:99], v[128:131]
s_add_u32 s94, s92, 1835008
v_mul_f32 v78, v78, v94
v_mul_f32 v79, v79, v95
v_cvt_pk_bf16_f32 v88, v72, v73
v_mfma_f32_16x16x32_bf16 v[128:131], a[144:147], a[100:103], v[128:131]
ds_read_b64_tr_b16 a[152:153], v13 offset:21600
v_cvt_pk_bf16_f32 v90, v76, v77
v_cvt_pk_bf16_f32 v89, v74, v75
v_cvt_pk_bf16_f32 v91, v78, v79
v_mfma_f32_16x16x32_bf16 v[132:135], a[144:147], a[108:111], v[132:135]
ds_read_b64_tr_b16 a[154:155], v13 offset:25184
s_nop 0
v_permlane16_swap_b32 v88, v90
v_mfma_f32_16x16x32_bf16 v[132:135], a[140:143], a[104:107], v[132:135]
s_xor_b32 s85, s94, 128
v_permlane16_swap_b32 v89, v91
buffer_store_dwordx4 v[88:91], v3, s[12:15], s96 offen offset:512 sc1
v_mfma_f32_16x16x32_bf16 v[132:135], a[136:139], a[44:47], v[132:135]
ds_read_b64_tr_b16 a[156:157], v13 offset:47200
v_mul_f32 v96, v16, v96
v_mul_f32 v97, v16, v97
v_mul_f32 v98, v16, v98
v_mfma_f32_16x16x32_bf16 v[132:135], a[132:135], a[40:43], v[132:135]
ds_read_b64_tr_b16 a[158:159], v13 offset:50784
v_mul_f32 v99, v16, v99
v_exp_f32 v96, v96
v_mfma_f32_16x16x32_bf16 v[136:139], a[132:135], a[48:51], v[136:139]
s_add_u32 m0, s95, 131072
v_exp_f32 v97, v97
v_mfma_f32_16x16x32_bf16 v[136:139], a[136:139], a[52:55], v[136:139]
ds_read_b64_tr_b16 a[160:161], v13 offset:54368
v_exp_f32 v98, v98
v_mfma_f32_16x16x32_bf16 v[136:139], a[140:143], a[112:115], v[136:139]
ds_read_b64_tr_b16 a[162:163], v13 offset:57952
v_exp_f32 v99, v99
v_fma_f32 v96, v96, v24, v24
v_mfma_f32_16x16x32_bf16 v[136:139], a[144:147], a[116:119], v[136:139]
v_fma_f32 v97, v97, v24, v24
v_fma_f32 v98, v98, v24, v24
v_fma_f32 v99, v99, v24, v24
v_mfma_f32_16x16x32_bf16 v[140:143], a[144:147], a[124:127], v[140:143]
v_rcp_f32 v96, v96
v_rcp_f32 v97, v97
v_mfma_f32_16x16x32_bf16 v[140:143], a[140:143], a[120:123], v[140:143]
buffer_load_dwordx4 v4, s[40:43], s85 offen offset:0 lds
v_rcp_f32 v98, v98
v_mfma_f32_16x16x32_bf16 v[140:143], a[136:139], a[60:63], v[140:143]
v_rcp_f32 v99, v99
v_mul_f32 v100, v18, v100
v_mul_f32 v101, v18, v101
v_mfma_f32_16x16x32_bf16 v[140:143], a[132:135], a[56:59], v[140:143]
v_mul_f32 v102, v18, v102
v_mul_f32 v103, v18, v103
s_waitcnt lgkmcnt(0)
v_mfma_f32_16x16x32_bf16 v[144:147], a[148:151], a[32:35], v[144:147]
ds_read_b64_tr_b16 a[164:165], v13 offset:128
v_exp_f32 v100, v100
v_mfma_f32_16x16x32_bf16 v[144:147], a[152:155], a[36:39], v[144:147]
ds_read_b64_tr_b16 a[166:167], v13 offset:3712
v_exp_f32 v101, v101
v_mfma_f32_16x16x32_bf16 v[144:147], a[156:159], a[96:99], v[144:147]
buffer_load_dwordx4 v5, s[40:43], s85 offen offset:1024 lds
v_exp_f32 v102, v102
v_mfma_f32_16x16x32_bf16 v[144:147], a[160:163], a[100:103], v[144:147]
ds_read_b64_tr_b16 a[168:169], v13 offset:7296
v_exp_f32 v103, v103
v_fma_f32 v100, v100, v26, v26
v_mfma_f32_16x16x32_bf16 v[148:151], a[160:163], a[108:111], v[148:151]
ds_read_b64_tr_b16 a[170:171], v13 offset:10880
v_fma_f32 v101, v101, v26, v26
v_fma_f32 v102, v102, v26, v26
v_fma_f32 v103, v103, v26, v26
v_mfma_f32_16x16x32_bf16 v[148:151], a[156:159], a[104:107], v[148:151]
buffer_load_dwordx4 v6, s[40:43], s85 offen offset:2048 lds
v_rcp_f32 v100, v100
v_mfma_f32_16x16x32_bf16 v[148:151], a[152:155], a[44:47], v[148:151]
ds_read_b64_tr_b16 a[172:173], v13 offset:32896
v_rcp_f32 v101, v101
v_mfma_f32_16x16x32_bf16 v[148:151], a[148:151], a[40:43], v[148:151]
ds_read_b64_tr_b16 a[174:175], v13 offset:36480
v_rcp_f32 v102, v102
v_mfma_f32_16x16x32_bf16 v[152:155], a[148:151], a[48:51], v[152:155]
buffer_load_dwordx4 v7, s[40:43], s85 offen offset:3072 lds
v_rcp_f32 v103, v103
v_mul_f32 v104, v20, v104
v_mfma_f32_16x16x32_bf16 v[152:155], a[152:155], a[52:55], v[152:155]
ds_read_b64_tr_b16 a[176:177], v13 offset:40064
v_mul_f32 v105, v20, v105
v_mul_f32 v106, v20, v106
v_mul_f32 v107, v20, v107
v_mfma_f32_16x16x32_bf16 v[152:155], a[156:159], a[112:115], v[152:155]
ds_read_b64_tr_b16 a[178:179], v13 offset:43648
v_exp_f32 v104, v104
v_mfma_f32_16x16x32_bf16 v[152:155], a[160:163], a[116:119], v[152:155]
v_exp_f32 v105, v105
v_exp_f32 v106, v106
v_mfma_f32_16x16x32_bf16 v[156:159], a[160:163], a[124:127], v[156:159]
v_exp_f32 v107, v107
v_fma_f32 v104, v104, v28, v28
v_fma_f32 v105, v105, v28, v28
v_mfma_f32_16x16x32_bf16 v[156:159], a[156:159], a[120:123], v[156:159]
s_add_u32 m0, s95, 135168
v_fma_f32 v106, v106, v28, v28
v_fma_f32 v107, v107, v28, v28
v_mfma_f32_16x16x32_bf16 v[156:159], a[152:155], a[60:63], v[156:159]
v_rcp_f32 v104, v104
v_rcp_f32 v105, v105
v_mfma_f32_16x16x32_bf16 v[156:159], a[148:151], a[56:59], v[156:159]
v_rcp_f32 v106, v106
s_waitcnt lgkmcnt(0)
v_mfma_f32_16x16x32_bf16 v[160:163], a[164:167], a[32:35], v[160:163]
ds_read_b64_tr_b16 a[132:133], v13 offset:14464
v_rcp_f32 v107, v107
v_mul_f32 v108, v22, v108
v_mfma_f32_16x16x32_bf16 v[160:163], a[168:171], a[36:39], v[160:163]
ds_read_b64_tr_b16 a[134:135], v13 offset:18048
v_mul_f32 v109, v22, v109
v_mul_f32 v110, v22, v110
v_mul_f32 v111, v22, v111
v_mfma_f32_16x16x32_bf16 v[160:163], a[172:175], a[96:99], v[160:163]
buffer_load_dwordx4 v4, s[40:43], s94 offen offset:0 lds
v_exp_f32 v108, v108
v_mfma_f32_16x16x32_bf16 v[160:163], a[176:179], a[100:103], v[160:163]
ds_read_b64_tr_b16 a[136:137], v13 offset:21632
v_exp_f32 v109, v109
v_mfma_f32_16x16x32_bf16 v[164:167], a[176:179], a[108:111], v[164:167]
ds_read_b64_tr_b16 a[138:139], v13 offset:25216
v_exp_f32 v110, v110
v_mfma_f32_16x16x32_bf16 v[164:167], a[172:175], a[104:107], v[164:167]
buffer_load_dwordx4 v5, s[40:43], s94 offen offset:1024 lds
v_exp_f32 v111, v111
v_fma_f32 v108, v108, v30, v30
v_mfma_f32_16x16x32_bf16 v[164:167], a[168:171], a[44:47], v[164:167]
ds_read_b64_tr_b16 a[140:141], v13 offset:47232
v_fma_f32 v109, v109, v30, v30
v_fma_f32 v110, v110, v30, v30
v_fma_f32 v111, v111, v30, v30
v_mfma_f32_16x16x32_bf16 v[164:167], a[164:167], a[40:43], v[164:167]
ds_read_b64_tr_b16 a[142:143], v13 offset:50816
v_rcp_f32 v108, v108
v_mfma_f32_16x16x32_bf16 v[168:171], a[164:167], a[48:51], v[168:171]
buffer_load_dwordx4 v6, s[40:43], s94 offen offset:2048 lds
v_rcp_f32 v109, v109
v_mfma_f32_16x16x32_bf16 v[168:171], a[168:171], a[52:55], v[168:171]
ds_read_b64_tr_b16 a[144:145], v13 offset:54400
v_rcp_f32 v110, v110
v_mfma_f32_16x16x32_bf16 v[168:171], a[172:175], a[112:115], v[168:171]
ds_read_b64_tr_b16 a[146:147], v13 offset:57984
v_rcp_f32 v111, v111
v_mul_f32 v96, v96, v112
v_mfma_f32_16x16x32_bf16 v[168:171], a[176:179], a[116:119], v[168:171]
v_mul_f32 v97, v97, v113
v_mul_f32 v98, v98, v114
v_mul_f32 v99, v99, v115
v_mul_f32 v100, v100, v116
v_mfma_f32_16x16x32_bf16 v[172:175], a[176:179], a[124:127], v[172:175]
v_mul_f32 v101, v101, v117
v_mul_f32 v102, v102, v118
v_mul_f32 v103, v103, v119
v_cvt_pk_bf16_f32 v112, v96, v97
v_mfma_f32_16x16x32_bf16 v[172:175], a[172:175], a[120:123], v[172:175]
buffer_load_dwordx4 v7, s[40:43], s94 offen offset:3072 lds
v_cvt_pk_bf16_f32 v114, v100, v101
v_cvt_pk_bf16_f32 v113, v98, v99
v_cvt_pk_bf16_f32 v115, v102, v103
v_mfma_f32_16x16x32_bf16 v[172:175], a[168:171], a[60:63], v[172:175]
s_nop 0
v_permlane16_swap_b32 v112, v114
v_mfma_f32_16x16x32_bf16 v[172:175], a[164:167], a[56:59], v[172:175]
v_permlane16_swap_b32 v113, v115
buffer_store_dwordx4 v[112:115], v2, s[12:15], s97 offen offset:0 sc1
s_waitcnt lgkmcnt(0)
v_mfma_f32_16x16x32_bf16 v[176:179], a[132:135], a[32:35], v[176:179]
ds_read_b64_tr_b16 a[148:149], v13 offset:160
v_mul_f32 v104, v104, v120
v_mul_f32 v105, v105, v121
v_mul_f32 v106, v106, v122
v_mfma_f32_16x16x32_bf16 v[176:179], a[136:139], a[36:39], v[176:179]
ds_read_b64_tr_b16 a[150:151], v13 offset:3744
v_mul_f32 v107, v107, v123
v_mul_f32 v108, v108, v124
v_mul_f32 v109, v109, v125
v_mfma_f32_16x16x32_bf16 v[176:179], a[140:143], a[96:99], v[176:179]
v_mul_f32 v110, v110, v126
v_mul_f32 v111, v111, v127
v_cvt_pk_bf16_f32 v120, v104, v105
v_cvt_pk_bf16_f32 v122, v108, v109
v_mfma_f32_16x16x32_bf16 v[176:179], a[144:147], a[100:103], v[176:179]
ds_read_b64_tr_b16 a[152:153], v13 offset:7328
v_cvt_pk_bf16_f32 v121, v106, v107
v_cvt_pk_bf16_f32 v123, v110, v111
s_nop 0
v_mfma_f32_16x16x32_bf16 v[180:183], a[144:147], a[108:111], v[180:183]
ds_read_b64_tr_b16 a[154:155], v13 offset:10912
v_permlane16_swap_b32 v120, v122
v_mfma_f32_16x16x32_bf16 v[180:183], a[140:143], a[104:107], v[180:183]
v_permlane16_swap_b32 v121, v123
buffer_store_dwordx4 v[120:123], v3, s[12:15], s97 offen offset:0 sc1
v_mul_f32 v128, v16, v128
v_mfma_f32_16x16x32_bf16 v[180:183], a[136:139], a[44:47], v[180:183]
ds_read_b64_tr_b16 a[156:157], v13 offset:32928
v_mul_f32 v129, v16, v129
v_mul_f32 v130, v16, v130
v_mul_f32 v131, v16, v131
v_mfma_f32_16x16x32_bf16 v[180:183], a[132:135], a[40:43], v[180:183]
ds_read_b64_tr_b16 a[158:159], v13 offset:36512
v_exp_f32 v128, v128
v_mfma_f32_16x16x32_bf16 v[184:187], a[132:135], a[48:51], v[184:187]
v_exp_f32 v129, v129
v_exp_f32 v130, v130
v_mfma_f32_16x16x32_bf16 v[184:187], a[136:139], a[52:55], v[184:187]
ds_read_b64_tr_b16 a[160:161], v13 offset:40096
v_exp_f32 v131, v131
v_fma_f32 v128, v128, v24, v24
v_mfma_f32_16x16x32_bf16 v[184:187], a[140:143], a[112:115], v[184:187]
ds_read_b64_tr_b16 a[162:163], v13 offset:43680
v_fma_f32 v129, v129, v24, v24
v_fma_f32 v130, v130, v24, v24
v_fma_f32 v131, v131, v24, v24
v_mfma_f32_16x16x32_bf16 v[184:187], a[144:147], a[116:119], v[184:187]
v_rcp_f32 v128, v128
v_rcp_f32 v129, v129
v_mfma_f32_16x16x32_bf16 v[188:191], a[144:147], a[124:127], v[188:191]
s_waitcnt vmcnt(10)
v_mov_b32 v14, 4
buffer_store_dword v14, off, s[16:19], s100 sc1
v_mfma_f32_16x16x32_bf16 v[188:191], a[140:143], a[120:123], v[188:191]
v_rcp_f32 v130, v130
v_rcp_f32 v131, v131
v_mfma_f32_16x16x32_bf16 v[188:191], a[136:139], a[60:63], v[188:191]
v_mul_f32 v132, v18, v132
v_mul_f32 v133, v18, v133
v_mul_f32 v134, v18, v134
v_mul_f32 v135, v18, v135
v_mfma_f32_16x16x32_bf16 v[188:191], a[132:135], a[56:59], v[188:191]
v_exp_f32 v132, v132
s_waitcnt lgkmcnt(0)
v_mfma_f32_16x16x32_bf16 v[192:195], a[148:151], a[32:35], v[192:195]
ds_read_b64_tr_b16 a[164:165], v13 offset:14496
v_exp_f32 v133, v133
v_mfma_f32_16x16x32_bf16 v[192:195], a[152:155], a[36:39], v[192:195]
ds_read_b64_tr_b16 a[166:167], v13 offset:18080
L_pg10:
s_cbranch_execz L_vret
v_exp_f32 v134, v134
v_mfma_f32_16x16x32_bf16 v[192:195], a[156:159], a[96:99], v[192:195]
v_exp_f32 v135, v135
v_fma_f32 v132, v132, v26, v26
v_fma_f32 v133, v133, v26, v26
v_mfma_f32_16x16x32_bf16 v[192:195], a[160:163], a[100:103], v[192:195]
ds_read_b64_tr_b16 a[168:169], v13 offset:21664
v_fma_f32 v134, v134, v26, v26
v_fma_f32 v135, v135, v26, v26
v_mfma_f32_16x16x32_bf16 v[196:199], a[160:163], a[108:111], v[196:199]
ds_read_b64_tr_b16 a[170:171], v13 offset:25248
v_rcp_f32 v132, v132
v_mfma_f32_16x16x32_bf16 v[196:199], a[156:159], a[104:107], v[196:199]
v_rcp_f32 v133, v133
v_rcp_f32 v134, v134
v_mfma_f32_16x16x32_bf16 v[196:199], a[152:155], a[44:47], v[196:199]
ds_read_b64_tr_b16 a[172:173], v13 offset:47264
v_rcp_f32 v135, v135
v_mul_f32 v136, v20, v136
v_mfma_f32_16x16x32_bf16 v[196:199], a[148:151], a[40:43], v[196:199]
ds_read_b64_tr_b16 a[174:175], v13 offset:50848
v_mul_f32 v137, v20, v137
v_mul_f32 v138, v20, v138
v_mul_f32 v139, v20, v139
v_mfma_f32_16x16x32_bf16 v[200:203], a[148:151], a[48:51], v[200:203]
v_exp_f32 v136, v136
v_exp_f32 v137, v137
v_mfma_f32_16x16x32_bf16 v[200:203], a[152:155], a[52:55], v[200:203]
ds_read_b64_tr_b16 a[176:177], v13 offset:54432
v_exp_f32 v138, v138
v_mfma_f32_16x16x32_bf16 v[200:203], a[156:159], a[112:115], v[200:203]
ds_read_b64_tr_b16 a[178:179], v13 offset:58016
v_exp_f32 v139, v139
v_fma_f32 v136, v136, v28, v28
v_mfma_f32_16x16x32_bf16 v[200:203], a[160:163], a[116:119], v[200:203]
v_fma_f32 v137, v137, v28, v28
v_fma_f32 v138, v138, v28, v28
v_fma_f32 v139, v139, v28, v28
v_mfma_f32_16x16x32_bf16 v[204:207], a[160:163], a[124:127], v[204:207]
v_rcp_f32 v136, v136
v_rcp_f32 v137, v137
v_mfma_f32_16x16x32_bf16 v[204:207], a[156:159], a[120:123], v[204:207]
v_rcp_f32 v138, v138
v_rcp_f32 v139, v139
v_mfma_f32_16x16x32_bf16 v[204:207], a[152:155], a[60:63], v[204:207]
v_mul_f32 v140, v22, v140
v_mul_f32 v141, v22, v141
v_mul_f32 v142, v22, v142
v_mul_f32 v143, v22, v143
v_mfma_f32_16x16x32_bf16 v[204:207], a[148:151], a[56:59], v[204:207]
v_exp_f32 v140, v140
s_waitcnt lgkmcnt(0)
v_mfma_f32_16x16x32_bf16 v[208:211], a[164:167], a[32:35], v[208:211]
ds_read_b64_tr_b16 a[132:133], v13 offset:192
v_exp_f32 v141, v141
v_mfma_f32_16x16x32_bf16 v[208:211], a[168:171], a[36:39], v[208:211]
ds_read_b64_tr_b16 a[134:135], v13 offset:3776
v_exp_f32 v142, v142
v_mfma_f32_16x16x32_bf16 v[208:211], a[172:175], a[96:99], v[208:211]
v_exp_f32 v143, v143
v_fma_f32 v140, v140, v30, v30
v_fma_f32 v141, v141, v30, v30
v_mfma_f32_16x16x32_bf16 v[208:211], a[176:179], a[100:103], v[208:211]
ds_read_b64_tr_b16 a[136:137], v13 offset:7360
v_fma_f32 v142, v142, v30, v30
v_fma_f32 v143, v143, v30, v30
v_mfma_f32_16x16x32_bf16 v[212:215], a[176:179], a[108:111], v[212:215]
ds_read_b64_tr_b16 a[138:139], v13 offset:10944
v_rcp_f32 v140, v140
v_mfma_f32_16x16x32_bf16 v[212:215], a[172:175], a[104:107], v[212:215]
v_rcp_f32 v141, v141
v_rcp_f32 v142, v142
v_mfma_f32_16x16x32_bf16 v[212:215], a[168:171], a[44:47], v[212:215]
ds_read_b64_tr_b16 a[140:141], v13 offset:32960
v_rcp_f32 v143, v143
v_mul_f32 v128, v128, v144
v_mfma_f32_16x16x32_bf16 v[212:215], a[164:167], a[40:43], v[212:215]
ds_read_b64_tr_b16 a[142:143], v13 offset:36544
v_mul_f32 v129, v129, v145
v_mul_f32 v130, v130, v146
v_mul_f32 v131, v131, v147
v_mfma_f32_16x16x32_bf16 v[216:219], a[164:167], a[48:51], v[216:219]
v_mul_f32 v132, v132, v148
v_mul_f32 v133, v133, v149
v_mul_f32 v134, v134, v150
v_mul_f32 v135, v135, v151
v_mfma_f32_16x16x32_bf16 v[216:219], a[168:171], a[52:55], v[216:219]
ds_read_b64_tr_b16 a[144:145], v13 offset:40128
v_cvt_pk_bf16_f32 v144, v128, v129
v_cvt_pk_bf16_f32 v146, v132, v133
v_cvt_pk_bf16_f32 v145, v130, v131
v_mfma_f32_16x16x32_bf16 v[216:219], a[172:175], a[112:115], v[216:219]
ds_read_b64_tr_b16 a[146:147], v13 offset:43712
v_cvt_pk_bf16_f32 v147, v134, v135
s_nop 0
v_mfma_f32_16x16x32_bf16 v[216:219], a[176:179], a[116:119], v[216:219]
v_permlane16_swap_b32 v144, v146
v_permlane16_swap_b32 v145, v147
v_mfma_f32_16x16x32_bf16 v[220:223], a[176:179], a[124:127], v[220:223]
buffer_store_dwordx4 v[144:147], v2, s[12:15], s97 offen offset:512 sc1
v_mul_f32 v136, v136, v152
v_mul_f32 v137, v137, v153
v_mul_f32 v138, v138, v154
v_mfma_f32_16x16x32_bf16 v[220:223], a[172:175], a[120:123], v[220:223]
v_mul_f32 v139, v139, v155
v_mul_f32 v140, v140, v156
v_mul_f32 v141, v141, v157
v_mul_f32 v142, v142, v158
v_mfma_f32_16x16x32_bf16 v[220:223], a[168:171], a[60:63], v[220:223]
v_mul_f32 v143, v143, v159
v_cvt_pk_bf16_f32 v152, v136, v137
v_cvt_pk_bf16_f32 v154, v140, v141
v_cvt_pk_bf16_f32 v153, v138, v139
v_mfma_f32_16x16x32_bf16 v[220:223], a[164:167], a[56:59], v[220:223]
v_cvt_pk_bf16_f32 v155, v142, v143
s_nop 0
s_waitcnt lgkmcnt(0)
v_mfma_f32_16x16x32_bf16 v[224:227], a[132:135], a[32:35], v[224:227]
ds_read_b64_tr_b16 a[148:149], v13 offset:14528
v_permlane16_swap_b32 v152, v154
v_mfma_f32_16x16x32_bf16 v[224:227], a[136:139], a[36:39], v[224:227]
ds_read_b64_tr_b16 a[150:151], v13 offset:18112
v_permlane16_swap_b32 v153, v155
buffer_store_dwordx4 v[152:155], v3, s[12:15], s97 offen offset:512 sc1
v_mfma_f32_16x16x32_bf16 v[224:227], a[140:143], a[96:99], v[224:227]
v_mul_f32 v160, v16, v160
v_mul_f32 v161, v16, v161
v_mul_f32 v162, v16, v162
v_mul_f32 v163, v16, v163
v_mfma_f32_16x16x32_bf16 v[224:227], a[144:147], a[100:103], v[224:227]
ds_read_b64_tr_b16 a[152:153], v13 offset:21696
v_exp_f32 v160, v160
v_mfma_f32_16x16x32_bf16 v[228:231], a[144:147], a[108:111], v[228:231]
ds_read_b64_tr_b16 a[154:155], v13 offset:25280
v_exp_f32 v161, v161
v_mfma_f32_16x16x32_bf16 v[228:231], a[140:143], a[104:107], v[228:231]
v_exp_f32 v162, v162
v_exp_f32 v163, v163
v_mfma_f32_16x16x32_bf16 v[228:231], a[136:139], a[44:47], v[228:231]
ds_read_b64_tr_b16 a[156:157], v13 offset:47296
v_fma_f32 v160, v160, v24, v24
v_fma_f32 v161, v161, v24, v24
v_fma_f32 v162, v162, v24, v24
v_mfma_f32_16x16x32_bf16 v[228:231], a[132:135], a[40:43], v[228:231]
ds_read_b64_tr_b16 a[158:159], v13 offset:50880
v_fma_f32 v163, v163, v24, v24
v_rcp_f32 v160, v160
v_mfma_f32_16x16x32_bf16 v[232:235], a[132:135], a[48:51], v[232:235]
v_rcp_f32 v161, v161
v_rcp_f32 v162, v162
v_mfma_f32_16x16x32_bf16 v[232:235], a[136:139], a[52:55], v[232:235]
ds_read_b64_tr_b16 a[160:161], v13 offset:54464
v_rcp_f32 v163, v163
v_mul_f32 v164, v18, v164
v_mfma_f32_16x16x32_bf16 v[232:235], a[140:143], a[112:115], v[232:235]
ds_read_b64_tr_b16 a[162:163], v13 offset:58048
v_mul_f32 v165, v18, v165
v_mul_f32 v166, v18, v166
v_mul_f32 v167, v18, v167
v_mfma_f32_16x16x32_bf16 v[232:235], a[144:147], a[116:119], v[232:235]
v_exp_f32 v164, v164
v_exp_f32 v165, v165
v_mfma_f32_16x16x32_bf16 v[236:239], a[144:147], a[124:127], v[236:239]
v_exp_f32 v166, v166
v_exp_f32 v167, v167
v_mfma_f32_16x16x32_bf16 v[236:239], a[140:143], a[120:123], v[236:239]
v_fma_f32 v164, v164, v26, v26
v_fma_f32 v165, v165, v26, v26
v_fma_f32 v166, v166, v26, v26
v_fma_f32 v167, v167, v26, v26
v_mfma_f32_16x16x32_bf16 v[236:239], a[136:139], a[60:63], v[236:239]
v_rcp_f32 v164, v164
v_rcp_f32 v165, v165
v_mfma_f32_16x16x32_bf16 v[236:239], a[132:135], a[56:59], v[236:239]
v_rcp_f32 v166, v166
s_waitcnt lgkmcnt(0)
v_mfma_f32_16x16x32_bf16 v[240:243], a[148:151], a[32:35], v[240:243]
v_rcp_f32 v167, v167
v_mul_f32 v168, v20, v168
v_mul_f32 v169, v20, v169
v_mfma_f32_16x16x32_bf16 v[240:243], a[152:155], a[36:39], v[240:243]
v_mul_f32 v170, v20, v170
v_mul_f32 v171, v20, v171
v_exp_f32 v168, v168
v_mfma_f32_16x16x32_bf16 v[240:243], a[156:159], a[96:99], v[240:243]
v_exp_f32 v169, v169
v_exp_f32 v170, v170
v_mfma_f32_16x16x32_bf16 v[240:243], a[160:163], a[100:103], v[240:243]
v_exp_f32 v171, v171
v_fma_f32 v168, v168, v28, v28
v_fma_f32 v169, v169, v28, v28
v_mfma_f32_16x16x32_bf16 v[244:247], a[160:163], a[108:111], v[244:247]
v_fma_f32 v170, v170, v28, v28
v_fma_f32 v171, v171, v28, v28
v_rcp_f32 v168, v168
v_mfma_f32_16x16x32_bf16 v[244:247], a[156:159], a[104:107], v[244:247]
v_rcp_f32 v169, v169
v_rcp_f32 v170, v170
v_mfma_f32_16x16x32_bf16 v[244:247], a[152:155], a[44:47], v[244:247]
v_rcp_f32 v171, v171
v_mul_f32 v172, v22, v172
v_mul_f32 v173, v22, v173
v_mfma_f32_16x16x32_bf16 v[244:247], a[148:151], a[40:43], v[244:247]
v_mul_f32 v174, v22, v174
v_mul_f32 v175, v22, v175
v_exp_f32 v172, v172
v_mfma_f32_16x16x32_bf16 v[248:251], a[148:151], a[48:51], v[248:251]
v_exp_f32 v173, v173
v_exp_f32 v174, v174
v_mfma_f32_16x16x32_bf16 v[248:251], a[152:155], a[52:55], v[248:251]
v_exp_f32 v175, v175
v_fma_f32 v172, v172, v30, v30
v_fma_f32 v173, v173, v30, v30
v_mfma_f32_16x16x32_bf16 v[248:251], a[156:159], a[112:115], v[248:251]
v_fma_f32 v174, v174, v30, v30
v_fma_f32 v175, v175, v30, v30
v_rcp_f32 v172, v172
v_mfma_f32_16x16x32_bf16 v[248:251], a[160:163], a[116:119], v[248:251]
v_rcp_f32 v173, v173
v_rcp_f32 v174, v174
v_mfma_f32_16x16x32_bf16 v[252:255], a[160:163], a[124:127], v[252:255]
buffer_load_dword v12, v8, s[16:19], s101 offen sc1
v_rcp_f32 v175, v175
v_mul_f32 v160, v160, v176
v_mfma_f32_16x16x32_bf16 v[252:255], a[156:159], a[120:123], v[252:255]
v_mul_f32 v161, v161, v177
v_mul_f32 v162, v162, v178
v_mul_f32 v163, v163, v179
v_mul_f32 v164, v164, v180
v_mfma_f32_16x16x32_bf16 v[252:255], a[152:155], a[60:63], v[252:255]
v_mul_f32 v165, v165, v181
v_mul_f32 v166, v166, v182
v_mul_f32 v167, v167, v183
v_cvt_pk_bf16_f32 v176, v160, v161
v_mfma_f32_16x16x32_bf16 v[252:255], a[148:151], a[56:59], v[252:255]
v_cvt_pk_bf16_f32 v178, v164, v165
v_cvt_pk_bf16_f32 v177, v162, v163
v_cvt_pk_bf16_f32 v179, v166, v167
s_nop 0
v_permlane16_swap_b32 v176, v178
v_permlane16_swap_b32 v177, v179
buffer_store_dwordx4 v[176:179], v2, s[12:15], s98 offen offset:0 sc1
v_mul_f32 v168, v168, v184
v_mul_f32 v169, v169, v185
v_mul_f32 v170, v170, v186
v_mul_f32 v171, v171, v187
v_mul_f32 v172, v172, v188
v_mul_f32 v173, v173, v189
v_mul_f32 v174, v174, v190
v_mul_f32 v175, v175, v191
v_cvt_pk_bf16_f32 v184, v168, v169
v_cvt_pk_bf16_f32 v186, v172, v173
v_cvt_pk_bf16_f32 v185, v170, v171
v_cvt_pk_bf16_f32 v187, v174, v175
s_nop 0
v_permlane16_swap_b32 v184, v186
v_permlane16_swap_b32 v185, v187
buffer_store_dwordx4 v[184:187], v3, s[12:15], s98 offen offset:0 sc1
v_pk_mul_f32 v[192:193], v[192:193], v[16:17] op_sel_hi:[1,0]
v_pk_mul_f32 v[194:195], v[194:195], v[16:17] op_sel_hi:[1,0]
v_exp_f32 v192, v192
v_exp_f32 v193, v193
v_exp_f32 v194, v194
v_exp_f32 v195, v195
v_pk_fma_f32 v[192:193], v[192:193], v[24:25], v[24:25] op_sel_hi:[1,0,0]
v_pk_fma_f32 v[194:195], v[194:195], v[24:25], v[24:25] op_sel_hi:[1,0,0]
v_rcp_f32 v192, v192
v_rcp_f32 v193, v193
v_rcp_f32 v194, v194
v_rcp_f32 v195, v195
s_waitcnt vmcnt(2)
v_cmp_gt_u32 vcc, 4, v12
s_nop 0
s_cbranch_vccnz L_spin4
L_rdy4:
buffer_load_dwordx4 a[64:67], v1, s[12:15], s28 offen offset:0 sc1
v_pk_mul_f32 v[196:197], v[196:197], v[18:19] op_sel_hi:[1,0]
v_pk_mul_f32 v[198:199], v[198:199], v[18:19] op_sel_hi:[1,0]
v_exp_f32 v196, v196
v_exp_f32 v197, v197
v_exp_f32 v198, v198
v_exp_f32 v199, v199
v_pk_fma_f32 v[196:197], v[196:197], v[26:27], v[26:27] op_sel_hi:[1,0,0]
v_pk_fma_f32 v[198:199], v[198:199], v[26:27], v[26:27] op_sel_hi:[1,0,0]
buffer_load_dwordx4 a[68:71], v1, s[12:15], s28 offen offset:1024 sc1
v_rcp_f32 v196, v196
v_rcp_f32 v197, v197
v_rcp_f32 v198, v198
v_rcp_f32 v199, v199
v_pk_mul_f32 v[200:201], v[200:201], v[20:21] op_sel_hi:[1,0]
v_pk_mul_f32 v[202:203], v[202:203], v[20:21] op_sel_hi:[1,0]
v_exp_f32 v200, v200
buffer_load_dwordx4 a[72:75], v15, s[12:15], s28 offen offset:0 sc1
v_exp_f32 v201, v201
v_exp_f32 v202, v202
v_exp_f32 v203, v203
v_pk_fma_f32 v[200:201], v[200:201], v[28:29], v[28:29] op_sel_hi:[1,0,0]
v_pk_fma_f32 v[202:203], v[202:203], v[28:29], v[28:29] op_sel_hi:[1,0,0]
v_rcp_f32 v200, v200
v_rcp_f32 v201, v201
v_rcp_f32 v202, v202
buffer_load_dwordx4 a[76:79], v15, s[12:15], s28 offen offset:1024 sc1
v_rcp_f32 v203, v203
v_pk_mul_f32 v[204:205], v[204:205], v[22:23] op_sel_hi:[1,0]
v_pk_mul_f32 v[206:207], v[206:207], v[22:23] op_sel_hi:[1,0]
v_exp_f32 v204, v204
v_exp_f32 v205, v205
v_exp_f32 v206, v206
v_exp_f32 v207, v207
buffer_load_dwordx4 a[80:83], v1, s[12:15], s28 offen offset:2048 sc1
v_pk_fma_f32 v[204:205], v[204:205], v[30:31], v[30:31] op_sel_hi:[1,0,0]
v_pk_fma_f32 v[206:207], v[206:207], v[30:31], v[30:31] op_sel_hi:[1,0,0]
v_rcp_f32 v204, v204
v_rcp_f32 v205, v205
v_rcp_f32 v206, v206
v_rcp_f32 v207, v207
v_pk_mul_f32 v[192:193], v[192:193], v[208:209]
v_pk_mul_f32 v[194:195], v[194:195], v[210:211]
buffer_load_dwordx4 a[84:87], v1, s[12:15], s28 offen offset:3072 sc1
v_pk_mul_f32 v[196:197], v[196:197], v[212:213]
v_pk_mul_f32 v[198:199], v[198:199], v[214:215]
v_cvt_pk_bf16_f32 v208, v192, v193
v_cvt_pk_bf16_f32 v210, v196, v197
v_cvt_pk_bf16_f32 v209, v194, v195
v_cvt_pk_bf16_f32 v211, v198, v199
s_nop 0
buffer_load_dwordx4 a[88:91], v15, s[12:15], s28 offen offset:2048 sc1
v_permlane16_swap_b32 v208, v210
v_permlane16_swap_b32 v209, v211
buffer_store_dwordx4 v[208:211], v2, s[12:15], s98 offen offset:512 sc1
v_pk_mul_f32 v[200:201], v[200:201], v[216:217]
v_pk_mul_f32 v[202:203], v[202:203], v[218:219]
v_pk_mul_f32 v[204:205], v[204:205], v[220:221]
v_pk_mul_f32 v[206:207], v[206:207], v[222:223]
v_cvt_pk_bf16_f32 v216, v200, v201
buffer_load_dwordx4 a[92:95], v15, s[12:15], s28 offen offset:3072 sc1
v_cvt_pk_bf16_f32 v218, v204, v205
v_cvt_pk_bf16_f32 v217, v202, v203
v_cvt_pk_bf16_f32 v219, v206, v207
s_nop 0
v_permlane16_swap_b32 v216, v218
v_permlane16_swap_b32 v217, v219
buffer_store_dwordx4 v[216:219], v3, s[12:15], s98 offen offset:512 sc1
s_add_u32 s28, s28, 4096
buffer_load_dwordx4 a[0:3], v1, s[12:15], s28 offen offset:0 sc1
v_pk_mul_f32 v[224:225], v[224:225], v[16:17] op_sel_hi:[1,0]
v_pk_mul_f32 v[226:227], v[226:227], v[16:17] op_sel_hi:[1,0]
v_exp_f32 v224, v224
v_exp_f32 v225, v225
v_exp_f32 v226, v226
v_exp_f32 v227, v227
v_pk_fma_f32 v[224:225], v[224:225], v[24:25], v[24:25] op_sel_hi:[1,0,0]
v_pk_fma_f32 v[226:227], v[226:227], v[24:25], v[24:25] op_sel_hi:[1,0,0]
buffer_load_dwordx4 a[4:7], v1, s[12:15], s28 offen offset:1024 sc1
v_rcp_f32 v224, v224
v_rcp_f32 v225, v225
v_rcp_f32 v226, v226
v_rcp_f32 v227, v227
v_pk_mul_f32 v[228:229], v[228:229], v[18:19] op_sel_hi:[1,0]
v_pk_mul_f32 v[230:231], v[230:231], v[18:19] op_sel_hi:[1,0]
v_exp_f32 v228, v228
buffer_load_dwordx4 a[8:11], v15, s[12:15], s28 offen offset:0 sc1
v_exp_f32 v229, v229
v_exp_f32 v230, v230
v_exp_f32 v231, v231
v_pk_fma_f32 v[228:229], v[228:229], v[26:27], v[26:27] op_sel_hi:[1,0,0]
v_pk_fma_f32 v[230:231], v[230:231], v[26:27], v[26:27] op_sel_hi:[1,0,0]
v_rcp_f32 v228, v228
v_rcp_f32 v229, v229
v_rcp_f32 v230, v230
buffer_load_dwordx4 a[12:15], v15, s[12:15], s28 offen offset:1024 sc1
v_rcp_f32 v231, v231
v_pk_mul_f32 v[232:233], v[232:233], v[20:21] op_sel_hi:[1,0]
v_pk_mul_f32 v[234:235], v[234:235], v[20:21] op_sel_hi:[1,0]
v_exp_f32 v232, v232
v_exp_f32 v233, v233
v_exp_f32 v234, v234
v_exp_f32 v235, v235
buffer_load_dwordx4 a[16:19], v1, s[12:15], s28 offen offset:2048 sc1
v_pk_fma_f32 v[232:233], v[232:233], v[28:29], v[28:29] op_sel_hi:[1,0,0]
v_pk_fma_f32 v[234:235], v[234:235], v[28:29], v[28:29] op_sel_hi:[1,0,0]
v_rcp_f32 v232, v232
v_rcp_f32 v233, v233
v_rcp_f32 v234, v234
v_rcp_f32 v235, v235
v_pk_mul_f32 v[236:237], v[236:237], v[22:23] op_sel_hi:[1,0]
v_pk_mul_f32 v[238:239], v[238:239], v[22:23] op_sel_hi:[1,0]
buffer_load_dwordx4 a[20:23], v1, s[12:15], s28 offen offset:3072 sc1
v_exp_f32 v236, v236
v_exp_f32 v237, v237
v_exp_f32 v238, v238
v_exp_f32 v239, v239
v_pk_fma_f32 v[236:237], v[236:237], v[30:31], v[30:31] op_sel_hi:[1,0,0]
v_pk_fma_f32 v[238:239], v[238:239], v[30:31], v[30:31] op_sel_hi:[1,0,0]
v_rcp_f32 v236, v236
buffer_load_dwordx4 a[24:27], v15, s[12:15], s28 offen offset:2048 sc1
v_rcp_f32 v237, v237
v_rcp_f32 v238, v238
v_rcp_f32 v239, v239
v_pk_mul_f32 v[224:225], v[224:225], v[240:241]
v_pk_mul_f32 v[226:227], v[226:227], v[242:243]
v_pk_mul_f32 v[228:229], v[228:229], v[244:245]
v_pk_mul_f32 v[230:231], v[230:231], v[246:247]
v_cvt_pk_bf16_f32 v240, v224, v225
buffer_load_dwordx4 a[28:31], v15, s[12:15], s28 offen offset:3072 sc1
v_cvt_pk_bf16_f32 v242, v228, v229
v_cvt_pk_bf16_f32 v241, v226, v227
v_cvt_pk_bf16_f32 v243, v230, v231
s_nop 0
v_permlane16_swap_b32 v240, v242
v_permlane16_swap_b32 v241, v243
buffer_store_dwordx4 v[240:243], v2, s[12:15], s99 offen offset:0 sc1
v_pk_mul_f32 v[232:233], v[232:233], v[248:249]
v_pk_mul_f32 v[234:235], v[234:235], v[250:251]
v_pk_mul_f32 v[236:237], v[236:237], v[252:253]
v_pk_mul_f32 v[238:239], v[238:239], v[254:255]
v_cvt_pk_bf16_f32 v248, v232, v233
v_cvt_pk_bf16_f32 v250, v236, v237
v_cvt_pk_bf16_f32 v249, v234, v235
v_cvt_pk_bf16_f32 v251, v238, v239
s_nop 0
v_permlane16_swap_b32 v248, v250
v_permlane16_swap_b32 v249, v251
buffer_store_dwordx4 v[248:251], v3, s[12:15], s99 offen offset:0 sc1
v_mov_b32 v14, 5
buffer_store_dword v14, off, s[16:19], s100 sc1
L_ph4:
v_accvgpr_read_b32 v16, a216
v_accvgpr_read_b32 v17, a217
v_accvgpr_read_b32 v18, a218
v_accvgpr_read_b32 v19, a219
v_accvgpr_read_b32 v28, a220
v_accvgpr_read_b32 v29, a221
s_add_u32 s27, s95, 65536
v_add_u32 v20, s27, v9
s_barrier
ds_read_b64_tr_b16 a[132:133], v16 offset:0
ds_read_b64_tr_b16 a[134:135], v16 offset:2048
ds_read_b64_tr_b16 a[136:137], v16 offset:8192
ds_read_b64_tr_b16 a[138:139], v16 offset:10240
ds_read_b64_tr_b16 a[140:141], v17 offset:0
ds_read_b64_tr_b16 a[142:143], v17 offset:2048
ds_read_b64_tr_b16 a[144:145], v17 offset:8192
ds_read_b64_tr_b16 a[146:147], v17 offset:10240
ds_read_b64_tr_b16 a[148:149], v18 offset:0
ds_read_b64_tr_b16 a[150:151], v18 offset:2048
ds_read_b64_tr_b16 a[152:153], v18 offset:8192
ds_read_b64_tr_b16 a[154:155], v18 offset:10240
s_waitcnt vmcnt(17) lgkmcnt(8)
v_mfma_f32_16x16x32_bf16 v[32:35], a[132:135], a[64:67], 0
ds_read_b64_tr_b16 a[156:157], v19 offset:0
s_add_u32 s94, s92, 2752512
v_mfma_f32_16x16x32_bf16 v[32:35], a[136:139], a[68:71], v[32:35]
ds_read_b64_tr_b16 a[158:159], v19 offset:2048
s_xor_b32 s85, s94, 128
v_mfma_f32_16x16x32_bf16 v[36:39], a[136:139], a[76:79], 0
ds_read_b64_tr_b16 a[160:161], v19 offset:8192
s_add_u32 m0, s95, 65536
v_mfma_f32_16x16x32_bf16 v[36:39], a[132:135], a[72:75], v[36:39]
ds_read_b64_tr_b16 a[162:163], v19 offset:10240
s_waitcnt lgkmcnt(8)
v_mfma_f32_16x16x32_bf16 v[40:43], a[140:143], a[64:67], 0
ds_read_b64_tr_b16 a[132:133], v16 offset:4096
buffer_load_dwordx4 v4, s[40:43], s85 offen offset:0 lds
v_mfma_f32_16x16x32_bf16 v[40:43], a[144:147], a[68:71], v[40:43]
ds_read_b64_tr_b16 a[134:135], v16 offset:6144
v_mfma_f32_16x16x32_bf16 v[44:47], a[144:147], a[76:79], 0
ds_read_b64_tr_b16 a[136:137], v16 offset:12288
v_mfma_f32_16x16x32_bf16 v[44:47], a[140:143], a[72:75], v[44:47]
ds_read_b64_tr_b16 a[138:139], v16 offset:14336
s_waitcnt lgkmcnt(8)
v_mfma_f32_16x16x32_bf16 v[48:51], a[148:151], a[64:67], 0
ds_read_b64_tr_b16 a[140:141], v17 offset:4096
buffer_load_dwordx4 v5, s[40:43], s85 offen offset:1024 lds
v_mfma_f32_16x16x32_bf16 v[48:51], a[152:155], a[68:71], v[48:51]
ds_read_b64_tr_b16 a[142:143], v17 offset:6144
v_mfma_f32_16x16x32_bf16 v[52:55], a[152:155], a[76:79], 0
ds_read_b64_tr_b16 a[144:145], v17 offset:12288
v_mfma_f32_16x16x32_bf16 v[52:55], a[148:151], a[72:75], v[52:55]
ds_read_b64_tr_b16 a[146:147], v17 offset:14336
s_waitcnt lgkmcnt(8)
v_mfma_f32_16x16x32_bf16 v[56:59], a[156:159], a[64:67], 0
ds_read_b64_tr_b16 a[148:149], v18 offset:4096
v_mfma_f32_16x16x32_bf16 v[56:59], a[160:163], a[68:71], v[56:59]
ds_read_b64_tr_b16 a[150:151], v18 offset:6144
v_mfma_f32_16x16x32_bf16 v[60:63], a[160:163], a[76:79], 0
ds_read_b64_tr_b16 a[152:153], v18 offset:12288
v_mfma_f32_16x16x32_bf16 v[60:63], a[156:159], a[72:75], v[60:63]
ds_read_b64_tr_b16 a[154:155], v18 offset:14336
s_waitcnt lgkmcnt(8)
v_mfma_f32_16x16x32_bf16 v[64:67], a[132:135], a[64:67], 0
ds_read_b64_tr_b16 a[156:157], v19 offset:4096
v_mfma_f32_16x16x32_bf16 v[64:67], a[136:139], a[68:71], v[64:67]
ds_read_b64_tr_b16 a[158:159], v19 offset:6144
buffer_load_dwordx4 v6, s[40:43], s85 offen offset:2048 lds
v_mfma_f32_16x16x32_bf16 v[68:71], a[136:139], a[76:79], 0
ds_read_b64_tr_b16 a[160:161], v19 offset:12288
v_mfma_f32_16x16x32_bf16 v[68:71], a[132:135], a[72:75], v[68:71]
ds_read_b64_tr_b16 a[162:163], v19 offset:14336
s_waitcnt lgkmcnt(8)
v_mfma_f32_16x16x32_bf16 v[72:75], a[140:143], a[64:67], 0
ds_read_b64_tr_b16 a[132:133], v16 offset:16384
v_mfma_f32_16x16x32_bf16 v[72:75], a[144:147], a[68:71], v[72:75]
ds_read_b64_tr_b16 a[134:135], v16 offset:18432
v_mfma_f32_16x16x32_bf16 v[76:79], a[144:147], a[76:79], 0
ds_read_b64_tr_b16 a[136:137], v16 offset:24576
v_mfma_f32_16x16x32_bf16 v[76:79], a[140:143], a[72:75], v[76:79]
ds_read_b64_tr_b16 a[138:139], v16 offset:26624
s_waitcnt lgkmcnt(8)
v_mfma_f32_16x16x32_bf16 v[80:83], a[148:151], a[64:67], 0
ds_read_b64_tr_b16 a[140:141], v17 offset:16384
v_mfma_f32_16x16x32_bf16 v[80:83], a[152:155], a[68:71], v[80:83]
ds_read_b64_tr_b16 a[142:143], v17 offset:18432
v_mfma_f32_16x16x32_bf16 v[84:87], a[152:155], a[76:79], 0
ds_read_b64_tr_b16 a[144:145], v17 offset:24576
buffer_load_dwordx4 v7, s[40:43], s85 offen offset:3072 lds
v_mfma_f32_16x16x32_bf16 v[84:87], a[148:151], a[72:75], v[84:87]
ds_read_b64_tr_b16 a[146:147], v17 offset:26624
s_waitcnt lgkmcnt(8)
v_mfma_f32_16x16x32_bf16 v[88:91], a[156:159], a[64:67], 0
ds_read_b64_tr_b16 a[148:149], v18 offset:16384
v_mfma_f32_16x16x32_bf16 v[88:91], a[160:163], a[68:71], v[88:91]
ds_read_b64_tr_b16 a[150:151], v18 offset:18432
v_mfma_f32_16x16x32_bf16 v[92:95], a[160:163], a[76:79], 0
ds_read_b64_tr_b16 a[152:153], v18 offset:24576
v_mfma_f32_16x16x32_bf16 v[92:95], a[156:159], a[72:75], v[92:95]
ds_read_b64_tr_b16 a[154:155], v18 offset:26624
s_waitcnt vmcnt(16) lgkmcnt(8)
v_mfma_f32_16x16x32_bf16 v[32:35], a[132:135], a[80:83], v[32:35]
ds_read_b64_tr_b16 a[156:157], v19 offset:16384
v_mfma_f32_16x16x32_bf16 v[32:35], a[136:139], a[84:87], v[32:35]
ds_read_b64_tr_b16 a[158:159], v19 offset:18432
s_add_u32 s28, s28, 12288
v_mfma_f32_16x16x32_bf16 v[36:39], a[136:139], a[92:95], v[36:39]
ds_read_b64_tr_b16 a[160:161], v19 offset:24576
buffer_load_dwordx4 a[32:35], v1, s[12:15], s28 offen offset:0 sc1
v_mfma_f32_16x16x32_bf16 v[36:39], a[132:135], a[88:91], v[36:39]
ds_read_b64_tr_b16 a[162:163], v19 offset:26624
s_waitcnt lgkmcnt(8)
v_mfma_f32_16x16x32_bf16 v[40:43], a[140:143], a[80:83], v[40:43]
ds_read_b64_tr_b16 a[132:133], v16 offset:20480
s_add_u32 m0, s95, 69632
v_mfma_f32_16x16x32_bf16 v[40:43], a[144:147], a[84:87], v[40:43]
ds_read_b64_tr_b16 a[134:135], v16 offset:22528
buffer_load_dwordx4 v4, s[40:43], s94 offen offset:0 lds
v_mfma_f32_16x16x32_bf16 v[44:47], a[144:147], a[92:95], v[44:47]
ds_read_b64_tr_b16 a[136:137], v16 offset:28672
v_mfma_f32_16x16x32_bf16 v[44:47], a[140:143], a[88:91], v[44:47]
ds_read_b64_tr_b16 a[138:139], v16 offset:30720
s_waitcnt lgkmcnt(8)
v_mfma_f32_16x16x32_bf16 v[48:51], a[148:151], a[80:83], v[48:51]
ds_read_b64_tr_b16 a[140:141], v17 offset:20480
v_mfma_f32_16x16x32_bf16 v[48:51], a[152:155], a[84:87], v[48:51]
ds_read_b64_tr_b16 a[142:143], v17 offset:22528
buffer_load_dwordx4 a[36:39], v1, s[12:15], s28 offen offset:1024 sc1
v_mfma_f32_16x16x32_bf16 v[52:55], a[152:155], a[92:95], v[52:55]
ds_read_b64_tr_b16 a[144:145], v17 offset:28672
v_mfma_f32_16x16x32_bf16 v[52:55], a[148:151], a[88:91], v[52:55]
ds_read_b64_tr_b16 a[146:147], v17 offset:30720
s_waitcnt lgkmcnt(8)
v_mfma_f32_16x16x32_bf16 v[56:59], a[156:159], a[80:83], v[56:59]
ds_read_b64_tr_b16 a[148:149], v18 offset:20480
buffer_load_dwordx4 v5, s[40:43], s94 offen offset:1024 lds
v_mfma_f32_16x16x32_bf16 v[56:59], a[160:163], a[84:87], v[56:59]
ds_read_b64_tr_b16 a[150:151], v18 offset:22528
v_mfma_f32_16x16x32_bf16 v[60:63], a[160:163], a[92:95], v[60:63]
ds_read_b64_tr_b16 a[152:153], v18 offset:28672
s_add_u32 s53, s55, 65536
v_mfma_f32_16x16x32_bf16 v[60:63], a[156:159], a[88:91], v[60:63]
ds_read_b64_tr_b16 a[154:155], v18 offset:30720
s_waitcnt lgkmcnt(8)
v_mfma_f32_16x16x32_bf16 v[64:67], a[132:135], a[80:83], v[64:67]
ds_read_b64_tr_b16 a[156:157], v19 offset:20480
buffer_load_dword a250, v28, s[40:43], s53 offen
v_mfma_f32_16x16x32_bf16 v[64:67], a[136:139], a[84:87], v[64:67]
ds_read_b64_tr_b16 a[158:159], v19 offset:22528
buffer_load_dwordx4 a[40:43], v15, s[12:15], s28 offen offset:0 sc1
v_mfma_f32_16x16x32_bf16 v[68:71], a[136:139], a[92:95], v[68:71]
ds_read_b64_tr_b16 a[160:161], v19 offset:28672
v_mfma_f32_16x16x32_bf16 v[68:71], a[132:135], a[88:91], v[68:71]
ds_read_b64_tr_b16 a[162:163], v19 offset:30720
s_barrier
s_waitcnt lgkmcnt(8)
v_mfma_f32_16x16x32_bf16 v[72:75], a[140:143], a[80:83], v[72:75]
ds_read_b64_tr_b16 a[132:133], v16 offset:32768
v_mfma_f32_16x16x32_bf16 v[72:75], a[144:147], a[84:87], v[72:75]
ds_read_b64_tr_b16 a[134:135], v16 offset:34816
buffer_load_dwordx4 v6, s[40:43], s94 offen offset:2048 lds
v_mfma_f32_16x16x32_bf16 v[76:79], a[144:147], a[92:95], v[76:79]
ds_read_b64_tr_b16 a[136:137], v16 offset:40960
v_mfma_f32_16x16x32_bf16 v[76:79], a[140:143], a[88:91], v[76:79]
ds_read_b64_tr_b16 a[138:139], v16 offset:43008
s_waitcnt lgkmcnt(8)
v_mfma_f32_16x16x32_bf16 v[80:83], a[148:151], a[80:83], v[80:83]
ds_read_b64_tr_b16 a[140:141], v17 offset:32768
v_mfma_f32_16x16x32_bf16 v[80:83], a[152:155], a[84:87], v[80:83]
ds_read_b64_tr_b16 a[142:143], v17 offset:34816
buffer_load_dwordx4 a[44:47], v15, s[12:15], s28 offen offset:1024 sc1
v_mfma_f32_16x16x32_bf16 v[84:87], a[152:155], a[92:95], v[84:87]
ds_read_b64_tr_b16 a[144:145], v17 offset:40960
v_mfma_f32_16x16x32_bf16 v[84:87], a[148:151], a[88:91], v[84:87]
ds_read_b64_tr_b16 a[146:147], v17 offset:43008
s_waitcnt lgkmcnt(8)
v_mfma_f32_16x16x32_bf16 v[88:91], a[156:159], a[80:83], v[88:91]
ds_read_b64_tr_b16 a[148:149], v18 offset:32768
v_mfma_f32_16x16x32_bf16 v[88:91], a[160:163], a[84:87], v[88:91]
ds_read_b64_tr_b16 a[150:151], v18 offset:34816
v_mfma_f32_16x16x32_bf16 v[92:95], a[160:163], a[92:95], v[92:95]
ds_read_b64_tr_b16 a[152:153], v18 offset:40960
buffer_load_dwordx4 v7, s[40:43], s94 offen offset:3072 lds
v_mfma_f32_16x16x32_bf16 v[92:95], a[156:159], a[88:91], v[92:95]
ds_read_b64_tr_b16 a[154:155], v18 offset:43008
s_waitcnt vmcnt(20) lgkmcnt(8)
v_mfma_f32_16x16x32_bf16 v[32:35], a[132:135], a[0:3], v[32:35]
ds_read_b64_tr_b16 a[156:157], v19 offset:32768
v_mfma_f32_16x16x32_bf16 v[32:35], a[136:139], a[4:7], v[32:35]
ds_read_b64_tr_b16 a[158:159], v19 offset:34816
buffer_load_dwordx4 a[64:67], v1, s[12:15], s28 offen offset:2048 sc1
v_mfma_f32_16x16x32_bf16 v[36:39], a[136:139], a[12:15], v[36:39]
ds_read_b64_tr_b16 a[160:161], v19 offset:40960
v_mfma_f32_16x16x32_bf16 v[36:39], a[132:135], a[8:11], v[36:39]
ds_read_b64_tr_b16 a[162:163], v19 offset:43008
s_waitcnt lgkmcnt(8)
v_mfma_f32_16x16x32_bf16 v[40:43], a[140:143], a[0:3], v[40:43]
ds_read_b64_tr_b16 a[132:133], v16 offset:36864
v_mfma_f32_16x16x32_bf16 v[40:43], a[144:147], a[4:7], v[40:43]
ds_read_b64_tr_b16 a[134:135], v16 offset:38912
L_pg11:
s_cbranch_execz L_vret
v_mfma_f32_16x16x32_bf16 v[44:47], a[144:147], a[12:15], v[44:47]
ds_read_b64_tr_b16 a[136:137], v16 offset:45056
v_mfma_f32_16x16x32_bf16 v[44:47], a[140:143], a[8:11], v[44:47]
ds_read_b64_tr_b16 a[138:139], v16 offset:47104
s_waitcnt lgkmcnt(8)
v_mfma_f32_16x16x32_bf16 v[48:51], a[148:151], a[0:3], v[48:51]
ds_read_b64_tr_b16 a[140:141], v17 offset:36864
s_add_u32 s94, s92, 65536
v_mfma_f32_16x16x32_bf16 v[48:51], a[152:155], a[4:7], v[48:51]
ds_read_b64_tr_b16 a[142:143], v17 offset:38912
s_xor_b32 s85, s94, 128
v_mfma_f32_16x16x32_bf16 v[52:55], a[152:155], a[12:15], v[52:55]
ds_read_b64_tr_b16 a[144:145], v17 offset:45056
s_add_u32 m0, s95, 98304
v_mfma_f32_16x16x32_bf16 v[52:55], a[148:151], a[8:11], v[52:55]
ds_read_b64_tr_b16 a[146:147], v17 offset:47104
s_waitcnt lgkmcnt(8)
v_mfma_f32_16x16x32_bf16 v[56:59], a[156:159], a[0:3], v[56:59]
ds_read_b64_tr_b16 a[148:149], v18 offset:36864
buffer_load_dwordx4 v4, s[40:43], s85 offen offset:0 lds
v_mfma_f32_16x16x32_bf16 v[56:59], a[160:163], a[4:7], v[56:59]
ds_read_b64_tr_b16 a[150:151], v18 offset:38912
buffer_load_dwordx4 a[68:71], v1, s[12:15], s28 offen offset:3072 sc1
v_mfma_f32_16x16x32_bf16 v[60:63], a[160:163], a[12:15], v[60:63]
ds_read_b64_tr_b16 a[152:153], v18 offset:45056
v_mfma_f32_16x16x32_bf16 v[60:63], a[156:159], a[8:11], v[60:63]
ds_read_b64_tr_b16 a[154:155], v18 offset:47104
s_waitcnt lgkmcnt(8)
v_mfma_f32_16x16x32_bf16 v[64:67], a[132:135], a[0:3], v[64:67]
ds_read_b64_tr_b16 a[156:157], v19 offset:36864
buffer_load_dwordx4 v5, s[40:43], s85 offen offset:1024 lds
v_mfma_f32_16x16x32_bf16 v[64:67], a[136:139], a[4:7], v[64:67]
ds_read_b64_tr_b16 a[158:159], v19 offset:38912
buffer_load_dwordx4 a[72:75], v15, s[12:15], s28 offen offset:2048 sc1
v_mfma_f32_16x16x32_bf16 v[68:71], a[136:139], a[12:15], v[68:71]
ds_read_b64_tr_b16 a[160:161], v19 offset:45056
v_mfma_f32_16x16x32_bf16 v[68:71], a[132:135], a[8:11], v[68:71]
ds_read_b64_tr_b16 a[162:163], v19 offset:47104
s_waitcnt lgkmcnt(8)
v_mfma_f32_16x16x32_bf16 v[72:75], a[140:143], a[0:3], v[72:75]
ds_read_b64_tr_b16 a[132:133], v16 offset:49152
v_mfma_f32_16x16x32_bf16 v[72:75], a[144:147], a[4:7], v[72:75]
ds_read_b64_tr_b16 a[134:135], v16 offset:51200
v_mfma_f32_16x16x32_bf16 v[76:79], a[144:147], a[12:15], v[76:79]
ds_read_b64_tr_b16 a[136:137], v16 offset:57344
v_mfma_f32_16x16x32_bf16 v[76:79], a[140:143], a[8:11], v[76:79]
ds_read_b64_tr_b16 a[138:139], v16 offset:59392
s_waitcnt lgkmcnt(8)
v_mfma_f32_16x16x32_bf16 v[80:83], a[148:151], a[0:3], v[80:83]
ds_read_b64_tr_b16 a[140:141], v17 offset:49152
v_mfma_f32_16x16x32_bf16 v[80:83], a[152:155], a[4:7], v[80:83]
ds_read_b64_tr_b16 a[142:143], v17 offset:51200
buffer_load_dwordx4 v6, s[40:43], s85 offen offset:2048 lds
v_mfma_f32_16x16x32_bf16 v[84:87], a[152:155], a[12:15], v[84:87]
ds_read_b64_tr_b16 a[144:145], v17 offset:57344
buffer_load_dwordx4 a[76:79], v15, s[12:15], s28 offen offset:3072 sc1
v_mfma_f32_16x16x32_bf16 v[84:87], a[148:151], a[8:11], v[84:87]
ds_read_b64_tr_b16 a[146:147], v17 offset:59392
s_waitcnt lgkmcnt(8)
v_mfma_f32_16x16x32_bf16 v[88:91], a[156:159], a[0:3], v[88:91]
ds_read_b64_tr_b16 a[148:149], v18 offset:49152
v_mfma_f32_16x16x32_bf16 v[88:91], a[160:163], a[4:7], v[88:91]
ds_read_b64_tr_b16 a[150:151], v18 offset:51200
v_mfma_f32_16x16x32_bf16 v[92:95], a[160:163], a[12:15], v[92:95]
ds_read_b64_tr_b16 a[152:153], v18 offset:57344
v_mfma_f32_16x16x32_bf16 v[92:95], a[156:159], a[8:11], v[92:95]
ds_read_b64_tr_b16 a[154:155], v18 offset:59392
s_waitcnt vmcnt(23) lgkmcnt(8)
v_mfma_f32_16x16x32_bf16 v[32:35], a[132:135], a[16:19], v[32:35]
ds_read_b64_tr_b16 a[156:157], v19 offset:49152
v_mfma_f32_16x16x32_bf16 v[32:35], a[136:139], a[20:23], v[32:35]
ds_read_b64_tr_b16 a[158:159], v19 offset:51200
buffer_load_dwordx4 v7, s[40:43], s85 offen offset:3072 lds
v_mfma_f32_16x16x32_bf16 v[36:39], a[136:139], a[28:31], v[36:39]
ds_read_b64_tr_b16 a[160:161], v19 offset:57344
s_add_u32 s28, s28, 4096
v_mfma_f32_16x16x32_bf16 v[36:39], a[132:135], a[24:27], v[36:39]
ds_read_b64_tr_b16 a[162:163], v19 offset:59392
s_waitcnt lgkmcnt(8)
v_mfma_f32_16x16x32_bf16 v[40:43], a[140:143], a[16:19], v[40:43]
ds_read_b64_tr_b16 a[132:133], v16 offset:53248
buffer_load_dwordx4 a[80:83], v1, s[12:15], s28 offen offset:0 sc1
v_mfma_f32_16x16x32_bf16 v[40:43], a[144:147], a[20:23], v[40:43]
ds_read_b64_tr_b16 a[134:135], v16 offset:55296
buffer_load_dword v12, v8, s[16:19], s101 offen sc1
v_mfma_f32_16x16x32_bf16 v[44:47], a[144:147], a[28:31], v[44:47]
ds_read_b64_tr_b16 a[136:137], v16 offset:61440
v_mfma_f32_16x16x32_bf16 v[44:47], a[140:143], a[24:27], v[44:47]
ds_read_b64_tr_b16 a[138:139], v16 offset:63488
s_waitcnt lgkmcnt(8)
v_mfma_f32_16x16x32_bf16 v[48:51], a[148:151], a[16:19], v[48:51]
ds_read_b64_tr_b16 a[140:141], v17 offset:53248
v_mfma_f32_16x16x32_bf16 v[48:51], a[152:155], a[20:23], v[48:51]
ds_read_b64_tr_b16 a[142:143], v17 offset:55296
buffer_load_dwordx4 a[84:87], v1, s[12:15], s28 offen offset:1024 sc1
v_mfma_f32_16x16x32_bf16 v[52:55], a[152:155], a[28:31], v[52:55]
ds_read_b64_tr_b16 a[144:145], v17 offset:61440
s_add_u32 m0, s95, 102400
v_mfma_f32_16x16x32_bf16 v[52:55], a[148:151], a[24:27], v[52:55]
ds_read_b64_tr_b16 a[146:147], v17 offset:63488
s_waitcnt lgkmcnt(8)
v_mfma_f32_16x16x32_bf16 v[56:59], a[156:159], a[16:19], v[56:59]
ds_read_b64_tr_b16 a[148:149], v18 offset:53248
buffer_load_dwordx4 v4, s[40:43], s94 offen offset:0 lds
v_mfma_f32_16x16x32_bf16 v[56:59], a[160:163], a[20:23], v[56:59]
ds_read_b64_tr_b16 a[150:151], v18 offset:55296
v_mfma_f32_16x16x32_bf16 v[60:63], a[160:163], a[28:31], v[60:63]
ds_read_b64_tr_b16 a[152:153], v18 offset:61440
s_add_u32 s53, s55, 983040
v_mfma_f32_16x16x32_bf16 v[60:63], a[156:159], a[24:27], v[60:63]
ds_read_b64_tr_b16 a[154:155], v18 offset:63488
s_waitcnt lgkmcnt(8)
v_mfma_f32_16x16x32_bf16 v[64:67], a[132:135], a[16:19], v[64:67]
ds_read_b64_tr_b16 a[156:157], v19 offset:53248
buffer_load_dword a250, v28, s[40:43], s53 offen
v_mfma_f32_16x16x32_bf16 v[64:67], a[136:139], a[20:23], v[64:67]
ds_read_b64_tr_b16 a[158:159], v19 offset:55296
buffer_load_dwordx4 a[88:91], v15, s[12:15], s28 offen offset:0 sc1
v_mfma_f32_16x16x32_bf16 v[68:71], a[136:139], a[28:31], v[68:71]
ds_read_b64_tr_b16 a[160:161], v19 offset:61440
v_mfma_f32_16x16x32_bf16 v[68:71], a[132:135], a[24:27], v[68:71]
ds_read_b64_tr_b16 a[162:163], v19 offset:63488
s_barrier
v_add_u32 v16, 131072, v16
v_add_u32 v17, 131072, v17
v_add_u32 v18, 131072, v18
v_add_u32 v19, 131072, v19
s_waitcnt lgkmcnt(8)
v_mfma_f32_16x16x32_bf16 v[72:75], a[140:143], a[16:19], v[72:75]
ds_read_b64_tr_b16 a[132:133], v16 offset:0
buffer_load_dwordx4 v5, s[40:43], s94 offen offset:1024 lds
v_mfma_f32_16x16x32_bf16 v[72:75], a[144:147], a[20:23], v[72:75]
ds_read_b64_tr_b16 a[134:135], v16 offset:2048
v_mfma_f32_16x16x32_bf16 v[76:79], a[144:147], a[28:31], v[76:79]
ds_read_b64_tr_b16 a[136:137], v16 offset:8192
v_mfma_f32_16x16x32_bf16 v[76:79], a[140:143], a[24:27], v[76:79]
ds_read_b64_tr_b16 a[138:139], v16 offset:10240
s_waitcnt lgkmcnt(8)
v_mfma_f32_16x16x32_bf16 v[80:83], a[148:151], a[16:19], v[80:83]
ds_read_b64_tr_b16 a[140:141], v17 offset:0
v_mfma_f32_16x16x32_bf16 v[80:83], a[152:155], a[20:23], v[80:83]
ds_read_b64_tr_b16 a[142:143], v17 offset:2048
buffer_load_dwordx4 a[92:95], v15, s[12:15], s28 offen offset:1024 sc1
v_mfma_f32_16x16x32_bf16 v[84:87], a[152:155], a[28:31], v[84:87]
ds_read_b64_tr_b16 a[144:145], v17 offset:8192
v_mfma_f32_16x16x32_bf16 v[84:87], a[148:151], a[24:27], v[84:87]
ds_read_b64_tr_b16 a[146:147], v17 offset:10240
s_waitcnt lgkmcnt(8)
v_mfma_f32_16x16x32_bf16 v[88:91], a[156:159], a[16:19], v[88:91]
ds_read_b64_tr_b16 a[148:149], v18 offset:0
buffer_load_dwordx4 v6, s[40:43], s94 offen offset:2048 lds
v_mfma_f32_16x16x32_bf16 v[88:91], a[160:163], a[20:23], v[88:91]
ds_read_b64_tr_b16 a[150:151], v18 offset:2048
v_mfma_f32_16x16x32_bf16 v[92:95], a[160:163], a[28:31], v[92:95]
ds_read_b64_tr_b16 a[152:153], v18 offset:8192
v_mfma_f32_16x16x32_bf16 v[92:95], a[156:159], a[24:27], v[92:95]
ds_read_b64_tr_b16 a[154:155], v18 offset:10240
s_waitcnt vmcnt(18) lgkmcnt(8)
v_mfma_f32_16x16x32_bf16 v[32:35], a[132:135], a[32:35], v[32:35]
ds_read_b64_tr_b16 a[156:157], v19 offset:0
v_mfma_f32_16x16x32_bf16 v[32:35], a[136:139], a[36:39], v[32:35]
ds_read_b64_tr_b16 a[158:159], v19 offset:2048
buffer_load_dwordx4 a[0:3], v1, s[12:15], s28 offen offset:2048 sc1
v_mfma_f32_16x16x32_bf16 v[36:39], a[136:139], a[44:47], v[36:39]
ds_read_b64_tr_b16 a[160:161], v19 offset:8192
v_mfma_f32_16x16x32_bf16 v[36:39], a[132:135], a[40:43], v[36:39]
ds_read_b64_tr_b16 a[162:163], v19 offset:10240
s_waitcnt lgkmcnt(8)
v_mfma_f32_16x16x32_bf16 v[40:43], a[140:143], a[32:35], v[40:43]
ds_read_b64_tr_b16 a[132:133], v16 offset:4096
v_mfma_f32_16x16x32_bf16 v[40:43], a[144:147], a[36:39], v[40:43]
ds_read_b64_tr_b16 a[134:135], v16 offset:6144
buffer_load_dwordx4 v7, s[40:43], s94 offen offset:3072 lds
v_mfma_f32_16x16x32_bf16 v[44:47], a[144:147], a[44:47], v[44:47]
ds_read_b64_tr_b16 a[136:137], v16 offset:12288
v_mfma_f32_16x16x32_bf16 v[44:47], a[140:143], a[40:43], v[44:47]
ds_read_b64_tr_b16 a[138:139], v16 offset:14336
s_waitcnt lgkmcnt(8)
v_mfma_f32_16x16x32_bf16 v[48:51], a[148:151], a[32:35], v[48:51]
ds_read_b64_tr_b16 a[140:141], v17 offset:4096
v_mfma_f32_16x16x32_bf16 v[48:51], a[152:155], a[36:39], v[48:51]
ds_read_b64_tr_b16 a[142:143], v17 offset:6144
buffer_load_dwordx4 a[4:7], v1, s[12:15], s28 offen offset:3072 sc1
v_mfma_f32_16x16x32_bf16 v[52:55], a[152:155], a[44:47], v[52:55]
ds_read_b64_tr_b16 a[144:145], v17 offset:12288
v_mfma_f32_16x16x32_bf16 v[52:55], a[148:151], a[40:43], v[52:55]
ds_read_b64_tr_b16 a[146:147], v17 offset:14336
s_waitcnt lgkmcnt(8)
v_mfma_f32_16x16x32_bf16 v[56:59], a[156:159], a[32:35], v[56:59]
ds_read_b64_tr_b16 a[148:149], v18 offset:4096
v_mfma_f32_16x16x32_bf16 v[56:59], a[160:163], a[36:39], v[56:59]
ds_read_b64_tr_b16 a[150:151], v18 offset:6144
v_mfma_f32_16x16x32_bf16 v[60:63], a[160:163], a[44:47], v[60:63]
ds_read_b64_tr_b16 a[152:153], v18 offset:12288
s_add_u32 s94, s92, 983040
v_mfma_f32_16x16x32_bf16 v[60:63], a[156:159], a[40:43], v[60:63]
ds_read_b64_tr_b16 a[154:155], v18 offset:14336
s_waitcnt lgkmcnt(8)
v_mfma_f32_16x16x32_bf16 v[64:67], a[132:135], a[32:35], v[64:67]
ds_read_b64_tr_b16 a[156:157], v19 offset:4096
s_xor_b32 s85, s94, 128
v_mfma_f32_16x16x32_bf16 v[64:67], a[136:139], a[36:39], v[64:67]
ds_read_b64_tr_b16 a[158:159], v19 offset:6144
s_add_u32 m0, s95, 0
v_mfma_f32_16x16x32_bf16 v[68:71], a[136:139], a[44:47], v[68:71]
ds_read_b64_tr_b16 a[160:161], v19 offset:12288
buffer_load_dwordx4 v4, s[40:43], s85 offen offset:0 lds
v_mfma_f32_16x16x32_bf16 v[68:71], a[132:135], a[40:43], v[68:71]
ds_read_b64_tr_b16 a[162:163], v19 offset:14336
s_waitcnt lgkmcnt(8)
v_mfma_f32_16x16x32_bf16 v[72:75], a[140:143], a[32:35], v[72:75]
ds_read_b64_tr_b16 a[132:133], v16 offset:16384
buffer_load_dwordx4 a[8:11], v15, s[12:15], s28 offen offset:2048 sc1
v_mfma_f32_16x16x32_bf16 v[72:75], a[144:147], a[36:39], v[72:75]
ds_read_b64_tr_b16 a[134:135], v16 offset:18432
v_mfma_f32_16x16x32_bf16 v[76:79], a[144:147], a[44:47], v[76:79]
ds_read_b64_tr_b16 a[136:137], v16 offset:24576
v_mfma_f32_16x16x32_bf16 v[76:79], a[140:143], a[40:43], v[76:79]
ds_read_b64_tr_b16 a[138:139], v16 offset:26624
s_waitcnt lgkmcnt(8)
v_mfma_f32_16x16x32_bf16 v[80:83], a[148:151], a[32:35], v[80:83]
ds_read_b64_tr_b16 a[140:141], v17 offset:16384
buffer_load_dwordx4 v5, s[40:43], s85 offen offset:1024 lds
v_mfma_f32_16x16x32_bf16 v[80:83], a[152:155], a[36:39], v[80:83]
ds_read_b64_tr_b16 a[142:143], v17 offset:18432
buffer_load_dwordx4 a[12:15], v15, s[12:15], s28 offen offset:3072 sc1
v_mfma_f32_16x16x32_bf16 v[84:87], a[152:155], a[44:47], v[84:87]
ds_read_b64_tr_b16 a[144:145], v17 offset:24576
v_mfma_f32_16x16x32_bf16 v[84:87], a[148:151], a[40:43], v[84:87]
ds_read_b64_tr_b16 a[146:147], v17 offset:26624
s_waitcnt lgkmcnt(8)
v_mfma_f32_16x16x32_bf16 v[88:91], a[156:159], a[32:35], v[88:91]
ds_read_b64_tr_b16 a[148:149], v18 offset:16384
v_mfma_f32_16x16x32_bf16 v[88:91], a[160:163], a[36:39], v[88:91]
ds_read_b64_tr_b16 a[150:151], v18 offset:18432
v_mfma_f32_16x16x32_bf16 v[92:95], a[160:163], a[44:47], v[92:95]
ds_read_b64_tr_b16 a[152:153], v18 offset:24576
v_mfma_f32_16x16x32_bf16 v[92:95], a[156:159], a[40:43], v[92:95]
ds_read_b64_tr_b16 a[154:155], v18 offset:26624
s_waitcnt vmcnt(17) lgkmcnt(8)
v_mfma_f32_16x16x32_bf16 v[32:35], a[132:135], a[64:67], v[32:35]
ds_read_b64_tr_b16 a[156:157], v19 offset:16384
buffer_load_dwordx4 v6, s[40:43], s85 offen offset:2048 lds
v_mfma_f32_16x16x32_bf16 v[32:35], a[136:139], a[68:71], v[32:35]
ds_read_b64_tr_b16 a[158:159], v19 offset:18432
s_waitcnt vmcnt(15)
v_cmp_gt_u32 vcc, 5, v12
s_nop 0
s_cbranch_vccnz L_spin5
L_rdy5:
v_mfma_f32_16x16x32_bf16 v[36:39], a[136:139], a[76:79], v[36:39]
ds_read_b64_tr_b16 a[160:161], v19 offset:24576
s_add_u32 s28, s28, 12288
v_mfma_f32_16x16x32_bf16 v[36:39], a[132:135], a[72:75], v[36:39]
ds_read_b64_tr_b16 a[162:163], v19 offset:26624
s_waitcnt lgkmcnt(8)
v_mfma_f32_16x16x32_bf16 v[40:43], a[140:143], a[64:67], v[40:43]
ds_read_b64_tr_b16 a[132:133], v16 offset:20480
buffer_load_dwordx4 a[16:19], v1, s[12:15], s28 offen offset:0 sc1
v_mfma_f32_16x16x32_bf16 v[40:43], a[144:147], a[68:71], v[40:43]
ds_read_b64_tr_b16 a[134:135], v16 offset:22528
v_mfma_f32_16x16x32_bf16 v[44:47], a[144:147], a[76:79], v[44:47]
ds_read_b64_tr_b16 a[136:137], v16 offset:28672
v_mfma_f32_16x16x32_bf16 v[44:47], a[140:143], a[72:75], v[44:47]
ds_read_b64_tr_b16 a[138:139], v16 offset:30720
s_waitcnt lgkmcnt(8)
v_mfma_f32_16x16x32_bf16 v[48:51], a[148:151], a[64:67], v[48:51]
ds_read_b64_tr_b16 a[140:141], v17 offset:20480
v_mov_b32 v14, 6
buffer_store_dword v14, off, s[16:19], s100 sc1
v_mfma_f32_16x16x32_bf16 v[48:51], a[152:155], a[68:71], v[48:51]
ds_read_b64_tr_b16 a[142:143], v17 offset:22528
buffer_load_dwordx4 v7, s[40:43], s85 offen offset:3072 lds
v_mfma_f32_16x16x32_bf16 v[52:55], a[152:155], a[76:79], v[52:55]
ds_read_b64_tr_b16 a[144:145], v17 offset:28672
buffer_load_dwordx4 a[20:23], v1, s[12:15], s28 offen offset:1024 sc1
v_mfma_f32_16x16x32_bf16 v[52:55], a[148:151], a[72:75], v[52:55]
ds_read_b64_tr_b16 a[146:147], v17 offset:30720
s_waitcnt lgkmcnt(8)
v_mfma_f32_16x16x32_bf16 v[56:59], a[156:159], a[64:67], v[56:59]
ds_read_b64_tr_b16 a[148:149], v18 offset:20480
v_mfma_f32_16x16x32_bf16 v[56:59], a[160:163], a[68:71], v[56:59]
ds_read_b64_tr_b16 a[150:151], v18 offset:22528
v_mfma_f32_16x16x32_bf16 v[60:63], a[160:163], a[76:79], v[60:63]
ds_read_b64_tr_b16 a[152:153], v18 offset:28672
s_add_u32 s53, s55, 1900544
v_mfma_f32_16x16x32_bf16 v[60:63], a[156:159], a[72:75], v[60:63]
ds_read_b64_tr_b16 a[154:155], v18 offset:30720
s_waitcnt lgkmcnt(8)
v_mfma_f32_16x16x32_bf16 v[64:67], a[132:135], a[64:67], v[64:67]
ds_read_b64_tr_b16 a[156:157], v19 offset:20480
buffer_load_dword a250, v28, s[40:43], s53 offen
v_mfma_f32_16x16x32_bf16 v[64:67], a[136:139], a[68:71], v[64:67]
ds_read_b64_tr_b16 a[158:159], v19 offset:22528
buffer_load_dwordx4 a[24:27], v15, s[12:15], s28 offen offset:0 sc1
v_mfma_f32_16x16x32_bf16 v[68:71], a[136:139], a[76:79], v[68:71]
ds_read_b64_tr_b16 a[160:161], v19 offset:28672
s_add_u32 m0, s95, 4096
v_mfma_f32_16x16x32_bf16 v[68:71], a[132:135], a[72:75], v[68:71]
ds_read_b64_tr_b16 a[162:163], v19 offset:30720
s_barrier
v_add_u32 v16, 4294901760, v16
v_add_u32 v17, 4294901760, v17
v_add_u32 v18, 4294901760, v18
v_add_u32 v19, 4294901760, v19
s_waitcnt lgkmcnt(8)
v_mfma_f32_16x16x32_bf16 v[72:75], a[140:143], a[64:67], v[72:75]
ds_read_b64_tr_b16 a[132:133], v16 offset:0
buffer_load_dwordx4 v4, s[40:43], s94 offen offset:0 lds
v_mfma_f32_16x16x32_bf16 v[72:75], a[144:147], a[68:71], v[72:75]
ds_read_b64_tr_b16 a[134:135], v16 offset:2048
v_mfma_f32_16x16x32_bf16 v[76:79], a[144:147], a[76:79], v[76:79]
ds_read_b64_tr_b16 a[136:137], v16 offset:8192
v_mfma_f32_16x16x32_bf16 v[76:79], a[140:143], a[72:75], v[76:79]
ds_read_b64_tr_b16 a[138:139], v16 offset:10240
s_waitcnt lgkmcnt(8)
v_mfma_f32_16x16x32_bf16 v[80:83], a[148:151], a[64:67], v[80:83]
ds_read_b64_tr_b16 a[140:141], v17 offset:0
v_mfma_f32_16x16x32_bf16 v[80:83], a[152:155], a[68:71], v[80:83]
ds_read_b64_tr_b16 a[142:143], v17 offset:2048
buffer_load_dwordx4 a[28:31], v15, s[12:15], s28 offen offset:1024 sc1
v_mfma_f32_16x16x32_bf16 v[84:87], a[152:155], a[76:79], v[84:87]
ds_read_b64_tr_b16 a[144:145], v17 offset:8192
buffer_load_dwordx4 v5, s[40:43], s94 offen offset:1024 lds
v_mfma_f32_16x16x32_bf16 v[84:87], a[148:151], a[72:75], v[84:87]
ds_read_b64_tr_b16 a[146:147], v17 offset:10240
s_waitcnt lgkmcnt(8)
v_mfma_f32_16x16x32_bf16 v[88:91], a[156:159], a[64:67], v[88:91]
ds_read_b64_tr_b16 a[148:149], v18 offset:0
v_mfma_f32_16x16x32_bf16 v[88:91], a[160:163], a[68:71], v[88:91]
ds_read_b64_tr_b16 a[150:151], v18 offset:2048
v_mfma_f32_16x16x32_bf16 v[92:95], a[160:163], a[76:79], v[92:95]
ds_read_b64_tr_b16 a[152:153], v18 offset:8192
v_mfma_f32_16x16x32_bf16 v[92:95], a[156:159], a[72:75], v[92:95]
ds_read_b64_tr_b16 a[154:155], v18 offset:10240
s_waitcnt vmcnt(18) lgkmcnt(8)
v_mfma_f32_16x16x32_bf16 v[32:35], a[132:135], a[80:83], v[32:35]
ds_read_b64_tr_b16 a[156:157], v19 offset:0
v_mfma_f32_16x16x32_bf16 v[32:35], a[136:139], a[84:87], v[32:35]
ds_read_b64_tr_b16 a[158:159], v19 offset:2048
buffer_load_dwordx4 a[32:35], v1, s[12:15], s28 offen offset:2048 sc1
v_mfma_f32_16x16x32_bf16 v[36:39], a[136:139], a[92:95], v[36:39]
ds_read_b64_tr_b16 a[160:161], v19 offset:8192
v_mfma_f32_16x16x32_bf16 v[36:39], a[132:135], a[88:91], v[36:39]
ds_read_b64_tr_b16 a[162:163], v19 offset:10240
s_waitcnt lgkmcnt(8)
v_mfma_f32_16x16x32_bf16 v[40:43], a[140:143], a[80:83], v[40:43]
ds_read_b64_tr_b16 a[132:133], v16 offset:4096
buffer_load_dwordx4 v6, s[40:43], s94 offen offset:2048 lds
v_mfma_f32_16x16x32_bf16 v[40:43], a[144:147], a[84:87], v[40:43]
ds_read_b64_tr_b16 a[134:135], v16 offset:6144
v_mfma_f32_16x16x32_bf16 v[44:47], a[144:147], a[92:95], v[44:47]
ds_read_b64_tr_b16 a[136:137], v16 offset:12288
v_mfma_f32_16x16x32_bf16 v[44:47], a[140:143], a[88:91], v[44:47]
ds_read_b64_tr_b16 a[138:139], v16 offset:14336
s_waitcnt lgkmcnt(8)
v_mfma_f32_16x16x32_bf16 v[48:51], a[148:151], a[80:83], v[48:51]
ds_read_b64_tr_b16 a[140:141], v17 offset:4096
v_mfma_f32_16x16x32_bf16 v[48:51], a[152:155], a[84:87], v[48:51]
ds_read_b64_tr_b16 a[142:143], v17 offset:6144
buffer_load_dwordx4 a[36:39], v1, s[12:15], s28 offen offset:3072 sc1
v_mfma_f32_16x16x32_bf16 v[52:55], a[152:155], a[92:95], v[52:55]
ds_read_b64_tr_b16 a[144:145], v17 offset:12288
v_mfma_f32_16x16x32_bf16 v[52:55], a[148:151], a[88:91], v[52:55]
ds_read_b64_tr_b16 a[146:147], v17 offset:14336
s_waitcnt lgkmcnt(8)
v_mfma_f32_16x16x32_bf16 v[56:59], a[156:159], a[80:83], v[56:59]
ds_read_b64_tr_b16 a[148:149], v18 offset:4096
buffer_load_dwordx4 v7, s[40:43], s94 offen offset:3072 lds
v_mfma_f32_16x16x32_bf16 v[56:59], a[160:163], a[84:87], v[56:59]
ds_read_b64_tr_b16 a[150:151], v18 offset:6144
v_mfma_f32_16x16x32_bf16 v[60:63], a[160:163], a[92:95], v[60:63]
ds_read_b64_tr_b16 a[152:153], v18 offset:12288
v_mfma_f32_16x16x32_bf16 v[60:63], a[156:159], a[88:91], v[60:63]
ds_read_b64_tr_b16 a[154:155], v18 offset:14336
s_waitcnt lgkmcnt(8)
v_mfma_f32_16x16x32_bf16 v[64:67], a[132:135], a[80:83], v[64:67]
ds_read_b64_tr_b16 a[156:157], v19 offset:4096
v_mfma_f32_16x16x32_bf16 v[64:67], a[136:139], a[84:87], v[64:67]
ds_read_b64_tr_b16 a[158:159], v19 offset:6144
buffer_load_dwordx4 a[40:43], v15, s[12:15], s28 offen offset:2048 sc1
v_mfma_f32_16x16x32_bf16 v[68:71], a[136:139], a[92:95], v[68:71]
ds_read_b64_tr_b16 a[160:161], v19 offset:12288
v_mfma_f32_16x16x32_bf16 v[68:71], a[132:135], a[88:91], v[68:71]
ds_read_b64_tr_b16 a[162:163], v19 offset:14336
s_waitcnt lgkmcnt(8)
v_mfma_f32_16x16x32_bf16 v[72:75], a[140:143], a[80:83], v[72:75]
ds_read_b64_tr_b16 a[132:133], v16 offset:16384
v_mfma_f32_16x16x32_bf16 v[72:75], a[144:147], a[84:87], v[72:75]
ds_read_b64_tr_b16 a[134:135], v16 offset:18432
s_add_u32 s94, s92, 1900544
v_mfma_f32_16x16x32_bf16 v[76:79], a[144:147], a[92:95], v[76:79]
ds_read_b64_tr_b16 a[136:137], v16 offset:24576
s_xor_b32 s85, s94, 128
v_mfma_f32_16x16x32_bf16 v[76:79], a[140:143], a[88:91], v[76:79]
ds_read_b64_tr_b16 a[138:139], v16 offset:26624
s_waitcnt lgkmcnt(8)
v_mfma_f32_16x16x32_bf16 v[80:83], a[148:151], a[80:83], v[80:83]
ds_read_b64_tr_b16 a[140:141], v17 offset:16384
s_add_u32 m0, s95, 32768
v_mfma_f32_16x16x32_bf16 v[80:83], a[152:155], a[84:87], v[80:83]
ds_read_b64_tr_b16 a[142:143], v17 offset:18432
buffer_load_dwordx4 v4, s[40:43], s85 offen offset:0 lds
v_mfma_f32_16x16x32_bf16 v[84:87], a[152:155], a[92:95], v[84:87]
ds_read_b64_tr_b16 a[144:145], v17 offset:24576
buffer_load_dwordx4 a[44:47], v15, s[12:15], s28 offen offset:3072 sc1
v_mfma_f32_16x16x32_bf16 v[84:87], a[148:151], a[88:91], v[84:87]
ds_read_b64_tr_b16 a[146:147], v17 offset:26624
s_waitcnt lgkmcnt(8)
v_mfma_f32_16x16x32_bf16 v[88:91], a[156:159], a[80:83], v[88:91]
ds_read_b64_tr_b16 a[148:149], v18 offset:16384
v_mfma_f32_16x16x32_bf16 v[88:91], a[160:163], a[84:87], v[88:91]
ds_read_b64_tr_b16 a[150:151], v18 offset:18432
v_mfma_f32_16x16x32_bf16 v[92:95], a[160:163], a[92:95], v[92:95]
ds_read_b64_tr_b16 a[152:153], v18 offset:24576
buffer_load_dwordx4 v5, s[40:43], s85 offen offset:1024 lds
v_mfma_f32_16x16x32_bf16 v[92:95], a[156:159], a[88:91], v[92:95]
ds_read_b64_tr_b16 a[154:155], v18 offset:26624
s_waitcnt vmcnt(18) lgkmcnt(8)
v_mfma_f32_16x16x32_bf16 v[32:35], a[132:135], a[0:3], v[32:35]
ds_read_b64_tr_b16 a[156:157], v19 offset:16384
v_mfma_f32_16x16x32_bf16 v[32:35], a[136:139], a[4:7], v[32:35]
ds_read_b64_tr_b16 a[158:159], v19 offset:18432
s_add_u32 s28, s28, 4096
v_mfma_f32_16x16x32_bf16 v[36:39], a[136:139], a[12:15], v[36:39]
ds_read_b64_tr_b16 a[160:161], v19 offset:24576
buffer_load_dwordx4 a[64:67], v1, s[12:15], s28 offen offset:0 sc1
v_mfma_f32_16x16x32_bf16 v[36:39], a[132:135], a[8:11], v[36:39]
ds_read_b64_tr_b16 a[162:163], v19 offset:26624
s_waitcnt lgkmcnt(8)
v_mfma_f32_16x16x32_bf16 v[40:43], a[140:143], a[0:3], v[40:43]
ds_read_b64_tr_b16 a[132:133], v16 offset:20480
v_mfma_f32_16x16x32_bf16 v[40:43], a[144:147], a[4:7], v[40:43]
ds_read_b64_tr_b16 a[134:135], v16 offset:22528
v_mfma_f32_16x16x32_bf16 v[44:47], a[144:147], a[12:15], v[44:47]
ds_read_b64_tr_b16 a[136:137], v16 offset:28672
v_mfma_f32_16x16x32_bf16 v[44:47], a[140:143], a[8:11], v[44:47]
ds_read_b64_tr_b16 a[138:139], v16 offset:30720
s_waitcnt lgkmcnt(8)
v_mfma_f32_16x16x32_bf16 v[48:51], a[148:151], a[0:3], v[48:51]
ds_read_b64_tr_b16 a[140:141], v17 offset:20480
buffer_load_dwordx4 v6, s[40:43], s85 offen offset:2048 lds
v_mfma_f32_16x16x32_bf16 v[48:51], a[152:155], a[4:7], v[48:51]
ds_read_b64_tr_b16 a[142:143], v17 offset:22528
buffer_load_dwordx4 a[68:71], v1, s[12:15], s28 offen offset:1024 sc1
v_mfma_f32_16x16x32_bf16 v[52:55], a[152:155], a[12:15], v[52:55]
ds_read_b64_tr_b16 a[144:145], v17 offset:28672
v_mfma_f32_16x16x32_bf16 v[52:55], a[148:151], a[8:11], v[52:55]
ds_read_b64_tr_b16 a[146:147], v17 offset:30720
s_waitcnt lgkmcnt(8)
v_mfma_f32_16x16x32_bf16 v[56:59], a[156:159], a[0:3], v[56:59]
ds_read_b64_tr_b16 a[148:149], v18 offset:20480
v_mfma_f32_16x16x32_bf16 v[56:59], a[160:163], a[4:7], v[56:59]
ds_read_b64_tr_b16 a[150:151], v18 offset:22528
v_mfma_f32_16x16x32_bf16 v[60:63], a[160:163], a[12:15], v[60:63]
ds_read_b64_tr_b16 a[152:153], v18 offset:28672
s_add_u32 s53, s55, 2818048
v_mfma_f32_16x16x32_bf16 v[60:63], a[156:159], a[8:11], v[60:63]
ds_read_b64_tr_b16 a[154:155], v18 offset:30720
s_waitcnt lgkmcnt(8)
v_mfma_f32_16x16x32_bf16 v[64:67], a[132:135], a[0:3], v[64:67]
ds_read_b64_tr_b16 a[156:157], v19 offset:20480
buffer_load_dword a250, v28, s[40:43], s53 offen
v_mfma_f32_16x16x32_bf16 v[64:67], a[136:139], a[4:7], v[64:67]
ds_read_b64_tr_b16 a[158:159], v19 offset:22528
buffer_load_dwordx4 v7, s[40:43], s85 offen offset:3072 lds
v_mfma_f32_16x16x32_bf16 v[68:71], a[136:139], a[12:15], v[68:71]
ds_read_b64_tr_b16 a[160:161], v19 offset:28672
buffer_load_dwordx4 a[72:75], v15, s[12:15], s28 offen offset:0 sc1
v_mfma_f32_16x16x32_bf16 v[68:71], a[132:135], a[8:11], v[68:71]
ds_read_b64_tr_b16 a[162:163], v19 offset:30720
s_barrier
s_waitcnt lgkmcnt(8)
v_mfma_f32_16x16x32_bf16 v[72:75], a[140:143], a[0:3], v[72:75]
ds_read_b64_tr_b16 a[132:133], v16 offset:32768
v_mfma_f32_16x16x32_bf16 v[72:75], a[144:147], a[4:7], v[72:75]
ds_read_b64_tr_b16 a[134:135], v16 offset:34816
v_mfma_f32_16x16x32_bf16 v[76:79], a[144:147], a[12:15], v[76:79]
ds_read_b64_tr_b16 a[136:137], v16 offset:40960
v_mfma_f32_16x16x32_bf16 v[76:79], a[140:143], a[8:11], v[76:79]
ds_read_b64_tr_b16 a[138:139], v16 offset:43008
s_waitcnt lgkmcnt(8)
v_mfma_f32_16x16x32_bf16 v[80:83], a[148:151], a[0:3], v[80:83]
ds_read_b64_tr_b16 a[140:141], v17 offset:32768
v_mfma_f32_16x16x32_bf16 v[80:83], a[152:155], a[4:7], v[80:83]
ds_read_b64_tr_b16 a[142:143], v17 offset:34816
s_add_u32 m0, s95, 36864
v_mfma_f32_16x16x32_bf16 v[84:87], a[152:155], a[12:15], v[84:87]
ds_read_b64_tr_b16 a[144:145], v17 offset:40960
buffer_load_dwordx4 v4, s[40:43], s94 offen offset:0 lds
v_mfma_f32_16x16x32_bf16 v[84:87], a[148:151], a[8:11], v[84:87]
ds_read_b64_tr_b16 a[146:147], v17 offset:43008
s_waitcnt lgkmcnt(8)
v_mfma_f32_16x16x32_bf16 v[88:91], a[156:159], a[0:3], v[88:91]
ds_read_b64_tr_b16 a[148:149], v18 offset:32768
buffer_load_dwordx4 a[76:79], v15, s[12:15], s28 offen offset:1024 sc1
v_mfma_f32_16x16x32_bf16 v[88:91], a[160:163], a[4:7], v[88:91]
ds_read_b64_tr_b16 a[150:151], v18 offset:34816
v_mfma_f32_16x16x32_bf16 v[92:95], a[160:163], a[12:15], v[92:95]
ds_read_b64_tr_b16 a[152:153], v18 offset:40960
v_mfma_f32_16x16x32_bf16 v[92:95], a[156:159], a[8:11], v[92:95]
ds_read_b64_tr_b16 a[154:155], v18 offset:43008
s_waitcnt vmcnt(17) lgkmcnt(8)
v_mfma_f32_16x16x32_bf16 v[32:35], a[132:135], a[16:19], v[32:35]
ds_read_b64_tr_b16 a[156:157], v19 offset:32768
v_mfma_f32_16x16x32_bf16 v[32:35], a[136:139], a[20:23], v[32:35]
ds_read_b64_tr_b16 a[158:159], v19 offset:34816
buffer_load_dwordx4 a[80:83], v1, s[12:15], s28 offen offset:2048 sc1
v_mfma_f32_16x16x32_bf16 v[36:39], a[136:139], a[28:31], v[36:39]
ds_read_b64_tr_b16 a[160:161], v19 offset:40960
buffer_load_dwordx4 v5, s[40:43], s94 offen offset:1024 lds
v_mfma_f32_16x16x32_bf16 v[36:39], a[132:135], a[24:27], v[36:39]
ds_read_b64_tr_b16 a[162:163], v19 offset:43008
s_waitcnt lgkmcnt(8)
v_mfma_f32_16x16x32_bf16 v[40:43], a[140:143], a[16:19], v[40:43]
ds_read_b64_tr_b16 a[132:133], v16 offset:36864
v_mfma_f32_16x16x32_bf16 v[40:43], a[144:147], a[20:23], v[40:43]
ds_read_b64_tr_b16 a[134:135], v16 offset:38912
v_mfma_f32_16x16x32_bf16 v[44:47], a[144:147], a[28:31], v[44:47]
ds_read_b64_tr_b16 a[136:137], v16 offset:45056
v_mfma_f32_16x16x32_bf16 v[44:47], a[140:143], a[24:27], v[44:47]
ds_read_b64_tr_b16 a[138:139], v16 offset:47104
s_waitcnt lgkmcnt(8)
v_mfma_f32_16x16x32_bf16 v[48:51], a[148:151], a[16:19], v[48:51]
ds_read_b64_tr_b16 a[140:141], v17 offset:36864
v_mfma_f32_16x16x32_bf16 v[48:51], a[152:155], a[20:23], v[48:51]
ds_read_b64_tr_b16 a[142:143], v17 offset:38912
buffer_load_dwordx4 a[84:87], v1, s[12:15], s28 offen offset:3072 sc1
v_mfma_f32_16x16x32_bf16 v[52:55], a[152:155], a[28:31], v[52:55]
ds_read_b64_tr_b16 a[144:145], v17 offset:45056
v_mfma_f32_16x16x32_bf16 v[52:55], a[148:151], a[24:27], v[52:55]
ds_read_b64_tr_b16 a[146:147], v17 offset:47104
s_waitcnt lgkmcnt(8)
v_mfma_f32_16x16x32_bf16 v[56:59], a[156:159], a[16:19], v[56:59]
ds_read_b64_tr_b16 a[148:149], v18 offset:36864
buffer_load_dwordx4 v6, s[40:43], s94 offen offset:2048 lds
v_mfma_f32_16x16x32_bf16 v[56:59], a[160:163], a[20:23], v[56:59]
ds_read_b64_tr_b16 a[150:151], v18 offset:38912
v_mfma_f32_16x16x32_bf16 v[60:63], a[160:163], a[28:31], v[60:63]
ds_read_b64_tr_b16 a[152:153], v18 offset:45056
v_mfma_f32_16x16x32_bf16 v[60:63], a[156:159], a[24:27], v[60:63]
ds_read_b64_tr_b16 a[154:155], v18 offset:47104
L_pg12:
s_cbranch_execz L_vret
s_waitcnt lgkmcnt(8)
v_mfma_f32_16x16x32_bf16 v[64:67], a[132:135], a[16:19], v[64:67]
ds_read_b64_tr_b16 a[156:157], v19 offset:36864
v_mfma_f32_16x16x32_bf16 v[64:67], a[136:139], a[20:23], v[64:67]
ds_read_b64_tr_b16 a[158:159], v19 offset:38912
buffer_load_dwordx4 a[88:91], v15, s[12:15], s28 offen offset:2048 sc1
v_mfma_f32_16x16x32_bf16 v[68:71], a[136:139], a[28:31], v[68:71]
ds_read_b64_tr_b16 a[160:161], v19 offset:45056
v_mfma_f32_16x16x32_bf16 v[68:71], a[132:135], a[24:27], v[68:71]
ds_read_b64_tr_b16 a[162:163], v19 offset:47104
s_waitcnt lgkmcnt(8)
v_mfma_f32_16x16x32_bf16 v[72:75], a[140:143], a[16:19], v[72:75]
ds_read_b64_tr_b16 a[132:133], v16 offset:49152
buffer_load_dwordx4 v7, s[40:43], s94 offen offset:3072 lds
v_mfma_f32_16x16x32_bf16 v[72:75], a[144:147], a[20:23], v[72:75]
ds_read_b64_tr_b16 a[134:135], v16 offset:51200
v_mfma_f32_16x16x32_bf16 v[76:79], a[144:147], a[28:31], v[76:79]
ds_read_b64_tr_b16 a[136:137], v16 offset:57344
v_mfma_f32_16x16x32_bf16 v[76:79], a[140:143], a[24:27], v[76:79]
ds_read_b64_tr_b16 a[138:139], v16 offset:59392
s_waitcnt lgkmcnt(8)
v_mfma_f32_16x16x32_bf16 v[80:83], a[148:151], a[16:19], v[80:83]
ds_read_b64_tr_b16 a[140:141], v17 offset:49152
v_mfma_f32_16x16x32_bf16 v[80:83], a[152:155], a[20:23], v[80:83]
ds_read_b64_tr_b16 a[142:143], v17 offset:51200
buffer_load_dwordx4 a[92:95], v15, s[12:15], s28 offen offset:3072 sc1
v_mfma_f32_16x16x32_bf16 v[84:87], a[152:155], a[28:31], v[84:87]
ds_read_b64_tr_b16 a[144:145], v17 offset:57344
v_mfma_f32_16x16x32_bf16 v[84:87], a[148:151], a[24:27], v[84:87]
ds_read_b64_tr_b16 a[146:147], v17 offset:59392
s_waitcnt lgkmcnt(8)
v_mfma_f32_16x16x32_bf16 v[88:91], a[156:159], a[16:19], v[88:91]
ds_read_b64_tr_b16 a[148:149], v18 offset:49152
s_add_u32 s94, s92, 2818048
v_mfma_f32_16x16x32_bf16 v[88:91], a[160:163], a[20:23], v[88:91]
ds_read_b64_tr_b16 a[150:151], v18 offset:51200
s_xor_b32 s85, s94, 128
v_mfma_f32_16x16x32_bf16 v[92:95], a[160:163], a[28:31], v[92:95]
ds_read_b64_tr_b16 a[152:153], v18 offset:57344
s_add_u32 m0, s95, 131072
v_mfma_f32_16x16x32_bf16 v[92:95], a[156:159], a[24:27], v[92:95]
ds_read_b64_tr_b16 a[154:155], v18 offset:59392
s_waitcnt vmcnt(16) lgkmcnt(8)
v_mfma_f32_16x16x32_bf16 v[32:35], a[132:135], a[32:35], v[32:35]
ds_read_b64_tr_b16 a[156:157], v19 offset:49152
buffer_load_dwordx4 v4, s[40:43], s85 offen offset:0 lds
v_mfma_f32_16x16x32_bf16 v[32:35], a[136:139], a[36:39], v[32:35]
ds_read_b64_tr_b16 a[158:159], v19 offset:51200
s_add_u32 s28, s28, 12288
v_mfma_f32_16x16x32_bf16 v[36:39], a[136:139], a[44:47], v[36:39]
ds_read_b64_tr_b16 a[160:161], v19 offset:57344
buffer_load_dwordx4 a[0:3], v1, s[12:15], s28 offen offset:0 sc1
v_mfma_f32_16x16x32_bf16 v[36:39], a[132:135], a[40:43], v[36:39]
ds_read_b64_tr_b16 a[162:163], v19 offset:59392
s_waitcnt lgkmcnt(8)
v_mfma_f32_16x16x32_bf16 v[40:43], a[140:143], a[32:35], v[40:43]
ds_read_b64_tr_b16 a[132:133], v16 offset:53248
v_mfma_f32_16x16x32_bf16 v[40:43], a[144:147], a[36:39], v[40:43]
ds_read_b64_tr_b16 a[134:135], v16 offset:55296
buffer_load_dwordx4 v5, s[40:43], s85 offen offset:1024 lds
v_mfma_f32_16x16x32_bf16 v[44:47], a[144:147], a[44:47], v[44:47]
ds_read_b64_tr_b16 a[136:137], v16 offset:61440
v_mfma_f32_16x16x32_bf16 v[44:47], a[140:143], a[40:43], v[44:47]
ds_read_b64_tr_b16 a[138:139], v16 offset:63488
s_waitcnt lgkmcnt(8)
v_mfma_f32_16x16x32_bf16 v[48:51], a[148:151], a[32:35], v[48:51]
ds_read_b64_tr_b16 a[140:141], v17 offset:53248
v_mfma_f32_16x16x32_bf16 v[48:51], a[152:155], a[36:39], v[48:51]
ds_read_b64_tr_b16 a[142:143], v17 offset:55296
buffer_load_dwordx4 a[4:7], v1, s[12:15], s28 offen offset:1024 sc1
v_mfma_f32_16x16x32_bf16 v[52:55], a[152:155], a[44:47], v[52:55]
ds_read_b64_tr_b16 a[144:145], v17 offset:61440
v_mfma_f32_16x16x32_bf16 v[52:55], a[148:151], a[40:43], v[52:55]
ds_read_b64_tr_b16 a[146:147], v17 offset:63488
s_waitcnt lgkmcnt(8)
v_mfma_f32_16x16x32_bf16 v[56:59], a[156:159], a[32:35], v[56:59]
ds_read_b64_tr_b16 a[148:149], v18 offset:53248
v_mfma_f32_16x16x32_bf16 v[56:59], a[160:163], a[36:39], v[56:59]
ds_read_b64_tr_b16 a[150:151], v18 offset:55296
v_mfma_f32_16x16x32_bf16 v[60:63], a[160:163], a[44:47], v[60:63]
ds_read_b64_tr_b16 a[152:153], v18 offset:61440
buffer_load_dwordx4 v6, s[40:43], s85 offen offset:2048 lds
v_mfma_f32_16x16x32_bf16 v[60:63], a[156:159], a[40:43], v[60:63]
ds_read_b64_tr_b16 a[154:155], v18 offset:63488
s_waitcnt lgkmcnt(8)
v_mfma_f32_16x16x32_bf16 v[64:67], a[132:135], a[32:35], v[64:67]
ds_read_b64_tr_b16 a[156:157], v19 offset:53248
s_add_u32 s53, s55, 131072
v_mfma_f32_16x16x32_bf16 v[64:67], a[136:139], a[36:39], v[64:67]
ds_read_b64_tr_b16 a[158:159], v19 offset:55296
buffer_load_dword a250, v28, s[40:43], s53 offen
v_mfma_f32_16x16x32_bf16 v[68:71], a[136:139], a[44:47], v[68:71]
ds_read_b64_tr_b16 a[160:161], v19 offset:61440
buffer_load_dwordx4 a[8:11], v15, s[12:15], s28 offen offset:0 sc1
v_mfma_f32_16x16x32_bf16 v[68:71], a[132:135], a[40:43], v[68:71]
ds_read_b64_tr_b16 a[162:163], v19 offset:63488
s_barrier
v_add_u32 v16, 4294901760, v16
v_add_u32 v17, 4294901760, v17
v_add_u32 v18, 4294901760, v18
v_add_u32 v19, 4294901760, v19
s_waitcnt lgkmcnt(8)
v_mfma_f32_16x16x32_bf16 v[72:75], a[140:143], a[32:35], v[72:75]
ds_read_b64_tr_b16 a[132:133], v16 offset:0
v_mfma_f32_16x16x32_bf16 v[72:75], a[144:147], a[36:39], v[72:75]
ds_read_b64_tr_b16 a[134:135], v16 offset:2048
v_mfma_f32_16x16x32_bf16 v[76:79], a[144:147], a[44:47], v[76:79]
ds_read_b64_tr_b16 a[136:137], v16 offset:8192
v_mfma_f32_16x16x32_bf16 v[76:79], a[140:143], a[40:43], v[76:79]
ds_read_b64_tr_b16 a[138:139], v16 offset:10240
s_waitcnt lgkmcnt(8)
v_mfma_f32_16x16x32_bf16 v[80:83], a[148:151], a[32:35], v[80:83]
ds_read_b64_tr_b16 a[140:141], v17 offset:0
buffer_load_dwordx4 v7, s[40:43], s85 offen offset:3072 lds
v_mfma_f32_16x16x32_bf16 v[80:83], a[152:155], a[36:39], v[80:83]
ds_read_b64_tr_b16 a[142:143], v17 offset:2048
buffer_load_dwordx4 a[12:15], v15, s[12:15], s28 offen offset:1024 sc1
v_mfma_f32_16x16x32_bf16 v[84:87], a[152:155], a[44:47], v[84:87]
ds_read_b64_tr_b16 a[144:145], v17 offset:8192
v_mfma_f32_16x16x32_bf16 v[84:87], a[148:151], a[40:43], v[84:87]
ds_read_b64_tr_b16 a[146:147], v17 offset:10240
s_waitcnt lgkmcnt(8)
v_mfma_f32_16x16x32_bf16 v[88:91], a[156:159], a[32:35], v[88:91]
ds_read_b64_tr_b16 a[148:149], v18 offset:0
v_mfma_f32_16x16x32_bf16 v[88:91], a[160:163], a[36:39], v[88:91]
ds_read_b64_tr_b16 a[150:151], v18 offset:2048
v_mfma_f32_16x16x32_bf16 v[92:95], a[160:163], a[44:47], v[92:95]
ds_read_b64_tr_b16 a[152:153], v18 offset:8192
v_mfma_f32_16x16x32_bf16 v[92:95], a[156:159], a[40:43], v[92:95]
ds_read_b64_tr_b16 a[154:155], v18 offset:10240
s_waitcnt vmcnt(16) lgkmcnt(8)
v_mfma_f32_16x16x32_bf16 v[32:35], a[132:135], a[64:67], v[32:35]
ds_read_b64_tr_b16 a[156:157], v19 offset:0
s_add_u32 m0, s95, 135168
v_mfma_f32_16x16x32_bf16 v[32:35], a[136:139], a[68:71], v[32:35]
ds_read_b64_tr_b16 a[158:159], v19 offset:2048
buffer_load_dwordx4 v4, s[40:43], s94 offen offset:0 lds
v_mfma_f32_16x16x32_bf16 v[36:39], a[136:139], a[76:79], v[36:39]
ds_read_b64_tr_b16 a[160:161], v19 offset:8192
buffer_load_dwordx4 a[16:19], v1, s[12:15], s28 offen offset:2048 sc1
v_mfma_f32_16x16x32_bf16 v[36:39], a[132:135], a[72:75], v[36:39]
ds_read_b64_tr_b16 a[162:163], v19 offset:10240
s_waitcnt lgkmcnt(8)
v_mfma_f32_16x16x32_bf16 v[40:43], a[140:143], a[64:67], v[40:43]
ds_read_b64_tr_b16 a[132:133], v16 offset:4096
v_mfma_f32_16x16x32_bf16 v[40:43], a[144:147], a[68:71], v[40:43]
ds_read_b64_tr_b16 a[134:135], v16 offset:6144
v_mfma_f32_16x16x32_bf16 v[44:47], a[144:147], a[76:79], v[44:47]
ds_read_b64_tr_b16 a[136:137], v16 offset:12288
buffer_load_dword v12, v8, s[16:19], s101 offen sc1
v_mfma_f32_16x16x32_bf16 v[44:47], a[140:143], a[72:75], v[44:47]
ds_read_b64_tr_b16 a[138:139], v16 offset:14336
s_waitcnt lgkmcnt(8)
v_mfma_f32_16x16x32_bf16 v[48:51], a[148:151], a[64:67], v[48:51]
ds_read_b64_tr_b16 a[140:141], v17 offset:4096
v_mfma_f32_16x16x32_bf16 v[48:51], a[152:155], a[68:71], v[48:51]
ds_read_b64_tr_b16 a[142:143], v17 offset:6144
buffer_load_dwordx4 v5, s[40:43], s94 offen offset:1024 lds
v_mfma_f32_16x16x32_bf16 v[52:55], a[152:155], a[76:79], v[52:55]
ds_read_b64_tr_b16 a[144:145], v17 offset:12288
buffer_load_dwordx4 a[20:23], v1, s[12:15], s28 offen offset:3072 sc1
v_mfma_f32_16x16x32_bf16 v[52:55], a[148:151], a[72:75], v[52:55]
ds_read_b64_tr_b16 a[146:147], v17 offset:14336
s_waitcnt lgkmcnt(8)
v_mfma_f32_16x16x32_bf16 v[56:59], a[156:159], a[64:67], v[56:59]
ds_read_b64_tr_b16 a[148:149], v18 offset:4096
v_mfma_f32_16x16x32_bf16 v[56:59], a[160:163], a[68:71], v[56:59]
ds_read_b64_tr_b16 a[150:151], v18 offset:6144
v_mfma_f32_16x16x32_bf16 v[60:63], a[160:163], a[76:79], v[60:63]
ds_read_b64_tr_b16 a[152:153], v18 offset:12288
v_mfma_f32_16x16x32_bf16 v[60:63], a[156:159], a[72:75], v[60:63]
ds_read_b64_tr_b16 a[154:155], v18 offset:14336
s_waitcnt lgkmcnt(8)
v_mfma_f32_16x16x32_bf16 v[64:67], a[132:135], a[64:67], v[64:67]
ds_read_b64_tr_b16 a[156:157], v19 offset:4096
v_mfma_f32_16x16x32_bf16 v[64:67], a[136:139], a[68:71], v[64:67]
ds_read_b64_tr_b16 a[158:159], v19 offset:6144
buffer_load_dwordx4 a[24:27], v15, s[12:15], s28 offen offset:2048 sc1
v_mfma_f32_16x16x32_bf16 v[68:71], a[136:139], a[76:79], v[68:71]
ds_read_b64_tr_b16 a[160:161], v19 offset:12288
buffer_load_dwordx4 v6, s[40:43], s94 offen offset:2048 lds
v_mfma_f32_16x16x32_bf16 v[68:71], a[132:135], a[72:75], v[68:71]
ds_read_b64_tr_b16 a[162:163], v19 offset:14336
s_waitcnt lgkmcnt(8)
v_mfma_f32_16x16x32_bf16 v[72:75], a[140:143], a[64:67], v[72:75]
ds_read_b64_tr_b16 a[132:133], v16 offset:16384
v_mfma_f32_16x16x32_bf16 v[72:75], a[144:147], a[68:71], v[72:75]
ds_read_b64_tr_b16 a[134:135], v16 offset:18432
v_mfma_f32_16x16x32_bf16 v[76:79], a[144:147], a[76:79], v[76:79]
ds_read_b64_tr_b16 a[136:137], v16 offset:24576
v_mfma_f32_16x16x32_bf16 v[76:79], a[140:143], a[72:75], v[76:79]
ds_read_b64_tr_b16 a[138:139], v16 offset:26624
s_waitcnt lgkmcnt(8)
v_mfma_f32_16x16x32_bf16 v[80:83], a[148:151], a[64:67], v[80:83]
ds_read_b64_tr_b16 a[140:141], v17 offset:16384
v_mfma_f32_16x16x32_bf16 v[80:83], a[152:155], a[68:71], v[80:83]
ds_read_b64_tr_b16 a[142:143], v17 offset:18432
buffer_load_dwordx4 a[28:31], v15, s[12:15], s28 offen offset:3072 sc1
v_mfma_f32_16x16x32_bf16 v[84:87], a[152:155], a[76:79], v[84:87]
ds_read_b64_tr_b16 a[144:145], v17 offset:24576
v_mfma_f32_16x16x32_bf16 v[84:87], a[148:151], a[72:75], v[84:87]
ds_read_b64_tr_b16 a[146:147], v17 offset:26624
s_waitcnt lgkmcnt(8)
v_mfma_f32_16x16x32_bf16 v[88:91], a[156:159], a[64:67], v[88:91]
ds_read_b64_tr_b16 a[148:149], v18 offset:16384
buffer_load_dwordx4 v7, s[40:43], s94 offen offset:3072 lds
v_mfma_f32_16x16x32_bf16 v[88:91], a[160:163], a[68:71], v[88:91]
ds_read_b64_tr_b16 a[150:151], v18 offset:18432
v_mfma_f32_16x16x32_bf16 v[92:95], a[160:163], a[76:79], v[92:95]
ds_read_b64_tr_b16 a[152:153], v18 offset:24576
v_mfma_f32_16x16x32_bf16 v[92:95], a[156:159], a[72:75], v[92:95]
ds_read_b64_tr_b16 a[154:155], v18 offset:26624
s_waitcnt vmcnt(18) lgkmcnt(8)
v_mfma_f32_16x16x32_bf16 v[32:35], a[132:135], a[80:83], v[32:35]
ds_read_b64_tr_b16 a[156:157], v19 offset:16384
v_mfma_f32_16x16x32_bf16 v[32:35], a[136:139], a[84:87], v[32:35]
ds_read_b64_tr_b16 a[158:159], v19 offset:18432
s_add_u32 s28, s28, 4096
v_mfma_f32_16x16x32_bf16 v[36:39], a[136:139], a[92:95], v[36:39]
ds_read_b64_tr_b16 a[160:161], v19 offset:24576
buffer_load_dwordx4 a[32:35], v1, s[12:15], s28 offen offset:0 sc1
v_mfma_f32_16x16x32_bf16 v[36:39], a[132:135], a[88:91], v[36:39]
ds_read_b64_tr_b16 a[162:163], v19 offset:26624
s_waitcnt lgkmcnt(8)
v_mfma_f32_16x16x32_bf16 v[40:43], a[140:143], a[80:83], v[40:43]
ds_read_b64_tr_b16 a[132:133], v16 offset:20480
s_add_u32 s94, s92, 131072
v_mfma_f32_16x16x32_bf16 v[40:43], a[144:147], a[84:87], v[40:43]
ds_read_b64_tr_b16 a[134:135], v16 offset:22528
s_xor_b32 s85, s94, 128
v_mfma_f32_16x16x32_bf16 v[44:47], a[144:147], a[92:95], v[44:47]
ds_read_b64_tr_b16 a[136:137], v16 offset:28672
s_add_u32 m0, s95, 65536
v_mfma_f32_16x16x32_bf16 v[44:47], a[140:143], a[88:91], v[44:47]
ds_read_b64_tr_b16 a[138:139], v16 offset:30720
s_waitcnt lgkmcnt(8)
v_mfma_f32_16x16x32_bf16 v[48:51], a[148:151], a[80:83], v[48:51]
ds_read_b64_tr_b16 a[140:141], v17 offset:20480
buffer_load_dwordx4 v4, s[40:43], s85 offen offset:0 lds
v_mfma_f32_16x16x32_bf16 v[48:51], a[152:155], a[84:87], v[48:51]
ds_read_b64_tr_b16 a[142:143], v17 offset:22528
buffer_load_dwordx4 a[36:39], v1, s[12:15], s28 offen offset:1024 sc1
v_mfma_f32_16x16x32_bf16 v[52:55], a[152:155], a[92:95], v[52:55]
ds_read_b64_tr_b16 a[144:145], v17 offset:28672
v_mfma_f32_16x16x32_bf16 v[52:55], a[148:151], a[88:91], v[52:55]
ds_read_b64_tr_b16 a[146:147], v17 offset:30720
s_waitcnt lgkmcnt(8)
v_mfma_f32_16x16x32_bf16 v[56:59], a[156:159], a[80:83], v[56:59]
ds_read_b64_tr_b16 a[148:149], v18 offset:20480
buffer_load_dwordx4 v5, s[40:43], s85 offen offset:1024 lds
v_mfma_f32_16x16x32_bf16 v[56:59], a[160:163], a[84:87], v[56:59]
ds_read_b64_tr_b16 a[150:151], v18 offset:22528
v_mfma_f32_16x16x32_bf16 v[60:63], a[160:163], a[92:95], v[60:63]
ds_read_b64_tr_b16 a[152:153], v18 offset:28672
s_add_u32 s53, s55, 1048576
v_mfma_f32_16x16x32_bf16 v[60:63], a[156:159], a[88:91], v[60:63]
ds_read_b64_tr_b16 a[154:155], v18 offset:30720
s_waitcnt lgkmcnt(8)
v_mfma_f32_16x16x32_bf16 v[64:67], a[132:135], a[80:83], v[64:67]
ds_read_b64_tr_b16 a[156:157], v19 offset:20480
buffer_load_dword a250, v28, s[40:43], s53 offen
v_mfma_f32_16x16x32_bf16 v[64:67], a[136:139], a[84:87], v[64:67]
ds_read_b64_tr_b16 a[158:159], v19 offset:22528
buffer_load_dwordx4 a[40:43], v15, s[12:15], s28 offen offset:0 sc1
v_mfma_f32_16x16x32_bf16 v[68:71], a[136:139], a[92:95], v[68:71]
ds_read_b64_tr_b16 a[160:161], v19 offset:28672
v_mfma_f32_16x16x32_bf16 v[68:71], a[132:135], a[88:91], v[68:71]
ds_read_b64_tr_b16 a[162:163], v19 offset:30720
s_barrier
s_waitcnt lgkmcnt(8)
v_mfma_f32_16x16x32_bf16 v[72:75], a[140:143], a[80:83], v[72:75]
ds_read_b64_tr_b16 a[132:133], v16 offset:32768
v_mfma_f32_16x16x32_bf16 v[72:75], a[144:147], a[84:87], v[72:75]
ds_read_b64_tr_b16 a[134:135], v16 offset:34816
buffer_load_dwordx4 v6, s[40:43], s85 offen offset:2048 lds
v_mfma_f32_16x16x32_bf16 v[76:79], a[144:147], a[92:95], v[76:79]
ds_read_b64_tr_b16 a[136:137], v16 offset:40960
v_mfma_f32_16x16x32_bf16 v[76:79], a[140:143], a[88:91], v[76:79]
ds_read_b64_tr_b16 a[138:139], v16 offset:43008
s_waitcnt lgkmcnt(8)
v_mfma_f32_16x16x32_bf16 v[80:83], a[148:151], a[80:83], v[80:83]
ds_read_b64_tr_b16 a[140:141], v17 offset:32768
v_mfma_f32_16x16x32_bf16 v[80:83], a[152:155], a[84:87], v[80:83]
ds_read_b64_tr_b16 a[142:143], v17 offset:34816
buffer_load_dwordx4 a[44:47], v15, s[12:15], s28 offen offset:1024 sc1
v_mfma_f32_16x16x32_bf16 v[84:87], a[152:155], a[92:95], v[84:87]
ds_read_b64_tr_b16 a[144:145], v17 offset:40960
v_mfma_f32_16x16x32_bf16 v[84:87], a[148:151], a[88:91], v[84:87]
ds_read_b64_tr_b16 a[146:147], v17 offset:43008
s_waitcnt lgkmcnt(8)
v_mfma_f32_16x16x32_bf16 v[88:91], a[156:159], a[80:83], v[88:91]
ds_read_b64_tr_b16 a[148:149], v18 offset:32768
v_mfma_f32_16x16x32_bf16 v[88:91], a[160:163], a[84:87], v[88:91]
ds_read_b64_tr_b16 a[150:151], v18 offset:34816
v_mfma_f32_16x16x32_bf16 v[92:95], a[160:163], a[92:95], v[92:95]
ds_read_b64_tr_b16 a[152:153], v18 offset:40960
buffer_load_dwordx4 v7, s[40:43], s85 offen offset:3072 lds
v_mfma_f32_16x16x32_bf16 v[92:95], a[156:159], a[88:91], v[92:95]
ds_read_b64_tr_b16 a[154:155], v18 offset:43008
s_waitcnt vmcnt(18) lgkmcnt(8)
v_mfma_f32_16x16x32_bf16 v[32:35], a[132:135], a[0:3], v[32:35]
ds_read_b64_tr_b16 a[156:157], v19 offset:32768
v_mfma_f32_16x16x32_bf16 v[32:35], a[136:139], a[4:7], v[32:35]
ds_read_b64_tr_b16 a[158:159], v19 offset:34816
buffer_load_dwordx4 a[64:67], v1, s[12:15], s28 offen offset:2048 sc1
v_mfma_f32_16x16x32_bf16 v[36:39], a[136:139], a[12:15], v[36:39]
ds_read_b64_tr_b16 a[160:161], v19 offset:40960
v_mfma_f32_16x16x32_bf16 v[36:39], a[132:135], a[8:11], v[36:39]
ds_read_b64_tr_b16 a[162:163], v19 offset:43008
s_waitcnt lgkmcnt(8)
v_mfma_f32_16x16x32_bf16 v[40:43], a[140:143], a[0:3], v[40:43]
ds_read_b64_tr_b16 a[132:133], v16 offset:36864
v_mfma_f32_16x16x32_bf16 v[40:43], a[144:147], a[4:7], v[40:43]
ds_read_b64_tr_b16 a[134:135], v16 offset:38912
v_mfma_f32_16x16x32_bf16 v[44:47], a[144:147], a[12:15], v[44:47]
ds_read_b64_tr_b16 a[136:137], v16 offset:45056
v_mfma_f32_16x16x32_bf16 v[44:47], a[140:143], a[8:11], v[44:47]
ds_read_b64_tr_b16 a[138:139], v16 offset:47104
s_waitcnt lgkmcnt(8)
v_mfma_f32_16x16x32_bf16 v[48:51], a[148:151], a[0:3], v[48:51]
ds_read_b64_tr_b16 a[140:141], v17 offset:36864
s_add_u32 m0, s95, 69632
v_mfma_f32_16x16x32_bf16 v[48:51], a[152:155], a[4:7], v[48:51]
ds_read_b64_tr_b16 a[142:143], v17 offset:38912
buffer_load_dwordx4 v4, s[40:43], s94 offen offset:0 lds
v_mfma_f32_16x16x32_bf16 v[52:55], a[152:155], a[12:15], v[52:55]
ds_read_b64_tr_b16 a[144:145], v17 offset:45056
buffer_load_dwordx4 a[68:71], v1, s[12:15], s28 offen offset:3072 sc1
v_mfma_f32_16x16x32_bf16 v[52:55], a[148:151], a[8:11], v[52:55]
ds_read_b64_tr_b16 a[146:147], v17 offset:47104
s_waitcnt lgkmcnt(8)
v_mfma_f32_16x16x32_bf16 v[56:59], a[156:159], a[0:3], v[56:59]
ds_read_b64_tr_b16 a[148:149], v18 offset:36864
v_mfma_f32_16x16x32_bf16 v[56:59], a[160:163], a[4:7], v[56:59]
ds_read_b64_tr_b16 a[150:151], v18 offset:38912
v_mfma_f32_16x16x32_bf16 v[60:63], a[160:163], a[12:15], v[60:63]
ds_read_b64_tr_b16 a[152:153], v18 offset:45056
v_mfma_f32_16x16x32_bf16 v[60:63], a[156:159], a[8:11], v[60:63]
ds_read_b64_tr_b16 a[154:155], v18 offset:47104
s_waitcnt lgkmcnt(8)
v_mfma_f32_16x16x32_bf16 v[64:67], a[132:135], a[0:3], v[64:67]
ds_read_b64_tr_b16 a[156:157], v19 offset:36864
buffer_load_dwordx4 v5, s[40:43], s94 offen offset:1024 lds
v_mfma_f32_16x16x32_bf16 v[64:67], a[136:139], a[4:7], v[64:67]
ds_read_b64_tr_b16 a[158:159], v19 offset:38912
buffer_load_dwordx4 a[72:75], v15, s[12:15], s28 offen offset:2048 sc1
v_mfma_f32_16x16x32_bf16 v[68:71], a[136:139], a[12:15], v[68:71]
ds_read_b64_tr_b16 a[160:161], v19 offset:45056
v_mfma_f32_16x16x32_bf16 v[68:71], a[132:135], a[8:11], v[68:71]
ds_read_b64_tr_b16 a[162:163], v19 offset:47104
s_waitcnt lgkmcnt(8)
v_mfma_f32_16x16x32_bf16 v[72:75], a[140:143], a[0:3], v[72:75]
ds_read_b64_tr_b16 a[132:133], v16 offset:49152
v_mfma_f32_16x16x32_bf16 v[72:75], a[144:147], a[4:7], v[72:75]
ds_read_b64_tr_b16 a[134:135], v16 offset:51200
v_mfma_f32_16x16x32_bf16 v[76:79], a[144:147], a[12:15], v[76:79]
ds_read_b64_tr_b16 a[136:137], v16 offset:57344
v_mfma_f32_16x16x32_bf16 v[76:79], a[140:143], a[8:11], v[76:79]
ds_read_b64_tr_b16 a[138:139], v16 offset:59392
s_waitcnt lgkmcnt(8)
v_mfma_f32_16x16x32_bf16 v[80:83], a[148:151], a[0:3], v[80:83]
ds_read_b64_tr_b16 a[140:141], v17 offset:49152
v_mfma_f32_16x16x32_bf16 v[80:83], a[152:155], a[4:7], v[80:83]
ds_read_b64_tr_b16 a[142:143], v17 offset:51200
buffer_load_dwordx4 v6, s[40:43], s94 offen offset:2048 lds
v_mfma_f32_16x16x32_bf16 v[84:87], a[152:155], a[12:15], v[84:87]
ds_read_b64_tr_b16 a[144:145], v17 offset:57344
buffer_load_dwordx4 a[76:79], v15, s[12:15], s28 offen offset:3072 sc1
v_mfma_f32_16x16x32_bf16 v[84:87], a[148:151], a[8:11], v[84:87]
ds_read_b64_tr_b16 a[146:147], v17 offset:59392
s_waitcnt lgkmcnt(8)
v_mfma_f32_16x16x32_bf16 v[88:91], a[156:159], a[0:3], v[88:91]
ds_read_b64_tr_b16 a[148:149], v18 offset:49152
v_mfma_f32_16x16x32_bf16 v[88:91], a[160:163], a[4:7], v[88:91]
ds_read_b64_tr_b16 a[150:151], v18 offset:51200
v_mfma_f32_16x16x32_bf16 v[92:95], a[160:163], a[12:15], v[92:95]
ds_read_b64_tr_b16 a[152:153], v18 offset:57344
v_mfma_f32_16x16x32_bf16 v[92:95], a[156:159], a[8:11], v[92:95]
ds_read_b64_tr_b16 a[154:155], v18 offset:59392
s_waitcnt vmcnt(17) lgkmcnt(8)
v_mfma_f32_16x16x32_bf16 v[32:35], a[132:135], a[16:19], v[32:35]
ds_read_b64_tr_b16 a[156:157], v19 offset:49152
v_cmp_gt_u32 vcc, 6, v12
s_nop 0
s_cbranch_vccnz L_spin6
L_rdy6:
v_mfma_f32_16x16x32_bf16 v[32:35], a[136:139], a[20:23], v[32:35]
ds_read_b64_tr_b16 a[158:159], v19 offset:51200
s_add_u32 s28, s28, 12288
v_mfma_f32_16x16x32_bf16 v[36:39], a[136:139], a[28:31], v[36:39]
ds_read_b64_tr_b16 a[160:161], v19 offset:57344
buffer_load_dwordx4 a[80:83], v1, s[12:15], s28 offen offset:0 sc1
v_mfma_f32_16x16x32_bf16 v[36:39], a[132:135], a[24:27], v[36:39]
ds_read_b64_tr_b16 a[162:163], v19 offset:59392
s_waitcnt lgkmcnt(8)
v_mfma_f32_16x16x32_bf16 v[40:43], a[140:143], a[16:19], v[40:43]
ds_read_b64_tr_b16 a[132:133], v16 offset:53248
buffer_load_dwordx4 v7, s[40:43], s94 offen offset:3072 lds
v_mfma_f32_16x16x32_bf16 v[40:43], a[144:147], a[20:23], v[40:43]
ds_read_b64_tr_b16 a[134:135], v16 offset:55296
v_mfma_f32_16x16x32_bf16 v[44:47], a[144:147], a[28:31], v[44:47]
ds_read_b64_tr_b16 a[136:137], v16 offset:61440
v_mfma_f32_16x16x32_bf16 v[44:47], a[140:143], a[24:27], v[44:47]
ds_read_b64_tr_b16 a[138:139], v16 offset:63488
s_waitcnt lgkmcnt(8)
v_mfma_f32_16x16x32_bf16 v[48:51], a[148:151], a[16:19], v[48:51]
ds_read_b64_tr_b16 a[140:141], v17 offset:53248
v_mfma_f32_16x16x32_bf16 v[48:51], a[152:155], a[20:23], v[48:51]
ds_read_b64_tr_b16 a[142:143], v17 offset:55296
buffer_load_dwordx4 a[84:87], v1, s[12:15], s28 offen offset:1024 sc1
v_mfma_f32_16x16x32_bf16 v[52:55], a[152:155], a[28:31], v[52:55]
ds_read_b64_tr_b16 a[144:145], v17 offset:61440
v_mfma_f32_16x16x32_bf16 v[52:55], a[148:151], a[24:27], v[52:55]
ds_read_b64_tr_b16 a[146:147], v17 offset:63488
s_waitcnt lgkmcnt(8)
v_mfma_f32_16x16x32_bf16 v[56:59], a[156:159], a[16:19], v[56:59]
ds_read_b64_tr_b16 a[148:149], v18 offset:53248
s_add_u32 s94, s92, 1048576
v_mfma_f32_16x16x32_bf16 v[56:59], a[160:163], a[20:23], v[56:59]
ds_read_b64_tr_b16 a[150:151], v18 offset:55296
s_xor_b32 s85, s94, 128
v_mfma_f32_16x16x32_bf16 v[60:63], a[160:163], a[28:31], v[60:63]
ds_read_b64_tr_b16 a[152:153], v18 offset:61440
s_add_u32 m0, s95, 98304
v_mfma_f32_16x16x32_bf16 v[60:63], a[156:159], a[24:27], v[60:63]
ds_read_b64_tr_b16 a[154:155], v18 offset:63488
s_waitcnt lgkmcnt(8)
v_mfma_f32_16x16x32_bf16 v[64:67], a[132:135], a[16:19], v[64:67]
ds_read_b64_tr_b16 a[156:157], v19 offset:53248
buffer_load_dwordx4 v4, s[40:43], s85 offen offset:0 lds
v_mfma_f32_16x16x32_bf16 v[64:67], a[136:139], a[20:23], v[64:67]
ds_read_b64_tr_b16 a[158:159], v19 offset:55296
s_add_u32 s53, s55, 1966080
v_mfma_f32_16x16x32_bf16 v[68:71], a[136:139], a[28:31], v[68:71]
ds_read_b64_tr_b16 a[160:161], v19 offset:61440
buffer_load_dword a250, v28, s[40:43], s53 offen
v_mfma_f32_16x16x32_bf16 v[68:71], a[132:135], a[24:27], v[68:71]
ds_read_b64_tr_b16 a[162:163], v19 offset:63488
s_waitcnt vmcnt(21)
s_barrier
v_add_u32 v16, 131072, v16
v_add_u32 v17, 131072, v17
v_add_u32 v18, 131072, v18
v_add_u32 v19, 131072, v19
s_waitcnt lgkmcnt(8)
v_mfma_f32_16x16x32_bf16 v[72:75], a[140:143], a[16:19], v[72:75]
ds_read_b64_tr_b16 a[132:133], v16 offset:0
buffer_load_dwordx4 a[88:91], v15, s[12:15], s28 offen offset:0 sc1
v_mfma_f32_16x16x32_bf16 v[72:75], a[144:147], a[20:23], v[72:75]
ds_read_b64_tr_b16 a[134:135], v16 offset:2048
buffer_load_dwordx4 v5, s[40:43], s85 offen offset:1024 lds
v_mfma_f32_16x16x32_bf16 v[76:79], a[144:147], a[28:31], v[76:79]
ds_read_b64_tr_b16 a[136:137], v16 offset:8192
v_mfma_f32_16x16x32_bf16 v[76:79], a[140:143], a[24:27], v[76:79]
ds_read_b64_tr_b16 a[138:139], v16 offset:10240
s_waitcnt lgkmcnt(8)
v_mfma_f32_16x16x32_bf16 v[80:83], a[148:151], a[16:19], v[80:83]
ds_read_b64_tr_b16 a[140:141], v17 offset:0
v_mfma_f32_16x16x32_bf16 v[80:83], a[152:155], a[20:23], v[80:83]
ds_read_b64_tr_b16 a[142:143], v17 offset:2048
buffer_load_dwordx4 a[92:95], v15, s[12:15], s28 offen offset:1024 sc1
v_mfma_f32_16x16x32_bf16 v[84:87], a[152:155], a[28:31], v[84:87]
ds_read_b64_tr_b16 a[144:145], v17 offset:8192
v_mfma_f32_16x16x32_bf16 v[84:87], a[148:151], a[24:27], v[84:87]
ds_read_b64_tr_b16 a[146:147], v17 offset:10240
s_waitcnt lgkmcnt(8)
v_mfma_f32_16x16x32_bf16 v[88:91], a[156:159], a[16:19], v[88:91]
ds_read_b64_tr_b16 a[148:149], v18 offset:0
v_mfma_f32_16x16x32_bf16 v[88:91], a[160:163], a[20:23], v[88:91]
ds_read_b64_tr_b16 a[150:151], v18 offset:2048
buffer_load_dwordx4 v6, s[40:43], s85 offen offset:2048 lds
v_mfma_f32_16x16x32_bf16 v[92:95], a[160:163], a[28:31], v[92:95]
ds_read_b64_tr_b16 a[152:153], v18 offset:8192
v_mfma_f32_16x16x32_bf16 v[92:95], a[156:159], a[24:27], v[92:95]
ds_read_b64_tr_b16 a[154:155], v18 offset:10240
s_waitcnt vmcnt(17) lgkmcnt(8)
v_mfma_f32_16x16x32_bf16 v[32:35], a[132:135], a[32:35], v[32:35]
ds_read_b64_tr_b16 a[156:157], v19 offset:0
v_mfma_f32_16x16x32_bf16 v[32:35], a[136:139], a[36:39], v[32:35]
ds_read_b64_tr_b16 a[158:159], v19 offset:2048
buffer_load_dwordx4 a[0:3], v1, s[12:15], s28 offen offset:2048 sc1
v_mfma_f32_16x16x32_bf16 v[36:39], a[136:139], a[44:47], v[36:39]
ds_read_b64_tr_b16 a[160:161], v19 offset:8192
v_mfma_f32_16x16x32_bf16 v[36:39], a[132:135], a[40:43], v[36:39]
ds_read_b64_tr_b16 a[162:163], v19 offset:10240
s_waitcnt lgkmcnt(8)
v_mfma_f32_16x16x32_bf16 v[40:43], a[140:143], a[32:35], v[40:43]
ds_read_b64_tr_b16 a[132:133], v16 offset:4096
v_mfma_f32_16x16x32_bf16 v[40:43], a[144:147], a[36:39], v[40:43]
ds_read_b64_tr_b16 a[134:135], v16 offset:6144
buffer_load_dwordx4 v7, s[40:43], s85 offen offset:3072 lds
v_mfma_f32_16x16x32_bf16 v[44:47], a[144:147], a[44:47], v[44:47]
ds_read_b64_tr_b16 a[136:137], v16 offset:12288
v_mfma_f32_16x16x32_bf16 v[44:47], a[140:143], a[40:43], v[44:47]
ds_read_b64_tr_b16 a[138:139], v16 offset:14336
s_waitcnt lgkmcnt(8)
v_mfma_f32_16x16x32_bf16 v[48:51], a[148:151], a[32:35], v[48:51]
ds_read_b64_tr_b16 a[140:141], v17 offset:4096
v_mfma_f32_16x16x32_bf16 v[48:51], a[152:155], a[36:39], v[48:51]
ds_read_b64_tr_b16 a[142:143], v17 offset:6144
buffer_load_dwordx4 a[4:7], v1, s[12:15], s28 offen offset:3072 sc1
v_mfma_f32_16x16x32_bf16 v[52:55], a[152:155], a[44:47], v[52:55]
ds_read_b64_tr_b16 a[144:145], v17 offset:12288
v_mfma_f32_16x16x32_bf16 v[52:55], a[148:151], a[40:43], v[52:55]
ds_read_b64_tr_b16 a[146:147], v17 offset:14336
s_waitcnt lgkmcnt(8)
v_mfma_f32_16x16x32_bf16 v[56:59], a[156:159], a[32:35], v[56:59]
ds_read_b64_tr_b16 a[148:149], v18 offset:4096
v_mfma_f32_16x16x32_bf16 v[56:59], a[160:163], a[36:39], v[56:59]
ds_read_b64_tr_b16 a[150:151], v18 offset:6144
v_mfma_f32_16x16x32_bf16 v[60:63], a[160:163], a[44:47], v[60:63]
ds_read_b64_tr_b16 a[152:153], v18 offset:12288
s_add_u32 m0, s95, 102400
v_mfma_f32_16x16x32_bf16 v[60:63], a[156:159], a[40:43], v[60:63]
ds_read_b64_tr_b16 a[154:155], v18 offset:14336
s_waitcnt lgkmcnt(8)
v_mfma_f32_16x16x32_bf16 v[64:67], a[132:135], a[32:35], v[64:67]
ds_read_b64_tr_b16 a[156:157], v19 offset:4096
buffer_load_dwordx4 v4, s[40:43], s94 offen offset:0 lds
v_mfma_f32_16x16x32_bf16 v[64:67], a[136:139], a[36:39], v[64:67]
ds_read_b64_tr_b16 a[158:159], v19 offset:6144
buffer_load_dwordx4 a[8:11], v15, s[12:15], s28 offen offset:2048 sc1
v_mfma_f32_16x16x32_bf16 v[68:71], a[136:139], a[44:47], v[68:71]
ds_read_b64_tr_b16 a[160:161], v19 offset:12288
v_mfma_f32_16x16x32_bf16 v[68:71], a[132:135], a[40:43], v[68:71]
ds_read_b64_tr_b16 a[162:163], v19 offset:14336
s_waitcnt lgkmcnt(8)
v_mfma_f32_16x16x32_bf16 v[72:75], a[140:143], a[32:35], v[72:75]
ds_read_b64_tr_b16 a[132:133], v16 offset:16384
v_mfma_f32_16x16x32_bf16 v[72:75], a[144:147], a[36:39], v[72:75]
ds_read_b64_tr_b16 a[134:135], v16 offset:18432
v_mfma_f32_16x16x32_bf16 v[76:79], a[144:147], a[44:47], v[76:79]
ds_read_b64_tr_b16 a[136:137], v16 offset:24576
v_mfma_f32_16x16x32_bf16 v[76:79], a[140:143], a[40:43], v[76:79]
ds_read_b64_tr_b16 a[138:139], v16 offset:26624
s_waitcnt lgkmcnt(8)
v_mfma_f32_16x16x32_bf16 v[80:83], a[148:151], a[32:35], v[80:83]
ds_read_b64_tr_b16 a[140:141], v17 offset:16384
buffer_load_dwordx4 v5, s[40:43], s94 offen offset:1024 lds
v_mfma_f32_16x16x32_bf16 v[80:83], a[152:155], a[36:39], v[80:83]
ds_read_b64_tr_b16 a[142:143], v17 offset:18432
L_pg13:
s_cbranch_execz L_vret
buffer_load_dwordx4 a[12:15], v15, s[12:15], s28 offen offset:3072 sc1
v_mfma_f32_16x16x32_bf16 v[84:87], a[152:155], a[44:47], v[84:87]
ds_read_b64_tr_b16 a[144:145], v17 offset:24576
v_mfma_f32_16x16x32_bf16 v[84:87], a[148:151], a[40:43], v[84:87]
ds_read_b64_tr_b16 a[146:147], v17 offset:26624
s_waitcnt lgkmcnt(8)
v_mfma_f32_16x16x32_bf16 v[88:91], a[156:159], a[32:35], v[88:91]
ds_read_b64_tr_b16 a[148:149], v18 offset:16384
v_mfma_f32_16x16x32_bf16 v[88:91], a[160:163], a[36:39], v[88:91]
ds_read_b64_tr_b16 a[150:151], v18 offset:18432
v_mfma_f32_16x16x32_bf16 v[92:95], a[160:163], a[44:47], v[92:95]
ds_read_b64_tr_b16 a[152:153], v18 offset:24576
v_mfma_f32_16x16x32_bf16 v[92:95], a[156:159], a[40:43], v[92:95]
ds_read_b64_tr_b16 a[154:155], v18 offset:26624
s_waitcnt vmcnt(16) lgkmcnt(8)
v_mfma_f32_16x16x32_bf16 v[32:35], a[132:135], a[64:67], v[32:35]
ds_read_b64_tr_b16 a[156:157], v19 offset:16384
buffer_load_dwordx4 v6, s[40:43], s94 offen offset:2048 lds
v_mfma_f32_16x16x32_bf16 v[32:35], a[136:139], a[68:71], v[32:35]
ds_read_b64_tr_b16 a[158:159], v19 offset:18432
s_add_u32 s28, s28, 4096
v_mfma_f32_16x16x32_bf16 v[36:39], a[136:139], a[76:79], v[36:39]
ds_read_b64_tr_b16 a[160:161], v19 offset:24576
buffer_load_dwordx4 a[16:19], v1, s[12:15], s28 offen offset:0 sc1
v_mfma_f32_16x16x32_bf16 v[36:39], a[132:135], a[72:75], v[36:39]
ds_read_b64_tr_b16 a[162:163], v19 offset:26624
s_waitcnt lgkmcnt(8)
v_mfma_f32_16x16x32_bf16 v[40:43], a[140:143], a[64:67], v[40:43]
ds_read_b64_tr_b16 a[132:133], v16 offset:20480
v_mfma_f32_16x16x32_bf16 v[40:43], a[144:147], a[68:71], v[40:43]
ds_read_b64_tr_b16 a[134:135], v16 offset:22528
v_mfma_f32_16x16x32_bf16 v[44:47], a[144:147], a[76:79], v[44:47]
ds_read_b64_tr_b16 a[136:137], v16 offset:28672
v_mfma_f32_16x16x32_bf16 v[44:47], a[140:143], a[72:75], v[44:47]
ds_read_b64_tr_b16 a[138:139], v16 offset:30720
s_waitcnt lgkmcnt(8)
v_mfma_f32_16x16x32_bf16 v[48:51], a[148:151], a[64:67], v[48:51]
ds_read_b64_tr_b16 a[140:141], v17 offset:20480
v_mfma_f32_16x16x32_bf16 v[48:51], a[152:155], a[68:71], v[48:51]
ds_read_b64_tr_b16 a[142:143], v17 offset:22528
buffer_load_dwordx4 v7, s[40:43], s94 offen offset:3072 lds
v_mfma_f32_16x16x32_bf16 v[52:55], a[152:155], a[76:79], v[52:55]
ds_read_b64_tr_b16 a[144:145], v17 offset:28672
buffer_load_dwordx4 a[20:23], v1, s[12:15], s28 offen offset:1024 sc1
v_mfma_f32_16x16x32_bf16 v[52:55], a[148:151], a[72:75], v[52:55]
ds_read_b64_tr_b16 a[146:147], v17 offset:30720
s_waitcnt lgkmcnt(8)
v_mfma_f32_16x16x32_bf16 v[56:59], a[156:159], a[64:67], v[56:59]
ds_read_b64_tr_b16 a[148:149], v18 offset:20480
v_mfma_f32_16x16x32_bf16 v[56:59], a[160:163], a[68:71], v[56:59]
ds_read_b64_tr_b16 a[150:151], v18 offset:22528
v_mfma_f32_16x16x32_bf16 v[60:63], a[160:163], a[76:79], v[60:63]
ds_read_b64_tr_b16 a[152:153], v18 offset:28672
s_add_u32 s53, s55, 2883584
v_mfma_f32_16x16x32_bf16 v[60:63], a[156:159], a[72:75], v[60:63]
ds_read_b64_tr_b16 a[154:155], v18 offset:30720
s_waitcnt lgkmcnt(8)
v_mfma_f32_16x16x32_bf16 v[64:67], a[132:135], a[64:67], v[64:67]
ds_read_b64_tr_b16 a[156:157], v19 offset:20480
buffer_load_dword a250, v28, s[40:43], s53 offen
v_mfma_f32_16x16x32_bf16 v[64:67], a[136:139], a[68:71], v[64:67]
ds_read_b64_tr_b16 a[158:159], v19 offset:22528
buffer_load_dwordx4 a[24:27], v15, s[12:15], s28 offen offset:0 sc1
v_mfma_f32_16x16x32_bf16 v[68:71], a[136:139], a[76:79], v[68:71]
ds_read_b64_tr_b16 a[160:161], v19 offset:28672
s_add_u32 s94, s92, 1966080
v_mfma_f32_16x16x32_bf16 v[68:71], a[132:135], a[72:75], v[68:71]
ds_read_b64_tr_b16 a[162:163], v19 offset:30720
s_waitcnt vmcnt(20)
s_barrier
v_add_u32 v16, 4294901760, v16
v_add_u32 v17, 4294901760, v17
v_add_u32 v18, 4294901760, v18
v_add_u32 v19, 4294901760, v19
s_waitcnt lgkmcnt(8)
v_mfma_f32_16x16x32_bf16 v[72:75], a[140:143], a[64:67], v[72:75]
ds_read_b64_tr_b16 a[132:133], v16 offset:0
s_xor_b32 s85, s94, 128
v_mfma_f32_16x16x32_bf16 v[72:75], a[144:147], a[68:71], v[72:75]
ds_read_b64_tr_b16 a[134:135], v16 offset:2048
s_add_u32 m0, s95, 0
v_mfma_f32_16x16x32_bf16 v[76:79], a[144:147], a[76:79], v[76:79]
ds_read_b64_tr_b16 a[136:137], v16 offset:8192
buffer_load_dwordx4 v4, s[40:43], s85 offen offset:0 lds
v_mfma_f32_16x16x32_bf16 v[76:79], a[140:143], a[72:75], v[76:79]
ds_read_b64_tr_b16 a[138:139], v16 offset:10240
s_waitcnt lgkmcnt(8)
v_mfma_f32_16x16x32_bf16 v[80:83], a[148:151], a[64:67], v[80:83]
ds_read_b64_tr_b16 a[140:141], v17 offset:0
v_mfma_f32_16x16x32_bf16 v[80:83], a[152:155], a[68:71], v[80:83]
ds_read_b64_tr_b16 a[142:143], v17 offset:2048
buffer_load_dwordx4 a[28:31], v15, s[12:15], s28 offen offset:1024 sc1
v_mfma_f32_16x16x32_bf16 v[84:87], a[152:155], a[76:79], v[84:87]
ds_read_b64_tr_b16 a[144:145], v17 offset:8192
v_mfma_f32_16x16x32_bf16 v[84:87], a[148:151], a[72:75], v[84:87]
ds_read_b64_tr_b16 a[146:147], v17 offset:10240
s_waitcnt lgkmcnt(8)
v_mfma_f32_16x16x32_bf16 v[88:91], a[156:159], a[64:67], v[88:91]
ds_read_b64_tr_b16 a[148:149], v18 offset:0
buffer_load_dwordx4 v5, s[40:43], s85 offen offset:1024 lds
v_mfma_f32_16x16x32_bf16 v[88:91], a[160:163], a[68:71], v[88:91]
ds_read_b64_tr_b16 a[150:151], v18 offset:2048
v_mfma_f32_16x16x32_bf16 v[92:95], a[160:163], a[76:79], v[92:95]
ds_read_b64_tr_b16 a[152:153], v18 offset:8192
v_mfma_f32_16x16x32_bf16 v[92:95], a[156:159], a[72:75], v[92:95]
ds_read_b64_tr_b16 a[154:155], v18 offset:10240
s_waitcnt vmcnt(17) lgkmcnt(8)
v_mfma_f32_16x16x32_bf16 v[32:35], a[132:135], a[80:83], v[32:35]
ds_read_b64_tr_b16 a[156:157], v19 offset:0
v_mfma_f32_16x16x32_bf16 v[32:35], a[136:139], a[84:87], v[32:35]
ds_read_b64_tr_b16 a[158:159], v19 offset:2048
buffer_load_dwordx4 a[32:35], v1, s[12:15], s28 offen offset:2048 sc1
v_mfma_f32_16x16x32_bf16 v[36:39], a[136:139], a[92:95], v[36:39]
ds_read_b64_tr_b16 a[160:161], v19 offset:8192
v_mfma_f32_16x16x32_bf16 v[36:39], a[132:135], a[88:91], v[36:39]
ds_read_b64_tr_b16 a[162:163], v19 offset:10240
s_waitcnt lgkmcnt(8)
v_mfma_f32_16x16x32_bf16 v[40:43], a[140:143], a[80:83], v[40:43]
ds_read_b64_tr_b16 a[132:133], v16 offset:4096
buffer_load_dwordx4 v6, s[40:43], s85 offen offset:2048 lds
v_mfma_f32_16x16x32_bf16 v[40:43], a[144:147], a[84:87], v[40:43]
ds_read_b64_tr_b16 a[134:135], v16 offset:6144
v_mfma_f32_16x16x32_bf16 v[44:47], a[144:147], a[92:95], v[44:47]
ds_read_b64_tr_b16 a[136:137], v16 offset:12288
v_mfma_f32_16x16x32_bf16 v[44:47], a[140:143], a[88:91], v[44:47]
ds_read_b64_tr_b16 a[138:139], v16 offset:14336
s_waitcnt lgkmcnt(8)
v_mfma_f32_16x16x32_bf16 v[48:51], a[148:151], a[80:83], v[48:51]
ds_read_b64_tr_b16 a[140:141], v17 offset:4096
v_mfma_f32_16x16x32_bf16 v[48:51], a[152:155], a[84:87], v[48:51]
ds_read_b64_tr_b16 a[142:143], v17 offset:6144
buffer_load_dwordx4 a[36:39], v1, s[12:15], s28 offen offset:3072 sc1
v_mfma_f32_16x16x32_bf16 v[52:55], a[152:155], a[92:95], v[52:55]
ds_read_b64_tr_b16 a[144:145], v17 offset:12288
v_mfma_f32_16x16x32_bf16 v[52:55], a[148:151], a[88:91], v[52:55]
ds_read_b64_tr_b16 a[146:147], v17 offset:14336
s_waitcnt lgkmcnt(8)
v_mfma_f32_16x16x32_bf16 v[56:59], a[156:159], a[80:83], v[56:59]
ds_read_b64_tr_b16 a[148:149], v18 offset:4096
v_mfma_f32_16x16x32_bf16 v[56:59], a[160:163], a[84:87], v[56:59]
ds_read_b64_tr_b16 a[150:151], v18 offset:6144
buffer_load_dwordx4 v7, s[40:43], s85 offen offset:3072 lds
v_mfma_f32_16x16x32_bf16 v[60:63], a[160:163], a[92:95], v[60:63]
ds_read_b64_tr_b16 a[152:153], v18 offset:12288
v_mfma_f32_16x16x32_bf16 v[60:63], a[156:159], a[88:91], v[60:63]
ds_read_b64_tr_b16 a[154:155], v18 offset:14336
s_waitcnt lgkmcnt(8)
v_mfma_f32_16x16x32_bf16 v[64:67], a[132:135], a[80:83], v[64:67]
ds_read_b64_tr_b16 a[156:157], v19 offset:4096
v_mfma_f32_16x16x32_bf16 v[64:67], a[136:139], a[84:87], v[64:67]
ds_read_b64_tr_b16 a[158:159], v19 offset:6144
buffer_load_dwordx4 a[40:43], v15, s[12:15], s28 offen offset:2048 sc1
v_mfma_f32_16x16x32_bf16 v[68:71], a[136:139], a[92:95], v[68:71]
ds_read_b64_tr_b16 a[160:161], v19 offset:12288
v_mfma_f32_16x16x32_bf16 v[68:71], a[132:135], a[88:91], v[68:71]
ds_read_b64_tr_b16 a[162:163], v19 offset:14336
s_waitcnt lgkmcnt(8)
v_mfma_f32_16x16x32_bf16 v[72:75], a[140:143], a[80:83], v[72:75]
ds_read_b64_tr_b16 a[132:133], v16 offset:16384
v_mfma_f32_16x16x32_bf16 v[72:75], a[144:147], a[84:87], v[72:75]
ds_read_b64_tr_b16 a[134:135], v16 offset:18432
v_mfma_f32_16x16x32_bf16 v[76:79], a[144:147], a[92:95], v[76:79]
ds_read_b64_tr_b16 a[136:137], v16 offset:24576
s_add_u32 m0, s95, 4096
v_mfma_f32_16x16x32_bf16 v[76:79], a[140:143], a[88:91], v[76:79]
ds_read_b64_tr_b16 a[138:139], v16 offset:26624
s_waitcnt lgkmcnt(8)
v_mfma_f32_16x16x32_bf16 v[80:83], a[148:151], a[80:83], v[80:83]
ds_read_b64_tr_b16 a[140:141], v17 offset:16384
buffer_load_dwordx4 v4, s[40:43], s94 offen offset:0 lds
v_mfma_f32_16x16x32_bf16 v[80:83], a[152:155], a[84:87], v[80:83]
ds_read_b64_tr_b16 a[142:143], v17 offset:18432
buffer_load_dwordx4 a[44:47], v15, s[12:15], s28 offen offset:3072 sc1
v_mfma_f32_16x16x32_bf16 v[84:87], a[152:155], a[92:95], v[84:87]
ds_read_b64_tr_b16 a[144:145], v17 offset:24576
v_mfma_f32_16x16x32_bf16 v[84:87], a[148:151], a[88:91], v[84:87]
ds_read_b64_tr_b16 a[146:147], v17 offset:26624
s_waitcnt lgkmcnt(8)
v_mfma_f32_16x16x32_bf16 v[88:91], a[156:159], a[80:83], v[88:91]
ds_read_b64_tr_b16 a[148:149], v18 offset:16384
v_mfma_f32_16x16x32_bf16 v[88:91], a[160:163], a[84:87], v[88:91]
ds_read_b64_tr_b16 a[150:151], v18 offset:18432
v_mfma_f32_16x16x32_bf16 v[92:95], a[160:163], a[92:95], v[92:95]
ds_read_b64_tr_b16 a[152:153], v18 offset:24576
buffer_load_dwordx4 v5, s[40:43], s94 offen offset:1024 lds
v_mfma_f32_16x16x32_bf16 v[92:95], a[156:159], a[88:91], v[92:95]
ds_read_b64_tr_b16 a[154:155], v18 offset:26624
s_waitcnt vmcnt(17) lgkmcnt(8)
v_mfma_f32_16x16x32_bf16 v[32:35], a[132:135], a[0:3], v[32:35]
ds_read_b64_tr_b16 a[156:157], v19 offset:16384
v_mfma_f32_16x16x32_bf16 v[32:35], a[136:139], a[4:7], v[32:35]
ds_read_b64_tr_b16 a[158:159], v19 offset:18432
s_add_u32 s28, s28, 12288
v_mfma_f32_16x16x32_bf16 v[36:39], a[136:139], a[12:15], v[36:39]
ds_read_b64_tr_b16 a[160:161], v19 offset:24576
buffer_load_dwordx4 a[64:67], v1, s[12:15], s28 offen offset:0 sc1
v_mfma_f32_16x16x32_bf16 v[36:39], a[132:135], a[8:11], v[36:39]
ds_read_b64_tr_b16 a[162:163], v19 offset:26624
s_waitcnt lgkmcnt(8)
v_mfma_f32_16x16x32_bf16 v[40:43], a[140:143], a[0:3], v[40:43]
ds_read_b64_tr_b16 a[132:133], v16 offset:20480
v_mfma_f32_16x16x32_bf16 v[40:43], a[144:147], a[4:7], v[40:43]
ds_read_b64_tr_b16 a[134:135], v16 offset:22528
v_mfma_f32_16x16x32_bf16 v[44:47], a[144:147], a[12:15], v[44:47]
ds_read_b64_tr_b16 a[136:137], v16 offset:28672
v_mfma_f32_16x16x32_bf16 v[44:47], a[140:143], a[8:11], v[44:47]
ds_read_b64_tr_b16 a[138:139], v16 offset:30720
s_waitcnt lgkmcnt(8)
v_mfma_f32_16x16x32_bf16 v[48:51], a[148:151], a[0:3], v[48:51]
ds_read_b64_tr_b16 a[140:141], v17 offset:20480
buffer_load_dwordx4 v6, s[40:43], s94 offen offset:2048 lds
v_mfma_f32_16x16x32_bf16 v[48:51], a[152:155], a[4:7], v[48:51]
ds_read_b64_tr_b16 a[142:143], v17 offset:22528
buffer_load_dwordx4 a[68:71], v1, s[12:15], s28 offen offset:1024 sc1
v_mfma_f32_16x16x32_bf16 v[52:55], a[152:155], a[12:15], v[52:55]
ds_read_b64_tr_b16 a[144:145], v17 offset:28672
v_mfma_f32_16x16x32_bf16 v[52:55], a[148:151], a[8:11], v[52:55]
ds_read_b64_tr_b16 a[146:147], v17 offset:30720
s_waitcnt lgkmcnt(8)
v_mfma_f32_16x16x32_bf16 v[56:59], a[156:159], a[0:3], v[56:59]
ds_read_b64_tr_b16 a[148:149], v18 offset:20480
v_mfma_f32_16x16x32_bf16 v[56:59], a[160:163], a[4:7], v[56:59]
ds_read_b64_tr_b16 a[150:151], v18 offset:22528
v_mfma_f32_16x16x32_bf16 v[60:63], a[160:163], a[12:15], v[60:63]
ds_read_b64_tr_b16 a[152:153], v18 offset:28672
s_add_u32 s53, s55, 196608
v_mfma_f32_16x16x32_bf16 v[60:63], a[156:159], a[8:11], v[60:63]
ds_read_b64_tr_b16 a[154:155], v18 offset:30720
s_waitcnt lgkmcnt(8)
v_mfma_f32_16x16x32_bf16 v[64:67], a[132:135], a[0:3], v[64:67]
ds_read_b64_tr_b16 a[156:157], v19 offset:20480
buffer_load_dword a250, v29, s[40:43], s53 offen
v_mfma_f32_16x16x32_bf16 v[64:67], a[136:139], a[4:7], v[64:67]
ds_read_b64_tr_b16 a[158:159], v19 offset:22528
buffer_load_dwordx4 v7, s[40:43], s94 offen offset:3072 lds
v_mfma_f32_16x16x32_bf16 v[68:71], a[136:139], a[12:15], v[68:71]
ds_read_b64_tr_b16 a[160:161], v19 offset:28672
buffer_load_dwordx4 a[72:75], v15, s[12:15], s28 offen offset:0 sc1
v_mfma_f32_16x16x32_bf16 v[68:71], a[132:135], a[8:11], v[68:71]
ds_read_b64_tr_b16 a[162:163], v19 offset:30720
s_waitcnt vmcnt(20)
s_barrier
s_waitcnt lgkmcnt(8)
v_mfma_f32_16x16x32_bf16 v[72:75], a[140:143], a[0:3], v[72:75]
ds_read_b64_tr_b16 a[132:133], v16 offset:32768
v_mfma_f32_16x16x32_bf16 v[72:75], a[144:147], a[4:7], v[72:75]
ds_read_b64_tr_b16 a[134:135], v16 offset:34816
v_mfma_f32_16x16x32_bf16 v[76:79], a[144:147], a[12:15], v[76:79]
ds_read_b64_tr_b16 a[136:137], v16 offset:40960
v_mfma_f32_16x16x32_bf16 v[76:79], a[140:143], a[8:11], v[76:79]
ds_read_b64_tr_b16 a[138:139], v16 offset:43008
s_waitcnt lgkmcnt(8)
v_mfma_f32_16x16x32_bf16 v[80:83], a[148:151], a[0:3], v[80:83]
ds_read_b64_tr_b16 a[140:141], v17 offset:32768
v_mfma_f32_16x16x32_bf16 v[80:83], a[152:155], a[4:7], v[80:83]
ds_read_b64_tr_b16 a[142:143], v17 offset:34816
s_add_u32 s94, s92, 2883584
v_mfma_f32_16x16x32_bf16 v[84:87], a[152:155], a[12:15], v[84:87]
ds_read_b64_tr_b16 a[144:145], v17 offset:40960
s_xor_b32 s85, s94, 128
v_mfma_f32_16x16x32_bf16 v[84:87], a[148:151], a[8:11], v[84:87]
ds_read_b64_tr_b16 a[146:147], v17 offset:43008
s_waitcnt lgkmcnt(8)
v_mfma_f32_16x16x32_bf16 v[88:91], a[156:159], a[0:3], v[88:91]
ds_read_b64_tr_b16 a[148:149], v18 offset:32768
s_add_u32 m0, s95, 32768
v_mfma_f32_16x16x32_bf16 v[88:91], a[160:163], a[4:7], v[88:91]
ds_read_b64_tr_b16 a[150:151], v18 offset:34816
buffer_load_dwordx4 v4, s[40:43], s85 offen offset:0 lds
v_mfma_f32_16x16x32_bf16 v[92:95], a[160:163], a[12:15], v[92:95]
ds_read_b64_tr_b16 a[152:153], v18 offset:40960
buffer_load_dwordx4 a[76:79], v15, s[12:15], s28 offen offset:1024 sc1
v_mfma_f32_16x16x32_bf16 v[92:95], a[156:159], a[8:11], v[92:95]
ds_read_b64_tr_b16 a[154:155], v18 offset:43008
s_waitcnt vmcnt(17) lgkmcnt(8)
v_mfma_f32_16x16x32_bf16 v[32:35], a[132:135], a[16:19], v[32:35]
ds_read_b64_tr_b16 a[156:157], v19 offset:32768
v_mfma_f32_16x16x32_bf16 v[32:35], a[136:139], a[20:23], v[32:35]
ds_read_b64_tr_b16 a[158:159], v19 offset:34816
buffer_load_dwordx4 a[80:83], v1, s[12:15], s28 offen offset:2048 sc1
v_mfma_f32_16x16x32_bf16 v[36:39], a[136:139], a[28:31], v[36:39]
ds_read_b64_tr_b16 a[160:161], v19 offset:40960
buffer_load_dwordx4 v5, s[40:43], s85 offen offset:1024 lds
v_mfma_f32_16x16x32_bf16 v[36:39], a[132:135], a[24:27], v[36:39]
ds_read_b64_tr_b16 a[162:163], v19 offset:43008
s_waitcnt lgkmcnt(8)
v_mfma_f32_16x16x32_bf16 v[40:43], a[140:143], a[16:19], v[40:43]
ds_read_b64_tr_b16 a[132:133], v16 offset:36864
v_mfma_f32_16x16x32_bf16 v[40:43], a[144:147], a[20:23], v[40:43]
ds_read_b64_tr_b16 a[134:135], v16 offset:38912
v_mfma_f32_16x16x32_bf16 v[44:47], a[144:147], a[28:31], v[44:47]
ds_read_b64_tr_b16 a[136:137], v16 offset:45056
v_mfma_f32_16x16x32_bf16 v[44:47], a[140:143], a[24:27], v[44:47]
ds_read_b64_tr_b16 a[138:139], v16 offset:47104
s_waitcnt lgkmcnt(8)
v_mfma_f32_16x16x32_bf16 v[48:51], a[148:151], a[16:19], v[48:51]
ds_read_b64_tr_b16 a[140:141], v17 offset:36864
v_mfma_f32_16x16x32_bf16 v[48:51], a[152:155], a[20:23], v[48:51]
ds_read_b64_tr_b16 a[142:143], v17 offset:38912
buffer_load_dwordx4 a[84:87], v1, s[12:15], s28 offen offset:3072 sc1
v_mfma_f32_16x16x32_bf16 v[52:55], a[152:155], a[28:31], v[52:55]
ds_read_b64_tr_b16 a[144:145], v17 offset:45056
v_mfma_f32_16x16x32_bf16 v[52:55], a[148:151], a[24:27], v[52:55]
ds_read_b64_tr_b16 a[146:147], v17 offset:47104
s_waitcnt lgkmcnt(8)
v_mfma_f32_16x16x32_bf16 v[56:59], a[156:159], a[16:19], v[56:59]
ds_read_b64_tr_b16 a[148:149], v18 offset:36864
buffer_load_dwordx4 v6, s[40:43], s85 offen offset:2048 lds
v_mfma_f32_16x16x32_bf16 v[56:59], a[160:163], a[20:23], v[56:59]
ds_read_b64_tr_b16 a[150:151], v18 offset:38912
v_mfma_f32_16x16x32_bf16 v[60:63], a[160:163], a[28:31], v[60:63]
ds_read_b64_tr_b16 a[152:153], v18 offset:45056
v_mfma_f32_16x16x32_bf16 v[60:63], a[156:159], a[24:27], v[60:63]
ds_read_b64_tr_b16 a[154:155], v18 offset:47104
s_waitcnt lgkmcnt(8)
v_mfma_f32_16x16x32_bf16 v[64:67], a[132:135], a[16:19], v[64:67]
ds_read_b64_tr_b16 a[156:157], v19 offset:36864
v_mfma_f32_16x16x32_bf16 v[64:67], a[136:139], a[20:23], v[64:67]
ds_read_b64_tr_b16 a[158:159], v19 offset:38912
buffer_load_dwordx4 a[88:91], v15, s[12:15], s28 offen offset:2048 sc1
v_mfma_f32_16x16x32_bf16 v[68:71], a[136:139], a[28:31], v[68:71]
ds_read_b64_tr_b16 a[160:161], v19 offset:45056
v_mfma_f32_16x16x32_bf16 v[68:71], a[132:135], a[24:27], v[68:71]
ds_read_b64_tr_b16 a[162:163], v19 offset:47104
s_waitcnt lgkmcnt(8)
v_mfma_f32_16x16x32_bf16 v[72:75], a[140:143], a[16:19], v[72:75]
ds_read_b64_tr_b16 a[132:133], v16 offset:49152
buffer_load_dwordx4 v7, s[40:43], s85 offen offset:3072 lds
v_mfma_f32_16x16x32_bf16 v[72:75], a[144:147], a[20:23], v[72:75]
ds_read_b64_tr_b16 a[134:135], v16 offset:51200
v_mfma_f32_16x16x32_bf16 v[76:79], a[144:147], a[28:31], v[76:79]
ds_read_b64_tr_b16 a[136:137], v16 offset:57344
v_mfma_f32_16x16x32_bf16 v[76:79], a[140:143], a[24:27], v[76:79]
ds_read_b64_tr_b16 a[138:139], v16 offset:59392
s_waitcnt lgkmcnt(8)
v_mfma_f32_16x16x32_bf16 v[80:83], a[148:151], a[16:19], v[80:83]
ds_read_b64_tr_b16 a[140:141], v17 offset:49152
v_mfma_f32_16x16x32_bf16 v[80:83], a[152:155], a[20:23], v[80:83]
ds_read_b64_tr_b16 a[142:143], v17 offset:51200
buffer_load_dwordx4 a[92:95], v15, s[12:15], s28 offen offset:3072 sc1
v_mfma_f32_16x16x32_bf16 v[84:87], a[152:155], a[28:31], v[84:87]
ds_read_b64_tr_b16 a[144:145], v17 offset:57344
v_mfma_f32_16x16x32_bf16 v[84:87], a[148:151], a[24:27], v[84:87]
ds_read_b64_tr_b16 a[146:147], v17 offset:59392
s_waitcnt lgkmcnt(8)
v_mfma_f32_16x16x32_bf16 v[88:91], a[156:159], a[16:19], v[88:91]
ds_read_b64_tr_b16 a[148:149], v18 offset:49152
v_mfma_f32_16x16x32_bf16 v[88:91], a[160:163], a[20:23], v[88:91]
ds_read_b64_tr_b16 a[150:151], v18 offset:51200
s_add_u32 m0, s95, 36864
v_mfma_f32_16x16x32_bf16 v[92:95], a[160:163], a[28:31], v[92:95]
ds_read_b64_tr_b16 a[152:153], v18 offset:57344
buffer_load_dwordx4 v4, s[40:43], s94 offen offset:0 lds
v_mfma_f32_16x16x32_bf16 v[92:95], a[156:159], a[24:27], v[92:95]
ds_read_b64_tr_b16 a[154:155], v18 offset:59392
s_waitcnt vmcnt(17) lgkmcnt(8)
v_mfma_f32_16x16x32_bf16 v[32:35], a[132:135], a[32:35], v[32:35]
ds_read_b64_tr_b16 a[156:157], v19 offset:49152
v_mfma_f32_16x16x32_bf16 v[32:35], a[136:139], a[36:39], v[32:35]
ds_read_b64_tr_b16 a[158:159], v19 offset:51200
s_add_u32 s28, s28, 4096
v_mfma_f32_16x16x32_bf16 v[36:39], a[136:139], a[44:47], v[36:39]
ds_read_b64_tr_b16 a[160:161], v19 offset:57344
buffer_load_dwordx4 a[0:3], v1, s[12:15], s28 offen offset:0 sc1
v_mfma_f32_16x16x32_bf16 v[36:39], a[132:135], a[40:43], v[36:39]
ds_read_b64_tr_b16 a[162:163], v19 offset:59392
s_waitcnt lgkmcnt(8)
v_mfma_f32_16x16x32_bf16 v[40:43], a[140:143], a[32:35], v[40:43]
ds_read_b64_tr_b16 a[132:133], v16 offset:53248
v_mfma_f32_16x16x32_bf16 v[40:43], a[144:147], a[36:39], v[40:43]
ds_read_b64_tr_b16 a[134:135], v16 offset:55296
v_mfma_f32_16x16x32_bf16 v[44:47], a[144:147], a[44:47], v[44:47]
ds_read_b64_tr_b16 a[136:137], v16 offset:61440
buffer_load_dwordx4 v5, s[40:43], s94 offen offset:1024 lds
v_mfma_f32_16x16x32_bf16 v[44:47], a[140:143], a[40:43], v[44:47]
ds_read_b64_tr_b16 a[138:139], v16 offset:63488
s_waitcnt lgkmcnt(8)
v_mfma_f32_16x16x32_bf16 v[48:51], a[148:151], a[32:35], v[48:51]
ds_read_b64_tr_b16 a[140:141], v17 offset:53248
v_mfma_f32_16x16x32_bf16 v[48:51], a[152:155], a[36:39], v[48:51]
ds_read_b64_tr_b16 a[142:143], v17 offset:55296
buffer_load_dwordx4 a[4:7], v1, s[12:15], s28 offen offset:1024 sc1
v_mfma_f32_16x16x32_bf16 v[52:55], a[152:155], a[44:47], v[52:55]
ds_read_b64_tr_b16 a[144:145], v17 offset:61440
v_mfma_f32_16x16x32_bf16 v[52:55], a[148:151], a[40:43], v[52:55]
ds_read_b64_tr_b16 a[146:147], v17 offset:63488
s_waitcnt lgkmcnt(8)
v_mfma_f32_16x16x32_bf16 v[56:59], a[156:159], a[32:35], v[56:59]
ds_read_b64_tr_b16 a[148:149], v18 offset:53248
v_mfma_f32_16x16x32_bf16 v[56:59], a[160:163], a[36:39], v[56:59]
ds_read_b64_tr_b16 a[150:151], v18 offset:55296
v_mfma_f32_16x16x32_bf16 v[60:63], a[160:163], a[44:47], v[60:63]
ds_read_b64_tr_b16 a[152:153], v18 offset:61440
s_add_u32 s53, s55, 2031616
v_mfma_f32_16x16x32_bf16 v[60:63], a[156:159], a[40:43], v[60:63]
ds_read_b64_tr_b16 a[154:155], v18 offset:63488
s_waitcnt lgkmcnt(8)
v_mfma_f32_16x16x32_bf16 v[64:67], a[132:135], a[32:35], v[64:67]
ds_read_b64_tr_b16 a[156:157], v19 offset:53248
buffer_load_dword a250, v29, s[40:43], s53 offen
v_mfma_f32_16x16x32_bf16 v[64:67], a[136:139], a[36:39], v[64:67]
ds_read_b64_tr_b16 a[158:159], v19 offset:55296
buffer_load_dwordx4 v6, s[40:43], s94 offen offset:2048 lds
v_mfma_f32_16x16x32_bf16 v[68:71], a[136:139], a[44:47], v[68:71]
ds_read_b64_tr_b16 a[160:161], v19 offset:61440
buffer_load_dwordx4 a[8:11], v15, s[12:15], s28 offen offset:0 sc1
v_mfma_f32_16x16x32_bf16 v[68:71], a[132:135], a[40:43], v[68:71]
ds_read_b64_tr_b16 a[162:163], v19 offset:63488
s_waitcnt vmcnt(17)
s_barrier
v_add_u32 v16, 4294901760, v16
v_add_u32 v17, 4294901760, v17
v_add_u32 v18, 4294901760, v18
v_add_u32 v19, 4294901760, v19
s_waitcnt lgkmcnt(8)
v_mfma_f32_16x16x32_bf16 v[72:75], a[140:143], a[32:35], v[72:75]
ds_read_b64_tr_b16 a[132:133], v16 offset:0
v_mfma_f32_16x16x32_bf16 v[72:75], a[144:147], a[36:39], v[72:75]
ds_read_b64_tr_b16 a[134:135], v16 offset:2048
v_mfma_f32_16x16x32_bf16 v[76:79], a[144:147], a[44:47], v[76:79]
ds_read_b64_tr_b16 a[136:137], v16 offset:8192
v_mfma_f32_16x16x32_bf16 v[76:79], a[140:143], a[40:43], v[76:79]
ds_read_b64_tr_b16 a[138:139], v16 offset:10240
s_waitcnt lgkmcnt(8)
v_mfma_f32_16x16x32_bf16 v[80:83], a[148:151], a[32:35], v[80:83]
ds_read_b64_tr_b16 a[140:141], v17 offset:0
buffer_load_dwordx4 v7, s[40:43], s94 offen offset:3072 lds
v_mfma_f32_16x16x32_bf16 v[80:83], a[152:155], a[36:39], v[80:83]
ds_read_b64_tr_b16 a[142:143], v17 offset:2048
buffer_load_dwordx4 a[12:15], v15, s[12:15], s28 offen offset:1024 sc1
v_mfma_f32_16x16x32_bf16 v[84:87], a[152:155], a[44:47], v[84:87]
ds_read_b64_tr_b16 a[144:145], v17 offset:8192
v_mfma_f32_16x16x32_bf16 v[84:87], a[148:151], a[40:43], v[84:87]
ds_read_b64_tr_b16 a[146:147], v17 offset:10240
s_waitcnt lgkmcnt(8)
v_mfma_f32_16x16x32_bf16 v[88:91], a[156:159], a[32:35], v[88:91]
ds_read_b64_tr_b16 a[148:149], v18 offset:0
v_mfma_f32_16x16x32_bf16 v[88:91], a[160:163], a[36:39], v[88:91]
ds_read_b64_tr_b16 a[150:151], v18 offset:2048
v_mfma_f32_16x16x32_bf16 v[92:95], a[160:163], a[44:47], v[92:95]
ds_read_b64_tr_b16 a[152:153], v18 offset:8192
v_mfma_f32_16x16x32_bf16 v[92:95], a[156:159], a[40:43], v[92:95]
ds_read_b64_tr_b16 a[154:155], v18 offset:10240
s_waitcnt vmcnt(16) lgkmcnt(8)
v_mfma_f32_16x16x32_bf16 v[32:35], a[132:135], a[64:67], v[32:35]
ds_read_b64_tr_b16 a[156:157], v19 offset:0
v_add_u32 v5, 196608, v5
v_mfma_f32_16x16x32_bf16 v[32:35], a[136:139], a[68:71], v[32:35]
ds_read_b64_tr_b16 a[158:159], v19 offset:2048
v_add_u32 v7, 196608, v7
v_mfma_f32_16x16x32_bf16 v[36:39], a[136:139], a[76:79], v[36:39]
ds_read_b64_tr_b16 a[160:161], v19 offset:8192
s_add_u32 s94, s93, 196608
v_mfma_f32_16x16x32_bf16 v[36:39], a[132:135], a[72:75], v[36:39]
ds_read_b64_tr_b16 a[162:163], v19 offset:10240
s_waitcnt lgkmcnt(8)
v_mfma_f32_16x16x32_bf16 v[40:43], a[140:143], a[64:67], v[40:43]
ds_read_b64_tr_b16 a[132:133], v16 offset:4096
s_xor_b32 s85, s94, 128
v_mfma_f32_16x16x32_bf16 v[40:43], a[144:147], a[68:71], v[40:43]
ds_read_b64_tr_b16 a[134:135], v16 offset:6144
s_add_u32 m0, s95, 131072
v_mfma_f32_16x16x32_bf16 v[44:47], a[144:147], a[76:79], v[44:47]
ds_read_b64_tr_b16 a[136:137], v16 offset:12288
buffer_load_dwordx4 v4, s[40:43], s85 offen offset:0 lds
v_mfma_f32_16x16x32_bf16 v[44:47], a[140:143], a[72:75], v[44:47]
ds_read_b64_tr_b16 a[138:139], v16 offset:14336
s_waitcnt lgkmcnt(8)
v_mfma_f32_16x16x32_bf16 v[48:51], a[148:151], a[64:67], v[48:51]
ds_read_b64_tr_b16 a[140:141], v17 offset:4096
buffer_load_dwordx4 a[16:19], v1, s[12:15], s28 offen offset:2048 sc1
v_mfma_f32_16x16x32_bf16 v[48:51], a[152:155], a[68:71], v[48:51]
ds_read_b64_tr_b16 a[142:143], v17 offset:6144
buffer_load_dwordx4 v5, s[40:43], s85 offen offset:1024 lds
v_mfma_f32_16x16x32_bf16 v[52:55], a[152:155], a[76:79], v[52:55]
ds_read_b64_tr_b16 a[144:145], v17 offset:12288
buffer_load_dwordx4 a[20:23], v1, s[12:15], s28 offen offset:3072 sc1
v_mfma_f32_16x16x32_bf16 v[52:55], a[148:151], a[72:75], v[52:55]
ds_read_b64_tr_b16 a[146:147], v17 offset:14336
s_waitcnt lgkmcnt(8)
v_mfma_f32_16x16x32_bf16 v[56:59], a[156:159], a[64:67], v[56:59]
ds_read_b64_tr_b16 a[148:149], v18 offset:4096
v_mfma_f32_16x16x32_bf16 v[56:59], a[160:163], a[68:71], v[56:59]
ds_read_b64_tr_b16 a[150:151], v18 offset:6144
v_mfma_f32_16x16x32_bf16 v[60:63], a[160:163], a[76:79], v[60:63]
ds_read_b64_tr_b16 a[152:153], v18 offset:12288
v_mfma_f32_16x16x32_bf16 v[60:63], a[156:159], a[72:75], v[60:63]
ds_read_b64_tr_b16 a[154:155], v18 offset:14336
s_waitcnt lgkmcnt(8)
v_mfma_f32_16x16x32_bf16 v[64:67], a[132:135], a[64:67], v[64:67]
ds_read_b64_tr_b16 a[156:157], v19 offset:4096
v_mfma_f32_16x16x32_bf16 v[64:67], a[136:139], a[68:71], v[64:67]
ds_read_b64_tr_b16 a[158:159], v19 offset:6144
buffer_load_dwordx4 a[24:27], v15, s[12:15], s28 offen offset:2048 sc1
v_mfma_f32_16x16x32_bf16 v[68:71], a[136:139], a[76:79], v[68:71]
ds_read_b64_tr_b16 a[160:161], v19 offset:12288
buffer_load_dwordx4 v6, s[40:43], s85 offen offset:2048 lds
v_mfma_f32_16x16x32_bf16 v[68:71], a[132:135], a[72:75], v[68:71]
ds_read_b64_tr_b16 a[162:163], v19 offset:14336
s_waitcnt lgkmcnt(8)
v_mfma_f32_16x16x32_bf16 v[72:75], a[140:143], a[64:67], v[72:75]
ds_read_b64_tr_b16 a[132:133], v16 offset:16384
v_mfma_f32_16x16x32_bf16 v[72:75], a[144:147], a[68:71], v[72:75]
ds_read_b64_tr_b16 a[134:135], v16 offset:18432
v_mfma_f32_16x16x32_bf16 v[76:79], a[144:147], a[76:79], v[76:79]
ds_read_b64_tr_b16 a[136:137], v16 offset:24576
v_mfma_f32_16x16x32_bf16 v[76:79], a[140:143], a[72:75], v[76:79]
ds_read_b64_tr_b16 a[138:139], v16 offset:26624
s_waitcnt lgkmcnt(8)
v_mfma_f32_16x16x32_bf16 v[80:83], a[148:151], a[64:67], v[80:83]
ds_read_b64_tr_b16 a[140:141], v17 offset:16384
v_mfma_f32_16x16x32_bf16 v[80:83], a[152:155], a[68:71], v[80:83]
ds_read_b64_tr_b16 a[142:143], v17 offset:18432
buffer_load_dwordx4 a[28:31], v15, s[12:15], s28 offen offset:3072 sc1
v_mfma_f32_16x16x32_bf16 v[84:87], a[152:155], a[76:79], v[84:87]
ds_read_b64_tr_b16 a[144:145], v17 offset:24576
v_mfma_f32_16x16x32_bf16 v[84:87], a[148:151], a[72:75], v[84:87]
ds_read_b64_tr_b16 a[146:147], v17 offset:26624
s_waitcnt lgkmcnt(8)
v_mfma_f32_16x16x32_bf16 v[88:91], a[156:159], a[64:67], v[88:91]
ds_read_b64_tr_b16 a[148:149], v18 offset:16384
buffer_load_dwordx4 v7, s[40:43], s85 offen offset:3072 lds
v_mfma_f32_16x16x32_bf16 v[88:91], a[160:163], a[68:71], v[88:91]
ds_read_b64_tr_b16 a[150:151], v18 offset:18432
v_mfma_f32_16x16x32_bf16 v[92:95], a[160:163], a[76:79], v[92:95]
ds_read_b64_tr_b16 a[152:153], v18 offset:24576
v_mfma_f32_16x16x32_bf16 v[92:95], a[156:159], a[72:75], v[92:95]
ds_read_b64_tr_b16 a[154:155], v18 offset:26624
s_waitcnt vmcnt(17) lgkmcnt(8)
v_mfma_f32_16x16x32_bf16 v[32:35], a[132:135], a[80:83], v[32:35]
ds_read_b64_tr_b16 a[156:157], v19 offset:16384
v_mfma_f32_16x16x32_bf16 v[32:35], a[136:139], a[84:87], v[32:35]
ds_read_b64_tr_b16 a[158:159], v19 offset:18432
s_add_u32 s28, s28, 12288
v_mfma_f32_16x16x32_bf16 v[36:39], a[136:139], a[92:95], v[36:39]
ds_read_b64_tr_b16 a[160:161], v19 offset:24576
buffer_load_dwordx4 a[32:35], v1, s[12:15], s28 offen offset:0 sc1
v_mfma_f32_16x16x32_bf16 v[36:39], a[132:135], a[88:91], v[36:39]
ds_read_b64_tr_b16 a[162:163], v19 offset:26624
s_waitcnt lgkmcnt(8)
v_mfma_f32_16x16x32_bf16 v[40:43], a[140:143], a[80:83], v[40:43]
L_pg14:
s_cbranch_execz L_vret
ds_read_b64_tr_b16 a[132:133], v16 offset:20480
s_add_u32 m0, s95, 135168
v_mfma_f32_16x16x32_bf16 v[40:43], a[144:147], a[84:87], v[40:43]
ds_read_b64_tr_b16 a[134:135], v16 offset:22528
buffer_load_dwordx4 v4, s[40:43], s94 offen offset:0 lds
v_mfma_f32_16x16x32_bf16 v[44:47], a[144:147], a[92:95], v[44:47]
ds_read_b64_tr_b16 a[136:137], v16 offset:28672
v_mfma_f32_16x16x32_bf16 v[44:47], a[140:143], a[88:91], v[44:47]
ds_read_b64_tr_b16 a[138:139], v16 offset:30720
s_waitcnt lgkmcnt(8)
v_mfma_f32_16x16x32_bf16 v[48:51], a[148:151], a[80:83], v[48:51]
ds_read_b64_tr_b16 a[140:141], v17 offset:20480
v_mfma_f32_16x16x32_bf16 v[48:51], a[152:155], a[84:87], v[48:51]
ds_read_b64_tr_b16 a[142:143], v17 offset:22528
buffer_load_dwordx4 a[36:39], v1, s[12:15], s28 offen offset:1024 sc1
v_mfma_f32_16x16x32_bf16 v[52:55], a[152:155], a[92:95], v[52:55]
ds_read_b64_tr_b16 a[144:145], v17 offset:28672
v_mfma_f32_16x16x32_bf16 v[52:55], a[148:151], a[88:91], v[52:55]
ds_read_b64_tr_b16 a[146:147], v17 offset:30720
s_waitcnt lgkmcnt(8)
v_mfma_f32_16x16x32_bf16 v[56:59], a[156:159], a[80:83], v[56:59]
ds_read_b64_tr_b16 a[148:149], v18 offset:20480
v_mfma_f32_16x16x32_bf16 v[56:59], a[160:163], a[84:87], v[56:59]
ds_read_b64_tr_b16 a[150:151], v18 offset:22528
buffer_load_dwordx4 v5, s[40:43], s94 offen offset:1024 lds
v_mfma_f32_16x16x32_bf16 v[60:63], a[160:163], a[92:95], v[60:63]
ds_read_b64_tr_b16 a[152:153], v18 offset:28672
v_mfma_f32_16x16x32_bf16 v[60:63], a[156:159], a[88:91], v[60:63]
ds_read_b64_tr_b16 a[154:155], v18 offset:30720
s_waitcnt lgkmcnt(8)
v_mfma_f32_16x16x32_bf16 v[64:67], a[132:135], a[80:83], v[64:67]
ds_read_b64_tr_b16 a[156:157], v19 offset:20480
v_mfma_f32_16x16x32_bf16 v[64:67], a[136:139], a[84:87], v[64:67]
ds_read_b64_tr_b16 a[158:159], v19 offset:22528
buffer_load_dwordx4 a[40:43], v15, s[12:15], s28 offen offset:0 sc1
v_mfma_f32_16x16x32_bf16 v[68:71], a[136:139], a[92:95], v[68:71]
ds_read_b64_tr_b16 a[160:161], v19 offset:28672
v_mfma_f32_16x16x32_bf16 v[68:71], a[132:135], a[88:91], v[68:71]
ds_read_b64_tr_b16 a[162:163], v19 offset:30720
s_waitcnt vmcnt(14)
s_barrier
s_waitcnt lgkmcnt(8)
v_mfma_f32_16x16x32_bf16 v[72:75], a[140:143], a[80:83], v[72:75]
ds_read_b64_tr_b16 a[132:133], v16 offset:32768
v_mfma_f32_16x16x32_bf16 v[72:75], a[144:147], a[84:87], v[72:75]
ds_read_b64_tr_b16 a[134:135], v16 offset:34816
v_mfma_f32_16x16x32_bf16 v[76:79], a[144:147], a[92:95], v[76:79]
ds_read_b64_tr_b16 a[136:137], v16 offset:40960
buffer_load_dwordx4 v6, s[40:43], s94 offen offset:2048 lds
v_mfma_f32_16x16x32_bf16 v[76:79], a[140:143], a[88:91], v[76:79]
ds_read_b64_tr_b16 a[138:139], v16 offset:43008
s_waitcnt lgkmcnt(8)
v_mfma_f32_16x16x32_bf16 v[80:83], a[148:151], a[80:83], v[80:83]
ds_read_b64_tr_b16 a[140:141], v17 offset:32768
v_mfma_f32_16x16x32_bf16 v[80:83], a[152:155], a[84:87], v[80:83]
ds_read_b64_tr_b16 a[142:143], v17 offset:34816
buffer_load_dwordx4 a[44:47], v15, s[12:15], s28 offen offset:1024 sc1
v_mfma_f32_16x16x32_bf16 v[84:87], a[152:155], a[92:95], v[84:87]
ds_read_b64_tr_b16 a[144:145], v17 offset:40960
v_mfma_f32_16x16x32_bf16 v[84:87], a[148:151], a[88:91], v[84:87]
ds_read_b64_tr_b16 a[146:147], v17 offset:43008
s_waitcnt lgkmcnt(8)
v_mfma_f32_16x16x32_bf16 v[88:91], a[156:159], a[80:83], v[88:91]
ds_read_b64_tr_b16 a[148:149], v18 offset:32768
v_mfma_f32_16x16x32_bf16 v[88:91], a[160:163], a[84:87], v[88:91]
ds_read_b64_tr_b16 a[150:151], v18 offset:34816
v_mfma_f32_16x16x32_bf16 v[92:95], a[160:163], a[92:95], v[92:95]
ds_read_b64_tr_b16 a[152:153], v18 offset:40960
v_mfma_f32_16x16x32_bf16 v[92:95], a[156:159], a[88:91], v[92:95]
ds_read_b64_tr_b16 a[154:155], v18 offset:43008
s_waitcnt vmcnt(15) lgkmcnt(8)
v_mfma_f32_16x16x32_bf16 v[32:35], a[132:135], a[0:3], v[32:35]
ds_read_b64_tr_b16 a[156:157], v19 offset:32768
buffer_load_dwordx4 v7, s[40:43], s94 offen offset:3072 lds
v_mfma_f32_16x16x32_bf16 v[32:35], a[136:139], a[4:7], v[32:35]
ds_read_b64_tr_b16 a[158:159], v19 offset:34816
buffer_load_dwordx4 a[64:67], v1, s[12:15], s28 offen offset:2048 sc1
v_mfma_f32_16x16x32_bf16 v[36:39], a[136:139], a[12:15], v[36:39]
ds_read_b64_tr_b16 a[160:161], v19 offset:40960
v_and_b32 v24, 15, v0
v_mfma_f32_16x16x32_bf16 v[36:39], a[132:135], a[8:11], v[36:39]
ds_read_b64_tr_b16 a[162:163], v19 offset:43008
s_waitcnt lgkmcnt(8)
v_mfma_f32_16x16x32_bf16 v[40:43], a[140:143], a[0:3], v[40:43]
ds_read_b64_tr_b16 a[132:133], v16 offset:36864
v_lshlrev_b32 v24, 11, v24
v_mfma_f32_16x16x32_bf16 v[40:43], a[144:147], a[4:7], v[40:43]
ds_read_b64_tr_b16 a[134:135], v16 offset:38912
v_bfe_u32 v25, v0, 4, 1
v_mfma_f32_16x16x32_bf16 v[44:47], a[144:147], a[12:15], v[44:47]
ds_read_b64_tr_b16 a[136:137], v16 offset:45056
v_lshlrev_b32 v25, 5, v25
v_mfma_f32_16x16x32_bf16 v[44:47], a[140:143], a[8:11], v[44:47]
ds_read_b64_tr_b16 a[138:139], v16 offset:47104
s_waitcnt lgkmcnt(8)
v_mfma_f32_16x16x32_bf16 v[48:51], a[148:151], a[0:3], v[48:51]
ds_read_b64_tr_b16 a[140:141], v17 offset:36864
s_add_u32 s94, s93, 2031616
v_mfma_f32_16x16x32_bf16 v[48:51], a[152:155], a[4:7], v[48:51]
ds_read_b64_tr_b16 a[142:143], v17 offset:38912
s_xor_b32 s85, s94, 128
v_mfma_f32_16x16x32_bf16 v[52:55], a[152:155], a[12:15], v[52:55]
ds_read_b64_tr_b16 a[144:145], v17 offset:45056
s_add_u32 m0, s95, 65536
v_mfma_f32_16x16x32_bf16 v[52:55], a[148:151], a[8:11], v[52:55]
ds_read_b64_tr_b16 a[146:147], v17 offset:47104
s_waitcnt lgkmcnt(8)
v_mfma_f32_16x16x32_bf16 v[56:59], a[156:159], a[0:3], v[56:59]
ds_read_b64_tr_b16 a[148:149], v18 offset:36864
buffer_load_dwordx4 v4, s[40:43], s85 offen offset:0 lds
v_mfma_f32_16x16x32_bf16 v[56:59], a[160:163], a[4:7], v[56:59]
ds_read_b64_tr_b16 a[150:151], v18 offset:38912
buffer_load_dwordx4 a[68:71], v1, s[12:15], s28 offen offset:3072 sc1
v_mfma_f32_16x16x32_bf16 v[60:63], a[160:163], a[12:15], v[60:63]
ds_read_b64_tr_b16 a[152:153], v18 offset:45056
v_lshrrev_b32 v26, 5, v0
v_mfma_f32_16x16x32_bf16 v[60:63], a[156:159], a[8:11], v[60:63]
ds_read_b64_tr_b16 a[154:155], v18 offset:47104
s_waitcnt lgkmcnt(8)
v_mfma_f32_16x16x32_bf16 v[64:67], a[132:135], a[0:3], v[64:67]
ds_read_b64_tr_b16 a[156:157], v19 offset:36864
buffer_load_dwordx4 v5, s[40:43], s85 offen offset:1024 lds
v_mfma_f32_16x16x32_bf16 v[64:67], a[136:139], a[4:7], v[64:67]
ds_read_b64_tr_b16 a[158:159], v19 offset:38912
buffer_load_dwordx4 a[72:75], v15, s[12:15], s28 offen offset:2048 sc1
v_mfma_f32_16x16x32_bf16 v[68:71], a[136:139], a[12:15], v[68:71]
ds_read_b64_tr_b16 a[160:161], v19 offset:45056
v_lshlrev_b32 v26, 4, v26
v_mfma_f32_16x16x32_bf16 v[68:71], a[132:135], a[8:11], v[68:71]
ds_read_b64_tr_b16 a[162:163], v19 offset:47104
s_waitcnt lgkmcnt(8)
v_mfma_f32_16x16x32_bf16 v[72:75], a[140:143], a[0:3], v[72:75]
ds_read_b64_tr_b16 a[132:133], v16 offset:49152
v_add3_u32 v24, v24, v25, v26
v_mfma_f32_16x16x32_bf16 v[72:75], a[144:147], a[4:7], v[72:75]
ds_read_b64_tr_b16 a[134:135], v16 offset:51200
v_add_u32 v25, 32768, v24
v_mfma_f32_16x16x32_bf16 v[76:79], a[144:147], a[12:15], v[76:79]
ds_read_b64_tr_b16 a[136:137], v16 offset:57344
s_lshl_b32 s86, s82, 15
v_mfma_f32_16x16x32_bf16 v[76:79], a[140:143], a[8:11], v[76:79]
ds_read_b64_tr_b16 a[138:139], v16 offset:59392
s_waitcnt lgkmcnt(8)
v_mfma_f32_16x16x32_bf16 v[80:83], a[148:151], a[0:3], v[80:83]
ds_read_b64_tr_b16 a[140:141], v17 offset:49152
s_lshl_b32 s27, s81, 7
v_mfma_f32_16x16x32_bf16 v[80:83], a[152:155], a[4:7], v[80:83]
ds_read_b64_tr_b16 a[142:143], v17 offset:51200
buffer_load_dwordx4 v6, s[40:43], s85 offen offset:2048 lds
v_mfma_f32_16x16x32_bf16 v[84:87], a[152:155], a[12:15], v[84:87]
ds_read_b64_tr_b16 a[144:145], v17 offset:57344
buffer_load_dwordx4 a[76:79], v15, s[12:15], s28 offen offset:3072 sc1
v_mfma_f32_16x16x32_bf16 v[84:87], a[148:151], a[8:11], v[84:87]
ds_read_b64_tr_b16 a[146:147], v17 offset:59392
s_waitcnt lgkmcnt(8)
v_mfma_f32_16x16x32_bf16 v[88:91], a[156:159], a[0:3], v[88:91]
ds_read_b64_tr_b16 a[148:149], v18 offset:49152
s_add_u32 s86, s86, s27
v_mfma_f32_16x16x32_bf16 v[88:91], a[160:163], a[4:7], v[88:91]
ds_read_b64_tr_b16 a[150:151], v18 offset:51200
s_mov_b32 s8, s78
v_mfma_f32_16x16x32_bf16 v[92:95], a[160:163], a[12:15], v[92:95]
ds_read_b64_tr_b16 a[152:153], v18 offset:57344
s_mov_b32 s9, s79
v_mfma_f32_16x16x32_bf16 v[92:95], a[156:159], a[8:11], v[92:95]
ds_read_b64_tr_b16 a[154:155], v18 offset:59392
s_waitcnt vmcnt(16) lgkmcnt(8)
v_mfma_f32_16x16x32_bf16 v[32:35], a[132:135], a[16:19], v[32:35]
ds_read_b64_tr_b16 a[156:157], v19 offset:49152
s_mov_b32 s10, 4194304
v_mfma_f32_16x16x32_bf16 v[32:35], a[136:139], a[20:23], v[32:35]
ds_read_b64_tr_b16 a[158:159], v19 offset:51200
s_add_u32 s28, s28, 4096
v_mfma_f32_16x16x32_bf16 v[36:39], a[136:139], a[28:31], v[36:39]
ds_read_b64_tr_b16 a[160:161], v19 offset:57344
buffer_load_dwordx4 a[80:83], v1, s[12:15], s28 offen offset:0 sc1
v_mfma_f32_16x16x32_bf16 v[36:39], a[132:135], a[24:27], v[36:39]
ds_read_b64_tr_b16 a[162:163], v19 offset:59392
s_waitcnt lgkmcnt(8)
v_mfma_f32_16x16x32_bf16 v[40:43], a[140:143], a[16:19], v[40:43]
ds_read_b64_tr_b16 a[132:133], v16 offset:53248
buffer_load_dwordx4 v7, s[40:43], s85 offen offset:3072 lds
v_mfma_f32_16x16x32_bf16 v[40:43], a[144:147], a[20:23], v[40:43]
ds_read_b64_tr_b16 a[134:135], v16 offset:55296
s_mov_b32 s11, 0x20000
v_mfma_f32_16x16x32_bf16 v[44:47], a[144:147], a[28:31], v[44:47]
ds_read_b64_tr_b16 a[136:137], v16 offset:61440
s_xor_b32 s48, s60, 4096
v_mfma_f32_16x16x32_bf16 v[44:47], a[140:143], a[24:27], v[44:47]
ds_read_b64_tr_b16 a[138:139], v16 offset:63488
s_waitcnt lgkmcnt(8)
v_mfma_f32_16x16x32_bf16 v[48:51], a[148:151], a[16:19], v[48:51]
ds_read_b64_tr_b16 a[140:141], v17 offset:53248
s_xor_b32 s49, s61, 4096
v_mfma_f32_16x16x32_bf16 v[48:51], a[152:155], a[20:23], v[48:51]
ds_read_b64_tr_b16 a[142:143], v17 offset:55296
buffer_load_dwordx4 a[84:87], v1, s[12:15], s28 offen offset:1024 sc1
v_mfma_f32_16x16x32_bf16 v[52:55], a[152:155], a[28:31], v[52:55]
ds_read_b64_tr_b16 a[144:145], v17 offset:61440
s_xor_b32 s50, s62, 4096
v_mfma_f32_16x16x32_bf16 v[52:55], a[148:151], a[24:27], v[52:55]
ds_read_b64_tr_b16 a[146:147], v17 offset:63488
s_waitcnt lgkmcnt(8)
v_mfma_f32_16x16x32_bf16 v[56:59], a[156:159], a[16:19], v[56:59]
ds_read_b64_tr_b16 a[148:149], v18 offset:53248
s_add_u32 m0, s95, 69632
v_mfma_f32_16x16x32_bf16 v[56:59], a[160:163], a[20:23], v[56:59]
ds_read_b64_tr_b16 a[150:151], v18 offset:55296
buffer_load_dwordx4 v4, s[40:43], s94 offen offset:0 lds
v_mfma_f32_16x16x32_bf16 v[60:63], a[160:163], a[28:31], v[60:63]
ds_read_b64_tr_b16 a[152:153], v18 offset:61440
s_xor_b32 s51, s63, 4096
v_mfma_f32_16x16x32_bf16 v[60:63], a[156:159], a[24:27], v[60:63]
ds_read_b64_tr_b16 a[154:155], v18 offset:63488
s_waitcnt lgkmcnt(8)
v_mfma_f32_16x16x32_bf16 v[64:67], a[132:135], a[16:19], v[64:67]
ds_read_b64_tr_b16 a[156:157], v19 offset:53248
v_mfma_f32_16x16x32_bf16 v[64:67], a[136:139], a[20:23], v[64:67]
ds_read_b64_tr_b16 a[158:159], v19 offset:55296
buffer_load_dwordx4 a[88:91], v15, s[12:15], s28 offen offset:0 sc1
v_mfma_f32_16x16x32_bf16 v[68:71], a[136:139], a[28:31], v[68:71]
ds_read_b64_tr_b16 a[160:161], v19 offset:61440
v_mfma_f32_16x16x32_bf16 v[68:71], a[132:135], a[24:27], v[68:71]
ds_read_b64_tr_b16 a[162:163], v19 offset:63488
s_waitcnt vmcnt(12)
s_barrier
v_add_u32 v16, 131072, v16
v_add_u32 v17, 131072, v17
v_add_u32 v18, 131072, v18
v_add_u32 v19, 131072, v19
s_waitcnt lgkmcnt(8)
v_mfma_f32_16x16x32_bf16 v[72:75], a[140:143], a[16:19], v[72:75]
ds_read_b64_tr_b16 a[132:133], v16 offset:0
buffer_load_dwordx4 v5, s[40:43], s94 offen offset:1024 lds
v_mfma_f32_16x16x32_bf16 v[72:75], a[144:147], a[20:23], v[72:75]
ds_read_b64_tr_b16 a[134:135], v16 offset:2048
v_mfma_f32_16x16x32_bf16 v[76:79], a[144:147], a[28:31], v[76:79]
ds_read_b64_tr_b16 a[136:137], v16 offset:8192
v_mfma_f32_16x16x32_bf16 v[76:79], a[140:143], a[24:27], v[76:79]
ds_read_b64_tr_b16 a[138:139], v16 offset:10240
s_waitcnt lgkmcnt(8)
v_mfma_f32_16x16x32_bf16 v[80:83], a[148:151], a[16:19], v[80:83]
ds_read_b64_tr_b16 a[140:141], v17 offset:0
v_mfma_f32_16x16x32_bf16 v[80:83], a[152:155], a[20:23], v[80:83]
ds_read_b64_tr_b16 a[142:143], v17 offset:2048
buffer_load_dwordx4 a[92:95], v15, s[12:15], s28 offen offset:1024 sc1
v_mfma_f32_16x16x32_bf16 v[84:87], a[152:155], a[28:31], v[84:87]
ds_read_b64_tr_b16 a[144:145], v17 offset:8192
v_mfma_f32_16x16x32_bf16 v[84:87], a[148:151], a[24:27], v[84:87]
ds_read_b64_tr_b16 a[146:147], v17 offset:10240
s_waitcnt lgkmcnt(8)
v_mfma_f32_16x16x32_bf16 v[88:91], a[156:159], a[16:19], v[88:91]
ds_read_b64_tr_b16 a[148:149], v18 offset:0
v_mfma_f32_16x16x32_bf16 v[88:91], a[160:163], a[20:23], v[88:91]
ds_read_b64_tr_b16 a[150:151], v18 offset:2048
buffer_load_dwordx4 v6, s[40:43], s94 offen offset:2048 lds
v_mfma_f32_16x16x32_bf16 v[92:95], a[160:163], a[28:31], v[92:95]
ds_read_b64_tr_b16 a[152:153], v18 offset:8192
v_mfma_f32_16x16x32_bf16 v[92:95], a[156:159], a[24:27], v[92:95]
ds_read_b64_tr_b16 a[154:155], v18 offset:10240
s_waitcnt lgkmcnt(8)
v_mfma_f32_16x16x32_bf16 v[32:35], a[132:135], a[32:35], v[32:35]
ds_read_b64_tr_b16 a[156:157], v19 offset:0
v_mfma_f32_16x16x32_bf16 v[32:35], a[136:139], a[36:39], v[32:35]
ds_read_b64_tr_b16 a[158:159], v19 offset:2048
buffer_load_dwordx4 a[0:3], v1, s[12:15], s28 offen offset:2048 sc1
v_mfma_f32_16x16x32_bf16 v[36:39], a[136:139], a[44:47], v[36:39]
ds_read_b64_tr_b16 a[160:161], v19 offset:8192
v_mfma_f32_16x16x32_bf16 v[36:39], a[132:135], a[40:43], v[36:39]
ds_read_b64_tr_b16 a[162:163], v19 offset:10240
s_waitcnt lgkmcnt(8)
v_mfma_f32_16x16x32_bf16 v[40:43], a[140:143], a[32:35], v[40:43]
ds_read_b64_tr_b16 a[132:133], v16 offset:4096
v_mfma_f32_16x16x32_bf16 v[40:43], a[144:147], a[36:39], v[40:43]
ds_read_b64_tr_b16 a[134:135], v16 offset:6144
v_mfma_f32_16x16x32_bf16 v[44:47], a[144:147], a[44:47], v[44:47]
ds_read_b64_tr_b16 a[136:137], v16 offset:12288
buffer_load_dwordx4 v7, s[40:43], s94 offen offset:3072 lds
v_mfma_f32_16x16x32_bf16 v[44:47], a[140:143], a[40:43], v[44:47]
ds_read_b64_tr_b16 a[138:139], v16 offset:14336
s_waitcnt lgkmcnt(8)
v_mfma_f32_16x16x32_bf16 v[48:51], a[148:151], a[32:35], v[48:51]
ds_read_b64_tr_b16 a[140:141], v17 offset:4096
v_mfma_f32_16x16x32_bf16 v[48:51], a[152:155], a[36:39], v[48:51]
ds_read_b64_tr_b16 a[142:143], v17 offset:6144
buffer_load_dwordx4 a[4:7], v1, s[12:15], s28 offen offset:3072 sc1
v_mfma_f32_16x16x32_bf16 v[52:55], a[152:155], a[44:47], v[52:55]
ds_read_b64_tr_b16 a[144:145], v17 offset:12288
v_mfma_f32_16x16x32_bf16 v[52:55], a[148:151], a[40:43], v[52:55]
ds_read_b64_tr_b16 a[146:147], v17 offset:14336
s_waitcnt lgkmcnt(8)
v_mfma_f32_16x16x32_bf16 v[56:59], a[156:159], a[32:35], v[56:59]
ds_read_b64_tr_b16 a[148:149], v18 offset:4096
v_mfma_f32_16x16x32_bf16 v[56:59], a[160:163], a[36:39], v[56:59]
ds_read_b64_tr_b16 a[150:151], v18 offset:6144
v_mfma_f32_16x16x32_bf16 v[60:63], a[160:163], a[44:47], v[60:63]
ds_read_b64_tr_b16 a[152:153], v18 offset:12288
v_mfma_f32_16x16x32_bf16 v[60:63], a[156:159], a[40:43], v[60:63]
ds_read_b64_tr_b16 a[154:155], v18 offset:14336
s_waitcnt lgkmcnt(8)
v_mfma_f32_16x16x32_bf16 v[64:67], a[132:135], a[32:35], v[64:67]
ds_read_b64_tr_b16 a[156:157], v19 offset:4096
v_mfma_f32_16x16x32_bf16 v[64:67], a[136:139], a[36:39], v[64:67]
ds_read_b64_tr_b16 a[158:159], v19 offset:6144
buffer_load_dwordx4 a[8:11], v15, s[12:15], s28 offen offset:2048 sc1
v_mfma_f32_16x16x32_bf16 v[68:71], a[136:139], a[44:47], v[68:71]
ds_read_b64_tr_b16 a[160:161], v19 offset:12288
v_mfma_f32_16x16x32_bf16 v[68:71], a[132:135], a[40:43], v[68:71]
ds_read_b64_tr_b16 a[162:163], v19 offset:14336
s_waitcnt lgkmcnt(8)
v_mfma_f32_16x16x32_bf16 v[72:75], a[140:143], a[32:35], v[72:75]
ds_read_b64_tr_b16 a[132:133], v16 offset:16384
v_mfma_f32_16x16x32_bf16 v[72:75], a[144:147], a[36:39], v[72:75]
ds_read_b64_tr_b16 a[134:135], v16 offset:18432
v_mfma_f32_16x16x32_bf16 v[76:79], a[144:147], a[44:47], v[76:79]
ds_read_b64_tr_b16 a[136:137], v16 offset:24576
v_mfma_f32_16x16x32_bf16 v[76:79], a[140:143], a[40:43], v[76:79]
ds_read_b64_tr_b16 a[138:139], v16 offset:26624
s_waitcnt lgkmcnt(8)
v_mfma_f32_16x16x32_bf16 v[80:83], a[148:151], a[32:35], v[80:83]
ds_read_b64_tr_b16 a[140:141], v17 offset:16384
v_mfma_f32_16x16x32_bf16 v[80:83], a[152:155], a[36:39], v[80:83]
ds_read_b64_tr_b16 a[142:143], v17 offset:18432
buffer_load_dwordx4 a[12:15], v15, s[12:15], s28 offen offset:3072 sc1
v_mfma_f32_16x16x32_bf16 v[84:87], a[152:155], a[44:47], v[84:87]
ds_read_b64_tr_b16 a[144:145], v17 offset:24576
v_mfma_f32_16x16x32_bf16 v[84:87], a[148:151], a[40:43], v[84:87]
ds_read_b64_tr_b16 a[146:147], v17 offset:26624
s_waitcnt lgkmcnt(8)
v_mfma_f32_16x16x32_bf16 v[88:91], a[156:159], a[32:35], v[88:91]
ds_read_b64_tr_b16 a[148:149], v18 offset:16384
v_mfma_f32_16x16x32_bf16 v[88:91], a[160:163], a[36:39], v[88:91]
ds_read_b64_tr_b16 a[150:151], v18 offset:18432
v_mfma_f32_16x16x32_bf16 v[92:95], a[160:163], a[44:47], v[92:95]
ds_read_b64_tr_b16 a[152:153], v18 offset:24576
v_mfma_f32_16x16x32_bf16 v[92:95], a[156:159], a[40:43], v[92:95]
ds_read_b64_tr_b16 a[154:155], v18 offset:26624
s_waitcnt vmcnt(13) lgkmcnt(8)
v_mfma_f32_16x16x32_bf16 v[32:35], a[132:135], a[64:67], v[32:35]
ds_read_b64_tr_b16 a[156:157], v19 offset:16384
v_mfma_f32_16x16x32_bf16 v[32:35], a[136:139], a[68:71], v[32:35]
ds_read_b64_tr_b16 a[158:159], v19 offset:18432
v_mfma_f32_16x16x32_bf16 v[36:39], a[136:139], a[76:79], v[36:39]
ds_read_b64_tr_b16 a[160:161], v19 offset:24576
v_mfma_f32_16x16x32_bf16 v[36:39], a[132:135], a[72:75], v[36:39]
ds_read_b64_tr_b16 a[162:163], v19 offset:26624
s_waitcnt lgkmcnt(8)
v_mfma_f32_16x16x32_bf16 v[40:43], a[140:143], a[64:67], v[40:43]
ds_read_b64_tr_b16 a[132:133], v16 offset:20480
v_mfma_f32_16x16x32_bf16 v[40:43], a[144:147], a[68:71], v[40:43]
ds_read_b64_tr_b16 a[134:135], v16 offset:22528
v_mfma_f32_16x16x32_bf16 v[44:47], a[144:147], a[76:79], v[44:47]
ds_read_b64_tr_b16 a[136:137], v16 offset:28672
v_mfma_f32_16x16x32_bf16 v[44:47], a[140:143], a[72:75], v[44:47]
ds_read_b64_tr_b16 a[138:139], v16 offset:30720
s_waitcnt lgkmcnt(8)
v_mfma_f32_16x16x32_bf16 v[48:51], a[148:151], a[64:67], v[48:51]
ds_read_b64_tr_b16 a[140:141], v17 offset:20480
v_mfma_f32_16x16x32_bf16 v[48:51], a[152:155], a[68:71], v[48:51]
ds_read_b64_tr_b16 a[142:143], v17 offset:22528
v_mfma_f32_16x16x32_bf16 v[52:55], a[152:155], a[76:79], v[52:55]
ds_read_b64_tr_b16 a[144:145], v17 offset:28672
v_mfma_f32_16x16x32_bf16 v[52:55], a[148:151], a[72:75], v[52:55]
ds_read_b64_tr_b16 a[146:147], v17 offset:30720
s_waitcnt lgkmcnt(8)
v_mfma_f32_16x16x32_bf16 v[56:59], a[156:159], a[64:67], v[56:59]
ds_read_b64_tr_b16 a[148:149], v18 offset:20480
v_mfma_f32_16x16x32_bf16 v[56:59], a[160:163], a[68:71], v[56:59]
ds_read_b64_tr_b16 a[150:151], v18 offset:22528
v_mfma_f32_16x16x32_bf16 v[60:63], a[160:163], a[76:79], v[60:63]
ds_read_b64_tr_b16 a[152:153], v18 offset:28672
v_mfma_f32_16x16x32_bf16 v[60:63], a[156:159], a[72:75], v[60:63]
ds_read_b64_tr_b16 a[154:155], v18 offset:30720
s_waitcnt lgkmcnt(8)
v_mfma_f32_16x16x32_bf16 v[64:67], a[132:135], a[64:67], v[64:67]
ds_read_b64_tr_b16 a[156:157], v19 offset:20480
v_mfma_f32_16x16x32_bf16 v[64:67], a[136:139], a[68:71], v[64:67]
ds_read_b64_tr_b16 a[158:159], v19 offset:22528
v_mfma_f32_16x16x32_bf16 v[68:71], a[136:139], a[76:79], v[68:71]
ds_read_b64_tr_b16 a[160:161], v19 offset:28672
v_mfma_f32_16x16x32_bf16 v[68:71], a[132:135], a[72:75], v[68:71]
ds_read_b64_tr_b16 a[162:163], v19 offset:30720
s_waitcnt vmcnt(3)
s_barrier
v_add_u32 v16, 4294901760, v16
v_add_u32 v17, 4294901760, v17
v_add_u32 v18, 4294901760, v18
v_add_u32 v19, 4294901760, v19
s_waitcnt lgkmcnt(8)
v_mfma_f32_16x16x32_bf16 v[72:75], a[140:143], a[64:67], v[72:75]
ds_read_b64_tr_b16 a[132:133], v16 offset:0
v_mfma_f32_16x16x32_bf16 v[72:75], a[144:147], a[68:71], v[72:75]
ds_read_b64_tr_b16 a[134:135], v16 offset:2048
v_mfma_f32_16x16x32_bf16 v[76:79], a[144:147], a[76:79], v[76:79]
ds_read_b64_tr_b16 a[136:137], v16 offset:8192
v_mfma_f32_16x16x32_bf16 v[76:79], a[140:143], a[72:75], v[76:79]
ds_read_b64_tr_b16 a[138:139], v16 offset:10240
s_waitcnt lgkmcnt(8)
v_mfma_f32_16x16x32_bf16 v[80:83], a[148:151], a[64:67], v[80:83]
ds_read_b64_tr_b16 a[140:141], v16 offset:16384
v_mfma_f32_16x16x32_bf16 v[80:83], a[152:155], a[68:71], v[80:83]
ds_read_b64_tr_b16 a[142:143], v16 offset:18432
v_mfma_f32_16x16x32_bf16 v[84:87], a[152:155], a[76:79], v[84:87]
ds_read_b64_tr_b16 a[144:145], v16 offset:24576
v_mfma_f32_16x16x32_bf16 v[84:87], a[148:151], a[72:75], v[84:87]
ds_read_b64_tr_b16 a[146:147], v16 offset:26624
s_waitcnt lgkmcnt(8)
v_mfma_f32_16x16x32_bf16 v[88:91], a[156:159], a[64:67], v[88:91]
ds_read_b64_tr_b16 a[148:149], v17 offset:0
v_mfma_f32_16x16x32_bf16 v[88:91], a[160:163], a[68:71], v[88:91]
ds_read_b64_tr_b16 a[150:151], v17 offset:2048
v_mfma_f32_16x16x32_bf16 v[92:95], a[160:163], a[76:79], v[92:95]
ds_read_b64_tr_b16 a[152:153], v17 offset:8192
v_mfma_f32_16x16x32_bf16 v[92:95], a[156:159], a[72:75], v[92:95]
ds_read_b64_tr_b16 a[154:155], v17 offset:10240
s_waitcnt lgkmcnt(8)
v_mfma_f32_16x16x32_bf16 v[32:35], a[132:135], a[80:83], v[32:35]
ds_read_b64_tr_b16 a[156:157], v17 offset:16384
v_mfma_f32_16x16x32_bf16 v[32:35], a[136:139], a[84:87], v[32:35]
ds_read_b64_tr_b16 a[158:159], v17 offset:18432
v_mfma_f32_16x16x32_bf16 v[36:39], a[136:139], a[92:95], v[36:39]
ds_read_b64_tr_b16 a[160:161], v17 offset:24576
v_mfma_f32_16x16x32_bf16 v[36:39], a[132:135], a[88:91], v[36:39]
ds_read_b64_tr_b16 a[162:163], v17 offset:26624
s_waitcnt vmcnt(0) lgkmcnt(8)
v_mfma_f32_16x16x32_bf16 v[32:35], a[140:143], a[0:3], v[32:35]
ds_read_b64_tr_b16 a[132:133], v18 offset:0
v_mfma_f32_16x16x32_bf16 v[32:35], a[144:147], a[4:7], v[32:35]
ds_read_b64_tr_b16 a[134:135], v18 offset:2048
v_mfma_f32_16x16x32_bf16 v[36:39], a[144:147], a[12:15], v[36:39]
ds_read_b64_tr_b16 a[136:137], v18 offset:8192
v_mfma_f32_16x16x32_bf16 v[36:39], a[140:143], a[8:11], v[36:39]
ds_read_b64_tr_b16 a[138:139], v18 offset:10240
s_waitcnt lgkmcnt(8)
v_mfma_f32_16x16x32_bf16 v[40:43], a[148:151], a[80:83], v[40:43]
ds_read_b64_tr_b16 a[140:141], v18 offset:16384
v_mfma_f32_16x16x32_bf16 v[40:43], a[152:155], a[84:87], v[40:43]
ds_read_b64_tr_b16 a[142:143], v18 offset:18432
v_mfma_f32_16x16x32_bf16 v[44:47], a[152:155], a[92:95], v[44:47]
ds_read_b64_tr_b16 a[144:145], v18 offset:24576
v_cvt_pk_bf16_f32 v96, v32, v33
v_mfma_f32_16x16x32_bf16 v[44:47], a[148:151], a[88:91], v[44:47]
ds_read_b64_tr_b16 a[146:147], v18 offset:26624
v_cvt_pk_bf16_f32 v97, v34, v35
s_waitcnt lgkmcnt(8)
v_mfma_f32_16x16x32_bf16 v[40:43], a[156:159], a[0:3], v[40:43]
ds_read_b64_tr_b16 a[148:149], v19 offset:0
v_cvt_pk_bf16_f32 v98, v36, v37
v_mfma_f32_16x16x32_bf16 v[40:43], a[160:163], a[4:7], v[40:43]
ds_read_b64_tr_b16 a[150:151], v19 offset:2048
v_cvt_pk_bf16_f32 v99, v38, v39
v_mfma_f32_16x16x32_bf16 v[44:47], a[160:163], a[12:15], v[44:47]
ds_read_b64_tr_b16 a[152:153], v19 offset:8192
buffer_store_dwordx4 v[96:99], v9, s[16:19], s60 offen sc1
v_mfma_f32_16x16x32_bf16 v[44:47], a[156:159], a[8:11], v[44:47]
ds_read_b64_tr_b16 a[154:155], v19 offset:10240
s_waitcnt lgkmcnt(8)
v_mfma_f32_16x16x32_bf16 v[48:51], a[132:135], a[80:83], v[48:51]
ds_read_b64_tr_b16 a[156:157], v19 offset:16384
v_mfma_f32_16x16x32_bf16 v[48:51], a[136:139], a[84:87], v[48:51]
ds_read_b64_tr_b16 a[158:159], v19 offset:18432
v_mfma_f32_16x16x32_bf16 v[52:55], a[136:139], a[92:95], v[52:55]
ds_read_b64_tr_b16 a[160:161], v19 offset:24576
v_cvt_pk_bf16_f32 v100, v40, v41
v_mfma_f32_16x16x32_bf16 v[52:55], a[132:135], a[88:91], v[52:55]
ds_read_b64_tr_b16 a[162:163], v19 offset:26624
v_cvt_pk_bf16_f32 v101, v42, v43
s_waitcnt lgkmcnt(8)
v_mfma_f32_16x16x32_bf16 v[48:51], a[140:143], a[0:3], v[48:51]
ds_read_b64_tr_b16 a[132:133], v16 offset:4096
v_cvt_pk_bf16_f32 v102, v44, v45
v_mfma_f32_16x16x32_bf16 v[48:51], a[144:147], a[4:7], v[48:51]
ds_read_b64_tr_b16 a[134:135], v16 offset:6144
v_cvt_pk_bf16_f32 v103, v46, v47
v_mfma_f32_16x16x32_bf16 v[52:55], a[144:147], a[12:15], v[52:55]
ds_read_b64_tr_b16 a[136:137], v16 offset:12288
buffer_store_dwordx4 v[100:103], v9, s[16:19], s61 offen sc1
v_mfma_f32_16x16x32_bf16 v[52:55], a[140:143], a[8:11], v[52:55]
ds_read_b64_tr_b16 a[138:139], v16 offset:14336
s_waitcnt lgkmcnt(8)
v_mfma_f32_16x16x32_bf16 v[56:59], a[148:151], a[80:83], v[56:59]
ds_read_b64_tr_b16 a[140:141], v16 offset:20480
v_mfma_f32_16x16x32_bf16 v[56:59], a[152:155], a[84:87], v[56:59]
ds_read_b64_tr_b16 a[142:143], v16 offset:22528
v_mfma_f32_16x16x32_bf16 v[60:63], a[152:155], a[92:95], v[60:63]
ds_read_b64_tr_b16 a[144:145], v16 offset:28672
v_cvt_pk_bf16_f32 v104, v48, v49
v_mfma_f32_16x16x32_bf16 v[60:63], a[148:151], a[88:91], v[60:63]
ds_read_b64_tr_b16 a[146:147], v16 offset:30720
v_cvt_pk_bf16_f32 v105, v50, v51
s_waitcnt lgkmcnt(8)
v_mfma_f32_16x16x32_bf16 v[56:59], a[156:159], a[0:3], v[56:59]
ds_read_b64_tr_b16 a[148:149], v17 offset:4096
v_cvt_pk_bf16_f32 v106, v52, v53
v_mfma_f32_16x16x32_bf16 v[56:59], a[160:163], a[4:7], v[56:59]
ds_read_b64_tr_b16 a[150:151], v17 offset:6144
v_cvt_pk_bf16_f32 v107, v54, v55
v_mfma_f32_16x16x32_bf16 v[60:63], a[160:163], a[12:15], v[60:63]
ds_read_b64_tr_b16 a[152:153], v17 offset:12288
buffer_store_dwordx4 v[104:107], v9, s[16:19], s62 offen sc1
v_mfma_f32_16x16x32_bf16 v[60:63], a[156:159], a[8:11], v[60:63]
ds_read_b64_tr_b16 a[154:155], v17 offset:14336
s_waitcnt lgkmcnt(8)
v_mfma_f32_16x16x32_bf16 v[64:67], a[132:135], a[80:83], v[64:67]
ds_read_b64_tr_b16 a[156:157], v17 offset:20480
v_mfma_f32_16x16x32_bf16 v[64:67], a[136:139], a[84:87], v[64:67]
ds_read_b64_tr_b16 a[158:159], v17 offset:22528
v_mfma_f32_16x16x32_bf16 v[68:71], a[136:139], a[92:95], v[68:71]
ds_read_b64_tr_b16 a[160:161], v17 offset:28672
v_cvt_pk_bf16_f32 v108, v56, v57
v_mfma_f32_16x16x32_bf16 v[68:71], a[132:135], a[88:91], v[68:71]
ds_read_b64_tr_b16 a[162:163], v17 offset:30720
v_cvt_pk_bf16_f32 v109, v58, v59
s_waitcnt lgkmcnt(8)
v_mfma_f32_16x16x32_bf16 v[64:67], a[140:143], a[0:3], v[64:67]
ds_read_b64_tr_b16 a[132:133], v18 offset:4096
v_cvt_pk_bf16_f32 v110, v60, v61
v_mfma_f32_16x16x32_bf16 v[64:67], a[144:147], a[4:7], v[64:67]
ds_read_b64_tr_b16 a[134:135], v18 offset:6144
v_cvt_pk_bf16_f32 v111, v62, v63
v_mfma_f32_16x16x32_bf16 v[68:71], a[144:147], a[12:15], v[68:71]
ds_read_b64_tr_b16 a[136:137], v18 offset:12288
buffer_store_dwordx4 v[108:111], v9, s[16:19], s63 offen sc1
v_mfma_f32_16x16x32_bf16 v[68:71], a[140:143], a[8:11], v[68:71]
ds_read_b64_tr_b16 a[138:139], v18 offset:14336
s_waitcnt lgkmcnt(8)
v_mfma_f32_16x16x32_bf16 v[72:75], a[148:151], a[80:83], v[72:75]
ds_read_b64_tr_b16 a[140:141], v18 offset:20480
v_mfma_f32_16x16x32_bf16 v[72:75], a[152:155], a[84:87], v[72:75]
ds_read_b64_tr_b16 a[142:143], v18 offset:22528
v_mfma_f32_16x16x32_bf16 v[76:79], a[152:155], a[92:95], v[76:79]
ds_read_b64_tr_b16 a[144:145], v18 offset:28672
v_mfma_f32_16x16x32_bf16 v[76:79], a[148:151], a[88:91], v[76:79]
ds_read_b64_tr_b16 a[146:147], v18 offset:30720
s_waitcnt lgkmcnt(8)
v_mfma_f32_16x16x32_bf16 v[72:75], a[156:159], a[0:3], v[72:75]
ds_read_b64_tr_b16 a[148:149], v19 offset:4096
v_mfma_f32_16x16x32_bf16 v[72:75], a[160:163], a[4:7], v[72:75]
ds_read_b64_tr_b16 a[150:151], v19 offset:6144
v_mfma_f32_16x16x32_bf16 v[76:79], a[160:163], a[12:15], v[76:79]
ds_read_b64_tr_b16 a[152:153], v19 offset:12288
v_mfma_f32_16x16x32_bf16 v[76:79], a[156:159], a[8:11], v[76:79]
ds_read_b64_tr_b16 a[154:155], v19 offset:14336
s_waitcnt lgkmcnt(8)
v_mfma_f32_16x16x32_bf16 v[80:83], a[132:135], a[80:83], v[80:83]
L_pg15:
s_cbranch_execz L_vret
ds_read_b64_tr_b16 a[156:157], v19 offset:20480
v_mfma_f32_16x16x32_bf16 v[80:83], a[136:139], a[84:87], v[80:83]
ds_read_b64_tr_b16 a[158:159], v19 offset:22528
v_mfma_f32_16x16x32_bf16 v[84:87], a[136:139], a[92:95], v[84:87]
ds_read_b64_tr_b16 a[160:161], v19 offset:28672
v_mfma_f32_16x16x32_bf16 v[84:87], a[132:135], a[88:91], v[84:87]
ds_read_b64_tr_b16 a[162:163], v19 offset:30720
s_waitcnt lgkmcnt(8)
v_mfma_f32_16x16x32_bf16 v[80:83], a[140:143], a[0:3], v[80:83]
v_mfma_f32_16x16x32_bf16 v[80:83], a[144:147], a[4:7], v[80:83]
v_mfma_f32_16x16x32_bf16 v[84:87], a[144:147], a[12:15], v[84:87]
v_mfma_f32_16x16x32_bf16 v[84:87], a[140:143], a[8:11], v[84:87]
s_waitcnt lgkmcnt(4)
v_mfma_f32_16x16x32_bf16 v[88:91], a[148:151], a[80:83], v[88:91]
v_mfma_f32_16x16x32_bf16 v[88:91], a[152:155], a[84:87], v[88:91]
v_mfma_f32_16x16x32_bf16 v[92:95], a[152:155], a[92:95], v[92:95]
v_mfma_f32_16x16x32_bf16 v[92:95], a[148:151], a[88:91], v[92:95]
s_waitcnt lgkmcnt(0)
v_mfma_f32_16x16x32_bf16 v[88:91], a[156:159], a[0:3], v[88:91]
v_mfma_f32_16x16x32_bf16 v[88:91], a[160:163], a[4:7], v[88:91]
v_mfma_f32_16x16x32_bf16 v[92:95], a[160:163], a[12:15], v[92:95]
v_mfma_f32_16x16x32_bf16 v[92:95], a[156:159], a[8:11], v[92:95]
v_accvgpr_read_b32 v20, a184
v_accvgpr_read_b32 v21, a185
v_pk_add_f32 v[64:65], v[64:65], v[20:21]
v_accvgpr_read_b32 v20, a186
v_accvgpr_read_b32 v21, a187
v_pk_add_f32 v[66:67], v[66:67], v[20:21]
v_accvgpr_read_b32 v20, a188
v_accvgpr_read_b32 v21, a189
v_pk_add_f32 v[68:69], v[68:69], v[20:21]
v_accvgpr_read_b32 v20, a190
v_accvgpr_read_b32 v21, a191
v_pk_add_f32 v[70:71], v[70:71], v[20:21]
buffer_load_dwordx4 v[112:115], v9, s[16:19], s48 offen sc1
buffer_load_dwordx4 v[116:119], v9, s[16:19], s49 offen sc1
buffer_load_dwordx4 v[120:123], v9, s[16:19], s50 offen sc1
buffer_load_dwordx4 v[124:127], v9, s[16:19], s51 offen sc1
v_accvgpr_read_b32 v20, a192
v_accvgpr_read_b32 v21, a193
v_pk_add_f32 v[72:73], v[72:73], v[20:21]
v_accvgpr_read_b32 v20, a194
v_accvgpr_read_b32 v21, a195
v_pk_add_f32 v[74:75], v[74:75], v[20:21]
v_accvgpr_read_b32 v20, a196
v_accvgpr_read_b32 v21, a197
v_pk_add_f32 v[76:77], v[76:77], v[20:21]
v_accvgpr_read_b32 v20, a198
v_accvgpr_read_b32 v21, a199
v_pk_add_f32 v[78:79], v[78:79], v[20:21]
v_accvgpr_read_b32 v20, a200
v_accvgpr_read_b32 v21, a201
v_pk_add_f32 v[80:81], v[80:81], v[20:21]
v_accvgpr_read_b32 v20, a202
v_accvgpr_read_b32 v21, a203
v_pk_add_f32 v[82:83], v[82:83], v[20:21]
v_accvgpr_read_b32 v20, a204
v_accvgpr_read_b32 v21, a205
v_pk_add_f32 v[84:85], v[84:85], v[20:21]
v_accvgpr_read_b32 v20, a206
v_accvgpr_read_b32 v21, a207
v_pk_add_f32 v[86:87], v[86:87], v[20:21]
v_accvgpr_read_b32 v20, a208
v_accvgpr_read_b32 v21, a209
v_pk_add_f32 v[88:89], v[88:89], v[20:21]
v_accvgpr_read_b32 v20, a210
v_accvgpr_read_b32 v21, a211
v_pk_add_f32 v[90:91], v[90:91], v[20:21]
v_accvgpr_read_b32 v20, a212
v_accvgpr_read_b32 v21, a213
v_pk_add_f32 v[92:93], v[92:93], v[20:21]
v_accvgpr_read_b32 v20, a214
v_accvgpr_read_b32 v21, a215
v_pk_add_f32 v[94:95], v[94:95], v[20:21]
s_waitcnt vmcnt(0)
s_mov_b32 s27, 131072
L_chk4:
v_max3_u32 v20, v112, v113, v114
v_max3_u32 v20, v20, v115, v116
v_max3_u32 v20, v20, v117, v118
v_max3_u32 v20, v20, v119, v120
v_max3_u32 v20, v20, v121, v122
v_max3_u32 v20, v20, v123, v124
v_max3_u32 v20, v20, v125, v126
v_max_u32 v20, v20, v127
v_cmp_eq_u32 vcc, -1, v20
s_sub_u32 s27, s27, 1
s_cbranch_vccz L_ok4
s_cmp_eq_u32 s27, 0
s_cbranch_scc1 L_ok4
buffer_load_dwordx4 v[112:115], v9, s[16:19], s48 offen sc1
buffer_load_dwordx4 v[116:119], v9, s[16:19], s49 offen sc1
buffer_load_dwordx4 v[120:123], v9, s[16:19], s50 offen sc1
buffer_load_dwordx4 v[124:127], v9, s[16:19], s51 offen sc1
s_waitcnt vmcnt(0)
s_branch L_chk4
L_ok4:
v_lshlrev_b32 v20, 16, v112
v_and_b32 v21, 0xffff0000, v112
v_pk_add_f32 v[64:65], v[64:65], v[20:21]
v_cvt_pk_bf16_f32 v96, v64, v65
v_lshlrev_b32 v20, 16, v113
v_and_b32 v21, 0xffff0000, v113
v_pk_add_f32 v[66:67], v[66:67], v[20:21]
v_cvt_pk_bf16_f32 v97, v66, v67
v_lshlrev_b32 v20, 16, v116
v_and_b32 v21, 0xffff0000, v116
v_pk_add_f32 v[72:73], v[72:73], v[20:21]
v_cvt_pk_bf16_f32 v98, v72, v73
v_lshlrev_b32 v20, 16, v117
v_and_b32 v21, 0xffff0000, v117
v_pk_add_f32 v[74:75], v[74:75], v[20:21]
v_cvt_pk_bf16_f32 v99, v74, v75
s_nop 1
v_permlane16_swap_b32 v96, v98
v_permlane16_swap_b32 v97, v99
buffer_store_dwordx4 v[96:99], v24, s[8:11], s86 offen offset:0 sc1 nt
v_lshlrev_b32 v20, 16, v120
v_and_b32 v21, 0xffff0000, v120
v_pk_add_f32 v[80:81], v[80:81], v[20:21]
v_cvt_pk_bf16_f32 v100, v80, v81
v_lshlrev_b32 v20, 16, v121
v_and_b32 v21, 0xffff0000, v121
v_pk_add_f32 v[82:83], v[82:83], v[20:21]
v_cvt_pk_bf16_f32 v101, v82, v83
v_lshlrev_b32 v20, 16, v124
v_and_b32 v21, 0xffff0000, v124
v_pk_add_f32 v[88:89], v[88:89], v[20:21]
v_cvt_pk_bf16_f32 v102, v88, v89
v_lshlrev_b32 v20, 16, v125
v_and_b32 v21, 0xffff0000, v125
v_pk_add_f32 v[90:91], v[90:91], v[20:21]
v_cvt_pk_bf16_f32 v103, v90, v91
s_nop 1
v_permlane16_swap_b32 v100, v102
v_permlane16_swap_b32 v101, v103
buffer_store_dwordx4 v[100:103], v24, s[8:11], s86 offen offset:64 sc1 nt
v_lshlrev_b32 v20, 16, v114
v_and_b32 v21, 0xffff0000, v114
v_pk_add_f32 v[68:69], v[68:69], v[20:21]
v_cvt_pk_bf16_f32 v104, v68, v69
v_lshlrev_b32 v20, 16, v115
v_and_b32 v21, 0xffff0000, v115
v_pk_add_f32 v[70:71], v[70:71], v[20:21]
v_cvt_pk_bf16_f32 v105, v70, v71
v_lshlrev_b32 v20, 16, v118
v_and_b32 v21, 0xffff0000, v118
v_pk_add_f32 v[76:77], v[76:77], v[20:21]
v_cvt_pk_bf16_f32 v106, v76, v77
v_lshlrev_b32 v20, 16, v119
v_and_b32 v21, 0xffff0000, v119
v_pk_add_f32 v[78:79], v[78:79], v[20:21]
v_cvt_pk_bf16_f32 v107, v78, v79
s_nop 1
v_permlane16_swap_b32 v104, v106
v_permlane16_swap_b32 v105, v107
buffer_store_dwordx4 v[104:107], v25, s[8:11], s86 offen offset:0 sc1 nt
v_lshlrev_b32 v20, 16, v122
v_and_b32 v21, 0xffff0000, v122
v_pk_add_f32 v[84:85], v[84:85], v[20:21]
v_cvt_pk_bf16_f32 v108, v84, v85
v_lshlrev_b32 v20, 16, v123
v_and_b32 v21, 0xffff0000, v123
v_pk_add_f32 v[86:87], v[86:87], v[20:21]
v_cvt_pk_bf16_f32 v109, v86, v87
v_lshlrev_b32 v20, 16, v126
v_and_b32 v21, 0xffff0000, v126
v_pk_add_f32 v[92:93], v[92:93], v[20:21]
v_cvt_pk_bf16_f32 v110, v92, v93
v_lshlrev_b32 v20, 16, v127
v_and_b32 v21, 0xffff0000, v127
v_pk_add_f32 v[94:95], v[94:95], v[20:21]
v_cvt_pk_bf16_f32 v111, v94, v95
s_nop 1
v_permlane16_swap_b32 v108, v110
v_permlane16_swap_b32 v109, v111
buffer_store_dwordx4 v[108:111], v25, s[8:11], s86 offen offset:64 sc1 nt
L_done:
s_endpgm
L_spin0:
s_mov_b32 s27, 131072
L_spin0b:
buffer_load_dword v20, v19, s[16:19], s40 offen sc1
buffer_load_dword v18, v28, s[12:15], 0 offen offset:128 sc1
s_waitcnt vmcnt(0)
v_min_u32 v20, v20, v18
v_cmp_gt_u32 vcc, 1, v20
s_sub_u32 s27, s27, 1
s_cbranch_vccz L_rdy0
s_cmp_lg_u32 s27, 0
s_cbranch_scc1 L_spin0b
s_branch L_rdy0
L_spin4:
s_mov_b32 s27, 131072
L_spin4b:
buffer_load_dword v12, v8, s[16:19], s101 offen sc1
s_waitcnt vmcnt(0)
v_cmp_gt_u32 vcc, 4, v12
s_sub_u32 s27, s27, 1
s_cbranch_vccz L_rdy4
s_cmp_lg_u32 s27, 0
s_cbranch_scc1 L_spin4b
s_branch L_rdy4
L_spin5:
s_mov_b32 s27, 131072
L_spin5b:
buffer_load_dword v12, v8, s[16:19], s101 offen sc1
s_waitcnt vmcnt(0)
v_cmp_gt_u32 vcc, 5, v12
s_sub_u32 s27, s27, 1
s_cbranch_vccz L_rdy5
s_cmp_lg_u32 s27, 0
s_cbranch_scc1 L_spin5b
s_branch L_rdy5
L_spin6:
s_mov_b32 s27, 131072
L_spin6b:
buffer_load_dword v12, v8, s[16:19], s101 offen sc1
s_waitcnt vmcnt(0)
v_cmp_gt_u32 vcc, 6, v12
s_sub_u32 s27, s27, 1
s_cbranch_vccz L_rdy6
s_cmp_lg_u32 s27, 0
s_cbranch_scc1 L_spin6b
s_branch L_rdy6
L_code_end:
.section .rodata,"a"
.p2align 6
.amdhsa_kernel sequential_preLN__linear_kernel_hedgehog__glu_gated_glu__prompt_kernel
  .amdhsa_next_free_vgpr 512
  .amdhsa_next_free_sgpr 102
  .amdhsa_accum_offset 256
  .amdhsa_group_segment_fixed_size 0
  .amdhsa_kernarg_size 88
  .amdhsa_user_sgpr_count 2
  .amdhsa_user_sgpr_kernarg_segment_ptr 1
  .amdhsa_system_sgpr_workgroup_id_x 1
.end_amdhsa_kernel
```
